```python
import torch

def _softmax(x, axis=-1):
    return torch.softmax(x, dim=axis)
def _gelu(x):
    return torch.nn.functional.gelu(x, approximate="tanh")
def _silu(x):
    return torch.nn.functional.silu(x)
def _sigmoid(x):
    return torch.sigmoid(x)
def _layernorm(x, axis=-1, eps=1e-5):
    m = x.mean(dim=axis, keepdim=True)
    v = x.var(dim=axis, keepdim=True, unbiased=False)
    return (x - m) / torch.sqrt(v + eps)
def _scatter_add(tgt, idx, src, axis=0):
    return tgt.clone().index_add_(axis, idx, src)
def _segment_sum(src, seg, n):
    out = torch.zeros((n,) + src.shape[1:], dtype=src.dtype)
    return out.index_add_(0, seg, src)
def _pad(x, pw):
    flat = tuple(v for pair in reversed(pw) for v in pair)
    return torch.nn.functional.pad(x, flat)

kernel_name = 'gated_mix__spectral_gfnet__mixer_token_mlp__prompt'

def setup_inputs():

    _w = (lambda a: (lambda t: t.to(torch.bfloat16) if t.is_floating_point() else t)(torch.as_tensor(a)))
    def _A_setup():
        B, S, D = 1, 2048, 640
        Df = D // 2 + 1
        return {
            "x": _w((lambda *s: torch.randn(*s, dtype=torch.bfloat16) * 0.05)(B, S, D)),
            "w_r": _w((lambda *s: torch.randn(*s, dtype=torch.bfloat16) * 0.8)(S, Df) * 0.02),
            "w_i": _w((lambda *s: torch.randn(*s, dtype=torch.bfloat16) * 0.8)(S, Df) * 0.02),
        }
    _A_in = _A_setup()

    def _B_setup():
        B, S, D, F = 1, 2048, 640, 1728
        return {
            "x": _w((lambda *s: torch.randn(*s, dtype=torch.bfloat16) * 0.05)(B, S, D)),
            "w1": _w((lambda *s: torch.randn(*s, dtype=torch.bfloat16) * 0.2)(S, F) * (S ** -0.5)),
            "b1": _w((lambda *s: torch.randn(*s, dtype=torch.bfloat16) * 3.2)(F) * 0.02),
            "w2": _w((lambda *s: torch.randn(*s, dtype=torch.bfloat16) * 0.05)(F, S) * (F ** -0.5)),
            "b2": _w((lambda *s: torch.randn(*s, dtype=torch.bfloat16) * 0.1)(S) * 0.02),
        }
    _B_in = _B_setup()

    return {
        "A_x": _A_in["x"],
        "A_w_r": _A_in["w_r"],
        "A_w_i": _A_in["w_i"],
        "B_x": _B_in["x"],
        "B_w1": _B_in["w1"],
        "B_b1": _B_in["b1"],
        "B_w2": _B_in["w2"],
        "B_b2": _B_in["b2"],
        "gate_w": _w((lambda *s: torch.randn(*s, dtype=torch.bfloat16) * 0.05)(640) * 16.0),
    }

def reference(A_x, A_w_r, A_w_i, B_x, B_w1, B_b1, B_w2, B_b2, gate_w):
    def _A_ref(x, w_r, w_i):
        B, S, D = x.shape
        X = (lambda x, axes=(-2,-1): torch.fft.rfft2(x.float(), dim=axes))(x, axes=(-2, -1))
        W = w_r + 1j * w_i
        X = X * W
        y = (lambda x, s, axes=(-2,-1): torch.fft.irfft2(x, s=s, dim=axes).to(torch.bfloat16))(X, (S, D), axes=(-2, -1))
        return y

    def _B_ref(x, w1, b1, w2, b2):
        B, S, D = x.shape
        h = _layernorm(x, axis=-1)
        u = torch.einsum("bsd,sf->bdf", h, w1) + b1
        u = _gelu(u)
        y = torch.einsum("bdf,fs->bds", u, w2) + b2
        return (lambda x, *d: x.permute(*d))(y, 0, 2, 1)

    x = A_x
    g = _sigmoid((x * gate_w).sum(-1, keepdims=True))
    a = _A_ref(x, A_w_r, A_w_i)
    b = _B_ref(x, B_w1, B_b1, B_w2, B_b2)
    return g * a + (1 - g) * b
```

```asm
; @launch kernel=k1_kernel grid=(512,1,1) block=(512,1,1) lds=39936
; @launch kernel=k2_kernel grid=(256,1,1) block=(512,1,1) lds=123968
; @launch kernel=k3_kernel grid=(256,1,1) block=(512,1,1) lds=91136
.amdgcn_target "amdgcn-amd-amdhsa--gfx950"
.text
    .globl k1_kernel
    .p2align 8
    .type k1_kernel,@function
k1_kernel:
    s_cmp_ge_u32 s2, 512
    s_cbranch_scc1 K1_OOB
    s_load_dwordx2 s[4:5], s[0:1], 0
    s_load_dwordx2 s[6:7], s[0:1], 88
    s_load_dwordx2 s[28:29], s[0:1], 64
    s_load_dwordx4 s[32:35], s[0:1], 8
    s_load_dwordx2 s[46:47], s[0:1], 32
    v_lshrrev_b32 v1, 6, v0
    v_and_b32 v2, 63, v0
    s_getpc_b64 s[30:31]
    s_add_u32 s30, s30, table1@rel32@lo+4
    s_addc_u32 s31, s31, table1@rel32@hi+12
    v_readfirstlane_b32 s24, v1
    v_lshlrev_b32 v3, 4, v2
    v_lshlrev_b32 v4, 2, v2
    s_waitcnt lgkmcnt(0)
    s_mov_b32 s12, s6
    s_and_b32 s13, s7, 0xffff
    s_mov_b32 s14, 13414400
    s_mov_b32 s15, 0x20000
    s_cmp_ge_u32 s2, 256
    s_cbranch_scc1 K1_WPATH
    s_mov_b32 s8, s4
    s_and_b32 s9, s5, 0xffff
    s_mov_b32 s10, 2621440
    s_mov_b32 s11, 0x20000
    s_mov_b32 s16, s30
    s_and_b32 s17, s31, 0xffff
    s_mov_b32 s18, 11264
    s_mov_b32 s19, 0x20000
    s_mov_b32 s20, s28
    s_and_b32 s21, s29, 0xffff
    s_mov_b32 s22, 1280
    s_mov_b32 s23, 0x20000
    s_and_b32 s25, s2, 7
    s_lshr_b32 s26, s2, 3
    s_and_b32 s27, s26, 7
    s_lshr_b32 s26, s26, 3
    s_lshl_b32 s25, s25, 3
    s_add_u32 s25, s25, s27
    s_lshr_b32 s36, s26, 1
    s_and_b32 s37, s26, 1
    s_lshl_b32 s38, s36, 4
    s_lshr_b32 s39, s24, 2
    s_lshl_b32 s39, s39, 3
    s_add_u32 s38, s38, s39
    s_lshl_b32 s39, s37, 2
    s_add_u32 s38, s38, s39
    s_and_b32 s39, s24, 3
    s_add_u32 s38, s38, s39
    s_lshl_b32 s38, s38, 6
    s_add_u32 s38, s38, s25
    s_mul_i32 s39, s38, 1280
    buffer_load_dword v8, v4, s[8:11], s39 offen offset:0 nt
    buffer_load_dword v9, v4, s[8:11], s39 offen offset:256 nt
    buffer_load_dword v10, v4, s[8:11], s39 offen offset:512 nt
    buffer_load_dword v11, v4, s[8:11], s39 offen offset:768 nt
    buffer_load_dword v12, v4, s[8:11], s39 offen offset:1024 nt
    buffer_load_dword v13, v4, s[20:23], 0 offen offset:0
    buffer_load_dword v14, v4, s[20:23], 0 offen offset:256
    buffer_load_dword v15, v4, s[20:23], 0 offen offset:512
    buffer_load_dword v16, v4, s[20:23], 0 offen offset:768
    buffer_load_dword v17, v4, s[20:23], 0 offen offset:1024
    s_mul_i32 s40, s24, 1344
    s_mov_b32 m0, s40
    s_add_u32 s41, s39, 1024
    buffer_load_dwordx4 v3, s[8:11], s39 offen nt lds
    s_add_u32 m0, s40, 1024
    s_lshl_b32 s42, s24, 10
    buffer_load_dword v4, s[8:11], s41 offen nt lds
    s_add_u32 m0, s42, 10752
    s_cmp_ge_u32 s24, 3
    buffer_load_dwordx4 v3, s[16:19], s42 offen lds
    s_cbranch_scc1 K1_NOC2
    s_add_u32 s42, s42, 8192
    s_add_u32 m0, s42, 10752
    s_nop 0
    buffer_load_dwordx4 v3, s[16:19], s42 offen lds
K1_NOC2:
    s_mov_b32 s43, 0xffff0000
    s_waitcnt vmcnt(8)
    v_lshlrev_b32 v20, 16, v8
    v_and_b32 v21, s43, v8
    v_lshlrev_b32 v22, 16, v9
    v_and_b32 v23, s43, v9
    v_lshlrev_b32 v24, 16, v10
    v_and_b32 v25, s43, v10
    v_lshlrev_b32 v26, 16, v11
    v_and_b32 v27, s43, v11
    v_lshlrev_b32 v28, 16, v12
    v_and_b32 v29, s43, v12
    v_add_f32 v40, v20, v21
    v_add_f32 v41, v22, v23
    v_add_f32 v42, v24, v25
    v_add_f32 v43, v26, v27
    v_add_f32 v44, v28, v29
    v_add_f32 v40, v40, v41
    v_add_f32 v42, v42, v43
    v_add_f32 v40, v40, v44
    v_add_f32 v40, v40, v42
    s_waitcnt vmcnt(3)
    v_lshlrev_b32 v30, 16, v13
    v_and_b32 v31, s43, v13
    v_lshlrev_b32 v32, 16, v14
    v_and_b32 v33, s43, v14
    v_lshlrev_b32 v34, 16, v15
    v_and_b32 v35, s43, v15
    v_lshlrev_b32 v36, 16, v16
    v_and_b32 v37, s43, v16
    v_lshlrev_b32 v38, 16, v17
    v_and_b32 v39, s43, v17
    v_mul_f32 v30, v20, v30
    v_mul_f32 v31, v21, v31
    v_mul_f32 v32, v22, v32
    v_mul_f32 v33, v23, v33
    v_mul_f32 v34, v24, v34
    v_mul_f32 v35, v25, v35
    v_mul_f32 v36, v26, v36
    v_mul_f32 v37, v27, v37
    v_mul_f32 v38, v28, v38
    v_mul_f32 v39, v29, v39
    v_cvt_pk_bf16_f32 v13, v30, v31
    v_cvt_pk_bf16_f32 v14, v32, v33
    v_cvt_pk_bf16_f32 v15, v34, v35
    v_cvt_pk_bf16_f32 v16, v36, v37
    v_cvt_pk_bf16_f32 v17, v38, v39
    v_lshlrev_b32 v30, 16, v13
    v_and_b32 v31, s43, v13
    v_lshlrev_b32 v32, 16, v14
    v_and_b32 v33, s43, v14
    v_lshlrev_b32 v34, 16, v15
    v_and_b32 v35, s43, v15
    v_lshlrev_b32 v36, 16, v16
    v_and_b32 v37, s43, v16
    v_lshlrev_b32 v38, 16, v17
    v_and_b32 v39, s43, v17
    v_add_f32 v41, v30, v31
    v_add_f32 v42, v32, v33
    v_add_f32 v43, v34, v35
    v_add_f32 v44, v36, v37
    v_add_f32 v45, v38, v39
    v_add_f32 v41, v41, v42
    v_add_f32 v43, v43, v44
    v_add_f32 v41, v41, v45
    v_add_f32 v41, v41, v43
    s_nop 1
    v_add_f32_dpp v40, v40, v40 quad_perm:[1,0,3,2] row_mask:0xf bank_mask:0xf
    v_add_f32_dpp v41, v41, v41 quad_perm:[1,0,3,2] row_mask:0xf bank_mask:0xf
    s_nop 0
    v_add_f32_dpp v40, v40, v40 quad_perm:[2,3,0,1] row_mask:0xf bank_mask:0xf
    v_add_f32_dpp v41, v41, v41 quad_perm:[2,3,0,1] row_mask:0xf bank_mask:0xf
    s_nop 0
    v_add_f32_dpp v40, v40, v40 row_half_mirror row_mask:0xf bank_mask:0xf
    v_add_f32_dpp v41, v41, v41 row_half_mirror row_mask:0xf bank_mask:0xf
    s_nop 0
    v_add_f32_dpp v40, v40, v40 row_mirror row_mask:0xf bank_mask:0xf
    v_add_f32_dpp v41, v41, v41 row_mirror row_mask:0xf bank_mask:0xf
    s_nop 0
    v_mov_b32 v46, v40
    v_mov_b32 v47, v41
    s_nop 1
    v_permlane16_swap_b32 v40, v46
    v_permlane16_swap_b32 v41, v47
    s_nop 1
    v_add_f32 v40, v40, v46
    v_add_f32 v41, v41, v47
    s_nop 1
    v_mov_b32 v46, v40
    v_mov_b32 v47, v41
    s_nop 1
    v_permlane32_swap_b32 v40, v46
    v_permlane32_swap_b32 v41, v47
    s_nop 1
    v_add_f32 v40, v40, v46
    v_add_f32 v41, v41, v47
    s_nop 1
    v_mul_f32 v40, 0x3acccccd, v40
    v_sub_f32 v20, v20, v40
    v_sub_f32 v21, v21, v40
    v_sub_f32 v22, v22, v40
    v_sub_f32 v23, v23, v40
    v_sub_f32 v24, v24, v40
    v_sub_f32 v25, v25, v40
    v_sub_f32 v26, v26, v40
    v_sub_f32 v27, v27, v40
    v_sub_f32 v28, v28, v40
    v_sub_f32 v29, v29, v40
    v_mul_f32 v42, v20, v20
    v_mul_f32 v43, v21, v21
    v_fmac_f32 v42, v22, v22
    v_fmac_f32 v43, v23, v23
    v_fmac_f32 v42, v24, v24
    v_fmac_f32 v43, v25, v25
    v_fmac_f32 v42, v26, v26
    v_fmac_f32 v43, v27, v27
    v_fmac_f32 v42, v28, v28
    v_fmac_f32 v43, v29, v29
    v_add_f32 v42, v42, v43
    s_nop 1
    v_add_f32_dpp v42, v42, v42 quad_perm:[1,0,3,2] row_mask:0xf bank_mask:0xf
    s_nop 1
    v_add_f32_dpp v42, v42, v42 quad_perm:[2,3,0,1] row_mask:0xf bank_mask:0xf
    s_nop 1
    v_add_f32_dpp v42, v42, v42 row_half_mirror row_mask:0xf bank_mask:0xf
    s_nop 1
    v_add_f32_dpp v42, v42, v42 row_mirror row_mask:0xf bank_mask:0xf
    s_nop 1
    v_mov_b32 v46, v42
    s_nop 1
    v_permlane16_swap_b32 v42, v46
    s_nop 1
    v_add_f32 v42, v42, v46
    s_nop 1
    v_mov_b32 v46, v42
    s_nop 1
    v_permlane32_swap_b32 v42, v46
    s_nop 1
    v_add_f32 v42, v42, v46
    s_nop 1
    v_mul_f32 v42, 0x3acccccd, v42
    v_cvt_pk_bf16_f32 v44, v40, v42
    v_cvt_pk_bf16_f32 v45, v41, v41
    v_lshlrev_b32 v40, 16, v44
    v_and_b32 v42, s43, v44
    v_and_b32 v41, s43, v45
    v_add_f32 v42, 0x3727c5ac, v42
    v_mul_f32 v41, 0xbfb8aa3b, v41
    v_cvt_pk_bf16_f32 v42, v42, v42
    v_exp_f32 v41, v41
    v_and_b32 v42, s43, v42
    v_add_f32 v41, 1.0, v41
    v_sqrt_f32 v42, v42
    v_rcp_f32 v41, v41
    s_nop 0
    v_cvt_pk_bf16_f32 v42, v42, v42
    v_cvt_pk_bf16_f32 v41, v41, v41
    v_and_b32 v42, s43, v42
    v_and_b32 v41, s43, v41
    v_rcp_f32 v42, v42
    s_lshl_b32 s44, s24, 2
    s_add_u32 s44, s44, 22016
    v_mov_b32 v46, s44
    s_lshl_b32 s45, s38, 2
    s_add_u32 s45, s45, 7938048
    v_mov_b32 v47, 0
    s_waitcnt vmcnt(0)
    s_mov_b64 exec, 1
    ds_write_b32 v46, v40
    ds_write_b32 v46, v42 offset:32
    buffer_store_dword v41, v47, s[12:15], s45 offen sc1
    s_mov_b64 exec, -1
    s_waitcnt lgkmcnt(0)
    s_barrier
    v_lshrrev_b32 v5, 4, v2
    v_and_b32 v6, 15, v2
    v_lshrrev_b32 v7, 2, v6
    v_and_b32 v6, 3, v6
    s_cmp_ge_u32 s24, 4
    s_cbranch_scc1 K1_HT
    v_lshrrev_b32 v1, 5, v2
    v_lshlrev_b32 v3, 3, v1
    v_add_u32 v3, v3, v7
    v_mul_u32_u24 v3, 40, v3
    v_and_b32 v4, 1, v5
    v_lshlrev_b32 v4, 5, v4
    v_add_u32 v3, v3, v4
    v_lshlrev_b32 v4, 3, v6
    v_add_u32 v3, v3, v4
    s_mul_i32 s40, s24, 2688
    v_add_u32 v3, s40, v3
    v_lshlrev_b32 v4, 4, v2
    ds_read_b64_tr_b16 v[8:9], v3 offset:0
    ds_read_b64_tr_b16 v[10:11], v3 offset:160
    ds_read_b64_tr_b16 v[12:13], v3 offset:640
    ds_read_b64_tr_b16 v[14:15], v3 offset:800
    ds_read_b64_tr_b16 v[16:17], v3 offset:1344
    ds_read_b64_tr_b16 v[18:19], v3 offset:1504
    ds_read_b64_tr_b16 v[20:21], v3 offset:1984
    ds_read_b64_tr_b16 v[22:23], v3 offset:2144
    ds_read_b128 v[24:27], v4 offset:10752
    ds_read_b128 v[28:31], v4 offset:11776
    ds_read_b128 v[32:35], v4 offset:12800
    ds_read_b128 v[36:39], v4 offset:13824
    ds_read_b128 v[40:43], v4 offset:14848
    ds_read_b128 v[44:47], v4 offset:15872
    ds_read_b128 v[48:51], v4 offset:16896
    ds_read_b128 v[52:55], v4 offset:17920
    ds_read_b128 v[56:59], v4 offset:18944
    ds_read_b128 v[60:63], v4 offset:19968
    s_waitcnt lgkmcnt(6)
    v_mfma_f32_32x32x16_bf16 v[64:79], v[8:11], v[24:27], 0
    v_mfma_f32_32x32x16_bf16 v[64:79], v[12:15], v[32:35], v[64:79]
    v_mfma_f32_32x32x16_bf16 v[80:95], v[8:11], v[28:31], 0
    v_mfma_f32_32x32x16_bf16 v[80:95], v[12:15], v[36:39], v[80:95]
    v_mfma_f32_32x32x16_bf16 v[96:111], v[16:19], v[24:27], 0
    v_mfma_f32_32x32x16_bf16 v[96:111], v[20:23], v[32:35], v[96:111]
    v_mfma_f32_32x32x16_bf16 v[112:127], v[16:19], v[28:31], 0
    v_mfma_f32_32x32x16_bf16 v[112:127], v[20:23], v[36:39], v[112:127]
    s_waitcnt lgkmcnt(0)
    s_nop 7
    v_fma_mix_f32 v4, v80, v56, 0 op_sel:[0,1,0] op_sel_hi:[0,1,0]
    v_fma_mix_f32 v5, v80, v56, 0 op_sel_hi:[0,1,0]
    v_fma_mix_f32 v80, v64, v56, v5 op_sel:[0,1,0] op_sel_hi:[0,1,0]
    v_fma_mix_f32 v64, v64, v56, -v4 op_sel_hi:[0,1,0]
    v_fma_mix_f32 v4, v81, v57, 0 op_sel:[0,1,0] op_sel_hi:[0,1,0]
    v_fma_mix_f32 v5, v81, v57, 0 op_sel_hi:[0,1,0]
    v_fma_mix_f32 v81, v65, v57, v5 op_sel:[0,1,0] op_sel_hi:[0,1,0]
    v_fma_mix_f32 v65, v65, v57, -v4 op_sel_hi:[0,1,0]
    v_fma_mix_f32 v4, v82, v58, 0 op_sel:[0,1,0] op_sel_hi:[0,1,0]
    v_fma_mix_f32 v5, v82, v58, 0 op_sel_hi:[0,1,0]
    v_fma_mix_f32 v82, v66, v58, v5 op_sel:[0,1,0] op_sel_hi:[0,1,0]
    v_fma_mix_f32 v66, v66, v58, -v4 op_sel_hi:[0,1,0]
    v_fma_mix_f32 v4, v83, v59, 0 op_sel:[0,1,0] op_sel_hi:[0,1,0]
    v_fma_mix_f32 v5, v83, v59, 0 op_sel_hi:[0,1,0]
    v_fma_mix_f32 v83, v67, v59, v5 op_sel:[0,1,0] op_sel_hi:[0,1,0]
    v_fma_mix_f32 v67, v67, v59, -v4 op_sel_hi:[0,1,0]
    v_fma_mix_f32 v4, v84, v60, 0 op_sel:[0,1,0] op_sel_hi:[0,1,0]
    v_fma_mix_f32 v5, v84, v60, 0 op_sel_hi:[0,1,0]
    v_fma_mix_f32 v84, v68, v60, v5 op_sel:[0,1,0] op_sel_hi:[0,1,0]
    v_fma_mix_f32 v68, v68, v60, -v4 op_sel_hi:[0,1,0]
    v_fma_mix_f32 v4, v85, v61, 0 op_sel:[0,1,0] op_sel_hi:[0,1,0]
    v_fma_mix_f32 v5, v85, v61, 0 op_sel_hi:[0,1,0]
    v_fma_mix_f32 v85, v69, v61, v5 op_sel:[0,1,0] op_sel_hi:[0,1,0]
    v_fma_mix_f32 v69, v69, v61, -v4 op_sel_hi:[0,1,0]
    v_fma_mix_f32 v4, v86, v62, 0 op_sel:[0,1,0] op_sel_hi:[0,1,0]
    v_fma_mix_f32 v5, v86, v62, 0 op_sel_hi:[0,1,0]
    v_fma_mix_f32 v86, v70, v62, v5 op_sel:[0,1,0] op_sel_hi:[0,1,0]
    v_fma_mix_f32 v70, v70, v62, -v4 op_sel_hi:[0,1,0]
    v_fma_mix_f32 v4, v87, v63, 0 op_sel:[0,1,0] op_sel_hi:[0,1,0]
    v_fma_mix_f32 v5, v87, v63, 0 op_sel_hi:[0,1,0]
    v_fma_mix_f32 v87, v71, v63, v5 op_sel:[0,1,0] op_sel_hi:[0,1,0]
    v_fma_mix_f32 v71, v71, v63, -v4 op_sel_hi:[0,1,0]
    v_fma_mix_f32 v4, v112, v56, 0 op_sel:[0,1,0] op_sel_hi:[0,1,0]
    v_fma_mix_f32 v5, v112, v56, 0 op_sel_hi:[0,1,0]
    v_fma_mix_f32 v112, v96, v56, v5 op_sel:[0,1,0] op_sel_hi:[0,1,0]
    v_fma_mix_f32 v96, v96, v56, -v4 op_sel_hi:[0,1,0]
    v_fma_mix_f32 v4, v113, v57, 0 op_sel:[0,1,0] op_sel_hi:[0,1,0]
    v_fma_mix_f32 v5, v113, v57, 0 op_sel_hi:[0,1,0]
    v_fma_mix_f32 v113, v97, v57, v5 op_sel:[0,1,0] op_sel_hi:[0,1,0]
    v_fma_mix_f32 v97, v97, v57, -v4 op_sel_hi:[0,1,0]
    v_fma_mix_f32 v4, v114, v58, 0 op_sel:[0,1,0] op_sel_hi:[0,1,0]
    v_fma_mix_f32 v5, v114, v58, 0 op_sel_hi:[0,1,0]
    v_fma_mix_f32 v114, v98, v58, v5 op_sel:[0,1,0] op_sel_hi:[0,1,0]
    v_fma_mix_f32 v98, v98, v58, -v4 op_sel_hi:[0,1,0]
    v_fma_mix_f32 v4, v115, v59, 0 op_sel:[0,1,0] op_sel_hi:[0,1,0]
    v_fma_mix_f32 v5, v115, v59, 0 op_sel_hi:[0,1,0]
    v_fma_mix_f32 v115, v99, v59, v5 op_sel:[0,1,0] op_sel_hi:[0,1,0]
    v_fma_mix_f32 v99, v99, v59, -v4 op_sel_hi:[0,1,0]
    v_fma_mix_f32 v4, v116, v60, 0 op_sel:[0,1,0] op_sel_hi:[0,1,0]
    v_fma_mix_f32 v5, v116, v60, 0 op_sel_hi:[0,1,0]
    v_fma_mix_f32 v116, v100, v60, v5 op_sel:[0,1,0] op_sel_hi:[0,1,0]
    v_fma_mix_f32 v100, v100, v60, -v4 op_sel_hi:[0,1,0]
    v_fma_mix_f32 v4, v117, v61, 0 op_sel:[0,1,0] op_sel_hi:[0,1,0]
    v_fma_mix_f32 v5, v117, v61, 0 op_sel_hi:[0,1,0]
    v_fma_mix_f32 v117, v101, v61, v5 op_sel:[0,1,0] op_sel_hi:[0,1,0]
    v_fma_mix_f32 v101, v101, v61, -v4 op_sel_hi:[0,1,0]
    v_fma_mix_f32 v4, v118, v62, 0 op_sel:[0,1,0] op_sel_hi:[0,1,0]
    v_fma_mix_f32 v5, v118, v62, 0 op_sel_hi:[0,1,0]
    v_fma_mix_f32 v118, v102, v62, v5 op_sel:[0,1,0] op_sel_hi:[0,1,0]
    v_fma_mix_f32 v102, v102, v62, -v4 op_sel_hi:[0,1,0]
    v_fma_mix_f32 v4, v119, v63, 0 op_sel:[0,1,0] op_sel_hi:[0,1,0]
    v_fma_mix_f32 v5, v119, v63, 0 op_sel_hi:[0,1,0]
    v_fma_mix_f32 v119, v103, v63, v5 op_sel:[0,1,0] op_sel_hi:[0,1,0]
    v_fma_mix_f32 v103, v103, v63, -v4 op_sel_hi:[0,1,0]
    v_lshlrev_b32 v4, 4, v2
    ds_read_b128 v[56:59], v4 offset:20992
    v_cvt_pk_bf16_f32 v8, v64, v65
    v_cvt_pk_bf16_f32 v9, v66, v67
    v_cvt_pk_bf16_f32 v10, v68, v69
    v_cvt_pk_bf16_f32 v11, v70, v71
    v_cvt_pk_bf16_f32 v16, v80, v81
    v_cvt_pk_bf16_f32 v17, v82, v83
    v_cvt_pk_bf16_f32 v18, v84, v85
    v_cvt_pk_bf16_f32 v19, v86, v87
    v_cvt_pk_bf16_f32 v24, v96, v97
    v_cvt_pk_bf16_f32 v25, v98, v99
    v_cvt_pk_bf16_f32 v26, v100, v101
    v_cvt_pk_bf16_f32 v27, v102, v103
    v_cvt_pk_bf16_f32 v32, v112, v113
    v_cvt_pk_bf16_f32 v33, v114, v115
    v_cvt_pk_bf16_f32 v34, v116, v117
    v_cvt_pk_bf16_f32 v35, v118, v119
    v_mov_b32 v12, 0
    v_mov_b32 v13, 0
    v_mov_b32 v14, 0
    v_mov_b32 v15, 0
    v_mov_b32 v20, 0
    v_mov_b32 v21, 0
    v_mov_b32 v22, 0
    v_mov_b32 v23, 0
    v_mov_b32 v28, 0
    v_mov_b32 v29, 0
    v_mov_b32 v30, 0
    v_mov_b32 v31, 0
    v_mov_b32 v36, 0
    v_mov_b32 v37, 0
    v_mov_b32 v38, 0
    v_mov_b32 v39, 0
    s_waitcnt lgkmcnt(0)
    v_fma_mix_f32 v4, v88, v56, 0 op_sel:[0,1,0] op_sel_hi:[0,1,0]
    v_fma_mix_f32 v5, v88, v56, 0 op_sel_hi:[0,1,0]
    v_fma_mix_f32 v88, v72, v56, v5 op_sel:[0,1,0] op_sel_hi:[0,1,0]
    v_fma_mix_f32 v72, v72, v56, -v4 op_sel_hi:[0,1,0]
    v_fma_mix_f32 v4, v89, v57, 0 op_sel:[0,1,0] op_sel_hi:[0,1,0]
    v_fma_mix_f32 v5, v89, v57, 0 op_sel_hi:[0,1,0]
    v_fma_mix_f32 v89, v73, v57, v5 op_sel:[0,1,0] op_sel_hi:[0,1,0]
    v_fma_mix_f32 v73, v73, v57, -v4 op_sel_hi:[0,1,0]
    v_fma_mix_f32 v4, v90, v58, 0 op_sel:[0,1,0] op_sel_hi:[0,1,0]
    v_fma_mix_f32 v5, v90, v58, 0 op_sel_hi:[0,1,0]
    v_fma_mix_f32 v90, v74, v58, v5 op_sel:[0,1,0] op_sel_hi:[0,1,0]
    v_fma_mix_f32 v74, v74, v58, -v4 op_sel_hi:[0,1,0]
    v_fma_mix_f32 v4, v91, v59, 0 op_sel:[0,1,0] op_sel_hi:[0,1,0]
    v_fma_mix_f32 v5, v91, v59, 0 op_sel_hi:[0,1,0]
    v_fma_mix_f32 v91, v75, v59, v5 op_sel:[0,1,0] op_sel_hi:[0,1,0]
    v_fma_mix_f32 v75, v75, v59, -v4 op_sel_hi:[0,1,0]
    v_fma_mix_f32 v4, v120, v56, 0 op_sel:[0,1,0] op_sel_hi:[0,1,0]
    v_fma_mix_f32 v5, v120, v56, 0 op_sel_hi:[0,1,0]
    v_fma_mix_f32 v120, v104, v56, v5 op_sel:[0,1,0] op_sel_hi:[0,1,0]
    v_fma_mix_f32 v104, v104, v56, -v4 op_sel_hi:[0,1,0]
    v_fma_mix_f32 v4, v121, v57, 0 op_sel:[0,1,0] op_sel_hi:[0,1,0]
    v_fma_mix_f32 v5, v121, v57, 0 op_sel_hi:[0,1,0]
    v_fma_mix_f32 v121, v105, v57, v5 op_sel:[0,1,0] op_sel_hi:[0,1,0]
    v_fma_mix_f32 v105, v105, v57, -v4 op_sel_hi:[0,1,0]
    v_fma_mix_f32 v4, v122, v58, 0 op_sel:[0,1,0] op_sel_hi:[0,1,0]
    v_fma_mix_f32 v5, v122, v58, 0 op_sel_hi:[0,1,0]
    v_fma_mix_f32 v122, v106, v58, v5 op_sel:[0,1,0] op_sel_hi:[0,1,0]
    v_fma_mix_f32 v106, v106, v58, -v4 op_sel_hi:[0,1,0]
    v_fma_mix_f32 v4, v123, v59, 0 op_sel:[0,1,0] op_sel_hi:[0,1,0]
    v_fma_mix_f32 v5, v123, v59, 0 op_sel_hi:[0,1,0]
    v_fma_mix_f32 v123, v107, v59, v5 op_sel:[0,1,0] op_sel_hi:[0,1,0]
    v_fma_mix_f32 v107, v107, v59, -v4 op_sel_hi:[0,1,0]
    s_mov_b32 exec_hi, 0
    v_cvt_pk_bf16_f32 v12, v72, v73
    v_cvt_pk_bf16_f32 v13, v74, v75
    v_cvt_pk_bf16_f32 v20, v88, v89
    v_cvt_pk_bf16_f32 v21, v90, v91
    v_cvt_pk_bf16_f32 v28, v104, v105
    v_cvt_pk_bf16_f32 v29, v106, v107
    v_cvt_pk_bf16_f32 v36, v120, v121
    v_cvt_pk_bf16_f32 v37, v122, v123
    s_mov_b32 exec_hi, -1
    s_nop 4
    v_mfma_f32_32x32x16_bf16 v[64:79], v[40:43], v[8:11], 0
    v_mfma_f32_32x32x16_bf16 v[64:79], v[44:47], v[12:15], v[64:79]
    v_mfma_f32_32x32x16_bf16 v[64:79], v[48:51], v[16:19], v[64:79]
    v_mfma_f32_32x32x16_bf16 v[64:79], v[52:55], v[20:23], v[64:79]
    v_mfma_f32_32x32x16_bf16 v[80:95], v[40:43], v[24:27], 0
    v_mfma_f32_32x32x16_bf16 v[80:95], v[44:47], v[28:31], v[80:95]
    v_mfma_f32_32x32x16_bf16 v[80:95], v[48:51], v[32:35], v[80:95]
    v_mfma_f32_32x32x16_bf16 v[80:95], v[52:55], v[36:39], v[80:95]
    v_lshrrev_b32 v1, 5, v2
    v_lshlrev_b32 v1, 7, v1
    v_and_b32 v3, 31, v2
    v_add_u32 v1, v1, v3
    v_lshlrev_b32 v1, 4, v1
    s_lshl_b32 s40, s24, 2
    s_add_u32 s40, s40, 22272
    v_add_u32 v1, s40, v1
    s_nop 7
    s_nop 1
    v_cvt_pk_bf16_f32 v8, v64, v80
    v_cvt_pk_bf16_f32 v9, v65, v81
    v_cvt_pk_bf16_f32 v10, v66, v82
    v_cvt_pk_bf16_f32 v11, v67, v83
    v_cvt_pk_bf16_f32 v12, v68, v84
    v_cvt_pk_bf16_f32 v13, v69, v85
    v_cvt_pk_bf16_f32 v14, v70, v86
    v_cvt_pk_bf16_f32 v16, v72, v88
    v_cvt_pk_bf16_f32 v17, v73, v89
    v_cvt_pk_bf16_f32 v18, v74, v90
    v_cvt_pk_bf16_f32 v19, v75, v91
    v_cvt_pk_bf16_f32 v20, v76, v92
    v_cvt_pk_bf16_f32 v21, v77, v93
    v_cvt_pk_bf16_f32 v22, v78, v94
    ds_write_b32 v1, v8 offset:0
    ds_write_b32 v1, v9 offset:512
    ds_write_b32 v1, v10 offset:1024
    ds_write_b32 v1, v11 offset:1536
    ds_write_b32 v1, v12 offset:4096
    ds_write_b32 v1, v13 offset:4608
    ds_write_b32 v1, v14 offset:5120
    ds_write_b32 v1, v16 offset:8192
    ds_write_b32 v1, v17 offset:8704
    ds_write_b32 v1, v18 offset:9216
    ds_write_b32 v1, v19 offset:9728
    ds_write_b32 v1, v20 offset:12288
    ds_write_b32 v1, v21 offset:12800
    ds_write_b32 v1, v22 offset:13312
    s_branch K1_FIN
K1_HT:
    s_sub_u32 s40, s24, 4
    v_mul_u32_u24 v3, 1344, v7
    v_lshlrev_b32 v4, 3, v6
    v_add_u32 v3, v3, v4
    s_mul_i32 s41, s40, 160
    v_add_u32 v3, s41, v3
    v_mov_b32 v44, 0
    v_cmp_eq_u32 vcc, 1, v5
    v_mov_b32 v47, 32
    s_nop 0
    v_cndmask_b32 v44, v44, v47, vcc
    v_cmp_eq_u32 vcc, 2, v5
    v_mov_b32 v47, 64
    s_nop 0
    v_cndmask_b32 v44, v44, v47, vcc
    v_cmp_eq_u32 vcc, 3, v5
    v_mov_b32 v47, 640
    s_nop 0
    v_cndmask_b32 v44, v44, v47, vcc
    v_lshlrev_b32 v47, 2, v5
    v_lshrrev_b32 v48, 1, v6
    v_add_u32 v47, v47, v48
    v_cmp_eq_u32 vcc, 9, v47
    v_add_u32 v48, 624, v44
    s_nop 0
    v_cndmask_b32 v44, v44, v48, vcc
    v_add_u32 v44, v44, v3
    v_mov_b32 v45, 672
    v_cmp_eq_u32 vcc, 1, v5
    v_mov_b32 v47, 80
    s_nop 0
    v_cndmask_b32 v45, v45, v47, vcc
    v_cmp_eq_u32 vcc, 2, v5
    v_mov_b32 v47, 112
    s_nop 0
    v_cndmask_b32 v45, v45, v47, vcc
    v_cmp_eq_u32 vcc, 3, v5
    v_mov_b32 v47, 144
    s_nop 0
    v_cndmask_b32 v45, v45, v47, vcc
    v_lshlrev_b32 v47, 2, v5
    v_lshrrev_b32 v48, 1, v6
    v_add_u32 v47, v47, v48
    v_cmp_eq_u32 vcc, 13, v47
    v_add_u32 v48, 624, v45
    s_nop 0
    v_cndmask_b32 v45, v45, v48, vcc
    v_add_u32 v45, v45, v3
    v_mov_b32 v46, 720
    v_cmp_eq_u32 vcc, 1, v5
    v_mov_b32 v47, 752
    s_nop 0
    v_cndmask_b32 v46, v46, v47, vcc
    v_cmp_eq_u32 vcc, 2, v5
    v_mov_b32 v47, 752
    s_nop 0
    v_cndmask_b32 v46, v46, v47, vcc
    v_cmp_eq_u32 vcc, 3, v5
    v_mov_b32 v47, 752
    s_nop 0
    v_cndmask_b32 v46, v46, v47, vcc
    v_add_u32 v46, v46, v3
    v_mov_b32 v4, 22016
    ds_read_b64_tr_b16 v[24:25], v44 offset:0
    ds_read_b64_tr_b16 v[26:27], v44 offset:5376
    ds_read_b64_tr_b16 v[28:29], v45 offset:0
    ds_read_b64_tr_b16 v[30:31], v45 offset:5376
    ds_read_b64_tr_b16 v[32:33], v46 offset:0
    ds_read_b64_tr_b16 v[34:35], v46 offset:5376
    ds_read_b128 v[8:11], v4 offset:0
    ds_read_b128 v[12:15], v4 offset:16
    ds_read_b128 v[16:19], v4 offset:32
    ds_read_b128 v[20:23], v4 offset:48
    v_lshlrev_b32 v4, 16, v5
    v_and_b32 v1, 15, v2
    v_lshlrev_b32 v1, 4, v1
    v_add_u32 v4, v4, v1
    s_mul_i32 s41, s40, 655360
    s_lshl_b32 s42, s25, 10
    s_add_u32 s41, s41, s42
    s_lshl_b32 s42, s26, 8
    s_add_u32 s41, s41, s42
    s_waitcnt lgkmcnt(0)
    v_lshlrev_b32 v40, 16, v24
    v_and_b32 v41, s43, v24
    v_sub_f32 v40, v40, v8
    v_sub_f32 v41, v41, v9
    v_cvt_pk_bf16_f32 v42, v40, v41
    v_lshlrev_b32 v40, 16, v42
    v_and_b32 v41, s43, v42
    v_mul_f32 v40, v40, v16
    v_mul_f32 v41, v41, v17
    v_cvt_pk_bf16_f32 v24, v40, v41
    v_lshlrev_b32 v40, 16, v25
    v_and_b32 v41, s43, v25
    v_sub_f32 v40, v40, v10
    v_sub_f32 v41, v41, v11
    v_cvt_pk_bf16_f32 v42, v40, v41
    v_lshlrev_b32 v40, 16, v42
    v_and_b32 v41, s43, v42
    v_mul_f32 v40, v40, v18
    v_mul_f32 v41, v41, v19
    v_cvt_pk_bf16_f32 v25, v40, v41
    v_lshlrev_b32 v40, 16, v26
    v_and_b32 v41, s43, v26
    v_sub_f32 v40, v40, v12
    v_sub_f32 v41, v41, v13
    v_cvt_pk_bf16_f32 v42, v40, v41
    v_lshlrev_b32 v40, 16, v42
    v_and_b32 v41, s43, v42
    v_mul_f32 v40, v40, v20
    v_mul_f32 v41, v41, v21
    v_cvt_pk_bf16_f32 v26, v40, v41
    v_lshlrev_b32 v40, 16, v27
    v_and_b32 v41, s43, v27
    v_sub_f32 v40, v40, v14
    v_sub_f32 v41, v41, v15
    v_cvt_pk_bf16_f32 v42, v40, v41
    v_lshlrev_b32 v40, 16, v42
    v_and_b32 v41, s43, v42
    v_mul_f32 v40, v40, v22
    v_mul_f32 v41, v41, v23
    v_cvt_pk_bf16_f32 v27, v40, v41
    buffer_store_dwordx4 v[24:27], v4, s[12:15], s41 offen sc1
    s_add_u32 s41, s41, 262144
    v_lshlrev_b32 v40, 16, v28
    v_and_b32 v41, s43, v28
    v_sub_f32 v40, v40, v8
    v_sub_f32 v41, v41, v9
    v_cvt_pk_bf16_f32 v42, v40, v41
    v_lshlrev_b32 v40, 16, v42
    v_and_b32 v41, s43, v42
    v_mul_f32 v40, v40, v16
    v_mul_f32 v41, v41, v17
    v_cvt_pk_bf16_f32 v28, v40, v41
    v_lshlrev_b32 v40, 16, v29
    v_and_b32 v41, s43, v29
    v_sub_f32 v40, v40, v10
    v_sub_f32 v41, v41, v11
    v_cvt_pk_bf16_f32 v42, v40, v41
    v_lshlrev_b32 v40, 16, v42
    v_and_b32 v41, s43, v42
    v_mul_f32 v40, v40, v18
    v_mul_f32 v41, v41, v19
    v_cvt_pk_bf16_f32 v29, v40, v41
    v_lshlrev_b32 v40, 16, v30
    v_and_b32 v41, s43, v30
    v_sub_f32 v40, v40, v12
    v_sub_f32 v41, v41, v13
    v_cvt_pk_bf16_f32 v42, v40, v41
    v_lshlrev_b32 v40, 16, v42
    v_and_b32 v41, s43, v42
    v_mul_f32 v40, v40, v20
    v_mul_f32 v41, v41, v21
    v_cvt_pk_bf16_f32 v30, v40, v41
    v_lshlrev_b32 v40, 16, v31
    v_and_b32 v41, s43, v31
    v_sub_f32 v40, v40, v14
    v_sub_f32 v41, v41, v15
    v_cvt_pk_bf16_f32 v42, v40, v41
    v_lshlrev_b32 v40, 16, v42
    v_and_b32 v41, s43, v42
    v_mul_f32 v40, v40, v22
    v_mul_f32 v41, v41, v23
    v_cvt_pk_bf16_f32 v31, v40, v41
    buffer_store_dwordx4 v[28:31], v4, s[12:15], s41 offen sc1
    s_add_u32 s41, s41, 262144
    v_lshlrev_b32 v40, 16, v32
    v_and_b32 v41, s43, v32
    v_sub_f32 v40, v40, v8
    v_sub_f32 v41, v41, v9
    v_cvt_pk_bf16_f32 v42, v40, v41
    v_lshlrev_b32 v40, 16, v42
    v_and_b32 v41, s43, v42
    v_mul_f32 v40, v40, v16
    v_mul_f32 v41, v41, v17
    v_cvt_pk_bf16_f32 v32, v40, v41
    v_lshlrev_b32 v40, 16, v33
    v_and_b32 v41, s43, v33
    v_sub_f32 v40, v40, v10
    v_sub_f32 v41, v41, v11
    v_cvt_pk_bf16_f32 v42, v40, v41
    v_lshlrev_b32 v40, 16, v42
    v_and_b32 v41, s43, v42
    v_mul_f32 v40, v40, v18
    v_mul_f32 v41, v41, v19
    v_cvt_pk_bf16_f32 v33, v40, v41
    v_lshlrev_b32 v40, 16, v34
    v_and_b32 v41, s43, v34
    v_sub_f32 v40, v40, v12
    v_sub_f32 v41, v41, v13
    v_cvt_pk_bf16_f32 v42, v40, v41
    v_lshlrev_b32 v40, 16, v42
    v_and_b32 v41, s43, v42
    v_mul_f32 v40, v40, v20
    v_mul_f32 v41, v41, v21
    v_cvt_pk_bf16_f32 v34, v40, v41
    v_lshlrev_b32 v40, 16, v35
    v_and_b32 v41, s43, v35
    v_sub_f32 v40, v40, v14
    v_sub_f32 v41, v41, v15
    v_cvt_pk_bf16_f32 v42, v40, v41
    v_lshlrev_b32 v40, 16, v42
    v_and_b32 v41, s43, v42
    v_mul_f32 v40, v40, v22
    v_mul_f32 v41, v41, v23
    v_cvt_pk_bf16_f32 v35, v40, v41
    s_mov_b32 exec_hi, 0
    buffer_store_dwordx4 v[32:35], v4, s[12:15], s41 offen sc1
    s_mov_b32 exec_hi, -1
K1_FIN:
    s_waitcnt lgkmcnt(0)
    s_barrier
    v_lshlrev_b32 v3, 4, v0
    s_lshl_b32 s40, s26, 6
    s_add_u32 s40, s40, s25
    s_mul_i32 s40, s40, 10496
    s_add_u32 s40, s40, 2621440
    s_add_u32 s41, s40, 5248
    v_cmp_gt_u32 vcc, 321, v0
    ds_read_b128 v[8:11], v3 offset:22272
    ds_read_b128 v[12:15], v3 offset:30464
    s_and_saveexec_b64 s[44:45], vcc
    s_cbranch_execz K1_END
    s_waitcnt lgkmcnt(1)
    buffer_store_dwordx4 v[8:11], v3, s[12:15], s40 offen sc1
    s_waitcnt lgkmcnt(0)
    buffer_store_dwordx4 v[12:15], v3, s[12:15], s41 offen sc1
    v_cmp_eq_u32 vcc, 320, v0
    s_lshr_b32 s40, s25, 5
    s_lshl_b32 s40, s40, 1
    s_add_u32 s40, s40, s36
    s_lshl_b32 s40, s40, 10
    s_lshl_b32 s41, s37, 5
    s_and_b32 s42, s25, 31
    s_add_u32 s41, s41, s42
    s_lshl_b32 s41, s41, 4
    s_add_u32 s40, s40, s41
    s_add_u32 s40, s40, 13402112
    s_add_u32 s41, s40, 4096
    s_and_b64 exec, exec, vcc
    s_cbranch_execz K1_END
    v_mov_b32 v4, 0
    buffer_store_dwordx4 v[8:11], v4, s[12:15], s40 offen
    buffer_store_dwordx4 v[12:15], v4, s[12:15], s41 offen
    s_branch K1_END
K1_WPATH:
    s_cmp_ge_u32 s2, 384
    s_cbranch_scc1 K1_PF
    s_mov_b32 s8, s32
    s_and_b32 s9, s33, 0xffff
    s_mov_b32 s10, 1314816
    s_mov_b32 s11, 0x20000
    s_mov_b32 s16, s34
    s_and_b32 s17, s35, 0xffff
    s_mov_b32 s18, 1314816
    s_mov_b32 s19, 0x20000
    s_sub_u32 s25, s2, 256
    s_and_b32 s26, s25, 7
    s_lshr_b32 s25, s25, 3
    s_and_b32 s27, s25, 1
    s_lshr_b32 s25, s25, 1
    s_lshl_b32 s25, s25, 3
    s_add_u32 s25, s25, s26
    s_and_b32 s26, s25, 3
    s_lshr_b32 s25, s25, 2
    s_lshl_b32 s26, s26, 1
    s_add_u32 s26, s26, s27
    s_and_b32 s36, s24, 3
    s_lshl_b32 s37, s26, 2
    s_add_u32 s37, s37, s36
    s_lshl_b32 s38, s25, 7
    s_add_u32 s37, s37, s38
    s_mul_i32 s37, s37, 642
    s_mul_i32 s38, s24, 2624
    v_min_u32 v3, 626, v3
    s_mov_b32 exec_lo, -1
    s_mov_b32 exec_hi, 0x1ff
    s_cmp_ge_u32 s24, 4
    s_cbranch_scc1 K1_WI
    s_add_u32 m0, s38, 0
    s_add_u32 s39, s37, 0
    buffer_load_dwordx4 v3, s[8:11], s39 offen nt lds
    s_add_u32 m0, s38, 656
    s_add_u32 s39, s37, 20544
    buffer_load_dwordx4 v3, s[8:11], s39 offen nt lds
    s_add_u32 m0, s38, 1312
    s_add_u32 s39, s37, 41088
    buffer_load_dwordx4 v3, s[8:11], s39 offen nt lds
    s_add_u32 m0, s38, 1968
    s_add_u32 s39, s37, 61632
    buffer_load_dwordx4 v3, s[8:11], s39 offen nt lds
    s_branch K1_WJ
K1_WI:
    s_add_u32 m0, s38, 0
    s_add_u32 s39, s37, 0
    buffer_load_dwordx4 v3, s[16:19], s39 offen nt lds
    s_add_u32 m0, s38, 656
    s_add_u32 s39, s37, 20544
    buffer_load_dwordx4 v3, s[16:19], s39 offen nt lds
    s_add_u32 m0, s38, 1312
    s_add_u32 s39, s37, 41088
    buffer_load_dwordx4 v3, s[16:19], s39 offen nt lds
    s_add_u32 m0, s38, 1968
    s_add_u32 s39, s37, 61632
    buffer_load_dwordx4 v3, s[16:19], s39 offen nt lds
K1_WJ:
    s_mov_b64 exec, -1
    v_lshrrev_b32 v5, 4, v2
    v_and_b32 v6, 15, v2
    v_lshrrev_b32 v7, 2, v6
    v_and_b32 v1, 3, v6
    v_lshl_add_u32 v3, v5, 2, v7
    v_mul_u32_u24 v3, 656, v3
    v_lshl_add_u32 v3, v1, 3, v3
    s_lshl_b32 s36, s24, 5
    v_add_u32 v3, s36, v3
    v_lshlrev_b32 v4, 13, v6
    v_lshl_add_u32 v4, v5, 4, v4
    s_lshr_b32 s36, s25, 1
    s_lshl_b32 s36, s36, 10
    s_and_b32 s37, s25, 1
    s_lshl_b32 s37, s37, 5
    s_lshl_b32 s38, s26, 2
    s_add_u32 s37, s37, s38
    s_lshl_b32 s37, s37, 4
    s_add_u32 s36, s36, s37
    s_lshl_b32 s37, s24, 17
    s_add_u32 s36, s36, s37
    s_add_u32 s36, s36, 5308416
    s_waitcnt vmcnt(0)
    s_barrier
    ds_read_b64_tr_b16 v[8:9], v3 offset:0
    ds_read_b64_tr_b16 v[10:11], v3 offset:10496
    ds_read_b64_tr_b16 v[12:13], v3 offset:256
    ds_read_b64_tr_b16 v[14:15], v3 offset:10752
    ds_read_b64_tr_b16 v[16:17], v3 offset:512
    ds_read_b64_tr_b16 v[18:19], v3 offset:11008
    v_and_b32 v20, 3, v2
    v_lshlrev_b32 v20, 4, v20
    v_lshrrev_b32 v21, 2, v2
    v_add_u32 v20, v20, v21
    v_lshlrev_b32 v20, 2, v20
    v_lshlrev_b32 v4, 13, v21
    v_and_b32 v22, 3, v2
    v_lshl_add_u32 v4, v22, 4, v4
    s_waitcnt lgkmcnt(0)
    ds_bpermute_b32 v24, v20, v8
    ds_bpermute_b32 v25, v20, v9
    ds_bpermute_b32 v26, v20, v10
    ds_bpermute_b32 v27, v20, v11
    ds_bpermute_b32 v28, v20, v12
    ds_bpermute_b32 v29, v20, v13
    ds_bpermute_b32 v30, v20, v14
    ds_bpermute_b32 v31, v20, v15
    ds_bpermute_b32 v32, v20, v16
    ds_bpermute_b32 v33, v20, v17
    ds_bpermute_b32 v34, v20, v18
    ds_bpermute_b32 v35, v20, v19
    s_waitcnt lgkmcnt(8)
    buffer_store_dwordx4 v[24:27], v4, s[12:15], s36 offen sc1
    s_add_u32 s36, s36, 1048576
    s_waitcnt lgkmcnt(4)
    buffer_store_dwordx4 v[28:31], v4, s[12:15], s36 offen sc1
    s_cmp_gt_u32 s24, 4
    s_cbranch_scc1 K1_END
    s_add_u32 s36, s36, 1048576
    s_cmp_eq_u32 s24, 4
    s_cbranch_scc0 K1_W2
    s_sub_u32 s36, s36, 57344
    v_cmp_eq_u32 vcc, 7, v21
    s_and_b64 exec, exec, vcc
K1_W2:
    s_waitcnt lgkmcnt(0)
    buffer_store_dwordx4 v[32:35], v4, s[12:15], s36 offen sc1
    s_branch K1_END
K1_PF:
    s_sub_u32 s57, s2, 384
    s_lshr_b32 s57, s57, 3
    s_lshl_b32 s57, s57, 3
    s_add_u32 s57, s57, s24
    v_lshlrev_b32 v20, 4, v2
    s_mov_b32 m0, 38912
    s_cmp_ge_u32 s57, 40
    s_cbranch_scc1 K1_PFC1
    s_getpc_b64 s[58:59]
    s_add_u32 s58, s58, table2@rel32@lo+4
    s_addc_u32 s59, s59, table2@rel32@hi+12
    s_mov_b32 s60, s58
    s_and_b32 s61, s59, 0xffff
    s_mov_b32 s62, 40960
    s_mov_b32 s63, 0x20000
    s_lshl_b32 s57, s57, 10
    buffer_load_dwordx4 v20, s[60:63], s57 offen lds
    s_branch K1_PFC_END
K1_PFC1:
    s_cmp_ge_u32 s57, 82
    s_cbranch_scc1 K1_PFC_END
    s_getpc_b64 s[58:59]
    s_add_u32 s58, s58, k2_kernel@rel32@lo+4
    s_addc_u32 s59, s59, k2_kernel@rel32@hi+12
    s_mov_b32 s64, s58
    s_and_b32 s65, s59, 0xffff
    s_mov_b32 s66, CODE_END-k2_kernel
    s_mov_b32 s67, 0x20000
    s_sub_u32 s57, s57, 40
    s_lshl_b32 s57, s57, 10
    buffer_load_dwordx4 v20, s[64:67], s57 offen lds
K1_PFC_END:
    s_mov_b32 s48, s46
    s_and_b32 s49, s47, 0xffff
    s_mov_b32 s50, 7077888
    s_mov_b32 s51, 0x20000
    s_and_b32 s52, s2, 7
    s_mul_i32 s52, s52, 27
    s_add_u32 s57, s52, 26
    s_lshr_b32 s57, s57, 3
    s_lshr_b32 s52, s52, 3
    s_sub_u32 s57, s57, s52
    s_lshl_b32 s52, s52, 7
    s_cmp_eq_u32 s57, 4
    s_cselect_b32 s57, 0xff, 0
    s_mov_b32 exec_lo, -1
    s_mov_b32 exec_hi, s57
    s_sub_u32 s53, s2, 384
    s_lshr_b32 s53, s53, 3
    s_lshl_b32 s53, s53, 3
    s_add_u32 s53, s53, s24
    v_and_b32 v20, 63, v0
    v_lshlrev_b32 v20, 4, v20
    s_mov_b32 m0, 38912
    s_add_u32 s54, s53, 0
    s_lshr_b32 s55, s54, 7
    s_lshl_b32 s55, s55, 2
    s_and_b32 s56, s54, 31
    s_lshl_b32 s56, s56, 6
    s_add_u32 s55, s55, s56
    s_bfe_u32 s56, s54, 0x20005
    s_lshl_b32 s56, s56, 0
    s_add_u32 s55, s55, s56
    s_mul_i32 s55, s55, 3456
    s_add_u32 s55, s55, s52
    buffer_load_dwordx4 v20, s[48:51], s55 offen lds
    s_add_u32 s54, s53, 128
    s_lshr_b32 s55, s54, 7
    s_lshl_b32 s55, s55, 2
    s_and_b32 s56, s54, 31
    s_lshl_b32 s56, s56, 6
    s_add_u32 s55, s55, s56
    s_bfe_u32 s56, s54, 0x20005
    s_lshl_b32 s56, s56, 0
    s_add_u32 s55, s55, s56
    s_mul_i32 s55, s55, 3456
    s_add_u32 s55, s55, s52
    buffer_load_dwordx4 v20, s[48:51], s55 offen lds
    s_add_u32 s54, s53, 256
    s_lshr_b32 s55, s54, 7
    s_lshl_b32 s55, s55, 2
    s_and_b32 s56, s54, 31
    s_lshl_b32 s56, s56, 6
    s_add_u32 s55, s55, s56
    s_bfe_u32 s56, s54, 0x20005
    s_lshl_b32 s56, s56, 0
    s_add_u32 s55, s55, s56
    s_mul_i32 s55, s55, 3456
    s_add_u32 s55, s55, s52
    buffer_load_dwordx4 v20, s[48:51], s55 offen lds
    s_add_u32 s54, s53, 384
    s_lshr_b32 s55, s54, 7
    s_lshl_b32 s55, s55, 2
    s_and_b32 s56, s54, 31
    s_lshl_b32 s56, s56, 6
    s_add_u32 s55, s55, s56
    s_bfe_u32 s56, s54, 0x20005
    s_lshl_b32 s56, s56, 0
    s_add_u32 s55, s55, s56
    s_mul_i32 s55, s55, 3456
    s_add_u32 s55, s55, s52
    buffer_load_dwordx4 v20, s[48:51], s55 offen lds
    s_add_u32 s54, s53, 512
    s_lshr_b32 s55, s54, 7
    s_lshl_b32 s55, s55, 2
    s_and_b32 s56, s54, 31
    s_lshl_b32 s56, s56, 6
    s_add_u32 s55, s55, s56
    s_bfe_u32 s56, s54, 0x20005
    s_lshl_b32 s56, s56, 0
    s_add_u32 s55, s55, s56
    s_mul_i32 s55, s55, 3456
    s_add_u32 s55, s55, s52
    buffer_load_dwordx4 v20, s[48:51], s55 offen lds
    s_add_u32 s54, s53, 640
    s_lshr_b32 s55, s54, 7
    s_lshl_b32 s55, s55, 2
    s_and_b32 s56, s54, 31
    s_lshl_b32 s56, s56, 6
    s_add_u32 s55, s55, s56
    s_bfe_u32 s56, s54, 0x20005
    s_lshl_b32 s56, s56, 0
    s_add_u32 s55, s55, s56
    s_mul_i32 s55, s55, 3456
    s_add_u32 s55, s55, s52
    buffer_load_dwordx4 v20, s[48:51], s55 offen lds
    s_add_u32 s54, s53, 768
    s_lshr_b32 s55, s54, 7
    s_lshl_b32 s55, s55, 2
    s_and_b32 s56, s54, 31
    s_lshl_b32 s56, s56, 6
    s_add_u32 s55, s55, s56
    s_bfe_u32 s56, s54, 0x20005
    s_lshl_b32 s56, s56, 0
    s_add_u32 s55, s55, s56
    s_mul_i32 s55, s55, 3456
    s_add_u32 s55, s55, s52
    buffer_load_dwordx4 v20, s[48:51], s55 offen lds
    s_add_u32 s54, s53, 896
    s_lshr_b32 s55, s54, 7
    s_lshl_b32 s55, s55, 2
    s_and_b32 s56, s54, 31
    s_lshl_b32 s56, s56, 6
    s_add_u32 s55, s55, s56
    s_bfe_u32 s56, s54, 0x20005
    s_lshl_b32 s56, s56, 0
    s_add_u32 s55, s55, s56
    s_mul_i32 s55, s55, 3456
    s_add_u32 s55, s55, s52
    buffer_load_dwordx4 v20, s[48:51], s55 offen lds
    s_add_u32 s54, s53, 1024
    s_lshr_b32 s55, s54, 7
    s_lshl_b32 s55, s55, 2
    s_and_b32 s56, s54, 31
    s_lshl_b32 s56, s56, 6
    s_add_u32 s55, s55, s56
    s_bfe_u32 s56, s54, 0x20005
    s_lshl_b32 s56, s56, 0
    s_add_u32 s55, s55, s56
    s_mul_i32 s55, s55, 3456
    s_add_u32 s55, s55, s52
    buffer_load_dwordx4 v20, s[48:51], s55 offen lds
    s_add_u32 s54, s53, 1152
    s_lshr_b32 s55, s54, 7
    s_lshl_b32 s55, s55, 2
    s_and_b32 s56, s54, 31
    s_lshl_b32 s56, s56, 6
    s_add_u32 s55, s55, s56
    s_bfe_u32 s56, s54, 0x20005
    s_lshl_b32 s56, s56, 0
    s_add_u32 s55, s55, s56
    s_mul_i32 s55, s55, 3456
    s_add_u32 s55, s55, s52
    buffer_load_dwordx4 v20, s[48:51], s55 offen lds
    s_add_u32 s54, s53, 1280
    s_lshr_b32 s55, s54, 7
    s_lshl_b32 s55, s55, 2
    s_and_b32 s56, s54, 31
    s_lshl_b32 s56, s56, 6
    s_add_u32 s55, s55, s56
    s_bfe_u32 s56, s54, 0x20005
    s_lshl_b32 s56, s56, 0
    s_add_u32 s55, s55, s56
    s_mul_i32 s55, s55, 3456
    s_add_u32 s55, s55, s52
    buffer_load_dwordx4 v20, s[48:51], s55 offen lds
    s_add_u32 s54, s53, 1408
    s_lshr_b32 s55, s54, 7
    s_lshl_b32 s55, s55, 2
    s_and_b32 s56, s54, 31
    s_lshl_b32 s56, s56, 6
    s_add_u32 s55, s55, s56
    s_bfe_u32 s56, s54, 0x20005
    s_lshl_b32 s56, s56, 0
    s_add_u32 s55, s55, s56
    s_mul_i32 s55, s55, 3456
    s_add_u32 s55, s55, s52
    buffer_load_dwordx4 v20, s[48:51], s55 offen lds
    s_add_u32 s54, s53, 1536
    s_lshr_b32 s55, s54, 7
    s_lshl_b32 s55, s55, 2
    s_and_b32 s56, s54, 31
    s_lshl_b32 s56, s56, 6
    s_add_u32 s55, s55, s56
    s_bfe_u32 s56, s54, 0x20005
    s_lshl_b32 s56, s56, 0
    s_add_u32 s55, s55, s56
    s_mul_i32 s55, s55, 3456
    s_add_u32 s55, s55, s52
    buffer_load_dwordx4 v20, s[48:51], s55 offen lds
    s_add_u32 s54, s53, 1664
    s_lshr_b32 s55, s54, 7
    s_lshl_b32 s55, s55, 2
    s_and_b32 s56, s54, 31
    s_lshl_b32 s56, s56, 6
    s_add_u32 s55, s55, s56
    s_bfe_u32 s56, s54, 0x20005
    s_lshl_b32 s56, s56, 0
    s_add_u32 s55, s55, s56
    s_mul_i32 s55, s55, 3456
    s_add_u32 s55, s55, s52
    buffer_load_dwordx4 v20, s[48:51], s55 offen lds
K1_END:
    s_endpgm
K1_OOB:
    s_endpgm
    .globl k2_kernel
    .p2align 8
    .type k2_kernel,@function
k2_kernel:
    s_cmp_ge_u32 s2, 256
    s_cbranch_scc1 K2_OOB
    s_load_dwordx4 s[4:7], s[0:1], 32
    s_load_dwordx2 s[28:29], s[0:1], 88
    s_load_dwordx2 s[62:63], s[0:1], 48
    v_lshrrev_b32 v1, 6, v0
    v_and_b32 v2, 63, v0
    s_and_b32 s25, s2, 7
    s_lshr_b32 s26, s2, 3
    v_readfirstlane_b32 s24, v1
    s_mul_i32 s34, s25, 27
    s_add_u32 s34, s34, s26
    s_lshr_b32 s33, s34, 3
    s_and_b32 s27, s34, 7
    s_cmp_ge_u32 s26, 27
    s_cbranch_scc1 K2_FFT0
    s_cmp_ge_u32 s24, 4
    s_cbranch_scc1 K2_GGEN0
    s_mul_i32 s36, s24, 20480
    v_lshrrev_b32 v13, 3, v2
    v_lshrrev_b32 v14, 1, v13
    v_and_b32 v14, 3, v14
    v_lshlrev_b32 v14, 1, v14
    v_and_b32 v15, 7, v2
    v_xor_b32 v14, v14, v15
    v_lshlrev_b32 v1, 4, v14
    s_mov_b32 s37, 221184
    v_mul_lo_u32 v13, v13, s37
    v_add_u32 v3, v13, v1
    v_lshlrev_b32 v4, 4, v2
    v_add_u32 v5, 65536, v4
    v_add_u32 v6, 131072, v4
    v_add_u32 v7, 196608, v4
    v_add_u32 v8, 262144, v4
    s_lshl_b32 s38, s24, 0
    s_mul_i32 s39, s38, 3456
    s_lshl_b32 s40, s33, 7
    s_add_u32 s39, s39, s40
    s_mul_i32 s40, s27, 320
    s_add_u32 s40, s40, s38
    s_lshl_b32 s40, s40, 10
    s_mul_i32 s44, s27, 0
    s_and_b32 s44, s44, 15
    s_waitcnt lgkmcnt(0)
    s_mov_b32 s12, s28
    s_and_b32 s13, s29, 0xffff
    s_mov_b32 s14, 13414400
    s_mov_b32 s15, 0x20000
    s_mov_b32 s8, s4
    s_and_b32 s9, s5, 0xffff
    s_mov_b32 s10, 7077888
    s_mov_b32 s11, 0x20000
    s_add_u32 m0, s36, 0
    s_add_u32 s41, s39, 0
    buffer_load_dwordx4 v3, s[8:11], s41 offen lds
    s_add_u32 m0, s36, 1024
    s_add_u32 s41, s39, 3538944
    buffer_load_dwordx4 v3, s[8:11], s41 offen lds
    s_add_u32 m0, s36, 2048
    s_add_u32 s41, s39, 1769472
    buffer_load_dwordx4 v3, s[8:11], s41 offen lds
    s_add_u32 m0, s36, 3072
    s_add_u32 s41, s39, 5308416
    buffer_load_dwordx4 v3, s[8:11], s41 offen lds
    buffer_load_dwordx4 v[112:115], v4, s[12:15], s40 offen
    buffer_load_dwordx4 v[116:119], v5, s[12:15], s40 offen
    buffer_load_dwordx4 v[120:123], v6, s[12:15], s40 offen
    buffer_load_dwordx4 v[124:127], v7, s[12:15], s40 offen
    buffer_load_dwordx4 v[128:131], v8, s[12:15], s40 offen
    s_add_u32 m0, s36, 4096
    s_add_u32 s41, s39, 13824
    buffer_load_dwordx4 v3, s[8:11], s41 offen lds
    s_add_u32 m0, s36, 5120
    s_add_u32 s41, s39, 3552768
    buffer_load_dwordx4 v3, s[8:11], s41 offen lds
    s_add_u32 m0, s36, 6144
    s_add_u32 s41, s39, 1783296
    buffer_load_dwordx4 v3, s[8:11], s41 offen lds
    s_add_u32 m0, s36, 7168
    s_add_u32 s41, s39, 5322240
    buffer_load_dwordx4 v3, s[8:11], s41 offen lds
    s_add_u32 s40, s40, 4096
    buffer_load_dwordx4 v[132:135], v4, s[12:15], s40 offen
    buffer_load_dwordx4 v[136:139], v5, s[12:15], s40 offen
    buffer_load_dwordx4 v[140:143], v6, s[12:15], s40 offen
    buffer_load_dwordx4 v[144:147], v7, s[12:15], s40 offen
    buffer_load_dwordx4 v[148:151], v8, s[12:15], s40 offen
    v_lshrrev_b32 v13, 4, v2
    v_and_b32 v14, 15, v2
    v_lshrrev_b32 v15, 2, v14
    v_and_b32 v14, 3, v14
    v_lshl_add_u32 v13, v13, 2, v15
    v_lshrrev_b32 v15, 1, v13
    v_and_b32 v15, 3, v15
    v_lshlrev_b32 v13, 7, v13
    v_lshl_add_u32 v13, v14, 3, v13
    v_add_u32 v13, s36, v13
    v_xor_b32 v1, 0, v15
    v_lshl_add_u32 v9, v1, 5, v13
    v_xor_b32 v1, 1, v15
    v_lshl_add_u32 v10, v1, 5, v13
    v_xor_b32 v1, 2, v15
    v_lshl_add_u32 v11, v1, 5, v13
    v_xor_b32 v1, 3, v15
    v_lshl_add_u32 v12, v1, 5, v13
    s_getpc_b64 s[30:31]
    s_add_u32 s30, s30, table2@rel32@lo+4
    s_addc_u32 s31, s31, table2@rel32@hi+12
    s_mov_b32 s16, s6
    s_and_b32 s17, s7, 0xffff
    s_mov_b32 s18, 3456
    s_mov_b32 s19, 0x20000
    s_mov_b32 s68, s62
    s_and_b32 s69, s63, 0xffff
    s_mov_b32 s70, 7077888
    s_mov_b32 s71, 0x20000
    v_lshrrev_b32 v250, 4, v2
    v_lshlrev_b32 v250, 3, v250
    s_lshl_b32 s61, s33, 7
    s_add_u32 s46, s24, 0
    s_cmp_ge_u32 s46, 5
    s_cselect_b32 s47, 1, 0
    s_mul_i32 s48, s47, 5
    s_sub_u32 s48, s46, s48
    s_lshl_b32 s49, s47, 6
    s_add_u32 s49, s49, s61
    buffer_load_dwordx2 v[240:241], v250, s[16:19], s49 offen
    buffer_load_dwordx2 v[242:243], v250, s[16:19], s49 offen offset:32
    s_mul_i32 s46, s47, 10
    s_add_u32 s46, s46, s48
    s_lshl_b32 s52, s46, 10
    s_mul_i32 s50, s27, 5
    s_add_u32 s50, s50, s48
    s_mul_i32 s50, s50, 54
    s_lshl_b32 s51, s33, 1
    s_add_u32 s50, s50, s51
    s_add_u32 s50, s50, s47
    s_lshl_b32 s50, s50, 10
    s_add_u32 s56, s50, 7946240
    s_add_u32 s46, s24, 4
    s_cmp_ge_u32 s46, 5
    s_cselect_b32 s47, 1, 0
    s_mul_i32 s48, s47, 5
    s_sub_u32 s48, s46, s48
    s_lshl_b32 s49, s47, 6
    s_add_u32 s49, s49, s61
    buffer_load_dwordx2 v[244:245], v250, s[16:19], s49 offen
    buffer_load_dwordx2 v[246:247], v250, s[16:19], s49 offen offset:32
    s_mul_i32 s46, s47, 10
    s_add_u32 s46, s46, s48
    s_lshl_b32 s53, s46, 10
    s_mul_i32 s50, s27, 5
    s_add_u32 s50, s50, s48
    s_mul_i32 s50, s50, 54
    s_lshl_b32 s51, s33, 1
    s_add_u32 s50, s50, s51
    s_add_u32 s50, s50, s47
    s_lshl_b32 s50, s50, 10
    s_add_u32 s57, s50, 7946240
    s_waitcnt vmcnt(13)
    ds_read_b64_tr_b16 v[96:97], v9 offset:0
    ds_read_b64_tr_b16 v[98:99], v9 offset:2048
    ds_read_b64_tr_b16 v[100:101], v10 offset:0
    ds_read_b64_tr_b16 v[102:103], v10 offset:2048
    ds_read_b64_tr_b16 v[104:105], v11 offset:0
    ds_read_b64_tr_b16 v[106:107], v11 offset:2048
    ds_read_b64_tr_b16 v[108:109], v12 offset:0
    ds_read_b64_tr_b16 v[110:111], v12 offset:2048
    s_add_u32 m0, s36, 8192
    s_add_u32 s41, s39, 27648
    buffer_load_dwordx4 v3, s[8:11], s41 offen lds
    s_add_u32 m0, s36, 9216
    s_add_u32 s41, s39, 3566592
    buffer_load_dwordx4 v3, s[8:11], s41 offen lds
    s_add_u32 m0, s36, 10240
    s_add_u32 s41, s39, 1797120
    buffer_load_dwordx4 v3, s[8:11], s41 offen lds
    s_add_u32 m0, s36, 11264
    s_add_u32 s41, s39, 5336064
    buffer_load_dwordx4 v3, s[8:11], s41 offen lds
    s_add_u32 s40, s40, 4096
    buffer_load_dwordx4 v[152:155], v4, s[12:15], s40 offen
    buffer_load_dwordx4 v[156:159], v5, s[12:15], s40 offen
    buffer_load_dwordx4 v[160:163], v6, s[12:15], s40 offen
    buffer_load_dwordx4 v[164:167], v7, s[12:15], s40 offen
    buffer_load_dwordx4 v[168:171], v8, s[12:15], s40 offen
    s_waitcnt lgkmcnt(6)
    v_mfma_f32_16x16x32_bf16 v[16:19], v[96:99], v[112:115], 0
    v_mfma_f32_16x16x32_bf16 v[20:23], v[96:99], v[116:119], 0
    v_mfma_f32_16x16x32_bf16 v[24:27], v[96:99], v[120:123], 0
    v_mfma_f32_16x16x32_bf16 v[28:31], v[96:99], v[124:127], 0
    v_mfma_f32_16x16x32_bf16 v[32:35], v[96:99], v[128:131], 0
    s_waitcnt lgkmcnt(4)
    v_mfma_f32_16x16x32_bf16 v[36:39], v[100:103], v[112:115], 0
    v_mfma_f32_16x16x32_bf16 v[40:43], v[100:103], v[116:119], 0
    v_mfma_f32_16x16x32_bf16 v[44:47], v[100:103], v[120:123], 0
    v_mfma_f32_16x16x32_bf16 v[48:51], v[100:103], v[124:127], 0
    v_mfma_f32_16x16x32_bf16 v[52:55], v[100:103], v[128:131], 0
    s_waitcnt lgkmcnt(2)
    v_mfma_f32_16x16x32_bf16 v[56:59], v[104:107], v[112:115], 0
    v_mfma_f32_16x16x32_bf16 v[60:63], v[104:107], v[116:119], 0
    v_mfma_f32_16x16x32_bf16 v[64:67], v[104:107], v[120:123], 0
    v_mfma_f32_16x16x32_bf16 v[68:71], v[104:107], v[124:127], 0
    v_mfma_f32_16x16x32_bf16 v[72:75], v[104:107], v[128:131], 0
    s_waitcnt lgkmcnt(0)
    v_mfma_f32_16x16x32_bf16 v[76:79], v[108:111], v[112:115], 0
    v_mfma_f32_16x16x32_bf16 v[80:83], v[108:111], v[116:119], 0
    v_mfma_f32_16x16x32_bf16 v[84:87], v[108:111], v[120:123], 0
    v_mfma_f32_16x16x32_bf16 v[88:91], v[108:111], v[124:127], 0
    v_mfma_f32_16x16x32_bf16 v[92:95], v[108:111], v[128:131], 0
    s_waitcnt vmcnt(13)
    ds_read_b64_tr_b16 v[96:97], v9 offset:4096
    ds_read_b64_tr_b16 v[98:99], v9 offset:6144
    ds_read_b64_tr_b16 v[100:101], v10 offset:4096
    ds_read_b64_tr_b16 v[102:103], v10 offset:6144
    ds_read_b64_tr_b16 v[104:105], v11 offset:4096
    ds_read_b64_tr_b16 v[106:107], v11 offset:6144
    ds_read_b64_tr_b16 v[108:109], v12 offset:4096
    ds_read_b64_tr_b16 v[110:111], v12 offset:6144
    s_add_u32 m0, s36, 0
    s_add_u32 s41, s39, 41472
    buffer_load_dwordx4 v3, s[8:11], s41 offen lds
    s_add_u32 m0, s36, 1024
    s_add_u32 s41, s39, 3580416
    buffer_load_dwordx4 v3, s[8:11], s41 offen lds
    s_add_u32 m0, s36, 2048
    s_add_u32 s41, s39, 1810944
    buffer_load_dwordx4 v3, s[8:11], s41 offen lds
    s_add_u32 m0, s36, 3072
    s_add_u32 s41, s39, 5349888
    buffer_load_dwordx4 v3, s[8:11], s41 offen lds
    s_add_u32 s40, s40, 4096
    buffer_load_dwordx4 v[112:115], v4, s[12:15], s40 offen
    buffer_load_dwordx4 v[116:119], v5, s[12:15], s40 offen
    buffer_load_dwordx4 v[120:123], v6, s[12:15], s40 offen
    buffer_load_dwordx4 v[124:127], v7, s[12:15], s40 offen
    buffer_load_dwordx4 v[128:131], v8, s[12:15], s40 offen
    s_waitcnt lgkmcnt(6)
    v_mfma_f32_16x16x32_bf16 v[16:19], v[96:99], v[132:135], v[16:19]
    v_mfma_f32_16x16x32_bf16 v[20:23], v[96:99], v[136:139], v[20:23]
    v_mfma_f32_16x16x32_bf16 v[24:27], v[96:99], v[140:143], v[24:27]
    v_mfma_f32_16x16x32_bf16 v[28:31], v[96:99], v[144:147], v[28:31]
    v_mfma_f32_16x16x32_bf16 v[32:35], v[96:99], v[148:151], v[32:35]
    s_waitcnt lgkmcnt(4)
    v_mfma_f32_16x16x32_bf16 v[36:39], v[100:103], v[132:135], v[36:39]
    v_mfma_f32_16x16x32_bf16 v[40:43], v[100:103], v[136:139], v[40:43]
    v_mfma_f32_16x16x32_bf16 v[44:47], v[100:103], v[140:143], v[44:47]
    v_mfma_f32_16x16x32_bf16 v[48:51], v[100:103], v[144:147], v[48:51]
    v_mfma_f32_16x16x32_bf16 v[52:55], v[100:103], v[148:151], v[52:55]
    s_waitcnt lgkmcnt(2)
    v_mfma_f32_16x16x32_bf16 v[56:59], v[104:107], v[132:135], v[56:59]
    v_mfma_f32_16x16x32_bf16 v[60:63], v[104:107], v[136:139], v[60:63]
    v_mfma_f32_16x16x32_bf16 v[64:67], v[104:107], v[140:143], v[64:67]
    v_mfma_f32_16x16x32_bf16 v[68:71], v[104:107], v[144:147], v[68:71]
    v_mfma_f32_16x16x32_bf16 v[72:75], v[104:107], v[148:151], v[72:75]
    s_waitcnt lgkmcnt(0)
    v_mfma_f32_16x16x32_bf16 v[76:79], v[108:111], v[132:135], v[76:79]
    v_mfma_f32_16x16x32_bf16 v[80:83], v[108:111], v[136:139], v[80:83]
    v_mfma_f32_16x16x32_bf16 v[84:87], v[108:111], v[140:143], v[84:87]
    v_mfma_f32_16x16x32_bf16 v[88:91], v[108:111], v[144:147], v[88:91]
    v_mfma_f32_16x16x32_bf16 v[92:95], v[108:111], v[148:151], v[92:95]
    s_waitcnt vmcnt(9)
    ds_read_b64_tr_b16 v[96:97], v9 offset:8192
    ds_read_b64_tr_b16 v[98:99], v9 offset:10240
    ds_read_b64_tr_b16 v[100:101], v10 offset:8192
    ds_read_b64_tr_b16 v[102:103], v10 offset:10240
    ds_read_b64_tr_b16 v[104:105], v11 offset:8192
    ds_read_b64_tr_b16 v[106:107], v11 offset:10240
    ds_read_b64_tr_b16 v[108:109], v12 offset:8192
    ds_read_b64_tr_b16 v[110:111], v12 offset:10240
    s_add_u32 m0, s36, 4096
    s_add_u32 s41, s39, 55296
    buffer_load_dwordx4 v3, s[8:11], s41 offen lds
    s_add_u32 m0, s36, 5120
    s_add_u32 s41, s39, 3594240
    buffer_load_dwordx4 v3, s[8:11], s41 offen lds
    s_add_u32 m0, s36, 6144
    s_add_u32 s41, s39, 1824768
    buffer_load_dwordx4 v3, s[8:11], s41 offen lds
    s_add_u32 m0, s36, 7168
    s_add_u32 s41, s39, 5363712
    buffer_load_dwordx4 v3, s[8:11], s41 offen lds
    s_add_u32 s40, s40, 4096
    buffer_load_dwordx4 v[132:135], v4, s[12:15], s40 offen
    buffer_load_dwordx4 v[136:139], v5, s[12:15], s40 offen
    buffer_load_dwordx4 v[140:143], v6, s[12:15], s40 offen
    buffer_load_dwordx4 v[144:147], v7, s[12:15], s40 offen
    buffer_load_dwordx4 v[148:151], v8, s[12:15], s40 offen
    s_waitcnt lgkmcnt(6)
    v_mfma_f32_16x16x32_bf16 v[16:19], v[96:99], v[152:155], v[16:19]
    v_mfma_f32_16x16x32_bf16 v[20:23], v[96:99], v[156:159], v[20:23]
    v_mfma_f32_16x16x32_bf16 v[24:27], v[96:99], v[160:163], v[24:27]
    v_mfma_f32_16x16x32_bf16 v[28:31], v[96:99], v[164:167], v[28:31]
    v_mfma_f32_16x16x32_bf16 v[32:35], v[96:99], v[168:171], v[32:35]
    s_waitcnt lgkmcnt(4)
    v_mfma_f32_16x16x32_bf16 v[36:39], v[100:103], v[152:155], v[36:39]
    v_mfma_f32_16x16x32_bf16 v[40:43], v[100:103], v[156:159], v[40:43]
    v_mfma_f32_16x16x32_bf16 v[44:47], v[100:103], v[160:163], v[44:47]
    v_mfma_f32_16x16x32_bf16 v[48:51], v[100:103], v[164:167], v[48:51]
    v_mfma_f32_16x16x32_bf16 v[52:55], v[100:103], v[168:171], v[52:55]
    s_waitcnt lgkmcnt(2)
    v_mfma_f32_16x16x32_bf16 v[56:59], v[104:107], v[152:155], v[56:59]
    v_mfma_f32_16x16x32_bf16 v[60:63], v[104:107], v[156:159], v[60:63]
    v_mfma_f32_16x16x32_bf16 v[64:67], v[104:107], v[160:163], v[64:67]
    v_mfma_f32_16x16x32_bf16 v[68:71], v[104:107], v[164:167], v[68:71]
    v_mfma_f32_16x16x32_bf16 v[72:75], v[104:107], v[168:171], v[72:75]
    s_waitcnt lgkmcnt(0)
    v_mfma_f32_16x16x32_bf16 v[76:79], v[108:111], v[152:155], v[76:79]
    v_mfma_f32_16x16x32_bf16 v[80:83], v[108:111], v[156:159], v[80:83]
    v_mfma_f32_16x16x32_bf16 v[84:87], v[108:111], v[160:163], v[84:87]
    v_mfma_f32_16x16x32_bf16 v[88:91], v[108:111], v[164:167], v[88:91]
    v_mfma_f32_16x16x32_bf16 v[92:95], v[108:111], v[168:171], v[92:95]
    s_waitcnt vmcnt(9)
    ds_read_b64_tr_b16 v[96:97], v9 offset:0
    ds_read_b64_tr_b16 v[98:99], v9 offset:2048
    ds_read_b64_tr_b16 v[100:101], v10 offset:0
    ds_read_b64_tr_b16 v[102:103], v10 offset:2048
    ds_read_b64_tr_b16 v[104:105], v11 offset:0
    ds_read_b64_tr_b16 v[106:107], v11 offset:2048
    ds_read_b64_tr_b16 v[108:109], v12 offset:0
    ds_read_b64_tr_b16 v[110:111], v12 offset:2048
    s_add_u32 m0, s36, 8192
    s_add_u32 s41, s39, 69120
    buffer_load_dwordx4 v3, s[8:11], s41 offen lds
    s_add_u32 m0, s36, 9216
    s_add_u32 s41, s39, 3608064
    buffer_load_dwordx4 v3, s[8:11], s41 offen lds
    s_add_u32 m0, s36, 10240
    s_add_u32 s41, s39, 1838592
    buffer_load_dwordx4 v3, s[8:11], s41 offen lds
    s_add_u32 m0, s36, 11264
    s_add_u32 s41, s39, 5377536
    buffer_load_dwordx4 v3, s[8:11], s41 offen lds
    s_add_u32 s40, s40, 4096
    buffer_load_dwordx4 v[152:155], v4, s[12:15], s40 offen
    buffer_load_dwordx4 v[156:159], v5, s[12:15], s40 offen
    buffer_load_dwordx4 v[160:163], v6, s[12:15], s40 offen
    buffer_load_dwordx4 v[164:167], v7, s[12:15], s40 offen
    buffer_load_dwordx4 v[168:171], v8, s[12:15], s40 offen
    s_waitcnt lgkmcnt(6)
    v_mfma_f32_16x16x32_bf16 v[16:19], v[96:99], v[112:115], v[16:19]
    v_mfma_f32_16x16x32_bf16 v[20:23], v[96:99], v[116:119], v[20:23]
    v_mfma_f32_16x16x32_bf16 v[24:27], v[96:99], v[120:123], v[24:27]
    v_mfma_f32_16x16x32_bf16 v[28:31], v[96:99], v[124:127], v[28:31]
    v_mfma_f32_16x16x32_bf16 v[32:35], v[96:99], v[128:131], v[32:35]
    s_waitcnt lgkmcnt(4)
    v_mfma_f32_16x16x32_bf16 v[36:39], v[100:103], v[112:115], v[36:39]
    v_mfma_f32_16x16x32_bf16 v[40:43], v[100:103], v[116:119], v[40:43]
    v_mfma_f32_16x16x32_bf16 v[44:47], v[100:103], v[120:123], v[44:47]
    v_mfma_f32_16x16x32_bf16 v[48:51], v[100:103], v[124:127], v[48:51]
    v_mfma_f32_16x16x32_bf16 v[52:55], v[100:103], v[128:131], v[52:55]
    s_waitcnt lgkmcnt(2)
    v_mfma_f32_16x16x32_bf16 v[56:59], v[104:107], v[112:115], v[56:59]
    v_mfma_f32_16x16x32_bf16 v[60:63], v[104:107], v[116:119], v[60:63]
    v_mfma_f32_16x16x32_bf16 v[64:67], v[104:107], v[120:123], v[64:67]
    v_mfma_f32_16x16x32_bf16 v[68:71], v[104:107], v[124:127], v[68:71]
    v_mfma_f32_16x16x32_bf16 v[72:75], v[104:107], v[128:131], v[72:75]
    s_waitcnt lgkmcnt(0)
    v_mfma_f32_16x16x32_bf16 v[76:79], v[108:111], v[112:115], v[76:79]
    v_mfma_f32_16x16x32_bf16 v[80:83], v[108:111], v[116:119], v[80:83]
    v_mfma_f32_16x16x32_bf16 v[84:87], v[108:111], v[120:123], v[84:87]
    v_mfma_f32_16x16x32_bf16 v[88:91], v[108:111], v[124:127], v[88:91]
    v_mfma_f32_16x16x32_bf16 v[92:95], v[108:111], v[128:131], v[92:95]
    s_waitcnt vmcnt(9)
    ds_read_b64_tr_b16 v[96:97], v9 offset:4096
    ds_read_b64_tr_b16 v[98:99], v9 offset:6144
    ds_read_b64_tr_b16 v[100:101], v10 offset:4096
    ds_read_b64_tr_b16 v[102:103], v10 offset:6144
    ds_read_b64_tr_b16 v[104:105], v11 offset:4096
    ds_read_b64_tr_b16 v[106:107], v11 offset:6144
    ds_read_b64_tr_b16 v[108:109], v12 offset:4096
    ds_read_b64_tr_b16 v[110:111], v12 offset:6144
    s_add_u32 m0, s36, 0
    s_add_u32 s41, s39, 82944
    buffer_load_dwordx4 v3, s[8:11], s41 offen lds
    s_add_u32 m0, s36, 1024
    s_add_u32 s41, s39, 3621888
    buffer_load_dwordx4 v3, s[8:11], s41 offen lds
    s_add_u32 m0, s36, 2048
    s_add_u32 s41, s39, 1852416
    buffer_load_dwordx4 v3, s[8:11], s41 offen lds
    s_add_u32 m0, s36, 3072
    s_add_u32 s41, s39, 5391360
    buffer_load_dwordx4 v3, s[8:11], s41 offen lds
    s_add_u32 s40, s40, 4096
    buffer_load_dwordx4 v[112:115], v4, s[12:15], s40 offen
    buffer_load_dwordx4 v[116:119], v5, s[12:15], s40 offen
    buffer_load_dwordx4 v[120:123], v6, s[12:15], s40 offen
    buffer_load_dwordx4 v[124:127], v7, s[12:15], s40 offen
    buffer_load_dwordx4 v[128:131], v8, s[12:15], s40 offen
    s_waitcnt lgkmcnt(6)
    v_mfma_f32_16x16x32_bf16 v[16:19], v[96:99], v[132:135], v[16:19]
    v_mfma_f32_16x16x32_bf16 v[20:23], v[96:99], v[136:139], v[20:23]
    v_mfma_f32_16x16x32_bf16 v[24:27], v[96:99], v[140:143], v[24:27]
    v_mfma_f32_16x16x32_bf16 v[28:31], v[96:99], v[144:147], v[28:31]
    v_mfma_f32_16x16x32_bf16 v[32:35], v[96:99], v[148:151], v[32:35]
    s_waitcnt lgkmcnt(4)
    v_mfma_f32_16x16x32_bf16 v[36:39], v[100:103], v[132:135], v[36:39]
    v_mfma_f32_16x16x32_bf16 v[40:43], v[100:103], v[136:139], v[40:43]
    v_mfma_f32_16x16x32_bf16 v[44:47], v[100:103], v[140:143], v[44:47]
    v_mfma_f32_16x16x32_bf16 v[48:51], v[100:103], v[144:147], v[48:51]
    v_mfma_f32_16x16x32_bf16 v[52:55], v[100:103], v[148:151], v[52:55]
    s_waitcnt lgkmcnt(2)
    v_mfma_f32_16x16x32_bf16 v[56:59], v[104:107], v[132:135], v[56:59]
    v_mfma_f32_16x16x32_bf16 v[60:63], v[104:107], v[136:139], v[60:63]
    v_mfma_f32_16x16x32_bf16 v[64:67], v[104:107], v[140:143], v[64:67]
    v_mfma_f32_16x16x32_bf16 v[68:71], v[104:107], v[144:147], v[68:71]
    v_mfma_f32_16x16x32_bf16 v[72:75], v[104:107], v[148:151], v[72:75]
    s_waitcnt lgkmcnt(0)
    v_mfma_f32_16x16x32_bf16 v[76:79], v[108:111], v[132:135], v[76:79]
    v_mfma_f32_16x16x32_bf16 v[80:83], v[108:111], v[136:139], v[80:83]
    v_mfma_f32_16x16x32_bf16 v[84:87], v[108:111], v[140:143], v[84:87]
    v_mfma_f32_16x16x32_bf16 v[88:91], v[108:111], v[144:147], v[88:91]
    v_mfma_f32_16x16x32_bf16 v[92:95], v[108:111], v[148:151], v[92:95]
    s_waitcnt vmcnt(9)
    ds_read_b64_tr_b16 v[96:97], v9 offset:8192
    ds_read_b64_tr_b16 v[98:99], v9 offset:10240
    ds_read_b64_tr_b16 v[100:101], v10 offset:8192
    ds_read_b64_tr_b16 v[102:103], v10 offset:10240
    ds_read_b64_tr_b16 v[104:105], v11 offset:8192
    ds_read_b64_tr_b16 v[106:107], v11 offset:10240
    ds_read_b64_tr_b16 v[108:109], v12 offset:8192
    ds_read_b64_tr_b16 v[110:111], v12 offset:10240
    s_add_u32 m0, s36, 4096
    s_add_u32 s41, s39, 96768
    buffer_load_dwordx4 v3, s[8:11], s41 offen lds
    s_add_u32 m0, s36, 5120
    s_add_u32 s41, s39, 3635712
    buffer_load_dwordx4 v3, s[8:11], s41 offen lds
    s_add_u32 m0, s36, 6144
    s_add_u32 s41, s39, 1866240
    buffer_load_dwordx4 v3, s[8:11], s41 offen lds
    s_add_u32 m0, s36, 7168
    s_add_u32 s41, s39, 5405184
    buffer_load_dwordx4 v3, s[8:11], s41 offen lds
    s_add_u32 s40, s40, 4096
    buffer_load_dwordx4 v[132:135], v4, s[12:15], s40 offen
    buffer_load_dwordx4 v[136:139], v5, s[12:15], s40 offen
    buffer_load_dwordx4 v[140:143], v6, s[12:15], s40 offen
    buffer_load_dwordx4 v[144:147], v7, s[12:15], s40 offen
    buffer_load_dwordx4 v[148:151], v8, s[12:15], s40 offen
    s_waitcnt lgkmcnt(6)
    v_mfma_f32_16x16x32_bf16 v[16:19], v[96:99], v[152:155], v[16:19]
    v_mfma_f32_16x16x32_bf16 v[20:23], v[96:99], v[156:159], v[20:23]
    v_mfma_f32_16x16x32_bf16 v[24:27], v[96:99], v[160:163], v[24:27]
    v_mfma_f32_16x16x32_bf16 v[28:31], v[96:99], v[164:167], v[28:31]
    v_mfma_f32_16x16x32_bf16 v[32:35], v[96:99], v[168:171], v[32:35]
    s_waitcnt lgkmcnt(4)
    v_mfma_f32_16x16x32_bf16 v[36:39], v[100:103], v[152:155], v[36:39]
    v_mfma_f32_16x16x32_bf16 v[40:43], v[100:103], v[156:159], v[40:43]
    v_mfma_f32_16x16x32_bf16 v[44:47], v[100:103], v[160:163], v[44:47]
    v_mfma_f32_16x16x32_bf16 v[48:51], v[100:103], v[164:167], v[48:51]
    v_mfma_f32_16x16x32_bf16 v[52:55], v[100:103], v[168:171], v[52:55]
    s_waitcnt lgkmcnt(2)
    v_mfma_f32_16x16x32_bf16 v[56:59], v[104:107], v[152:155], v[56:59]
    v_mfma_f32_16x16x32_bf16 v[60:63], v[104:107], v[156:159], v[60:63]
    v_mfma_f32_16x16x32_bf16 v[64:67], v[104:107], v[160:163], v[64:67]
    v_mfma_f32_16x16x32_bf16 v[68:71], v[104:107], v[164:167], v[68:71]
    v_mfma_f32_16x16x32_bf16 v[72:75], v[104:107], v[168:171], v[72:75]
    s_waitcnt lgkmcnt(0)
    v_mfma_f32_16x16x32_bf16 v[76:79], v[108:111], v[152:155], v[76:79]
    v_mfma_f32_16x16x32_bf16 v[80:83], v[108:111], v[156:159], v[80:83]
    v_mfma_f32_16x16x32_bf16 v[84:87], v[108:111], v[160:163], v[84:87]
    v_mfma_f32_16x16x32_bf16 v[88:91], v[108:111], v[164:167], v[88:91]
    v_mfma_f32_16x16x32_bf16 v[92:95], v[108:111], v[168:171], v[92:95]
    s_waitcnt vmcnt(9)
    ds_read_b64_tr_b16 v[96:97], v9 offset:0
    ds_read_b64_tr_b16 v[98:99], v9 offset:2048
    ds_read_b64_tr_b16 v[100:101], v10 offset:0
    ds_read_b64_tr_b16 v[102:103], v10 offset:2048
    ds_read_b64_tr_b16 v[104:105], v11 offset:0
    ds_read_b64_tr_b16 v[106:107], v11 offset:2048
    ds_read_b64_tr_b16 v[108:109], v12 offset:0
    ds_read_b64_tr_b16 v[110:111], v12 offset:2048
    s_add_u32 m0, s36, 8192
    s_add_u32 s41, s39, 110592
    buffer_load_dwordx4 v3, s[8:11], s41 offen lds
    s_add_u32 m0, s36, 9216
    s_add_u32 s41, s39, 3649536
    buffer_load_dwordx4 v3, s[8:11], s41 offen lds
    s_add_u32 m0, s36, 10240
    s_add_u32 s41, s39, 1880064
    buffer_load_dwordx4 v3, s[8:11], s41 offen lds
    s_add_u32 m0, s36, 11264
    s_add_u32 s41, s39, 5419008
    buffer_load_dwordx4 v3, s[8:11], s41 offen lds
    s_add_u32 s40, s40, 4096
    buffer_load_dwordx4 v[152:155], v4, s[12:15], s40 offen
    buffer_load_dwordx4 v[156:159], v5, s[12:15], s40 offen
    buffer_load_dwordx4 v[160:163], v6, s[12:15], s40 offen
    buffer_load_dwordx4 v[164:167], v7, s[12:15], s40 offen
    buffer_load_dwordx4 v[168:171], v8, s[12:15], s40 offen
    s_waitcnt lgkmcnt(6)
    v_mfma_f32_16x16x32_bf16 v[16:19], v[96:99], v[112:115], v[16:19]
    v_mfma_f32_16x16x32_bf16 v[20:23], v[96:99], v[116:119], v[20:23]
    v_mfma_f32_16x16x32_bf16 v[24:27], v[96:99], v[120:123], v[24:27]
    v_mfma_f32_16x16x32_bf16 v[28:31], v[96:99], v[124:127], v[28:31]
    v_mfma_f32_16x16x32_bf16 v[32:35], v[96:99], v[128:131], v[32:35]
    s_waitcnt lgkmcnt(4)
    v_mfma_f32_16x16x32_bf16 v[36:39], v[100:103], v[112:115], v[36:39]
    v_mfma_f32_16x16x32_bf16 v[40:43], v[100:103], v[116:119], v[40:43]
    v_mfma_f32_16x16x32_bf16 v[44:47], v[100:103], v[120:123], v[44:47]
    v_mfma_f32_16x16x32_bf16 v[48:51], v[100:103], v[124:127], v[48:51]
    v_mfma_f32_16x16x32_bf16 v[52:55], v[100:103], v[128:131], v[52:55]
    s_waitcnt lgkmcnt(2)
    v_mfma_f32_16x16x32_bf16 v[56:59], v[104:107], v[112:115], v[56:59]
    v_mfma_f32_16x16x32_bf16 v[60:63], v[104:107], v[116:119], v[60:63]
    v_mfma_f32_16x16x32_bf16 v[64:67], v[104:107], v[120:123], v[64:67]
    v_mfma_f32_16x16x32_bf16 v[68:71], v[104:107], v[124:127], v[68:71]
    v_mfma_f32_16x16x32_bf16 v[72:75], v[104:107], v[128:131], v[72:75]
    s_waitcnt lgkmcnt(0)
    v_mfma_f32_16x16x32_bf16 v[76:79], v[108:111], v[112:115], v[76:79]
    v_mfma_f32_16x16x32_bf16 v[80:83], v[108:111], v[116:119], v[80:83]
    v_mfma_f32_16x16x32_bf16 v[84:87], v[108:111], v[120:123], v[84:87]
    v_mfma_f32_16x16x32_bf16 v[88:91], v[108:111], v[124:127], v[88:91]
    v_mfma_f32_16x16x32_bf16 v[92:95], v[108:111], v[128:131], v[92:95]
    s_waitcnt vmcnt(9)
    ds_read_b64_tr_b16 v[96:97], v9 offset:4096
    ds_read_b64_tr_b16 v[98:99], v9 offset:6144
    ds_read_b64_tr_b16 v[100:101], v10 offset:4096
    ds_read_b64_tr_b16 v[102:103], v10 offset:6144
    ds_read_b64_tr_b16 v[104:105], v11 offset:4096
    ds_read_b64_tr_b16 v[106:107], v11 offset:6144
    ds_read_b64_tr_b16 v[108:109], v12 offset:4096
    ds_read_b64_tr_b16 v[110:111], v12 offset:6144
    s_add_u32 m0, s36, 0
    s_add_u32 s41, s39, 124416
    buffer_load_dwordx4 v3, s[8:11], s41 offen lds
    s_add_u32 m0, s36, 1024
    s_add_u32 s41, s39, 3663360
    buffer_load_dwordx4 v3, s[8:11], s41 offen lds
    s_add_u32 m0, s36, 2048
    s_add_u32 s41, s39, 1893888
    buffer_load_dwordx4 v3, s[8:11], s41 offen lds
    s_add_u32 m0, s36, 3072
    s_add_u32 s41, s39, 5432832
    buffer_load_dwordx4 v3, s[8:11], s41 offen lds
    s_add_u32 s40, s40, 4096
    buffer_load_dwordx4 v[112:115], v4, s[12:15], s40 offen
    buffer_load_dwordx4 v[116:119], v5, s[12:15], s40 offen
    buffer_load_dwordx4 v[120:123], v6, s[12:15], s40 offen
    buffer_load_dwordx4 v[124:127], v7, s[12:15], s40 offen
    buffer_load_dwordx4 v[128:131], v8, s[12:15], s40 offen
    s_waitcnt lgkmcnt(6)
    v_mfma_f32_16x16x32_bf16 v[16:19], v[96:99], v[132:135], v[16:19]
    v_mfma_f32_16x16x32_bf16 v[20:23], v[96:99], v[136:139], v[20:23]
    v_mfma_f32_16x16x32_bf16 v[24:27], v[96:99], v[140:143], v[24:27]
    v_mfma_f32_16x16x32_bf16 v[28:31], v[96:99], v[144:147], v[28:31]
    v_mfma_f32_16x16x32_bf16 v[32:35], v[96:99], v[148:151], v[32:35]
    s_waitcnt lgkmcnt(4)
    v_mfma_f32_16x16x32_bf16 v[36:39], v[100:103], v[132:135], v[36:39]
    v_mfma_f32_16x16x32_bf16 v[40:43], v[100:103], v[136:139], v[40:43]
    v_mfma_f32_16x16x32_bf16 v[44:47], v[100:103], v[140:143], v[44:47]
    v_mfma_f32_16x16x32_bf16 v[48:51], v[100:103], v[144:147], v[48:51]
    v_mfma_f32_16x16x32_bf16 v[52:55], v[100:103], v[148:151], v[52:55]
    s_waitcnt lgkmcnt(2)
    v_mfma_f32_16x16x32_bf16 v[56:59], v[104:107], v[132:135], v[56:59]
    v_mfma_f32_16x16x32_bf16 v[60:63], v[104:107], v[136:139], v[60:63]
    v_mfma_f32_16x16x32_bf16 v[64:67], v[104:107], v[140:143], v[64:67]
    v_mfma_f32_16x16x32_bf16 v[68:71], v[104:107], v[144:147], v[68:71]
    v_mfma_f32_16x16x32_bf16 v[72:75], v[104:107], v[148:151], v[72:75]
    s_waitcnt lgkmcnt(0)
    v_mfma_f32_16x16x32_bf16 v[76:79], v[108:111], v[132:135], v[76:79]
    v_mfma_f32_16x16x32_bf16 v[80:83], v[108:111], v[136:139], v[80:83]
    v_mfma_f32_16x16x32_bf16 v[84:87], v[108:111], v[140:143], v[84:87]
    v_mfma_f32_16x16x32_bf16 v[88:91], v[108:111], v[144:147], v[88:91]
    v_mfma_f32_16x16x32_bf16 v[92:95], v[108:111], v[148:151], v[92:95]
    s_waitcnt vmcnt(9)
    ds_read_b64_tr_b16 v[96:97], v9 offset:8192
    ds_read_b64_tr_b16 v[98:99], v9 offset:10240
    ds_read_b64_tr_b16 v[100:101], v10 offset:8192
    ds_read_b64_tr_b16 v[102:103], v10 offset:10240
    ds_read_b64_tr_b16 v[104:105], v11 offset:8192
    ds_read_b64_tr_b16 v[106:107], v11 offset:10240
    ds_read_b64_tr_b16 v[108:109], v12 offset:8192
    ds_read_b64_tr_b16 v[110:111], v12 offset:10240
    s_add_u32 m0, s36, 4096
    s_add_u32 s41, s39, 138240
    buffer_load_dwordx4 v3, s[8:11], s41 offen lds
    s_add_u32 m0, s36, 5120
    s_add_u32 s41, s39, 3677184
    buffer_load_dwordx4 v3, s[8:11], s41 offen lds
    s_add_u32 m0, s36, 6144
    s_add_u32 s41, s39, 1907712
    buffer_load_dwordx4 v3, s[8:11], s41 offen lds
    s_add_u32 m0, s36, 7168
    s_add_u32 s41, s39, 5446656
    buffer_load_dwordx4 v3, s[8:11], s41 offen lds
    s_add_u32 s40, s40, 4096
    buffer_load_dwordx4 v[132:135], v4, s[12:15], s40 offen
    buffer_load_dwordx4 v[136:139], v5, s[12:15], s40 offen
    buffer_load_dwordx4 v[140:143], v6, s[12:15], s40 offen
    buffer_load_dwordx4 v[144:147], v7, s[12:15], s40 offen
    buffer_load_dwordx4 v[148:151], v8, s[12:15], s40 offen
    s_waitcnt lgkmcnt(6)
    v_mfma_f32_16x16x32_bf16 v[16:19], v[96:99], v[152:155], v[16:19]
    v_mfma_f32_16x16x32_bf16 v[20:23], v[96:99], v[156:159], v[20:23]
    v_mfma_f32_16x16x32_bf16 v[24:27], v[96:99], v[160:163], v[24:27]
    v_mfma_f32_16x16x32_bf16 v[28:31], v[96:99], v[164:167], v[28:31]
    v_mfma_f32_16x16x32_bf16 v[32:35], v[96:99], v[168:171], v[32:35]
    s_waitcnt lgkmcnt(4)
    v_mfma_f32_16x16x32_bf16 v[36:39], v[100:103], v[152:155], v[36:39]
    v_mfma_f32_16x16x32_bf16 v[40:43], v[100:103], v[156:159], v[40:43]
    v_mfma_f32_16x16x32_bf16 v[44:47], v[100:103], v[160:163], v[44:47]
    v_mfma_f32_16x16x32_bf16 v[48:51], v[100:103], v[164:167], v[48:51]
    v_mfma_f32_16x16x32_bf16 v[52:55], v[100:103], v[168:171], v[52:55]
    s_waitcnt lgkmcnt(2)
    v_mfma_f32_16x16x32_bf16 v[56:59], v[104:107], v[152:155], v[56:59]
    v_mfma_f32_16x16x32_bf16 v[60:63], v[104:107], v[156:159], v[60:63]
    v_mfma_f32_16x16x32_bf16 v[64:67], v[104:107], v[160:163], v[64:67]
    v_mfma_f32_16x16x32_bf16 v[68:71], v[104:107], v[164:167], v[68:71]
    v_mfma_f32_16x16x32_bf16 v[72:75], v[104:107], v[168:171], v[72:75]
    s_waitcnt lgkmcnt(0)
    v_mfma_f32_16x16x32_bf16 v[76:79], v[108:111], v[152:155], v[76:79]
    v_mfma_f32_16x16x32_bf16 v[80:83], v[108:111], v[156:159], v[80:83]
    v_mfma_f32_16x16x32_bf16 v[84:87], v[108:111], v[160:163], v[84:87]
    v_mfma_f32_16x16x32_bf16 v[88:91], v[108:111], v[164:167], v[88:91]
    v_mfma_f32_16x16x32_bf16 v[92:95], v[108:111], v[168:171], v[92:95]
    s_waitcnt vmcnt(9)
    ds_read_b64_tr_b16 v[96:97], v9 offset:0
    ds_read_b64_tr_b16 v[98:99], v9 offset:2048
    ds_read_b64_tr_b16 v[100:101], v10 offset:0
    ds_read_b64_tr_b16 v[102:103], v10 offset:2048
    ds_read_b64_tr_b16 v[104:105], v11 offset:0
    ds_read_b64_tr_b16 v[106:107], v11 offset:2048
    ds_read_b64_tr_b16 v[108:109], v12 offset:0
    ds_read_b64_tr_b16 v[110:111], v12 offset:2048
    s_add_u32 m0, s36, 8192
    s_add_u32 s41, s39, 152064
    buffer_load_dwordx4 v3, s[8:11], s41 offen lds
    s_add_u32 m0, s36, 9216
    s_add_u32 s41, s39, 3691008
    buffer_load_dwordx4 v3, s[8:11], s41 offen lds
    s_add_u32 m0, s36, 10240
    s_add_u32 s41, s39, 1921536
    buffer_load_dwordx4 v3, s[8:11], s41 offen lds
    s_add_u32 m0, s36, 11264
    s_add_u32 s41, s39, 5460480
    buffer_load_dwordx4 v3, s[8:11], s41 offen lds
    s_add_u32 s40, s40, 4096
    buffer_load_dwordx4 v[152:155], v4, s[12:15], s40 offen
    buffer_load_dwordx4 v[156:159], v5, s[12:15], s40 offen
    buffer_load_dwordx4 v[160:163], v6, s[12:15], s40 offen
    buffer_load_dwordx4 v[164:167], v7, s[12:15], s40 offen
    buffer_load_dwordx4 v[168:171], v8, s[12:15], s40 offen
    s_waitcnt lgkmcnt(6)
    v_mfma_f32_16x16x32_bf16 v[16:19], v[96:99], v[112:115], v[16:19]
    v_mfma_f32_16x16x32_bf16 v[20:23], v[96:99], v[116:119], v[20:23]
    v_mfma_f32_16x16x32_bf16 v[24:27], v[96:99], v[120:123], v[24:27]
    v_mfma_f32_16x16x32_bf16 v[28:31], v[96:99], v[124:127], v[28:31]
    v_mfma_f32_16x16x32_bf16 v[32:35], v[96:99], v[128:131], v[32:35]
    s_waitcnt lgkmcnt(4)
    v_mfma_f32_16x16x32_bf16 v[36:39], v[100:103], v[112:115], v[36:39]
    v_mfma_f32_16x16x32_bf16 v[40:43], v[100:103], v[116:119], v[40:43]
    v_mfma_f32_16x16x32_bf16 v[44:47], v[100:103], v[120:123], v[44:47]
    v_mfma_f32_16x16x32_bf16 v[48:51], v[100:103], v[124:127], v[48:51]
    v_mfma_f32_16x16x32_bf16 v[52:55], v[100:103], v[128:131], v[52:55]
    s_waitcnt lgkmcnt(2)
    v_mfma_f32_16x16x32_bf16 v[56:59], v[104:107], v[112:115], v[56:59]
    v_mfma_f32_16x16x32_bf16 v[60:63], v[104:107], v[116:119], v[60:63]
    v_mfma_f32_16x16x32_bf16 v[64:67], v[104:107], v[120:123], v[64:67]
    v_mfma_f32_16x16x32_bf16 v[68:71], v[104:107], v[124:127], v[68:71]
    v_mfma_f32_16x16x32_bf16 v[72:75], v[104:107], v[128:131], v[72:75]
    s_waitcnt lgkmcnt(0)
    v_mfma_f32_16x16x32_bf16 v[76:79], v[108:111], v[112:115], v[76:79]
    v_mfma_f32_16x16x32_bf16 v[80:83], v[108:111], v[116:119], v[80:83]
    v_mfma_f32_16x16x32_bf16 v[84:87], v[108:111], v[120:123], v[84:87]
    v_mfma_f32_16x16x32_bf16 v[88:91], v[108:111], v[124:127], v[88:91]
    v_mfma_f32_16x16x32_bf16 v[92:95], v[108:111], v[128:131], v[92:95]
    s_waitcnt vmcnt(9)
    ds_read_b64_tr_b16 v[96:97], v9 offset:4096
    ds_read_b64_tr_b16 v[98:99], v9 offset:6144
    ds_read_b64_tr_b16 v[100:101], v10 offset:4096
    ds_read_b64_tr_b16 v[102:103], v10 offset:6144
    ds_read_b64_tr_b16 v[104:105], v11 offset:4096
    ds_read_b64_tr_b16 v[106:107], v11 offset:6144
    ds_read_b64_tr_b16 v[108:109], v12 offset:4096
    ds_read_b64_tr_b16 v[110:111], v12 offset:6144
    s_add_u32 m0, s36, 0
    s_add_u32 s41, s39, 165888
    buffer_load_dwordx4 v3, s[8:11], s41 offen lds
    s_add_u32 m0, s36, 1024
    s_add_u32 s41, s39, 3704832
    buffer_load_dwordx4 v3, s[8:11], s41 offen lds
    s_add_u32 m0, s36, 2048
    s_add_u32 s41, s39, 1935360
    buffer_load_dwordx4 v3, s[8:11], s41 offen lds
    s_add_u32 m0, s36, 3072
    s_add_u32 s41, s39, 5474304
    buffer_load_dwordx4 v3, s[8:11], s41 offen lds
    s_add_u32 s40, s40, 4096
    buffer_load_dwordx4 v[112:115], v4, s[12:15], s40 offen
    buffer_load_dwordx4 v[116:119], v5, s[12:15], s40 offen
    buffer_load_dwordx4 v[120:123], v6, s[12:15], s40 offen
    buffer_load_dwordx4 v[124:127], v7, s[12:15], s40 offen
    buffer_load_dwordx4 v[128:131], v8, s[12:15], s40 offen
    s_waitcnt lgkmcnt(6)
    v_mfma_f32_16x16x32_bf16 v[16:19], v[96:99], v[132:135], v[16:19]
    v_mfma_f32_16x16x32_bf16 v[20:23], v[96:99], v[136:139], v[20:23]
    v_mfma_f32_16x16x32_bf16 v[24:27], v[96:99], v[140:143], v[24:27]
    v_mfma_f32_16x16x32_bf16 v[28:31], v[96:99], v[144:147], v[28:31]
    v_mfma_f32_16x16x32_bf16 v[32:35], v[96:99], v[148:151], v[32:35]
    s_waitcnt lgkmcnt(4)
    v_mfma_f32_16x16x32_bf16 v[36:39], v[100:103], v[132:135], v[36:39]
    v_mfma_f32_16x16x32_bf16 v[40:43], v[100:103], v[136:139], v[40:43]
    v_mfma_f32_16x16x32_bf16 v[44:47], v[100:103], v[140:143], v[44:47]
    v_mfma_f32_16x16x32_bf16 v[48:51], v[100:103], v[144:147], v[48:51]
    v_mfma_f32_16x16x32_bf16 v[52:55], v[100:103], v[148:151], v[52:55]
    s_waitcnt lgkmcnt(2)
    v_mfma_f32_16x16x32_bf16 v[56:59], v[104:107], v[132:135], v[56:59]
    v_mfma_f32_16x16x32_bf16 v[60:63], v[104:107], v[136:139], v[60:63]
    v_mfma_f32_16x16x32_bf16 v[64:67], v[104:107], v[140:143], v[64:67]
    v_mfma_f32_16x16x32_bf16 v[68:71], v[104:107], v[144:147], v[68:71]
    v_mfma_f32_16x16x32_bf16 v[72:75], v[104:107], v[148:151], v[72:75]
    s_waitcnt lgkmcnt(0)
    v_mfma_f32_16x16x32_bf16 v[76:79], v[108:111], v[132:135], v[76:79]
    v_mfma_f32_16x16x32_bf16 v[80:83], v[108:111], v[136:139], v[80:83]
    v_mfma_f32_16x16x32_bf16 v[84:87], v[108:111], v[140:143], v[84:87]
    v_mfma_f32_16x16x32_bf16 v[88:91], v[108:111], v[144:147], v[88:91]
    v_mfma_f32_16x16x32_bf16 v[92:95], v[108:111], v[148:151], v[92:95]
    s_waitcnt vmcnt(9)
    ds_read_b64_tr_b16 v[96:97], v9 offset:8192
    ds_read_b64_tr_b16 v[98:99], v9 offset:10240
    ds_read_b64_tr_b16 v[100:101], v10 offset:8192
    ds_read_b64_tr_b16 v[102:103], v10 offset:10240
    ds_read_b64_tr_b16 v[104:105], v11 offset:8192
    ds_read_b64_tr_b16 v[106:107], v11 offset:10240
    ds_read_b64_tr_b16 v[108:109], v12 offset:8192
    ds_read_b64_tr_b16 v[110:111], v12 offset:10240
    s_add_u32 m0, s36, 4096
    s_add_u32 s41, s39, 179712
    buffer_load_dwordx4 v3, s[8:11], s41 offen lds
    s_add_u32 m0, s36, 5120
    s_add_u32 s41, s39, 3718656
    buffer_load_dwordx4 v3, s[8:11], s41 offen lds
    s_add_u32 m0, s36, 6144
    s_add_u32 s41, s39, 1949184
    buffer_load_dwordx4 v3, s[8:11], s41 offen lds
    s_add_u32 m0, s36, 7168
    s_add_u32 s41, s39, 5488128
    buffer_load_dwordx4 v3, s[8:11], s41 offen lds
    s_add_u32 s40, s40, 4096
    buffer_load_dwordx4 v[132:135], v4, s[12:15], s40 offen
    buffer_load_dwordx4 v[136:139], v5, s[12:15], s40 offen
    buffer_load_dwordx4 v[140:143], v6, s[12:15], s40 offen
    buffer_load_dwordx4 v[144:147], v7, s[12:15], s40 offen
    buffer_load_dwordx4 v[148:151], v8, s[12:15], s40 offen
    s_waitcnt lgkmcnt(6)
    v_mfma_f32_16x16x32_bf16 v[16:19], v[96:99], v[152:155], v[16:19]
    v_mfma_f32_16x16x32_bf16 v[20:23], v[96:99], v[156:159], v[20:23]
    v_mfma_f32_16x16x32_bf16 v[24:27], v[96:99], v[160:163], v[24:27]
    v_mfma_f32_16x16x32_bf16 v[28:31], v[96:99], v[164:167], v[28:31]
    v_mfma_f32_16x16x32_bf16 v[32:35], v[96:99], v[168:171], v[32:35]
    s_waitcnt lgkmcnt(4)
    v_mfma_f32_16x16x32_bf16 v[36:39], v[100:103], v[152:155], v[36:39]
    v_mfma_f32_16x16x32_bf16 v[40:43], v[100:103], v[156:159], v[40:43]
    v_mfma_f32_16x16x32_bf16 v[44:47], v[100:103], v[160:163], v[44:47]
    v_mfma_f32_16x16x32_bf16 v[48:51], v[100:103], v[164:167], v[48:51]
    v_mfma_f32_16x16x32_bf16 v[52:55], v[100:103], v[168:171], v[52:55]
    s_waitcnt lgkmcnt(2)
    v_mfma_f32_16x16x32_bf16 v[56:59], v[104:107], v[152:155], v[56:59]
    v_mfma_f32_16x16x32_bf16 v[60:63], v[104:107], v[156:159], v[60:63]
    v_mfma_f32_16x16x32_bf16 v[64:67], v[104:107], v[160:163], v[64:67]
    v_mfma_f32_16x16x32_bf16 v[68:71], v[104:107], v[164:167], v[68:71]
    v_mfma_f32_16x16x32_bf16 v[72:75], v[104:107], v[168:171], v[72:75]
    s_waitcnt lgkmcnt(0)
    v_mfma_f32_16x16x32_bf16 v[76:79], v[108:111], v[152:155], v[76:79]
    v_mfma_f32_16x16x32_bf16 v[80:83], v[108:111], v[156:159], v[80:83]
    v_mfma_f32_16x16x32_bf16 v[84:87], v[108:111], v[160:163], v[84:87]
    v_mfma_f32_16x16x32_bf16 v[88:91], v[108:111], v[164:167], v[88:91]
    v_mfma_f32_16x16x32_bf16 v[92:95], v[108:111], v[168:171], v[92:95]
    s_waitcnt vmcnt(9)
    ds_read_b64_tr_b16 v[96:97], v9 offset:0
    ds_read_b64_tr_b16 v[98:99], v9 offset:2048
    ds_read_b64_tr_b16 v[100:101], v10 offset:0
    ds_read_b64_tr_b16 v[102:103], v10 offset:2048
    ds_read_b64_tr_b16 v[104:105], v11 offset:0
    ds_read_b64_tr_b16 v[106:107], v11 offset:2048
    ds_read_b64_tr_b16 v[108:109], v12 offset:0
    ds_read_b64_tr_b16 v[110:111], v12 offset:2048
    s_add_u32 m0, s36, 8192
    s_add_u32 s41, s39, 193536
    buffer_load_dwordx4 v3, s[8:11], s41 offen lds
    s_add_u32 m0, s36, 9216
    s_add_u32 s41, s39, 3732480
    buffer_load_dwordx4 v3, s[8:11], s41 offen lds
    s_add_u32 m0, s36, 10240
    s_add_u32 s41, s39, 1963008
    buffer_load_dwordx4 v3, s[8:11], s41 offen lds
    s_add_u32 m0, s36, 11264
    s_add_u32 s41, s39, 5501952
    buffer_load_dwordx4 v3, s[8:11], s41 offen lds
    s_add_u32 s40, s40, 4096
    buffer_load_dwordx4 v[152:155], v4, s[12:15], s40 offen
    buffer_load_dwordx4 v[156:159], v5, s[12:15], s40 offen
    buffer_load_dwordx4 v[160:163], v6, s[12:15], s40 offen
    buffer_load_dwordx4 v[164:167], v7, s[12:15], s40 offen
    buffer_load_dwordx4 v[168:171], v8, s[12:15], s40 offen
    s_waitcnt lgkmcnt(6)
    v_mfma_f32_16x16x32_bf16 v[16:19], v[96:99], v[112:115], v[16:19]
    v_mfma_f32_16x16x32_bf16 v[20:23], v[96:99], v[116:119], v[20:23]
    v_mfma_f32_16x16x32_bf16 v[24:27], v[96:99], v[120:123], v[24:27]
    v_mfma_f32_16x16x32_bf16 v[28:31], v[96:99], v[124:127], v[28:31]
    v_mfma_f32_16x16x32_bf16 v[32:35], v[96:99], v[128:131], v[32:35]
    s_waitcnt lgkmcnt(4)
    v_mfma_f32_16x16x32_bf16 v[36:39], v[100:103], v[112:115], v[36:39]
    v_mfma_f32_16x16x32_bf16 v[40:43], v[100:103], v[116:119], v[40:43]
    v_mfma_f32_16x16x32_bf16 v[44:47], v[100:103], v[120:123], v[44:47]
    v_mfma_f32_16x16x32_bf16 v[48:51], v[100:103], v[124:127], v[48:51]
    v_mfma_f32_16x16x32_bf16 v[52:55], v[100:103], v[128:131], v[52:55]
    s_waitcnt lgkmcnt(2)
    v_mfma_f32_16x16x32_bf16 v[56:59], v[104:107], v[112:115], v[56:59]
    v_mfma_f32_16x16x32_bf16 v[60:63], v[104:107], v[116:119], v[60:63]
    v_mfma_f32_16x16x32_bf16 v[64:67], v[104:107], v[120:123], v[64:67]
    v_mfma_f32_16x16x32_bf16 v[68:71], v[104:107], v[124:127], v[68:71]
    v_mfma_f32_16x16x32_bf16 v[72:75], v[104:107], v[128:131], v[72:75]
    s_waitcnt lgkmcnt(0)
    v_mfma_f32_16x16x32_bf16 v[76:79], v[108:111], v[112:115], v[76:79]
    v_mfma_f32_16x16x32_bf16 v[80:83], v[108:111], v[116:119], v[80:83]
    v_mfma_f32_16x16x32_bf16 v[84:87], v[108:111], v[120:123], v[84:87]
    v_mfma_f32_16x16x32_bf16 v[88:91], v[108:111], v[124:127], v[88:91]
    v_mfma_f32_16x16x32_bf16 v[92:95], v[108:111], v[128:131], v[92:95]
    s_waitcnt vmcnt(9)
    ds_read_b64_tr_b16 v[96:97], v9 offset:4096
    ds_read_b64_tr_b16 v[98:99], v9 offset:6144
    ds_read_b64_tr_b16 v[100:101], v10 offset:4096
    ds_read_b64_tr_b16 v[102:103], v10 offset:6144
    ds_read_b64_tr_b16 v[104:105], v11 offset:4096
    ds_read_b64_tr_b16 v[106:107], v11 offset:6144
    ds_read_b64_tr_b16 v[108:109], v12 offset:4096
    ds_read_b64_tr_b16 v[110:111], v12 offset:6144
    s_add_u32 m0, s36, 0
    s_add_u32 s41, s39, 207360
    buffer_load_dwordx4 v3, s[8:11], s41 offen lds
    s_add_u32 m0, s36, 1024
    s_add_u32 s41, s39, 3746304
    buffer_load_dwordx4 v3, s[8:11], s41 offen lds
    s_add_u32 m0, s36, 2048
    s_add_u32 s41, s39, 1976832
    buffer_load_dwordx4 v3, s[8:11], s41 offen lds
    s_add_u32 m0, s36, 3072
    s_add_u32 s41, s39, 5515776
    buffer_load_dwordx4 v3, s[8:11], s41 offen lds
    s_add_u32 s40, s40, 4096
    buffer_load_dwordx4 v[112:115], v4, s[12:15], s40 offen
    buffer_load_dwordx4 v[116:119], v5, s[12:15], s40 offen
    buffer_load_dwordx4 v[120:123], v6, s[12:15], s40 offen
    buffer_load_dwordx4 v[124:127], v7, s[12:15], s40 offen
    buffer_load_dwordx4 v[128:131], v8, s[12:15], s40 offen
    s_cmp_eq_u32 s34, 215
    s_cbranch_scc1 K2_NOBX
    s_barrier
K2_NOBX:
    s_waitcnt lgkmcnt(6)
    v_mfma_f32_16x16x32_bf16 v[16:19], v[96:99], v[132:135], v[16:19]
    v_mfma_f32_16x16x32_bf16 v[20:23], v[96:99], v[136:139], v[20:23]
    v_mfma_f32_16x16x32_bf16 v[24:27], v[96:99], v[140:143], v[24:27]
    v_mfma_f32_16x16x32_bf16 v[28:31], v[96:99], v[144:147], v[28:31]
    v_mfma_f32_16x16x32_bf16 v[32:35], v[96:99], v[148:151], v[32:35]
    s_waitcnt lgkmcnt(4)
    v_mfma_f32_16x16x32_bf16 v[36:39], v[100:103], v[132:135], v[36:39]
    v_mfma_f32_16x16x32_bf16 v[40:43], v[100:103], v[136:139], v[40:43]
    v_mfma_f32_16x16x32_bf16 v[44:47], v[100:103], v[140:143], v[44:47]
    v_mfma_f32_16x16x32_bf16 v[48:51], v[100:103], v[144:147], v[48:51]
    v_mfma_f32_16x16x32_bf16 v[52:55], v[100:103], v[148:151], v[52:55]
    s_waitcnt lgkmcnt(2)
    v_mfma_f32_16x16x32_bf16 v[56:59], v[104:107], v[132:135], v[56:59]
    v_mfma_f32_16x16x32_bf16 v[60:63], v[104:107], v[136:139], v[60:63]
    v_mfma_f32_16x16x32_bf16 v[64:67], v[104:107], v[140:143], v[64:67]
    v_mfma_f32_16x16x32_bf16 v[68:71], v[104:107], v[144:147], v[68:71]
    v_mfma_f32_16x16x32_bf16 v[72:75], v[104:107], v[148:151], v[72:75]
    s_waitcnt lgkmcnt(0)
    v_mfma_f32_16x16x32_bf16 v[76:79], v[108:111], v[132:135], v[76:79]
    v_mfma_f32_16x16x32_bf16 v[80:83], v[108:111], v[136:139], v[80:83]
    v_mfma_f32_16x16x32_bf16 v[84:87], v[108:111], v[140:143], v[84:87]
    v_mfma_f32_16x16x32_bf16 v[88:91], v[108:111], v[144:147], v[88:91]
    v_mfma_f32_16x16x32_bf16 v[92:95], v[108:111], v[148:151], v[92:95]
    s_waitcnt vmcnt(9)
    ds_read_b64_tr_b16 v[96:97], v9 offset:8192
    ds_read_b64_tr_b16 v[98:99], v9 offset:10240
    ds_read_b64_tr_b16 v[100:101], v10 offset:8192
    ds_read_b64_tr_b16 v[102:103], v10 offset:10240
    ds_read_b64_tr_b16 v[104:105], v11 offset:8192
    ds_read_b64_tr_b16 v[106:107], v11 offset:10240
    ds_read_b64_tr_b16 v[108:109], v12 offset:8192
    ds_read_b64_tr_b16 v[110:111], v12 offset:10240
    s_waitcnt lgkmcnt(6)
    v_mfma_f32_16x16x32_bf16 v[16:19], v[96:99], v[152:155], v[16:19]
    v_mfma_f32_16x16x32_bf16 v[20:23], v[96:99], v[156:159], v[20:23]
    v_mfma_f32_16x16x32_bf16 v[24:27], v[96:99], v[160:163], v[24:27]
    v_mfma_f32_16x16x32_bf16 v[28:31], v[96:99], v[164:167], v[28:31]
    v_mfma_f32_16x16x32_bf16 v[32:35], v[96:99], v[168:171], v[32:35]
    s_waitcnt lgkmcnt(4)
    v_mfma_f32_16x16x32_bf16 v[36:39], v[100:103], v[152:155], v[36:39]
    v_mfma_f32_16x16x32_bf16 v[40:43], v[100:103], v[156:159], v[40:43]
    v_mfma_f32_16x16x32_bf16 v[44:47], v[100:103], v[160:163], v[44:47]
    v_mfma_f32_16x16x32_bf16 v[48:51], v[100:103], v[164:167], v[48:51]
    v_mfma_f32_16x16x32_bf16 v[52:55], v[100:103], v[168:171], v[52:55]
    s_waitcnt lgkmcnt(2)
    v_mfma_f32_16x16x32_bf16 v[56:59], v[104:107], v[152:155], v[56:59]
    v_mfma_f32_16x16x32_bf16 v[60:63], v[104:107], v[156:159], v[60:63]
    v_mfma_f32_16x16x32_bf16 v[64:67], v[104:107], v[160:163], v[64:67]
    v_mfma_f32_16x16x32_bf16 v[68:71], v[104:107], v[164:167], v[68:71]
    v_mfma_f32_16x16x32_bf16 v[72:75], v[104:107], v[168:171], v[72:75]
    s_waitcnt lgkmcnt(0)
    v_mfma_f32_16x16x32_bf16 v[76:79], v[108:111], v[152:155], v[76:79]
    v_mfma_f32_16x16x32_bf16 v[80:83], v[108:111], v[156:159], v[80:83]
    v_mfma_f32_16x16x32_bf16 v[84:87], v[108:111], v[160:163], v[84:87]
    v_mfma_f32_16x16x32_bf16 v[88:91], v[108:111], v[164:167], v[88:91]
    v_mfma_f32_16x16x32_bf16 v[92:95], v[108:111], v[168:171], v[92:95]
    s_waitcnt vmcnt(0)
    ds_read_b64_tr_b16 v[96:97], v9 offset:0
    ds_read_b64_tr_b16 v[98:99], v9 offset:2048
    ds_read_b64_tr_b16 v[100:101], v10 offset:0
    ds_read_b64_tr_b16 v[102:103], v10 offset:2048
    ds_read_b64_tr_b16 v[104:105], v11 offset:0
    ds_read_b64_tr_b16 v[106:107], v11 offset:2048
    ds_read_b64_tr_b16 v[108:109], v12 offset:0
    ds_read_b64_tr_b16 v[110:111], v12 offset:2048
    s_waitcnt lgkmcnt(6)
    v_mfma_f32_16x16x32_bf16 v[16:19], v[96:99], v[112:115], v[16:19]
    v_mfma_f32_16x16x32_bf16 v[20:23], v[96:99], v[116:119], v[20:23]
    v_mfma_f32_16x16x32_bf16 v[24:27], v[96:99], v[120:123], v[24:27]
    v_mfma_f32_16x16x32_bf16 v[28:31], v[96:99], v[124:127], v[28:31]
    v_mfma_f32_16x16x32_bf16 v[32:35], v[96:99], v[128:131], v[32:35]
    s_waitcnt lgkmcnt(4)
    v_mfma_f32_16x16x32_bf16 v[36:39], v[100:103], v[112:115], v[36:39]
    v_mfma_f32_16x16x32_bf16 v[40:43], v[100:103], v[116:119], v[40:43]
    v_mfma_f32_16x16x32_bf16 v[44:47], v[100:103], v[120:123], v[44:47]
    v_mfma_f32_16x16x32_bf16 v[48:51], v[100:103], v[124:127], v[48:51]
    v_mfma_f32_16x16x32_bf16 v[52:55], v[100:103], v[128:131], v[52:55]
    s_waitcnt lgkmcnt(2)
    v_mfma_f32_16x16x32_bf16 v[56:59], v[104:107], v[112:115], v[56:59]
    v_mfma_f32_16x16x32_bf16 v[60:63], v[104:107], v[116:119], v[60:63]
    v_mfma_f32_16x16x32_bf16 v[64:67], v[104:107], v[120:123], v[64:67]
    v_mfma_f32_16x16x32_bf16 v[68:71], v[104:107], v[124:127], v[68:71]
    v_mfma_f32_16x16x32_bf16 v[72:75], v[104:107], v[128:131], v[72:75]
    s_waitcnt lgkmcnt(0)
    v_mfma_f32_16x16x32_bf16 v[76:79], v[108:111], v[112:115], v[76:79]
    v_mfma_f32_16x16x32_bf16 v[80:83], v[108:111], v[116:119], v[80:83]
    v_mfma_f32_16x16x32_bf16 v[84:87], v[108:111], v[120:123], v[84:87]
    v_mfma_f32_16x16x32_bf16 v[88:91], v[108:111], v[124:127], v[88:91]
    v_mfma_f32_16x16x32_bf16 v[92:95], v[108:111], v[128:131], v[92:95]
    v_lshlrev_b32 v1, 4, v2
    v_add_u32 v1, s36, v1
    s_nop 7
    ds_write_b128 v1, v[16:19] offset:0
    ds_write_b128 v1, v[20:23] offset:1024
    ds_write_b128 v1, v[24:27] offset:2048
    ds_write_b128 v1, v[28:31] offset:3072
    ds_write_b128 v1, v[32:35] offset:4096
    ds_write_b128 v1, v[36:39] offset:5120
    ds_write_b128 v1, v[40:43] offset:6144
    ds_write_b128 v1, v[44:47] offset:7168
    ds_write_b128 v1, v[48:51] offset:8192
    ds_write_b128 v1, v[52:55] offset:9216
    ds_write_b128 v1, v[56:59] offset:10240
    ds_write_b128 v1, v[60:63] offset:11264
    ds_write_b128 v1, v[64:67] offset:12288
    ds_write_b128 v1, v[68:71] offset:13312
    ds_write_b128 v1, v[72:75] offset:14336
    ds_write_b128 v1, v[76:79] offset:15360
    ds_write_b128 v1, v[80:83] offset:16384
    ds_write_b128 v1, v[84:87] offset:17408
    ds_write_b128 v1, v[88:91] offset:18432
    ds_write_b128 v1, v[92:95] offset:19456
    s_branch K2_EPI
K2_GGEN0:
    s_waitcnt lgkmcnt(0)
    s_mov_b32 s12, s28
    s_and_b32 s13, s29, 0xffff
    s_mov_b32 s14, 13414400
    s_mov_b32 s15, 0x20000
    s_mov_b32 s8, s4
    s_and_b32 s9, s5, 0xffff
    s_mov_b32 s10, 7077888
    s_mov_b32 s11, 0x20000
    s_getpc_b64 s[30:31]
    s_add_u32 s30, s30, table2@rel32@lo+4
    s_addc_u32 s31, s31, table2@rel32@hi+12
    s_mov_b32 s16, s6
    s_and_b32 s17, s7, 0xffff
    s_mov_b32 s18, 3456
    s_mov_b32 s19, 0x20000
    s_mov_b32 s68, s62
    s_and_b32 s69, s63, 0xffff
    s_mov_b32 s70, 7077888
    s_mov_b32 s71, 0x20000
K2_GGEN:
    s_cmp_eq_u32 s34, 215
    s_cbranch_scc0 K2_GG2
    s_cmp_eq_u32 s24, 4
    s_cbranch_scc1 K2_FFT_SPECIAL
K2_GG2:
    s_lshl_b32 s36, s34, 2
    s_add_u32 s36, s36, s24
    s_sub_u32 s36, s36, 4
    s_cmp_ge_u32 s36, 480
    s_cbranch_scc1 K2_SPF
    s_mul_hi_u32 s37, s36, 71582789
    s_mul_i32 s38, s37, 60
    s_sub_u32 s38, s36, s38
    s_mul_i32 s39, s38, 52429
    s_lshr_b32 s39, s39, 20
    s_mul_i32 s40, s39, 20
    s_sub_u32 s38, s38, s40
    v_and_b32 v3, 15, v2
    s_cmp_eq_u32 s39, 2
    s_cselect_b32 s40, 7, 15
    v_and_b32 v3, s40, v3
    s_mul_i32 s40, s37, 40
    s_lshl_b32 s41, s39, 4
    s_add_u32 s40, s40, s41
    v_add_u32 v3, s40, v3
    v_lshrrev_b32 v4, 4, v2
    v_lshlrev_b32 v4, 2, v4
    s_lshl_b32 s39, s38, 5
    v_add_u32 v4, s39, v4
    s_cmp_ge_u32 s38, 10
    s_cselect_b32 s42, 319, 0
    s_mov_b32 s40, 52429
    s_movk_i32 s41, 640
    v_add_u32 v5, 0, v4
    v_and_b32 v7, 1, v5
    v_sub_u32 v6, v5, v7
    v_subrev_u32 v6, s42, v6
    v_cmp_eq_u32 vcc, 1, v5
    v_mov_b32 v8, 320
    v_cvt_f32_u32 v7, v7
    v_cndmask_b32 v6, v6, v8, vcc
    v_cndmask_b32_e64 v7, v7, 0, vcc
    v_mul_u32_u24 v6, v6, v3
    v_lshrrev_b32 v8, 7, v6
    v_mul_u32_u24 v8, s40, v8
    v_lshrrev_b32 v8, 18, v8
    v_mul_u32_u24 v8, s41, v8
    v_sub_u32 v6, v6, v8
    v_cvt_f32_u32 v6, v6
    v_mul_f32 v7, 0x3e800000, v7
    v_mul_f32 v6, 0x3acccccd, v6
    v_add_f32 v6, v6, v7
    v_cos_f32 v6, v6
    v_cmp_gt_u32 vcc, 2, v5
    v_mov_b32 v8, 0x37000000
    v_mov_b32 v9, 0x36800000
    v_cndmask_b32 v8, v8, v9, vcc
    v_mul_f32 v16, v6, v8
    v_add_u32 v5, 1, v4
    v_and_b32 v7, 1, v5
    v_sub_u32 v6, v5, v7
    v_subrev_u32 v6, s42, v6
    v_cmp_eq_u32 vcc, 1, v5
    v_mov_b32 v8, 320
    v_cvt_f32_u32 v7, v7
    v_cndmask_b32 v6, v6, v8, vcc
    v_cndmask_b32_e64 v7, v7, 0, vcc
    v_mul_u32_u24 v6, v6, v3
    v_lshrrev_b32 v8, 7, v6
    v_mul_u32_u24 v8, s40, v8
    v_lshrrev_b32 v8, 18, v8
    v_mul_u32_u24 v8, s41, v8
    v_sub_u32 v6, v6, v8
    v_cvt_f32_u32 v6, v6
    v_mul_f32 v7, 0x3e800000, v7
    v_mul_f32 v6, 0x3acccccd, v6
    v_add_f32 v6, v6, v7
    v_cos_f32 v6, v6
    v_cmp_gt_u32 vcc, 2, v5
    v_mov_b32 v8, 0x37000000
    v_mov_b32 v9, 0x36800000
    v_cndmask_b32 v8, v8, v9, vcc
    v_mul_f32 v17, v6, v8
    v_add_u32 v5, 2, v4
    v_and_b32 v7, 1, v5
    v_sub_u32 v6, v5, v7
    v_subrev_u32 v6, s42, v6
    v_cmp_eq_u32 vcc, 1, v5
    v_mov_b32 v8, 320
    v_cvt_f32_u32 v7, v7
    v_cndmask_b32 v6, v6, v8, vcc
    v_cndmask_b32_e64 v7, v7, 0, vcc
    v_mul_u32_u24 v6, v6, v3
    v_lshrrev_b32 v8, 7, v6
    v_mul_u32_u24 v8, s40, v8
    v_lshrrev_b32 v8, 18, v8
    v_mul_u32_u24 v8, s41, v8
    v_sub_u32 v6, v6, v8
    v_cvt_f32_u32 v6, v6
    v_mul_f32 v7, 0x3e800000, v7
    v_mul_f32 v6, 0x3acccccd, v6
    v_add_f32 v6, v6, v7
    v_cos_f32 v6, v6
    v_cmp_gt_u32 vcc, 2, v5
    v_mov_b32 v8, 0x37000000
    v_mov_b32 v9, 0x36800000
    v_cndmask_b32 v8, v8, v9, vcc
    v_mul_f32 v18, v6, v8
    v_add_u32 v5, 3, v4
    v_and_b32 v7, 1, v5
    v_sub_u32 v6, v5, v7
    v_subrev_u32 v6, s42, v6
    v_cmp_eq_u32 vcc, 1, v5
    v_mov_b32 v8, 320
    v_cvt_f32_u32 v7, v7
    v_cndmask_b32 v6, v6, v8, vcc
    v_cndmask_b32_e64 v7, v7, 0, vcc
    v_mul_u32_u24 v6, v6, v3
    v_lshrrev_b32 v8, 7, v6
    v_mul_u32_u24 v8, s40, v8
    v_lshrrev_b32 v8, 18, v8
    v_mul_u32_u24 v8, s41, v8
    v_sub_u32 v6, v6, v8
    v_cvt_f32_u32 v6, v6
    v_mul_f32 v7, 0x3e800000, v7
    v_mul_f32 v6, 0x3acccccd, v6
    v_add_f32 v6, v6, v7
    v_cos_f32 v6, v6
    v_cmp_gt_u32 vcc, 2, v5
    v_mov_b32 v8, 0x37000000
    v_mov_b32 v9, 0x36800000
    v_cndmask_b32 v8, v8, v9, vcc
    v_mul_f32 v19, v6, v8
    v_add_u32 v5, 16, v4
    v_and_b32 v7, 1, v5
    v_sub_u32 v6, v5, v7
    v_subrev_u32 v6, s42, v6
    v_cmp_eq_u32 vcc, 1, v5
    v_mov_b32 v8, 320
    v_cvt_f32_u32 v7, v7
    v_cndmask_b32 v6, v6, v8, vcc
    v_cndmask_b32_e64 v7, v7, 0, vcc
    v_mul_u32_u24 v6, v6, v3
    v_lshrrev_b32 v8, 7, v6
    v_mul_u32_u24 v8, s40, v8
    v_lshrrev_b32 v8, 18, v8
    v_mul_u32_u24 v8, s41, v8
    v_sub_u32 v6, v6, v8
    v_cvt_f32_u32 v6, v6
    v_mul_f32 v7, 0x3e800000, v7
    v_mul_f32 v6, 0x3acccccd, v6
    v_add_f32 v6, v6, v7
    v_cos_f32 v6, v6
    v_cmp_gt_u32 vcc, 2, v5
    v_mov_b32 v8, 0x37000000
    v_mov_b32 v9, 0x36800000
    v_cndmask_b32 v8, v8, v9, vcc
    v_mul_f32 v20, v6, v8
    v_add_u32 v5, 17, v4
    v_and_b32 v7, 1, v5
    v_sub_u32 v6, v5, v7
    v_subrev_u32 v6, s42, v6
    v_cmp_eq_u32 vcc, 1, v5
    v_mov_b32 v8, 320
    v_cvt_f32_u32 v7, v7
    v_cndmask_b32 v6, v6, v8, vcc
    v_cndmask_b32_e64 v7, v7, 0, vcc
    v_mul_u32_u24 v6, v6, v3
    v_lshrrev_b32 v8, 7, v6
    v_mul_u32_u24 v8, s40, v8
    v_lshrrev_b32 v8, 18, v8
    v_mul_u32_u24 v8, s41, v8
    v_sub_u32 v6, v6, v8
    v_cvt_f32_u32 v6, v6
    v_mul_f32 v7, 0x3e800000, v7
    v_mul_f32 v6, 0x3acccccd, v6
    v_add_f32 v6, v6, v7
    v_cos_f32 v6, v6
    v_cmp_gt_u32 vcc, 2, v5
    v_mov_b32 v8, 0x37000000
    v_mov_b32 v9, 0x36800000
    v_cndmask_b32 v8, v8, v9, vcc
    v_mul_f32 v21, v6, v8
    v_add_u32 v5, 18, v4
    v_and_b32 v7, 1, v5
    v_sub_u32 v6, v5, v7
    v_subrev_u32 v6, s42, v6
    v_cmp_eq_u32 vcc, 1, v5
    v_mov_b32 v8, 320
    v_cvt_f32_u32 v7, v7
    v_cndmask_b32 v6, v6, v8, vcc
    v_cndmask_b32_e64 v7, v7, 0, vcc
    v_mul_u32_u24 v6, v6, v3
    v_lshrrev_b32 v8, 7, v6
    v_mul_u32_u24 v8, s40, v8
    v_lshrrev_b32 v8, 18, v8
    v_mul_u32_u24 v8, s41, v8
    v_sub_u32 v6, v6, v8
    v_cvt_f32_u32 v6, v6
    v_mul_f32 v7, 0x3e800000, v7
    v_mul_f32 v6, 0x3acccccd, v6
    v_add_f32 v6, v6, v7
    v_cos_f32 v6, v6
    v_cmp_gt_u32 vcc, 2, v5
    v_mov_b32 v8, 0x37000000
    v_mov_b32 v9, 0x36800000
    v_cndmask_b32 v8, v8, v9, vcc
    v_mul_f32 v22, v6, v8
    v_add_u32 v5, 19, v4
    v_and_b32 v7, 1, v5
    v_sub_u32 v6, v5, v7
    v_subrev_u32 v6, s42, v6
    v_cmp_eq_u32 vcc, 1, v5
    v_mov_b32 v8, 320
    v_cvt_f32_u32 v7, v7
    v_cndmask_b32 v6, v6, v8, vcc
    v_cndmask_b32_e64 v7, v7, 0, vcc
    v_mul_u32_u24 v6, v6, v3
    v_lshrrev_b32 v8, 7, v6
    v_mul_u32_u24 v8, s40, v8
    v_lshrrev_b32 v8, 18, v8
    v_mul_u32_u24 v8, s41, v8
    v_sub_u32 v6, v6, v8
    v_cvt_f32_u32 v6, v6
    v_mul_f32 v7, 0x3e800000, v7
    v_mul_f32 v6, 0x3acccccd, v6
    v_add_f32 v6, v6, v7
    v_cos_f32 v6, v6
    v_cmp_gt_u32 vcc, 2, v5
    v_mov_b32 v8, 0x37000000
    v_mov_b32 v9, 0x36800000
    v_cndmask_b32 v8, v8, v9, vcc
    v_mul_f32 v23, v6, v8
    v_cvt_pk_bf16_f32 v24, v16, v17
    v_cvt_pk_bf16_f32 v25, v18, v19
    v_cvt_pk_bf16_f32 v26, v20, v21
    v_cvt_pk_bf16_f32 v27, v22, v23
    v_lshlrev_b32 v1, 4, v2
    s_lshl_b32 s36, s36, 10
    s_add_u32 s36, s36, 12910592
    buffer_store_dwordx4 v[24:27], v1, s[12:15], s36 offen sc1
K2_SPF:
    s_cmp_eq_u32 s34, 215
    s_cbranch_scc1 K2_EPI_S
    s_barrier
    v_lshrrev_b32 v100, 5, v2
    v_lshlrev_b32 v100, 12, v100
    v_and_b32 v101, 31, v2
    v_lshl_add_u32 v100, v101, 4, v100
    s_mov_b32 m0, 122880
    s_lshl_b32 s59, s26, 2
    s_add_u32 s59, s59, s24
    s_sub_u32 s59, s59, 4
    s_add_u32 s59, s59, 320
    s_lshl_b32 s59, s59, 13
    s_lshl_b32 s60, s25, 9
    s_add_u32 s59, s59, s60
    v_lshrrev_b32 v250, 4, v2
    v_lshlrev_b32 v250, 3, v250
    s_lshl_b32 s61, s33, 7
    s_add_u32 s46, s24, 0
    s_cmp_ge_u32 s46, 5
    s_cselect_b32 s47, 1, 0
    s_mul_i32 s48, s47, 5
    s_sub_u32 s48, s46, s48
    s_lshl_b32 s49, s47, 6
    s_add_u32 s49, s49, s61
    buffer_load_dwordx2 v[240:241], v250, s[16:19], s49 offen
    buffer_load_dwordx2 v[242:243], v250, s[16:19], s49 offen offset:32
    s_mul_i32 s46, s47, 10
    s_add_u32 s46, s46, s48
    s_lshl_b32 s52, s46, 10
    s_mul_i32 s50, s27, 5
    s_add_u32 s50, s50, s48
    s_mul_i32 s50, s50, 54
    s_lshl_b32 s51, s33, 1
    s_add_u32 s50, s50, s51
    s_add_u32 s50, s50, s47
    s_lshl_b32 s50, s50, 10
    s_add_u32 s56, s50, 7946240
    s_add_u32 s46, s24, 4
    s_cmp_ge_u32 s46, 5
    s_cselect_b32 s47, 1, 0
    s_mul_i32 s48, s47, 5
    s_sub_u32 s48, s46, s48
    s_lshl_b32 s49, s47, 6
    s_add_u32 s49, s49, s61
    buffer_load_dwordx2 v[244:245], v250, s[16:19], s49 offen
    buffer_load_dwordx2 v[246:247], v250, s[16:19], s49 offen offset:32
    s_mul_i32 s46, s47, 10
    s_add_u32 s46, s46, s48
    s_lshl_b32 s53, s46, 10
    s_mul_i32 s50, s27, 5
    s_add_u32 s50, s50, s48
    s_mul_i32 s50, s50, 54
    s_lshl_b32 s51, s33, 1
    s_add_u32 s50, s50, s51
    s_add_u32 s50, s50, s47
    s_lshl_b32 s50, s50, 10
    s_add_u32 s57, s50, 7946240
    buffer_load_dwordx4 v100, s[68:71], s59 offen lds
    s_add_u32 s59, s59, 884736
    buffer_load_dwordx4 v100, s[68:71], s59 offen lds
    s_add_u32 s59, s59, 884736
    buffer_load_dwordx4 v100, s[68:71], s59 offen lds
    s_add_u32 s59, s59, 884736
    buffer_load_dwordx4 v100, s[68:71], s59 offen lds
    s_add_u32 s59, s59, 884736
    buffer_load_dwordx4 v100, s[68:71], s59 offen lds
    s_add_u32 s59, s59, 884736
    buffer_load_dwordx4 v100, s[68:71], s59 offen lds
    s_add_u32 s59, s59, 884736
    s_branch K2_EPI
K2_EPI_S:
    v_lshrrev_b32 v250, 4, v2
    v_lshlrev_b32 v250, 3, v250
    s_lshl_b32 s61, s33, 7
    s_add_u32 s46, s24, 0
    s_cmp_ge_u32 s46, 5
    s_cselect_b32 s47, 1, 0
    s_mul_i32 s48, s47, 5
    s_sub_u32 s48, s46, s48
    s_lshl_b32 s49, s47, 6
    s_add_u32 s49, s49, s61
    buffer_load_dwordx2 v[240:241], v250, s[16:19], s49 offen
    buffer_load_dwordx2 v[242:243], v250, s[16:19], s49 offen offset:32
    s_mul_i32 s46, s47, 10
    s_add_u32 s46, s46, s48
    s_lshl_b32 s52, s46, 10
    s_mul_i32 s50, s27, 5
    s_add_u32 s50, s50, s48
    s_mul_i32 s50, s50, 54
    s_lshl_b32 s51, s33, 1
    s_add_u32 s50, s50, s51
    s_add_u32 s50, s50, s47
    s_lshl_b32 s50, s50, 10
    s_add_u32 s56, s50, 7946240
    s_add_u32 s46, s24, 4
    s_cmp_ge_u32 s46, 5
    s_cselect_b32 s47, 1, 0
    s_mul_i32 s48, s47, 5
    s_sub_u32 s48, s46, s48
    s_lshl_b32 s49, s47, 6
    s_add_u32 s49, s49, s61
    buffer_load_dwordx2 v[244:245], v250, s[16:19], s49 offen
    buffer_load_dwordx2 v[246:247], v250, s[16:19], s49 offen offset:32
    s_mul_i32 s46, s47, 10
    s_add_u32 s46, s46, s48
    s_lshl_b32 s53, s46, 10
    s_mul_i32 s50, s27, 5
    s_add_u32 s50, s50, s48
    s_mul_i32 s50, s50, 54
    s_lshl_b32 s51, s33, 1
    s_add_u32 s50, s50, s51
    s_add_u32 s50, s50, s47
    s_lshl_b32 s50, s50, 10
    s_add_u32 s57, s50, 7946240
    s_waitcnt vmcnt(0)
K2_EPI:
    s_mov_b32 s43, 0xffff0000
    s_mov_b32 s44, 0xbdd2d3e8
    v_mov_b32 v96, s44
    v_mov_b32 v97, s44
    v_mov_b32 v98, 0xc0135761
    v_mov_b32 v99, 0xc0135761
    v_mov_b32 v102, 1.0
    v_mov_b32 v103, 1.0
    v_lshlrev_b32 v1, 4, v2
    s_waitcnt lgkmcnt(0)
    s_barrier
    v_add_u32 v10, s52, v1
    v_add_u32 v11, 40960, v10
    ds_read_b128 v[16:19], v10 offset:0
    ds_read_b128 v[20:23], v10 offset:5120
    ds_read_b128 v[24:27], v10 offset:20480
    ds_read_b128 v[28:31], v10 offset:25600
    ds_read_b128 v[32:35], v11 offset:0
    ds_read_b128 v[36:39], v11 offset:5120
    ds_read_b128 v[40:43], v11 offset:20480
    ds_read_b128 v[44:47], v11 offset:25600
    s_cmp_eq_u32 s24, 4
    s_cbranch_scc1 K2_EPI_2
    s_cmp_eq_u32 s24, 5
    s_cbranch_scc1 K2_EPI_2
    s_waitcnt vmcnt(6) lgkmcnt(0)
K2_MATH:
    v_pk_add_f32 v[16:17], v[16:17], v[24:25]
    v_pk_add_f32 v[18:19], v[18:19], v[26:27]
    v_pk_add_f32 v[20:21], v[20:21], v[28:29]
    v_pk_add_f32 v[22:23], v[22:23], v[30:31]
    v_pk_add_f32 v[32:33], v[32:33], v[40:41]
    v_pk_add_f32 v[34:35], v[34:35], v[42:43]
    v_pk_add_f32 v[36:37], v[36:37], v[44:45]
    v_pk_add_f32 v[38:39], v[38:39], v[46:47]
    v_lshlrev_b32 v24, 16, v240
    v_and_b32 v25, s43, v240
    v_lshlrev_b32 v26, 16, v241
    v_and_b32 v27, s43, v241
    v_lshlrev_b32 v28, 16, v242
    v_and_b32 v29, s43, v242
    v_lshlrev_b32 v30, 16, v243
    v_and_b32 v31, s43, v243
    v_pk_add_f32 v[16:17], v[16:17], v[32:33]
    v_pk_add_f32 v[18:19], v[18:19], v[34:35]
    v_pk_add_f32 v[20:21], v[20:21], v[36:37]
    v_pk_add_f32 v[22:23], v[22:23], v[38:39]
    v_cvt_pk_bf16_f32 v40, v16, v17
    v_cvt_pk_bf16_f32 v41, v18, v19
    v_cvt_pk_bf16_f32 v42, v20, v21
    v_cvt_pk_bf16_f32 v43, v22, v23
    v_lshlrev_b32 v16, 16, v40
    v_and_b32 v17, s43, v40
    v_lshlrev_b32 v18, 16, v41
    v_and_b32 v19, s43, v41
    v_lshlrev_b32 v20, 16, v42
    v_and_b32 v21, s43, v42
    v_lshlrev_b32 v22, 16, v43
    v_and_b32 v23, s43, v43
    v_pk_add_f32 v[16:17], v[16:17], v[24:25]
    v_pk_add_f32 v[18:19], v[18:19], v[26:27]
    v_pk_add_f32 v[20:21], v[20:21], v[28:29]
    v_pk_add_f32 v[22:23], v[22:23], v[30:31]
    v_cvt_pk_bf16_f32 v40, v16, v17
    v_cvt_pk_bf16_f32 v41, v18, v19
    v_cvt_pk_bf16_f32 v42, v20, v21
    v_cvt_pk_bf16_f32 v43, v22, v23
    v_lshlrev_b32 v16, 16, v40
    v_and_b32 v17, s43, v40
    v_lshlrev_b32 v18, 16, v41
    v_and_b32 v19, s43, v41
    v_lshlrev_b32 v20, 16, v42
    v_and_b32 v21, s43, v42
    v_lshlrev_b32 v22, 16, v43
    v_and_b32 v23, s43, v43
    v_pk_mul_f32 v[24:25], v[16:17], v[16:17]
    v_pk_mul_f32 v[26:27], v[18:19], v[18:19]
    v_pk_mul_f32 v[28:29], v[20:21], v[20:21]
    v_pk_mul_f32 v[30:31], v[22:23], v[22:23]
    v_pk_fma_f32 v[24:25], v[24:25], v[96:97], v[98:99]
    v_pk_fma_f32 v[26:27], v[26:27], v[96:97], v[98:99]
    v_pk_fma_f32 v[28:29], v[28:29], v[96:97], v[98:99]
    v_pk_fma_f32 v[30:31], v[30:31], v[96:97], v[98:99]
    v_pk_mul_f32 v[24:25], v[24:25], v[16:17]
    v_pk_mul_f32 v[26:27], v[26:27], v[18:19]
    v_pk_mul_f32 v[28:29], v[28:29], v[20:21]
    v_pk_mul_f32 v[30:31], v[30:31], v[22:23]
    v_exp_f32 v24, v24
    v_exp_f32 v25, v25
    v_exp_f32 v26, v26
    v_exp_f32 v27, v27
    v_exp_f32 v28, v28
    v_exp_f32 v29, v29
    v_exp_f32 v30, v30
    v_exp_f32 v31, v31
    v_pk_add_f32 v[24:25], v[24:25], v[102:103]
    v_pk_add_f32 v[26:27], v[26:27], v[102:103]
    v_pk_add_f32 v[28:29], v[28:29], v[102:103]
    v_pk_add_f32 v[30:31], v[30:31], v[102:103]
    v_rcp_f32 v24, v24
    v_rcp_f32 v25, v25
    v_rcp_f32 v26, v26
    v_rcp_f32 v27, v27
    v_rcp_f32 v28, v28
    v_rcp_f32 v29, v29
    v_rcp_f32 v30, v30
    v_rcp_f32 v31, v31
    v_pk_mul_f32 v[16:17], v[16:17], v[24:25]
    v_pk_mul_f32 v[18:19], v[18:19], v[26:27]
    v_pk_mul_f32 v[20:21], v[20:21], v[28:29]
    v_pk_mul_f32 v[22:23], v[22:23], v[30:31]
    v_cvt_pk_bf16_f32 v40, v16, v17
    v_cvt_pk_bf16_f32 v41, v18, v19
    v_cvt_pk_bf16_f32 v42, v20, v21
    v_cvt_pk_bf16_f32 v43, v22, v23
    buffer_store_dwordx4 v[40:43], v1, s[12:15], s56 offen sc1
    s_branch K2_END
K2_EPI_2:
    v_add_u32 v10, s53, v1
    v_add_u32 v11, 40960, v10
    ds_read_b128 v[48:51], v10 offset:0
    ds_read_b128 v[52:55], v10 offset:5120
    ds_read_b128 v[56:59], v10 offset:20480
    ds_read_b128 v[60:63], v10 offset:25600
    ds_read_b128 v[64:67], v11 offset:0
    ds_read_b128 v[68:71], v11 offset:5120
    ds_read_b128 v[72:75], v11 offset:20480
    ds_read_b128 v[76:79], v11 offset:25600
    s_waitcnt vmcnt(6) lgkmcnt(8)
K2_MATH2:
    v_pk_add_f32 v[16:17], v[16:17], v[24:25]
    v_pk_add_f32 v[18:19], v[18:19], v[26:27]
    v_pk_add_f32 v[20:21], v[20:21], v[28:29]
    v_pk_add_f32 v[22:23], v[22:23], v[30:31]
    v_pk_add_f32 v[32:33], v[32:33], v[40:41]
    v_pk_add_f32 v[34:35], v[34:35], v[42:43]
    v_pk_add_f32 v[36:37], v[36:37], v[44:45]
    v_pk_add_f32 v[38:39], v[38:39], v[46:47]
    v_lshlrev_b32 v24, 16, v240
    v_and_b32 v25, s43, v240
    v_lshlrev_b32 v26, 16, v241
    v_and_b32 v27, s43, v241
    v_lshlrev_b32 v28, 16, v242
    v_and_b32 v29, s43, v242
    v_lshlrev_b32 v30, 16, v243
    v_and_b32 v31, s43, v243
    v_pk_add_f32 v[16:17], v[16:17], v[32:33]
    v_pk_add_f32 v[18:19], v[18:19], v[34:35]
    v_pk_add_f32 v[20:21], v[20:21], v[36:37]
    v_pk_add_f32 v[22:23], v[22:23], v[38:39]
    v_cvt_pk_bf16_f32 v40, v16, v17
    v_cvt_pk_bf16_f32 v41, v18, v19
    v_cvt_pk_bf16_f32 v42, v20, v21
    v_cvt_pk_bf16_f32 v43, v22, v23
    v_lshlrev_b32 v16, 16, v40
    v_and_b32 v17, s43, v40
    v_lshlrev_b32 v18, 16, v41
    v_and_b32 v19, s43, v41
    v_lshlrev_b32 v20, 16, v42
    v_and_b32 v21, s43, v42
    v_lshlrev_b32 v22, 16, v43
    v_and_b32 v23, s43, v43
    v_pk_add_f32 v[16:17], v[16:17], v[24:25]
    v_pk_add_f32 v[18:19], v[18:19], v[26:27]
    v_pk_add_f32 v[20:21], v[20:21], v[28:29]
    v_pk_add_f32 v[22:23], v[22:23], v[30:31]
    v_cvt_pk_bf16_f32 v40, v16, v17
    v_cvt_pk_bf16_f32 v41, v18, v19
    v_cvt_pk_bf16_f32 v42, v20, v21
    v_cvt_pk_bf16_f32 v43, v22, v23
    v_lshlrev_b32 v16, 16, v40
    v_and_b32 v17, s43, v40
    v_lshlrev_b32 v18, 16, v41
    v_and_b32 v19, s43, v41
    v_lshlrev_b32 v20, 16, v42
    v_and_b32 v21, s43, v42
    v_lshlrev_b32 v22, 16, v43
    v_and_b32 v23, s43, v43
    v_pk_mul_f32 v[24:25], v[16:17], v[16:17]
    v_pk_mul_f32 v[26:27], v[18:19], v[18:19]
    v_pk_mul_f32 v[28:29], v[20:21], v[20:21]
    v_pk_mul_f32 v[30:31], v[22:23], v[22:23]
    v_pk_fma_f32 v[24:25], v[24:25], v[96:97], v[98:99]
    v_pk_fma_f32 v[26:27], v[26:27], v[96:97], v[98:99]
    v_pk_fma_f32 v[28:29], v[28:29], v[96:97], v[98:99]
    v_pk_fma_f32 v[30:31], v[30:31], v[96:97], v[98:99]
    v_pk_mul_f32 v[24:25], v[24:25], v[16:17]
    v_pk_mul_f32 v[26:27], v[26:27], v[18:19]
    v_pk_mul_f32 v[28:29], v[28:29], v[20:21]
    v_pk_mul_f32 v[30:31], v[30:31], v[22:23]
    v_exp_f32 v24, v24
    v_exp_f32 v25, v25
    v_exp_f32 v26, v26
    v_exp_f32 v27, v27
    v_exp_f32 v28, v28
    v_exp_f32 v29, v29
    v_exp_f32 v30, v30
    v_exp_f32 v31, v31
    v_pk_add_f32 v[24:25], v[24:25], v[102:103]
    v_pk_add_f32 v[26:27], v[26:27], v[102:103]
    v_pk_add_f32 v[28:29], v[28:29], v[102:103]
    v_pk_add_f32 v[30:31], v[30:31], v[102:103]
    v_rcp_f32 v24, v24
    v_rcp_f32 v25, v25
    v_rcp_f32 v26, v26
    v_rcp_f32 v27, v27
    v_rcp_f32 v28, v28
    v_rcp_f32 v29, v29
    v_rcp_f32 v30, v30
    v_rcp_f32 v31, v31
    v_pk_mul_f32 v[16:17], v[16:17], v[24:25]
    v_pk_mul_f32 v[18:19], v[18:19], v[26:27]
    v_pk_mul_f32 v[20:21], v[20:21], v[28:29]
    v_pk_mul_f32 v[22:23], v[22:23], v[30:31]
    v_cvt_pk_bf16_f32 v40, v16, v17
    v_cvt_pk_bf16_f32 v41, v18, v19
    v_cvt_pk_bf16_f32 v42, v20, v21
    v_cvt_pk_bf16_f32 v43, v22, v23
    buffer_store_dwordx4 v[40:43], v1, s[12:15], s56 offen sc1
    s_waitcnt lgkmcnt(0)
    v_pk_add_f32 v[48:49], v[48:49], v[56:57]
    v_pk_add_f32 v[50:51], v[50:51], v[58:59]
    v_pk_add_f32 v[52:53], v[52:53], v[60:61]
    v_pk_add_f32 v[54:55], v[54:55], v[62:63]
    v_pk_add_f32 v[64:65], v[64:65], v[72:73]
    v_pk_add_f32 v[66:67], v[66:67], v[74:75]
    v_pk_add_f32 v[68:69], v[68:69], v[76:77]
    v_pk_add_f32 v[70:71], v[70:71], v[78:79]
    v_lshlrev_b32 v56, 16, v244
    v_and_b32 v57, s43, v244
    v_lshlrev_b32 v58, 16, v245
    v_and_b32 v59, s43, v245
    v_lshlrev_b32 v60, 16, v246
    v_and_b32 v61, s43, v246
    v_lshlrev_b32 v62, 16, v247
    v_and_b32 v63, s43, v247
    v_pk_add_f32 v[48:49], v[48:49], v[64:65]
    v_pk_add_f32 v[50:51], v[50:51], v[66:67]
    v_pk_add_f32 v[52:53], v[52:53], v[68:69]
    v_pk_add_f32 v[54:55], v[54:55], v[70:71]
    v_cvt_pk_bf16_f32 v72, v48, v49
    v_cvt_pk_bf16_f32 v73, v50, v51
    v_cvt_pk_bf16_f32 v74, v52, v53
    v_cvt_pk_bf16_f32 v75, v54, v55
    v_lshlrev_b32 v48, 16, v72
    v_and_b32 v49, s43, v72
    v_lshlrev_b32 v50, 16, v73
    v_and_b32 v51, s43, v73
    v_lshlrev_b32 v52, 16, v74
    v_and_b32 v53, s43, v74
    v_lshlrev_b32 v54, 16, v75
    v_and_b32 v55, s43, v75
    v_pk_add_f32 v[48:49], v[48:49], v[56:57]
    v_pk_add_f32 v[50:51], v[50:51], v[58:59]
    v_pk_add_f32 v[52:53], v[52:53], v[60:61]
    v_pk_add_f32 v[54:55], v[54:55], v[62:63]
    v_cvt_pk_bf16_f32 v72, v48, v49
    v_cvt_pk_bf16_f32 v73, v50, v51
    v_cvt_pk_bf16_f32 v74, v52, v53
    v_cvt_pk_bf16_f32 v75, v54, v55
    v_lshlrev_b32 v48, 16, v72
    v_and_b32 v49, s43, v72
    v_lshlrev_b32 v50, 16, v73
    v_and_b32 v51, s43, v73
    v_lshlrev_b32 v52, 16, v74
    v_and_b32 v53, s43, v74
    v_lshlrev_b32 v54, 16, v75
    v_and_b32 v55, s43, v75
    v_pk_mul_f32 v[56:57], v[48:49], v[48:49]
    v_pk_mul_f32 v[58:59], v[50:51], v[50:51]
    v_pk_mul_f32 v[60:61], v[52:53], v[52:53]
    v_pk_mul_f32 v[62:63], v[54:55], v[54:55]
    v_pk_fma_f32 v[56:57], v[56:57], v[96:97], v[98:99]
    v_pk_fma_f32 v[58:59], v[58:59], v[96:97], v[98:99]
    v_pk_fma_f32 v[60:61], v[60:61], v[96:97], v[98:99]
    v_pk_fma_f32 v[62:63], v[62:63], v[96:97], v[98:99]
    v_pk_mul_f32 v[56:57], v[56:57], v[48:49]
    v_pk_mul_f32 v[58:59], v[58:59], v[50:51]
    v_pk_mul_f32 v[60:61], v[60:61], v[52:53]
    v_pk_mul_f32 v[62:63], v[62:63], v[54:55]
    v_exp_f32 v56, v56
    v_exp_f32 v57, v57
    v_exp_f32 v58, v58
    v_exp_f32 v59, v59
    v_exp_f32 v60, v60
    v_exp_f32 v61, v61
    v_exp_f32 v62, v62
    v_exp_f32 v63, v63
    v_pk_add_f32 v[56:57], v[56:57], v[102:103]
    v_pk_add_f32 v[58:59], v[58:59], v[102:103]
    v_pk_add_f32 v[60:61], v[60:61], v[102:103]
    v_pk_add_f32 v[62:63], v[62:63], v[102:103]
    v_rcp_f32 v56, v56
    v_rcp_f32 v57, v57
    v_rcp_f32 v58, v58
    v_rcp_f32 v59, v59
    v_rcp_f32 v60, v60
    v_rcp_f32 v61, v61
    v_rcp_f32 v62, v62
    v_rcp_f32 v63, v63
    v_pk_mul_f32 v[48:49], v[48:49], v[56:57]
    v_pk_mul_f32 v[50:51], v[50:51], v[58:59]
    v_pk_mul_f32 v[52:53], v[52:53], v[60:61]
    v_pk_mul_f32 v[54:55], v[54:55], v[62:63]
    v_cvt_pk_bf16_f32 v72, v48, v49
    v_cvt_pk_bf16_f32 v73, v50, v51
    v_cvt_pk_bf16_f32 v74, v52, v53
    v_cvt_pk_bf16_f32 v75, v54, v55
    buffer_store_dwordx4 v[72:75], v1, s[12:15], s57 offen sc1
    s_branch K2_END
K2_FFT0:
    s_waitcnt lgkmcnt(0)
    s_mov_b32 s12, s28
    s_and_b32 s13, s29, 0xffff
    s_mov_b32 s14, 13414400
    s_mov_b32 s15, 0x20000
    s_mov_b32 s8, s4
    s_and_b32 s9, s5, 0xffff
    s_mov_b32 s10, 7077888
    s_mov_b32 s11, 0x20000
    s_getpc_b64 s[30:31]
    s_add_u32 s30, s30, table2@rel32@lo+4
    s_addc_u32 s31, s31, table2@rel32@hi+12
    s_mov_b32 s16, s6
    s_and_b32 s17, s7, 0xffff
    s_mov_b32 s18, 3456
    s_mov_b32 s19, 0x20000
    s_mov_b32 s68, s62
    s_and_b32 s69, s63, 0xffff
    s_mov_b32 s70, 7077888
    s_mov_b32 s71, 0x20000
    s_branch K2_FFT
K2_FFT_SPECIAL:
    s_mov_b32 s64, s30
    s_and_b32 s65, s31, 0xffff
    s_mov_b32 s66, 40960
    s_mov_b32 s67, 0x20000
    s_setprio 1
    s_mov_b32 s78, 1
    s_movk_i32 s72, 320
    v_lshlrev_b32 v3, 4, v2
    v_add_u32 v7, 81920, v3
    s_mov_b32 m0, 81920
    s_mov_b32 s74, 0
    buffer_load_dwordx4 v3, s[64:67], s74 offen lds
    s_mov_b32 m0, 82944
    s_mov_b32 s74, 1024
    buffer_load_dwordx4 v3, s[64:67], s74 offen lds
    s_mov_b32 m0, 83968
    s_mov_b32 s74, 2048
    buffer_load_dwordx4 v3, s[64:67], s74 offen lds
    s_mov_b32 m0, 84992
    s_mov_b32 s74, 3072
    buffer_load_dwordx4 v3, s[64:67], s74 offen lds
    s_mov_b32 m0, 86016
    s_mov_b32 s74, 4096
    buffer_load_dwordx4 v3, s[64:67], s74 offen lds
    s_mov_b32 m0, 87040
    s_mov_b32 s74, 5120
    buffer_load_dwordx4 v3, s[64:67], s74 offen lds
    s_waitcnt vmcnt(0)
    s_lshl_b32 s74, s72, 13
    s_add_u32 s76, s74, 5308416
    s_mov_b32 s75, 13402112
    s_mov_b32 s77, 13406208
    buffer_load_dwordx4 v[8:11], v3, s[12:15], s75 offen offset:0
    buffer_load_dwordx4 v[12:15], v3, s[12:15], s75 offen offset:1024
    buffer_load_dwordx4 v[16:19], v3, s[12:15], s77 offen offset:0
    buffer_load_dwordx4 v[20:23], v3, s[12:15], s77 offen offset:1024
    buffer_load_dwordx4 v[24:27], v3, s[12:15], s75 offen offset:2048
    buffer_load_dwordx4 v[28:31], v3, s[12:15], s75 offen offset:3072
    buffer_load_dwordx4 v[32:35], v3, s[12:15], s77 offen offset:2048
    buffer_load_dwordx4 v[36:39], v3, s[12:15], s77 offen offset:3072
    s_mov_b32 m0, 106496
    s_mov_b32 s74, 24576
    buffer_load_dwordx4 v3, s[64:67], s74 offen lds
    s_mov_b32 m0, 107520
    s_mov_b32 s74, 25600
    buffer_load_dwordx4 v3, s[64:67], s74 offen lds
    s_mov_b32 m0, 108544
    s_mov_b32 s74, 26624
    buffer_load_dwordx4 v3, s[64:67], s74 offen lds
    s_mov_b32 m0, 109568
    s_mov_b32 s74, 27648
    buffer_load_dwordx4 v3, s[64:67], s74 offen lds
    s_mov_b32 m0, 110592
    s_mov_b32 s74, 28672
    buffer_load_dwordx4 v3, s[64:67], s74 offen lds
    s_mov_b32 m0, 111616
    s_mov_b32 s74, 29696
    buffer_load_dwordx4 v3, s[64:67], s74 offen lds
    s_mov_b32 m0, 112640
    s_mov_b32 s74, 30720
    buffer_load_dwordx4 v3, s[64:67], s74 offen lds
    s_mov_b32 m0, 113664
    s_mov_b32 s74, 31744
    buffer_load_dwordx4 v3, s[64:67], s74 offen lds
    s_branch K2_FFT_COL
K2_FFT:
    s_mov_b32 s64, s30
    s_and_b32 s65, s31, 0xffff
    s_mov_b32 s66, 40960
    s_mov_b32 s67, 0x20000
    s_mul_i32 s72, s25, 5
    s_add_u32 s72, s72, s26
    s_sub_u32 s72, s72, 27
    s_lshl_b32 s72, s72, 3
    s_add_u32 s72, s72, s24
    v_lshlrev_b32 v3, 4, v2
    v_mov_b32 v7, v3
    s_mov_b32 s78, 0
    s_lshl_b32 s74, s72, 13
    s_add_u32 s76, s74, 5308416
    v_lshrrev_b32 v5, 3, v2
    s_mov_b32 s74, 10496
    v_mul_lo_u32 v5, v5, s74
    v_and_b32 v6, 7, v2
    v_lshrrev_b32 v4, 4, v2
    v_xor_b32 v6, v6, v4
    v_lshl_add_u32 v241, v6, 4, v5
    v_xor_b32 v6, 4, v6
    v_lshl_add_u32 v242, v6, 4, v5
    s_and_b32 s73, s24, 3
    s_mul_i32 s73, s73, 671744
    s_lshr_b32 s75, s24, 2
    s_mul_i32 s75, s75, 5248
    s_add_u32 s73, s73, s75
    s_sub_u32 s75, s72, s24
    s_lshl_b32 s75, s75, 4
    s_add_u32 s73, s73, s75
    s_add_u32 s73, s73, 2621440
    s_lshl_b32 s75, s24, 13
    s_add_u32 s75, s75, 40960
    s_add_u32 m0, s75, 0
    s_add_u32 s74, s73, 0
    buffer_load_dwordx4 v241, s[12:15], s74 offen lds
    s_add_u32 m0, s75, 1024
    s_add_u32 s74, s73, 83968
    buffer_load_dwordx4 v242, s[12:15], s74 offen lds
    s_add_u32 m0, s75, 2048
    s_add_u32 s74, s73, 167936
    buffer_load_dwordx4 v241, s[12:15], s74 offen lds
    s_add_u32 m0, s75, 3072
    s_add_u32 s74, s73, 251904
    buffer_load_dwordx4 v242, s[12:15], s74 offen lds
    s_add_u32 m0, s75, 4096
    s_add_u32 s74, s73, 335872
    buffer_load_dwordx4 v241, s[12:15], s74 offen lds
    s_add_u32 m0, s75, 5120
    s_add_u32 s74, s73, 419840
    buffer_load_dwordx4 v242, s[12:15], s74 offen lds
    s_add_u32 m0, s75, 6144
    s_add_u32 s74, s73, 503808
    buffer_load_dwordx4 v241, s[12:15], s74 offen lds
    s_add_u32 m0, s75, 7168
    s_add_u32 s74, s73, 587776
    buffer_load_dwordx4 v242, s[12:15], s74 offen lds
    s_lshl_b32 s74, s24, 10
    s_add_u32 s74, s74, 0
    s_cmp_ge_u32 s24, 6
    s_cselect_b32 s73, 18432, 0
    s_add_u32 s74, s74, s73
    s_mov_b32 m0, s74
    s_nop 0
    buffer_load_dwordx4 v3, s[64:67], s74 offen lds
    s_lshl_b32 s74, s24, 10
    s_add_u32 s74, s74, 26624
    s_cmp_ge_u32 s24, 6
    s_cselect_b32 s73, 4294959104, 0
    s_add_u32 s74, s74, s73
    s_mov_b32 m0, s74
    s_nop 0
    buffer_load_dwordx4 v3, s[64:67], s74 offen lds
    s_waitcnt vmcnt(0)
    s_barrier
    v_lshrrev_b32 v5, 5, v2
    v_lshlrev_b32 v5, 13, v5
    v_and_b32 v6, 31, v2
    v_lshl_add_u32 v5, v6, 7, v5
    v_lshrrev_b32 v6, 1, v6
    v_and_b32 v6, 7, v6
    v_xor_b32 v6, s24, v6
    v_lshl_add_u32 v5, v6, 4, v5
    v_add_u32 v5, 40960, v5
    ds_read_b128 v[8:11], v5 offset:0
    ds_read_b128 v[12:15], v5 offset:16384
    ds_read_b128 v[16:19], v5 offset:32768
    ds_read_b128 v[20:23], v5 offset:49152
    ds_read_b128 v[24:27], v5 offset:4096
    ds_read_b128 v[28:31], v5 offset:20480
    ds_read_b128 v[32:35], v5 offset:36864
    ds_read_b128 v[36:39], v5 offset:53248
K2_FFT_COL:
    v_lshrrev_b32 v6, 5, v2
    v_lshlrev_b32 v6, 12, v6
    v_and_b32 v5, 31, v2
    v_lshl_add_u32 v240, v5, 4, v6
    s_sub_u32 s59, s26, 27
    s_lshl_b32 s59, s59, 3
    s_add_u32 s59, s59, s24
    s_lshl_b32 s59, s59, 13
    s_lshl_b32 s60, s25, 9
    s_add_u32 s59, s59, s60
    s_mov_b32 s43, 0xffff0000
    v_and_b32 v4, 31, v2
    v_lshlrev_b32 v4, 2, v4
    v_lshrrev_b32 v5, 5, v2
    v_lshl_add_u32 v4, v5, 9, v4
    s_cmp_eq_u32 s78, 1
    s_cbranch_scc1 K2WAa
    s_waitcnt vmcnt(63)
    s_branch K2WAb
K2WAa:
    s_waitcnt vmcnt(8)
K2WAb:
    ds_read_b128 v[200:203], v7 offset:0
    ds_read_b128 v[204:207], v7 offset:1024
    ds_read_b128 v[208:211], v7 offset:2048
    ds_read_b128 v[212:215], v7 offset:3072
    ds_read_b128 v[216:219], v7 offset:4096
    ds_read_b128 v[220:223], v7 offset:5120
    s_waitcnt lgkmcnt(0)
    v_mfma_f32_32x32x16_bf16 v[72:87], v[8:11], v[200:203], 0
    v_mfma_f32_32x32x16_bf16 v[88:103], v[8:11], v[208:211], 0
    v_mfma_f32_32x32x16_bf16 v[72:87], v[12:15], v[204:207], v[72:87]
    v_mfma_f32_32x32x16_bf16 v[88:103], v[12:15], v[212:215], v[88:103]
    s_cmp_eq_u32 s78, 1
    s_cbranch_scc1 K2NZI0
    v_mfma_f32_32x32x16_bf16 v[72:87], v[16:19], v[216:219], v[72:87]
    v_mfma_f32_32x32x16_bf16 v[88:103], v[16:19], v[200:203], v[88:103]
    v_mfma_f32_32x32x16_bf16 v[72:87], v[20:23], v[220:223], v[72:87]
    v_mfma_f32_32x32x16_bf16 v[88:103], v[20:23], v[204:207], v[88:103]
K2NZI0:
    v_mfma_f32_32x32x16_bf16 v[104:119], v[24:27], v[200:203], 0
    v_mfma_f32_32x32x16_bf16 v[120:135], v[24:27], v[208:211], 0
    v_mfma_f32_32x32x16_bf16 v[104:119], v[28:31], v[204:207], v[104:119]
    v_mfma_f32_32x32x16_bf16 v[120:135], v[28:31], v[212:215], v[120:135]
    s_cmp_eq_u32 s78, 1
    s_cbranch_scc1 K2NZI1
    v_mfma_f32_32x32x16_bf16 v[104:119], v[32:35], v[216:219], v[104:119]
    v_mfma_f32_32x32x16_bf16 v[120:135], v[32:35], v[200:203], v[120:135]
    v_mfma_f32_32x32x16_bf16 v[104:119], v[36:39], v[220:223], v[104:119]
    v_mfma_f32_32x32x16_bf16 v[120:135], v[36:39], v[204:207], v[120:135]
K2NZI1:
    s_cmp_eq_u32 s78, 1
    s_cbranch_scc0 K2SA
    s_mov_b32 m0, 88064
    s_mov_b32 s74, 6144
    buffer_load_dwordx4 v3, s[64:67], s74 offen lds
    s_mov_b32 m0, 89088
    s_mov_b32 s74, 7168
    buffer_load_dwordx4 v3, s[64:67], s74 offen lds
    s_mov_b32 m0, 90112
    s_mov_b32 s74, 8192
    buffer_load_dwordx4 v3, s[64:67], s74 offen lds
    s_mov_b32 m0, 91136
    s_mov_b32 s74, 9216
    buffer_load_dwordx4 v3, s[64:67], s74 offen lds
    s_mov_b32 m0, 92160
    s_mov_b32 s74, 10240
    buffer_load_dwordx4 v3, s[64:67], s74 offen lds
    s_mov_b32 m0, 93184
    s_mov_b32 s74, 11264
    buffer_load_dwordx4 v3, s[64:67], s74 offen lds
    s_mov_b32 m0, 94208
    s_mov_b32 s74, 12288
    buffer_load_dwordx4 v3, s[64:67], s74 offen lds
    s_mov_b32 m0, 95232
    s_mov_b32 s74, 13312
    buffer_load_dwordx4 v3, s[64:67], s74 offen lds
    s_mov_b32 m0, 96256
    s_mov_b32 s74, 14336
    buffer_load_dwordx4 v3, s[64:67], s74 offen lds
    s_mov_b32 m0, 97280
    s_mov_b32 s74, 15360
    buffer_load_dwordx4 v3, s[64:67], s74 offen lds
    s_mov_b32 m0, 98304
    s_mov_b32 s74, 16384
    buffer_load_dwordx4 v3, s[64:67], s74 offen lds
    s_mov_b32 m0, 99328
    s_mov_b32 s74, 17408
    buffer_load_dwordx4 v3, s[64:67], s74 offen lds
    s_add_u32 s77, s76, 4096
    buffer_load_dwordx4 v[40:43], v3, s[12:15], s76 offen offset:0
    buffer_load_dwordx4 v[44:47], v3, s[12:15], s76 offen offset:1024
    buffer_load_dwordx4 v[48:51], v3, s[12:15], s76 offen offset:2048
    buffer_load_dwordx4 v[52:55], v3, s[12:15], s76 offen offset:3072
    buffer_load_dwordx4 v[56:59], v3, s[12:15], s77 offen offset:0
    buffer_load_dwordx4 v[60:63], v3, s[12:15], s77 offen offset:1024
    buffer_load_dwordx4 v[64:67], v3, s[12:15], s77 offen offset:2048
    buffer_load_dwordx4 v[68:71], v3, s[12:15], s77 offen offset:3072
K2SA:
    s_cmp_eq_u32 s78, 1
    s_cbranch_scc1 K2WCa
    s_waitcnt vmcnt(63)
    s_branch K2WCb
K2WCa:
    s_waitcnt vmcnt(20)
K2WCb:
    s_nop 7
    s_nop 3
    ds_read_b128 v[224:227], v7 offset:24576
    ds_read_b128 v[228:231], v7 offset:25600
    s_waitcnt lgkmcnt(1)
    v_fma_mix_f32 v5, v88, v224, 0 op_sel:[0,1,0] op_sel_hi:[0,1,0]
    v_fma_mix_f32 v6, v88, v224, 0 op_sel_hi:[0,1,0]
    v_fma_mix_f32 v88, v72, v224, v6 op_sel:[0,1,0] op_sel_hi:[0,1,0]
    v_fma_mix_f32 v72, v72, v224, -v5 op_sel_hi:[0,1,0]
    v_fma_mix_f32 v5, v89, v225, 0 op_sel:[0,1,0] op_sel_hi:[0,1,0]
    v_fma_mix_f32 v6, v89, v225, 0 op_sel_hi:[0,1,0]
    v_fma_mix_f32 v89, v73, v225, v6 op_sel:[0,1,0] op_sel_hi:[0,1,0]
    v_fma_mix_f32 v73, v73, v225, -v5 op_sel_hi:[0,1,0]
    v_fma_mix_f32 v5, v90, v226, 0 op_sel:[0,1,0] op_sel_hi:[0,1,0]
    v_fma_mix_f32 v6, v90, v226, 0 op_sel_hi:[0,1,0]
    v_fma_mix_f32 v90, v74, v226, v6 op_sel:[0,1,0] op_sel_hi:[0,1,0]
    v_fma_mix_f32 v74, v74, v226, -v5 op_sel_hi:[0,1,0]
    v_fma_mix_f32 v5, v91, v227, 0 op_sel:[0,1,0] op_sel_hi:[0,1,0]
    v_fma_mix_f32 v6, v91, v227, 0 op_sel_hi:[0,1,0]
    v_fma_mix_f32 v91, v75, v227, v6 op_sel:[0,1,0] op_sel_hi:[0,1,0]
    v_fma_mix_f32 v75, v75, v227, -v5 op_sel_hi:[0,1,0]
    s_cmp_eq_u32 s78, 1
    s_cbranch_scc1 K2NQ0
    s_lshl_b32 s74, s24, 10
    s_add_u32 s74, s74, 6144
    s_mov_b32 m0, s74
    s_nop 0
    buffer_load_dwordx4 v3, s[64:67], s74 offen lds
    s_add_u32 s77, s76, 4096
    buffer_load_dwordx4 v[40:43], v3, s[12:15], s76 offen offset:0
K2NQ0:
    ds_read_b128 v[224:227], v7 offset:26624
    s_waitcnt lgkmcnt(1)
    v_fma_mix_f32 v5, v92, v228, 0 op_sel:[0,1,0] op_sel_hi:[0,1,0]
    v_fma_mix_f32 v6, v92, v228, 0 op_sel_hi:[0,1,0]
    v_fma_mix_f32 v92, v76, v228, v6 op_sel:[0,1,0] op_sel_hi:[0,1,0]
    v_fma_mix_f32 v76, v76, v228, -v5 op_sel_hi:[0,1,0]
    v_fma_mix_f32 v5, v93, v229, 0 op_sel:[0,1,0] op_sel_hi:[0,1,0]
    v_fma_mix_f32 v6, v93, v229, 0 op_sel_hi:[0,1,0]
    v_fma_mix_f32 v93, v77, v229, v6 op_sel:[0,1,0] op_sel_hi:[0,1,0]
    v_fma_mix_f32 v77, v77, v229, -v5 op_sel_hi:[0,1,0]
    v_fma_mix_f32 v5, v94, v230, 0 op_sel:[0,1,0] op_sel_hi:[0,1,0]
    v_fma_mix_f32 v6, v94, v230, 0 op_sel_hi:[0,1,0]
    v_fma_mix_f32 v94, v78, v230, v6 op_sel:[0,1,0] op_sel_hi:[0,1,0]
    v_fma_mix_f32 v78, v78, v230, -v5 op_sel_hi:[0,1,0]
    v_fma_mix_f32 v5, v95, v231, 0 op_sel:[0,1,0] op_sel_hi:[0,1,0]
    v_fma_mix_f32 v6, v95, v231, 0 op_sel_hi:[0,1,0]
    v_fma_mix_f32 v95, v79, v231, v6 op_sel:[0,1,0] op_sel_hi:[0,1,0]
    v_fma_mix_f32 v79, v79, v231, -v5 op_sel_hi:[0,1,0]
    s_cmp_eq_u32 s78, 1
    s_cbranch_scc1 K2NQ1
    s_lshl_b32 s74, s24, 10
    s_add_u32 s74, s74, 14336
    s_mov_b32 m0, s74
    s_nop 0
    buffer_load_dwordx4 v3, s[64:67], s74 offen lds
    buffer_load_dwordx4 v[44:47], v3, s[12:15], s76 offen offset:1024
K2NQ1:
    ds_read_b128 v[228:231], v7 offset:27648
    s_waitcnt lgkmcnt(1)
    v_fma_mix_f32 v5, v96, v224, 0 op_sel:[0,1,0] op_sel_hi:[0,1,0]
    v_fma_mix_f32 v6, v96, v224, 0 op_sel_hi:[0,1,0]
    v_fma_mix_f32 v96, v80, v224, v6 op_sel:[0,1,0] op_sel_hi:[0,1,0]
    v_fma_mix_f32 v80, v80, v224, -v5 op_sel_hi:[0,1,0]
    v_fma_mix_f32 v5, v97, v225, 0 op_sel:[0,1,0] op_sel_hi:[0,1,0]
    v_fma_mix_f32 v6, v97, v225, 0 op_sel_hi:[0,1,0]
    v_fma_mix_f32 v97, v81, v225, v6 op_sel:[0,1,0] op_sel_hi:[0,1,0]
    v_fma_mix_f32 v81, v81, v225, -v5 op_sel_hi:[0,1,0]
    v_fma_mix_f32 v5, v98, v226, 0 op_sel:[0,1,0] op_sel_hi:[0,1,0]
    v_fma_mix_f32 v6, v98, v226, 0 op_sel_hi:[0,1,0]
    v_fma_mix_f32 v98, v82, v226, v6 op_sel:[0,1,0] op_sel_hi:[0,1,0]
    v_fma_mix_f32 v82, v82, v226, -v5 op_sel_hi:[0,1,0]
    v_fma_mix_f32 v5, v99, v227, 0 op_sel:[0,1,0] op_sel_hi:[0,1,0]
    v_fma_mix_f32 v6, v99, v227, 0 op_sel_hi:[0,1,0]
    v_fma_mix_f32 v99, v83, v227, v6 op_sel:[0,1,0] op_sel_hi:[0,1,0]
    v_fma_mix_f32 v83, v83, v227, -v5 op_sel_hi:[0,1,0]
    s_cmp_eq_u32 s78, 1
    s_cbranch_scc1 K2NQ2
    s_lshl_b32 s74, s24, 10
    s_add_u32 s74, s74, 22528
    s_cmp_ge_u32 s24, 2
    s_cselect_b32 s73, 8192, 0
    s_add_u32 s74, s74, s73
    s_mov_b32 m0, s74
    s_nop 0
    buffer_load_dwordx4 v3, s[64:67], s74 offen lds
    buffer_load_dwordx4 v[48:51], v3, s[12:15], s76 offen offset:2048
K2NQ2:
    ds_read_b128 v[224:227], v7 offset:28672
    s_waitcnt lgkmcnt(1)
    v_fma_mix_f32 v5, v100, v228, 0 op_sel:[0,1,0] op_sel_hi:[0,1,0]
    v_fma_mix_f32 v6, v100, v228, 0 op_sel_hi:[0,1,0]
    v_fma_mix_f32 v100, v84, v228, v6 op_sel:[0,1,0] op_sel_hi:[0,1,0]
    v_fma_mix_f32 v84, v84, v228, -v5 op_sel_hi:[0,1,0]
    v_fma_mix_f32 v5, v101, v229, 0 op_sel:[0,1,0] op_sel_hi:[0,1,0]
    v_fma_mix_f32 v6, v101, v229, 0 op_sel_hi:[0,1,0]
    v_fma_mix_f32 v101, v85, v229, v6 op_sel:[0,1,0] op_sel_hi:[0,1,0]
    v_fma_mix_f32 v85, v85, v229, -v5 op_sel_hi:[0,1,0]
    v_fma_mix_f32 v5, v102, v230, 0 op_sel:[0,1,0] op_sel_hi:[0,1,0]
    v_fma_mix_f32 v6, v102, v230, 0 op_sel_hi:[0,1,0]
    v_fma_mix_f32 v102, v86, v230, v6 op_sel:[0,1,0] op_sel_hi:[0,1,0]
    v_fma_mix_f32 v86, v86, v230, -v5 op_sel_hi:[0,1,0]
    v_fma_mix_f32 v5, v103, v231, 0 op_sel:[0,1,0] op_sel_hi:[0,1,0]
    v_fma_mix_f32 v6, v103, v231, 0 op_sel_hi:[0,1,0]
    v_fma_mix_f32 v103, v87, v231, v6 op_sel:[0,1,0] op_sel_hi:[0,1,0]
    v_fma_mix_f32 v87, v87, v231, -v5 op_sel_hi:[0,1,0]
    s_cmp_eq_u32 s78, 1
    s_cbranch_scc1 K2NQ3
    s_lshl_b32 s74, s24, 10
    s_add_u32 s74, s74, 38912
    s_cmp_ge_u32 s24, 2
    s_cselect_b32 s73, 4294934528, 0
    s_add_u32 s74, s74, s73
    s_mov_b32 m0, s74
    s_nop 0
    buffer_load_dwordx4 v3, s[64:67], s74 offen lds
    buffer_load_dwordx4 v[52:55], v3, s[12:15], s76 offen offset:3072
K2NQ3:
    ds_read_b128 v[228:231], v7 offset:29696
    s_waitcnt lgkmcnt(1)
    v_fma_mix_f32 v5, v120, v224, 0 op_sel:[0,1,0] op_sel_hi:[0,1,0]
    v_fma_mix_f32 v6, v120, v224, 0 op_sel_hi:[0,1,0]
    v_fma_mix_f32 v120, v104, v224, v6 op_sel:[0,1,0] op_sel_hi:[0,1,0]
    v_fma_mix_f32 v104, v104, v224, -v5 op_sel_hi:[0,1,0]
    v_fma_mix_f32 v5, v121, v225, 0 op_sel:[0,1,0] op_sel_hi:[0,1,0]
    v_fma_mix_f32 v6, v121, v225, 0 op_sel_hi:[0,1,0]
    v_fma_mix_f32 v121, v105, v225, v6 op_sel:[0,1,0] op_sel_hi:[0,1,0]
    v_fma_mix_f32 v105, v105, v225, -v5 op_sel_hi:[0,1,0]
    v_fma_mix_f32 v5, v122, v226, 0 op_sel:[0,1,0] op_sel_hi:[0,1,0]
    v_fma_mix_f32 v6, v122, v226, 0 op_sel_hi:[0,1,0]
    v_fma_mix_f32 v122, v106, v226, v6 op_sel:[0,1,0] op_sel_hi:[0,1,0]
    v_fma_mix_f32 v106, v106, v226, -v5 op_sel_hi:[0,1,0]
    v_fma_mix_f32 v5, v123, v227, 0 op_sel:[0,1,0] op_sel_hi:[0,1,0]
    v_fma_mix_f32 v6, v123, v227, 0 op_sel_hi:[0,1,0]
    v_fma_mix_f32 v123, v107, v227, v6 op_sel:[0,1,0] op_sel_hi:[0,1,0]
    v_fma_mix_f32 v107, v107, v227, -v5 op_sel_hi:[0,1,0]
    s_cmp_eq_u32 s78, 1
    s_cbranch_scc1 K2NQ4
    buffer_load_dwordx4 v[56:59], v3, s[12:15], s77 offen offset:0
K2NQ4:
    ds_read_b128 v[224:227], v7 offset:30720
    s_waitcnt lgkmcnt(1)
    v_fma_mix_f32 v5, v124, v228, 0 op_sel:[0,1,0] op_sel_hi:[0,1,0]
    v_fma_mix_f32 v6, v124, v228, 0 op_sel_hi:[0,1,0]
    v_fma_mix_f32 v124, v108, v228, v6 op_sel:[0,1,0] op_sel_hi:[0,1,0]
    v_fma_mix_f32 v108, v108, v228, -v5 op_sel_hi:[0,1,0]
    v_fma_mix_f32 v5, v125, v229, 0 op_sel:[0,1,0] op_sel_hi:[0,1,0]
    v_fma_mix_f32 v6, v125, v229, 0 op_sel_hi:[0,1,0]
    v_fma_mix_f32 v125, v109, v229, v6 op_sel:[0,1,0] op_sel_hi:[0,1,0]
    v_fma_mix_f32 v109, v109, v229, -v5 op_sel_hi:[0,1,0]
    v_fma_mix_f32 v5, v126, v230, 0 op_sel:[0,1,0] op_sel_hi:[0,1,0]
    v_fma_mix_f32 v6, v126, v230, 0 op_sel_hi:[0,1,0]
    v_fma_mix_f32 v126, v110, v230, v6 op_sel:[0,1,0] op_sel_hi:[0,1,0]
    v_fma_mix_f32 v110, v110, v230, -v5 op_sel_hi:[0,1,0]
    v_fma_mix_f32 v5, v127, v231, 0 op_sel:[0,1,0] op_sel_hi:[0,1,0]
    v_fma_mix_f32 v6, v127, v231, 0 op_sel_hi:[0,1,0]
    v_fma_mix_f32 v127, v111, v231, v6 op_sel:[0,1,0] op_sel_hi:[0,1,0]
    v_fma_mix_f32 v111, v111, v231, -v5 op_sel_hi:[0,1,0]
    s_cmp_eq_u32 s78, 1
    s_cbranch_scc1 K2NQ5
    buffer_load_dwordx4 v[60:63], v3, s[12:15], s77 offen offset:1024
K2NQ5:
    ds_read_b128 v[228:231], v7 offset:31744
    s_waitcnt lgkmcnt(1)
    v_fma_mix_f32 v5, v128, v224, 0 op_sel:[0,1,0] op_sel_hi:[0,1,0]
    v_fma_mix_f32 v6, v128, v224, 0 op_sel_hi:[0,1,0]
    v_fma_mix_f32 v128, v112, v224, v6 op_sel:[0,1,0] op_sel_hi:[0,1,0]
    v_fma_mix_f32 v112, v112, v224, -v5 op_sel_hi:[0,1,0]
    v_fma_mix_f32 v5, v129, v225, 0 op_sel:[0,1,0] op_sel_hi:[0,1,0]
    v_fma_mix_f32 v6, v129, v225, 0 op_sel_hi:[0,1,0]
    v_fma_mix_f32 v129, v113, v225, v6 op_sel:[0,1,0] op_sel_hi:[0,1,0]
    v_fma_mix_f32 v113, v113, v225, -v5 op_sel_hi:[0,1,0]
    v_fma_mix_f32 v5, v130, v226, 0 op_sel:[0,1,0] op_sel_hi:[0,1,0]
    v_fma_mix_f32 v6, v130, v226, 0 op_sel_hi:[0,1,0]
    v_fma_mix_f32 v130, v114, v226, v6 op_sel:[0,1,0] op_sel_hi:[0,1,0]
    v_fma_mix_f32 v114, v114, v226, -v5 op_sel_hi:[0,1,0]
    v_fma_mix_f32 v5, v131, v227, 0 op_sel:[0,1,0] op_sel_hi:[0,1,0]
    v_fma_mix_f32 v6, v131, v227, 0 op_sel_hi:[0,1,0]
    v_fma_mix_f32 v131, v115, v227, v6 op_sel:[0,1,0] op_sel_hi:[0,1,0]
    v_fma_mix_f32 v115, v115, v227, -v5 op_sel_hi:[0,1,0]
    s_cmp_eq_u32 s78, 1
    s_cbranch_scc1 K2NQ6
    buffer_load_dwordx4 v[64:67], v3, s[12:15], s77 offen offset:2048
K2NQ6:
    s_waitcnt lgkmcnt(0)
    v_fma_mix_f32 v5, v132, v228, 0 op_sel:[0,1,0] op_sel_hi:[0,1,0]
    v_fma_mix_f32 v6, v132, v228, 0 op_sel_hi:[0,1,0]
    v_fma_mix_f32 v132, v116, v228, v6 op_sel:[0,1,0] op_sel_hi:[0,1,0]
    v_fma_mix_f32 v116, v116, v228, -v5 op_sel_hi:[0,1,0]
    v_fma_mix_f32 v5, v133, v229, 0 op_sel:[0,1,0] op_sel_hi:[0,1,0]
    v_fma_mix_f32 v6, v133, v229, 0 op_sel_hi:[0,1,0]
    v_fma_mix_f32 v133, v117, v229, v6 op_sel:[0,1,0] op_sel_hi:[0,1,0]
    v_fma_mix_f32 v117, v117, v229, -v5 op_sel_hi:[0,1,0]
    v_fma_mix_f32 v5, v134, v230, 0 op_sel:[0,1,0] op_sel_hi:[0,1,0]
    v_fma_mix_f32 v6, v134, v230, 0 op_sel_hi:[0,1,0]
    v_fma_mix_f32 v134, v118, v230, v6 op_sel:[0,1,0] op_sel_hi:[0,1,0]
    v_fma_mix_f32 v118, v118, v230, -v5 op_sel_hi:[0,1,0]
    v_fma_mix_f32 v5, v135, v231, 0 op_sel:[0,1,0] op_sel_hi:[0,1,0]
    v_fma_mix_f32 v6, v135, v231, 0 op_sel_hi:[0,1,0]
    v_fma_mix_f32 v135, v119, v231, v6 op_sel:[0,1,0] op_sel_hi:[0,1,0]
    v_fma_mix_f32 v119, v119, v231, -v5 op_sel_hi:[0,1,0]
    s_cmp_eq_u32 s78, 1
    s_cbranch_scc1 K2NQ7
    buffer_load_dwordx4 v[68:71], v3, s[12:15], s77 offen offset:3072
K2NQ7:
    s_cmp_eq_u32 s78, 1
    s_cbranch_scc1 K2WDa
    s_waitcnt vmcnt(5)
    s_branch K2WDb
K2WDa:
    s_waitcnt vmcnt(8)
K2WDb:
    s_cmp_eq_u32 s78, 1
    s_cbranch_scc1 K2NB
    s_barrier
K2NB:
    s_cmp_eq_u32 s78, 1
    s_cbranch_scc1 K2NW1
    s_mul_i32 s52, s25, 27
    s_add_u32 s57, s52, 26
    s_lshr_b32 s57, s57, 3
    s_lshr_b32 s52, s52, 3
    s_sub_u32 s57, s57, s52
    s_lshl_b32 s52, s52, 7
    s_cmp_eq_u32 s57, 4
    s_cselect_b32 s57, 0xff, 0
    s_sub_u32 s53, s26, 27
    s_lshl_b32 s53, s53, 3
    s_add_u32 s53, s53, s24
    s_add_u32 s53, s53, 1792
    s_mov_b32 m0, 122880
    s_mov_b32 exec_hi, s57
    s_add_u32 s54, s53, 0
    s_lshr_b32 s55, s54, 7
    s_lshl_b32 s55, s55, 2
    s_and_b32 s56, s54, 31
    s_lshl_b32 s56, s56, 6
    s_add_u32 s55, s55, s56
    s_bfe_u32 s56, s54, 0x20005
    s_lshl_b32 s56, s56, 0
    s_add_u32 s55, s55, s56
    s_mul_i32 s55, s55, 3456
    s_add_u32 s55, s55, s52
    buffer_load_dwordx4 v3, s[8:11], s55 offen lds
    s_add_u32 s54, s53, 40
    s_lshr_b32 s55, s54, 7
    s_lshl_b32 s55, s55, 2
    s_and_b32 s56, s54, 31
    s_lshl_b32 s56, s56, 6
    s_add_u32 s55, s55, s56
    s_bfe_u32 s56, s54, 0x20005
    s_lshl_b32 s56, s56, 0
    s_add_u32 s55, s55, s56
    s_mul_i32 s55, s55, 3456
    s_add_u32 s55, s55, s52
    buffer_load_dwordx4 v3, s[8:11], s55 offen lds
    s_add_u32 s54, s53, 80
    s_lshr_b32 s55, s54, 7
    s_lshl_b32 s55, s55, 2
    s_and_b32 s56, s54, 31
    s_lshl_b32 s56, s56, 6
    s_add_u32 s55, s55, s56
    s_bfe_u32 s56, s54, 0x20005
    s_lshl_b32 s56, s56, 0
    s_add_u32 s55, s55, s56
    s_mul_i32 s55, s55, 3456
    s_add_u32 s55, s55, s52
    buffer_load_dwordx4 v3, s[8:11], s55 offen lds
    s_add_u32 s54, s53, 120
    s_lshr_b32 s55, s54, 7
    s_lshl_b32 s55, s55, 2
    s_and_b32 s56, s54, 31
    s_lshl_b32 s56, s56, 6
    s_add_u32 s55, s55, s56
    s_bfe_u32 s56, s54, 0x20005
    s_lshl_b32 s56, s56, 0
    s_add_u32 s55, s55, s56
    s_mul_i32 s55, s55, 3456
    s_add_u32 s55, s55, s52
    buffer_load_dwordx4 v3, s[8:11], s55 offen lds
    s_add_u32 s54, s53, 160
    s_lshr_b32 s55, s54, 7
    s_lshl_b32 s55, s55, 2
    s_and_b32 s56, s54, 31
    s_lshl_b32 s56, s56, 6
    s_add_u32 s55, s55, s56
    s_bfe_u32 s56, s54, 0x20005
    s_lshl_b32 s56, s56, 0
    s_add_u32 s55, s55, s56
    s_mul_i32 s55, s55, 3456
    s_add_u32 s55, s55, s52
    buffer_load_dwordx4 v3, s[8:11], s55 offen lds
    s_add_u32 s54, s53, 200
    s_lshr_b32 s55, s54, 7
    s_lshl_b32 s55, s55, 2
    s_and_b32 s56, s54, 31
    s_lshl_b32 s56, s56, 6
    s_add_u32 s55, s55, s56
    s_bfe_u32 s56, s54, 0x20005
    s_lshl_b32 s56, s56, 0
    s_add_u32 s55, s55, s56
    s_mul_i32 s55, s55, 3456
    s_add_u32 s55, s55, s52
    buffer_load_dwordx4 v3, s[8:11], s55 offen lds
    s_add_u32 s54, s53, 240
    s_cmp_ge_u32 s54, 2048
    s_cbranch_scc1 K2_W1PF_END
    s_lshr_b32 s55, s54, 7
    s_lshl_b32 s55, s55, 2
    s_and_b32 s56, s54, 31
    s_lshl_b32 s56, s56, 6
    s_add_u32 s55, s55, s56
    s_bfe_u32 s56, s54, 0x20005
    s_lshl_b32 s56, s56, 0
    s_add_u32 s55, s55, s56
    s_mul_i32 s55, s55, 3456
    s_add_u32 s55, s55, s52
    buffer_load_dwordx4 v3, s[8:11], s55 offen lds
K2_W1PF_END:
    s_mov_b32 exec_hi, -1
K2NW1:
    v_cvt_pk_bf16_f32 v8, v72, v74
    v_cvt_pk_bf16_f32 v9, v76, v78
    v_cvt_pk_bf16_f32 v10, v80, v82
    v_cvt_pk_bf16_f32 v11, v84, v86
    v_cvt_pk_bf16_f32 v12, v88, v90
    v_cvt_pk_bf16_f32 v13, v92, v94
    v_cvt_pk_bf16_f32 v14, v96, v98
    v_cvt_pk_bf16_f32 v15, v100, v102
    v_cvt_pk_bf16_f32 v16, v104, v106
    v_cvt_pk_bf16_f32 v17, v108, v110
    v_cvt_pk_bf16_f32 v18, v112, v114
    v_cvt_pk_bf16_f32 v19, v116, v118
    v_cvt_pk_bf16_f32 v20, v120, v122
    v_cvt_pk_bf16_f32 v21, v124, v126
    v_cvt_pk_bf16_f32 v22, v128, v130
    v_cvt_pk_bf16_f32 v23, v132, v134
    v_cvt_pk_bf16_f32 v24, v73, v75
    v_cvt_pk_bf16_f32 v25, v77, v79
    v_cvt_pk_bf16_f32 v26, v81, v83
    v_cvt_pk_bf16_f32 v27, v85, v87
    v_cvt_pk_bf16_f32 v28, v89, v91
    v_cvt_pk_bf16_f32 v29, v93, v95
    v_cvt_pk_bf16_f32 v30, v97, v99
    v_cvt_pk_bf16_f32 v31, v101, v103
    v_cvt_pk_bf16_f32 v32, v105, v107
    v_cvt_pk_bf16_f32 v33, v109, v111
    v_cvt_pk_bf16_f32 v34, v113, v115
    v_cvt_pk_bf16_f32 v35, v117, v119
    v_cvt_pk_bf16_f32 v36, v121, v123
    v_cvt_pk_bf16_f32 v37, v125, v127
    v_cvt_pk_bf16_f32 v38, v129, v131
    v_cvt_pk_bf16_f32 v39, v133, v135
    ds_read_b128 v[200:203], v7 offset:6144
    ds_read_b128 v[204:207], v7 offset:7168
    ds_read_b128 v[208:211], v7 offset:8192
    ds_read_b128 v[212:215], v7 offset:9216
    ds_read_b128 v[216:219], v7 offset:10240
    ds_read_b128 v[220:223], v7 offset:11264
    s_waitcnt lgkmcnt(0)
    v_mfma_f32_32x32x16_bf16 v[136:151], v[200:203], v[8:11], 0
    v_mfma_f32_32x32x16_bf16 v[152:167], v[208:211], v[8:11], 0
    v_mfma_f32_32x32x16_bf16 v[136:151], v[204:207], v[16:19], v[136:151]
    v_mfma_f32_32x32x16_bf16 v[152:167], v[212:215], v[16:19], v[152:167]
    v_mfma_f32_32x32x16_bf16 v[136:151], v[216:219], v[12:15], v[136:151]
    v_mfma_f32_32x32x16_bf16 v[152:167], v[200:203], v[12:15], v[152:167]
    v_mfma_f32_32x32x16_bf16 v[136:151], v[220:223], v[20:23], v[136:151]
    v_mfma_f32_32x32x16_bf16 v[152:167], v[204:207], v[20:23], v[152:167]
    s_nop 1
    ds_read_b128 v[200:203], v7 offset:12288
    ds_read_b128 v[204:207], v7 offset:13312
    ds_read_b128 v[208:211], v7 offset:14336
    ds_read_b128 v[212:215], v7 offset:15360
    ds_read_b128 v[216:219], v7 offset:16384
    ds_read_b128 v[220:223], v7 offset:17408
    s_waitcnt lgkmcnt(0)
    v_mfma_f32_32x32x16_bf16 v[168:183], v[200:203], v[24:27], 0
    v_mfma_f32_32x32x16_bf16 v[184:199], v[208:211], v[24:27], 0
    v_mfma_f32_32x32x16_bf16 v[168:183], v[204:207], v[32:35], v[168:183]
    v_mfma_f32_32x32x16_bf16 v[184:199], v[212:215], v[32:35], v[184:199]
    v_mfma_f32_32x32x16_bf16 v[168:183], v[216:219], v[28:31], v[168:183]
    v_mfma_f32_32x32x16_bf16 v[184:199], v[200:203], v[28:31], v[184:199]
    v_mfma_f32_32x32x16_bf16 v[168:183], v[220:223], v[36:39], v[168:183]
    v_mfma_f32_32x32x16_bf16 v[184:199], v[204:207], v[36:39], v[184:199]
    s_cmp_eq_u32 s78, 1
    s_cbranch_scc0 K2SB
    s_mov_b32 m0, 100352
    s_mov_b32 s74, 18432
    buffer_load_dwordx4 v3, s[64:67], s74 offen lds
    s_mov_b32 m0, 101376
    s_mov_b32 s74, 19456
    buffer_load_dwordx4 v3, s[64:67], s74 offen lds
    s_mov_b32 m0, 102400
    s_mov_b32 s74, 20480
    buffer_load_dwordx4 v3, s[64:67], s74 offen lds
    s_mov_b32 m0, 103424
    s_mov_b32 s74, 21504
    buffer_load_dwordx4 v3, s[64:67], s74 offen lds
    s_mov_b32 m0, 104448
    s_mov_b32 s74, 22528
    buffer_load_dwordx4 v3, s[64:67], s74 offen lds
    s_mov_b32 m0, 105472
    s_mov_b32 s74, 23552
    buffer_load_dwordx4 v3, s[64:67], s74 offen lds
    s_mov_b32 m0, 114688
    s_mov_b32 s74, 32768
    buffer_load_dwordx4 v3, s[64:67], s74 offen lds
    s_mov_b32 m0, 115712
    s_mov_b32 s74, 33792
    buffer_load_dwordx4 v3, s[64:67], s74 offen lds
    s_mov_b32 m0, 116736
    s_mov_b32 s74, 34816
    buffer_load_dwordx4 v3, s[64:67], s74 offen lds
    s_mov_b32 m0, 117760
    s_mov_b32 s74, 35840
    buffer_load_dwordx4 v3, s[64:67], s74 offen lds
    s_mov_b32 m0, 118784
    s_mov_b32 s74, 36864
    buffer_load_dwordx4 v3, s[64:67], s74 offen lds
    s_mov_b32 m0, 119808
    s_mov_b32 s74, 37888
    buffer_load_dwordx4 v3, s[64:67], s74 offen lds
    s_mov_b32 m0, 120832
    s_mov_b32 s74, 38912
    buffer_load_dwordx4 v3, s[64:67], s74 offen lds
    s_mov_b32 m0, 121856
    s_mov_b32 s74, 39936
    buffer_load_dwordx4 v3, s[64:67], s74 offen lds
K2SB:
    s_cmp_eq_u32 s78, 1
    s_cbranch_scc1 K2WBa
    s_waitcnt vmcnt(6)
    s_branch K2WBb
K2WBa:
    s_waitcnt vmcnt(14)
K2WBb:
    s_nop 7
    s_nop 3
    v_lshlrev_b32 v224, 16, v40
    v_lshlrev_b32 v225, 16, v42
    v_lshlrev_b32 v226, 16, v56
    v_lshlrev_b32 v227, 16, v58
    v_add_f32 v228, v136, v168
    v_add_f32 v229, v152, v184
    v_sub_f32 v230, v136, v168
    v_sub_f32 v231, v152, v184
    v_mul_f32 v232, v228, v224
    v_mul_f32 v233, v228, v225
    v_mul_f32 v234, v230, v226
    v_mul_f32 v235, v230, v227
    v_fma_f32 v232, -v229, v225, v232
    v_fmac_f32 v233, v229, v224
    v_fma_f32 v234, -v231, v227, v234
    v_fmac_f32 v235, v231, v226
    v_add_f32 v72, v232, v234
    v_add_f32 v88, v233, v235
    v_sub_f32 v104, v232, v234
    v_sub_f32 v120, v233, v235
    v_and_b32 v224, s43, v40
    v_and_b32 v225, s43, v42
    v_and_b32 v226, s43, v56
    v_and_b32 v227, s43, v58
    v_add_f32 v228, v137, v169
    v_add_f32 v229, v153, v185
    v_sub_f32 v230, v137, v169
    v_sub_f32 v231, v153, v185
    v_mul_f32 v232, v228, v224
    v_mul_f32 v233, v228, v225
    v_mul_f32 v234, v230, v226
    v_mul_f32 v235, v230, v227
    v_fma_f32 v232, -v229, v225, v232
    v_fmac_f32 v233, v229, v224
    v_fma_f32 v234, -v231, v227, v234
    v_fmac_f32 v235, v231, v226
    v_add_f32 v73, v232, v234
    v_add_f32 v89, v233, v235
    v_sub_f32 v105, v232, v234
    v_sub_f32 v121, v233, v235
    v_lshlrev_b32 v224, 16, v41
    v_lshlrev_b32 v225, 16, v43
    v_lshlrev_b32 v226, 16, v57
    v_lshlrev_b32 v227, 16, v59
    v_add_f32 v228, v138, v170
    v_add_f32 v229, v154, v186
    v_sub_f32 v230, v138, v170
    v_sub_f32 v231, v154, v186
    v_mul_f32 v232, v228, v224
    v_mul_f32 v233, v228, v225
    v_mul_f32 v234, v230, v226
    v_mul_f32 v235, v230, v227
    v_fma_f32 v232, -v229, v225, v232
    v_fmac_f32 v233, v229, v224
    v_fma_f32 v234, -v231, v227, v234
    v_fmac_f32 v235, v231, v226
    v_add_f32 v74, v232, v234
    v_add_f32 v90, v233, v235
    v_sub_f32 v106, v232, v234
    v_sub_f32 v122, v233, v235
    v_and_b32 v224, s43, v41
    v_and_b32 v225, s43, v43
    v_and_b32 v226, s43, v57
    v_and_b32 v227, s43, v59
    v_add_f32 v228, v139, v171
    v_add_f32 v229, v155, v187
    v_sub_f32 v230, v139, v171
    v_sub_f32 v231, v155, v187
    v_mul_f32 v232, v228, v224
    v_mul_f32 v233, v228, v225
    v_mul_f32 v234, v230, v226
    v_mul_f32 v235, v230, v227
    v_fma_f32 v232, -v229, v225, v232
    v_fmac_f32 v233, v229, v224
    v_fma_f32 v234, -v231, v227, v234
    v_fmac_f32 v235, v231, v226
    v_add_f32 v75, v232, v234
    v_add_f32 v91, v233, v235
    v_sub_f32 v107, v232, v234
    v_sub_f32 v123, v233, v235
    s_cmp_eq_u32 s78, 1
    s_cbranch_scc1 K2T0
    s_mov_b32 m0, 122880
    s_nop 0
    buffer_load_dwordx4 v240, s[68:71], s59 offen lds
    s_add_u32 s59, s59, 327680
K2T0:
    v_lshlrev_b32 v224, 16, v44
    v_lshlrev_b32 v225, 16, v46
    v_lshlrev_b32 v226, 16, v60
    v_lshlrev_b32 v227, 16, v62
    v_add_f32 v228, v140, v172
    v_add_f32 v229, v156, v188
    v_sub_f32 v230, v140, v172
    v_sub_f32 v231, v156, v188
    v_mul_f32 v232, v228, v224
    v_mul_f32 v233, v228, v225
    v_mul_f32 v234, v230, v226
    v_mul_f32 v235, v230, v227
    v_fma_f32 v232, -v229, v225, v232
    v_fmac_f32 v233, v229, v224
    v_fma_f32 v234, -v231, v227, v234
    v_fmac_f32 v235, v231, v226
    v_add_f32 v76, v232, v234
    v_add_f32 v92, v233, v235
    v_sub_f32 v108, v232, v234
    v_sub_f32 v124, v233, v235
    v_and_b32 v224, s43, v44
    v_and_b32 v225, s43, v46
    v_and_b32 v226, s43, v60
    v_and_b32 v227, s43, v62
    v_add_f32 v228, v141, v173
    v_add_f32 v229, v157, v189
    v_sub_f32 v230, v141, v173
    v_sub_f32 v231, v157, v189
    v_mul_f32 v232, v228, v224
    v_mul_f32 v233, v228, v225
    v_mul_f32 v234, v230, v226
    v_mul_f32 v235, v230, v227
    v_fma_f32 v232, -v229, v225, v232
    v_fmac_f32 v233, v229, v224
    v_fma_f32 v234, -v231, v227, v234
    v_fmac_f32 v235, v231, v226
    v_add_f32 v77, v232, v234
    v_add_f32 v93, v233, v235
    v_sub_f32 v109, v232, v234
    v_sub_f32 v125, v233, v235
    v_lshlrev_b32 v224, 16, v45
    v_lshlrev_b32 v225, 16, v47
    v_lshlrev_b32 v226, 16, v61
    v_lshlrev_b32 v227, 16, v63
    v_add_f32 v228, v142, v174
    v_add_f32 v229, v158, v190
    v_sub_f32 v230, v142, v174
    v_sub_f32 v231, v158, v190
    v_mul_f32 v232, v228, v224
    v_mul_f32 v233, v228, v225
    v_mul_f32 v234, v230, v226
    v_mul_f32 v235, v230, v227
    v_fma_f32 v232, -v229, v225, v232
    v_fmac_f32 v233, v229, v224
    v_fma_f32 v234, -v231, v227, v234
    v_fmac_f32 v235, v231, v226
    v_add_f32 v78, v232, v234
    v_add_f32 v94, v233, v235
    v_sub_f32 v110, v232, v234
    v_sub_f32 v126, v233, v235
    v_and_b32 v224, s43, v45
    v_and_b32 v225, s43, v47
    v_and_b32 v226, s43, v61
    v_and_b32 v227, s43, v63
    v_add_f32 v228, v143, v175
    v_add_f32 v229, v159, v191
    v_sub_f32 v230, v143, v175
    v_sub_f32 v231, v159, v191
    v_mul_f32 v232, v228, v224
    v_mul_f32 v233, v228, v225
    v_mul_f32 v234, v230, v226
    v_mul_f32 v235, v230, v227
    v_fma_f32 v232, -v229, v225, v232
    v_fmac_f32 v233, v229, v224
    v_fma_f32 v234, -v231, v227, v234
    v_fmac_f32 v235, v231, v226
    v_add_f32 v79, v232, v234
    v_add_f32 v95, v233, v235
    v_sub_f32 v111, v232, v234
    v_sub_f32 v127, v233, v235
    s_cmp_eq_u32 s78, 1
    s_cbranch_scc1 K2T1
    s_mov_b32 m0, 122880
    s_nop 0
    buffer_load_dwordx4 v240, s[68:71], s59 offen lds
    s_add_u32 s59, s59, 327680
K2T1:
    v_lshlrev_b32 v224, 16, v48
    v_lshlrev_b32 v225, 16, v50
    v_lshlrev_b32 v226, 16, v64
    v_lshlrev_b32 v227, 16, v66
    v_add_f32 v228, v144, v176
    v_add_f32 v229, v160, v192
    v_sub_f32 v230, v144, v176
    v_sub_f32 v231, v160, v192
    v_mul_f32 v232, v228, v224
    v_mul_f32 v233, v228, v225
    v_mul_f32 v234, v230, v226
    v_mul_f32 v235, v230, v227
    v_fma_f32 v232, -v229, v225, v232
    v_fmac_f32 v233, v229, v224
    v_fma_f32 v234, -v231, v227, v234
    v_fmac_f32 v235, v231, v226
    v_add_f32 v80, v232, v234
    v_add_f32 v96, v233, v235
    v_sub_f32 v112, v232, v234
    v_sub_f32 v128, v233, v235
    v_and_b32 v224, s43, v48
    v_and_b32 v225, s43, v50
    v_and_b32 v226, s43, v64
    v_and_b32 v227, s43, v66
    v_add_f32 v228, v145, v177
    v_add_f32 v229, v161, v193
    v_sub_f32 v230, v145, v177
    v_sub_f32 v231, v161, v193
    v_mul_f32 v232, v228, v224
    v_mul_f32 v233, v228, v225
    v_mul_f32 v234, v230, v226
    v_mul_f32 v235, v230, v227
    v_fma_f32 v232, -v229, v225, v232
    v_fmac_f32 v233, v229, v224
    v_fma_f32 v234, -v231, v227, v234
    v_fmac_f32 v235, v231, v226
    v_add_f32 v81, v232, v234
    v_add_f32 v97, v233, v235
    v_sub_f32 v113, v232, v234
    v_sub_f32 v129, v233, v235
    v_lshlrev_b32 v224, 16, v49
    v_lshlrev_b32 v225, 16, v51
    v_lshlrev_b32 v226, 16, v65
    v_lshlrev_b32 v227, 16, v67
    v_add_f32 v228, v146, v178
    v_add_f32 v229, v162, v194
    v_sub_f32 v230, v146, v178
    v_sub_f32 v231, v162, v194
    v_mul_f32 v232, v228, v224
    v_mul_f32 v233, v228, v225
    v_mul_f32 v234, v230, v226
    v_mul_f32 v235, v230, v227
    v_fma_f32 v232, -v229, v225, v232
    v_fmac_f32 v233, v229, v224
    v_fma_f32 v234, -v231, v227, v234
    v_fmac_f32 v235, v231, v226
    v_add_f32 v82, v232, v234
    v_add_f32 v98, v233, v235
    v_sub_f32 v114, v232, v234
    v_sub_f32 v130, v233, v235
    v_and_b32 v224, s43, v49
    v_and_b32 v225, s43, v51
    v_and_b32 v226, s43, v65
    v_and_b32 v227, s43, v67
    v_add_f32 v228, v147, v179
    v_add_f32 v229, v163, v195
    v_sub_f32 v230, v147, v179
    v_sub_f32 v231, v163, v195
    v_mul_f32 v232, v228, v224
    v_mul_f32 v233, v228, v225
    v_mul_f32 v234, v230, v226
    v_mul_f32 v235, v230, v227
    v_fma_f32 v232, -v229, v225, v232
    v_fmac_f32 v233, v229, v224
    v_fma_f32 v234, -v231, v227, v234
    v_fmac_f32 v235, v231, v226
    v_add_f32 v83, v232, v234
    v_add_f32 v99, v233, v235
    v_sub_f32 v115, v232, v234
    v_sub_f32 v131, v233, v235
    s_cmp_eq_u32 s78, 1
    s_cbranch_scc1 K2T2
    s_mov_b32 m0, 122880
    s_nop 0
    buffer_load_dwordx4 v240, s[68:71], s59 offen lds
    s_add_u32 s59, s59, 327680
K2T2:
    v_lshlrev_b32 v224, 16, v52
    v_lshlrev_b32 v225, 16, v54
    v_lshlrev_b32 v226, 16, v68
    v_lshlrev_b32 v227, 16, v70
    v_add_f32 v228, v148, v180
    v_add_f32 v229, v164, v196
    v_sub_f32 v230, v148, v180
    v_sub_f32 v231, v164, v196
    v_mul_f32 v232, v228, v224
    v_mul_f32 v233, v228, v225
    v_mul_f32 v234, v230, v226
    v_mul_f32 v235, v230, v227
    v_fma_f32 v232, -v229, v225, v232
    v_fmac_f32 v233, v229, v224
    v_fma_f32 v234, -v231, v227, v234
    v_fmac_f32 v235, v231, v226
    v_add_f32 v84, v232, v234
    v_add_f32 v100, v233, v235
    v_sub_f32 v116, v232, v234
    v_sub_f32 v132, v233, v235
    v_and_b32 v224, s43, v52
    v_and_b32 v225, s43, v54
    v_and_b32 v226, s43, v68
    v_and_b32 v227, s43, v70
    v_add_f32 v228, v149, v181
    v_add_f32 v229, v165, v197
    v_sub_f32 v230, v149, v181
    v_sub_f32 v231, v165, v197
    v_mul_f32 v232, v228, v224
    v_mul_f32 v233, v228, v225
    v_mul_f32 v234, v230, v226
    v_mul_f32 v235, v230, v227
    v_fma_f32 v232, -v229, v225, v232
    v_fmac_f32 v233, v229, v224
    v_fma_f32 v234, -v231, v227, v234
    v_fmac_f32 v235, v231, v226
    v_add_f32 v85, v232, v234
    v_add_f32 v101, v233, v235
    v_sub_f32 v117, v232, v234
    v_sub_f32 v133, v233, v235
    v_lshlrev_b32 v224, 16, v53
    v_lshlrev_b32 v225, 16, v55
    v_lshlrev_b32 v226, 16, v69
    v_lshlrev_b32 v227, 16, v71
    v_add_f32 v228, v150, v182
    v_add_f32 v229, v166, v198
    v_sub_f32 v230, v150, v182
    v_sub_f32 v231, v166, v198
    v_mul_f32 v232, v228, v224
    v_mul_f32 v233, v228, v225
    v_mul_f32 v234, v230, v226
    v_mul_f32 v235, v230, v227
    v_fma_f32 v232, -v229, v225, v232
    v_fmac_f32 v233, v229, v224
    v_fma_f32 v234, -v231, v227, v234
    v_fmac_f32 v235, v231, v226
    v_add_f32 v86, v232, v234
    v_add_f32 v102, v233, v235
    v_sub_f32 v118, v232, v234
    v_sub_f32 v134, v233, v235
    v_and_b32 v224, s43, v53
    v_and_b32 v225, s43, v55
    v_and_b32 v226, s43, v69
    v_and_b32 v227, s43, v71
    v_add_f32 v228, v151, v183
    v_add_f32 v229, v167, v199
    v_sub_f32 v230, v151, v183
    v_sub_f32 v231, v167, v199
    v_mul_f32 v232, v228, v224
    v_mul_f32 v233, v228, v225
    v_mul_f32 v234, v230, v226
    v_mul_f32 v235, v230, v227
    v_fma_f32 v232, -v229, v225, v232
    v_fmac_f32 v233, v229, v224
    v_fma_f32 v234, -v231, v227, v234
    v_fmac_f32 v235, v231, v226
    v_add_f32 v87, v232, v234
    v_add_f32 v103, v233, v235
    v_sub_f32 v119, v232, v234
    v_sub_f32 v135, v233, v235
    s_cmp_eq_u32 s78, 1
    s_cbranch_scc1 K2T3
    s_mov_b32 m0, 122880
    s_nop 0
    buffer_load_dwordx4 v240, s[68:71], s59 offen lds
    s_add_u32 s59, s59, 327680
K2T3:
    ds_read_b128 v[200:203], v7 offset:0
    ds_read_b128 v[204:207], v7 offset:1024
    ds_read_b128 v[208:211], v7 offset:2048
    ds_read_b128 v[212:215], v7 offset:3072
    ds_read_b128 v[216:219], v7 offset:4096
    ds_read_b128 v[220:223], v7 offset:5120
    v_cvt_pk_bf16_f32 v8, v72, v73
    v_cvt_pk_bf16_f32 v9, v74, v75
    v_cvt_pk_bf16_f32 v10, v76, v77
    v_cvt_pk_bf16_f32 v11, v78, v79
    v_cvt_pk_bf16_f32 v12, v80, v81
    v_cvt_pk_bf16_f32 v13, v82, v83
    v_cvt_pk_bf16_f32 v14, v84, v85
    v_cvt_pk_bf16_f32 v15, v86, v87
    v_cvt_pk_bf16_f32 v16, v88, v89
    v_cvt_pk_bf16_f32 v17, v90, v91
    v_cvt_pk_bf16_f32 v18, v92, v93
    v_cvt_pk_bf16_f32 v19, v94, v95
    v_cvt_pk_bf16_f32 v20, v96, v97
    v_cvt_pk_bf16_f32 v21, v98, v99
    v_cvt_pk_bf16_f32 v22, v100, v101
    v_cvt_pk_bf16_f32 v23, v102, v103
    v_cvt_pk_bf16_f32 v24, v104, v105
    v_cvt_pk_bf16_f32 v25, v106, v107
    v_cvt_pk_bf16_f32 v26, v108, v109
    v_cvt_pk_bf16_f32 v27, v110, v111
    v_cvt_pk_bf16_f32 v28, v112, v113
    v_cvt_pk_bf16_f32 v29, v114, v115
    v_cvt_pk_bf16_f32 v30, v116, v117
    v_cvt_pk_bf16_f32 v31, v118, v119
    v_cvt_pk_bf16_f32 v32, v120, v121
    v_cvt_pk_bf16_f32 v33, v122, v123
    v_cvt_pk_bf16_f32 v34, v124, v125
    v_cvt_pk_bf16_f32 v35, v126, v127
    v_cvt_pk_bf16_f32 v36, v128, v129
    v_cvt_pk_bf16_f32 v37, v130, v131
    v_cvt_pk_bf16_f32 v38, v132, v133
    v_cvt_pk_bf16_f32 v39, v134, v135
    s_waitcnt lgkmcnt(0)
    s_cmp_eq_u32 s78, 1
    s_cbranch_scc1 K2WGa
    s_waitcnt vmcnt(63)
    s_branch K2WGb
K2WGa:
    s_waitcnt vmcnt(8)
K2WGb:
    ds_read_b128 v[40:43], v7 offset:18432
    ds_read_b128 v[44:47], v7 offset:19456
    ds_read_b128 v[48:51], v7 offset:20480
    ds_read_b128 v[52:55], v7 offset:21504
    ds_read_b128 v[56:59], v7 offset:22528
    ds_read_b128 v[60:63], v7 offset:23552
    v_mfma_f32_32x32x16_bf16 v[136:151], v[8:11], v[200:203], 0
    v_mfma_f32_32x32x16_bf16 v[152:167], v[8:11], v[216:219], 0
    v_mfma_f32_32x32x16_bf16 v[136:151], v[12:15], v[204:207], v[136:151]
    v_mfma_f32_32x32x16_bf16 v[152:167], v[12:15], v[220:223], v[152:167]
    v_mfma_f32_32x32x16_bf16 v[136:151], v[16:19], v[208:211], v[136:151]
    v_mfma_f32_32x32x16_bf16 v[152:167], v[16:19], v[200:203], v[152:167]
    v_mfma_f32_32x32x16_bf16 v[136:151], v[20:23], v[212:215], v[136:151]
    v_mfma_f32_32x32x16_bf16 v[152:167], v[20:23], v[204:207], v[152:167]
    s_waitcnt lgkmcnt(0)
    v_mfma_f32_32x32x16_bf16 v[168:183], v[24:27], v[40:43], 0
    v_mfma_f32_32x32x16_bf16 v[184:199], v[24:27], v[48:51], 0
    v_mfma_f32_32x32x16_bf16 v[168:183], v[28:31], v[44:47], v[168:183]
    v_mfma_f32_32x32x16_bf16 v[184:199], v[28:31], v[52:55], v[184:199]
    v_mfma_f32_32x32x16_bf16 v[168:183], v[32:35], v[56:59], v[168:183]
    v_mfma_f32_32x32x16_bf16 v[184:199], v[32:35], v[40:43], v[184:199]
    v_mfma_f32_32x32x16_bf16 v[168:183], v[36:39], v[60:63], v[168:183]
    v_mfma_f32_32x32x16_bf16 v[184:199], v[36:39], v[44:47], v[184:199]
    s_cmp_eq_u32 s78, 1
    s_cbranch_scc1 K2WEa
    s_waitcnt vmcnt(63)
    s_branch K2WEb
K2WEa:
    s_waitcnt vmcnt(0)
K2WEb:
    s_nop 7
    s_nop 3
    ds_read_b128 v[224:227], v7 offset:32768
    ds_read_b128 v[228:231], v7 offset:33792
    s_waitcnt lgkmcnt(1)
    v_fma_mix_f32 v5, v152, v224, 0 op_sel:[0,1,0] op_sel_hi:[0,1,0]
    v_fma_mix_f32 v6, v152, v224, 0 op_sel_hi:[0,1,0]
    v_fma_mix_f32 v152, v136, v224, v6 op_sel:[0,1,0] op_sel_hi:[0,1,0]
    v_fma_mix_f32 v136, v136, v224, -v5 op_sel_hi:[0,1,0]
    v_fma_mix_f32 v5, v153, v225, 0 op_sel:[0,1,0] op_sel_hi:[0,1,0]
    v_fma_mix_f32 v6, v153, v225, 0 op_sel_hi:[0,1,0]
    v_fma_mix_f32 v153, v137, v225, v6 op_sel:[0,1,0] op_sel_hi:[0,1,0]
    v_fma_mix_f32 v137, v137, v225, -v5 op_sel_hi:[0,1,0]
    v_fma_mix_f32 v5, v154, v226, 0 op_sel:[0,1,0] op_sel_hi:[0,1,0]
    v_fma_mix_f32 v6, v154, v226, 0 op_sel_hi:[0,1,0]
    v_fma_mix_f32 v154, v138, v226, v6 op_sel:[0,1,0] op_sel_hi:[0,1,0]
    v_fma_mix_f32 v138, v138, v226, -v5 op_sel_hi:[0,1,0]
    v_fma_mix_f32 v5, v155, v227, 0 op_sel:[0,1,0] op_sel_hi:[0,1,0]
    v_fma_mix_f32 v6, v155, v227, 0 op_sel_hi:[0,1,0]
    v_fma_mix_f32 v155, v139, v227, v6 op_sel:[0,1,0] op_sel_hi:[0,1,0]
    v_fma_mix_f32 v139, v139, v227, -v5 op_sel_hi:[0,1,0]
    s_cmp_eq_u32 s78, 1
    s_cbranch_scc1 K2T4
    s_mov_b32 m0, 122880
    s_nop 0
    buffer_load_dwordx4 v240, s[68:71], s59 offen lds
    s_add_u32 s59, s59, 327680
K2T4:
    ds_read_b128 v[224:227], v7 offset:34816
    s_waitcnt lgkmcnt(1)
    v_fma_mix_f32 v5, v156, v228, 0 op_sel:[0,1,0] op_sel_hi:[0,1,0]
    v_fma_mix_f32 v6, v156, v228, 0 op_sel_hi:[0,1,0]
    v_fma_mix_f32 v156, v140, v228, v6 op_sel:[0,1,0] op_sel_hi:[0,1,0]
    v_fma_mix_f32 v140, v140, v228, -v5 op_sel_hi:[0,1,0]
    v_fma_mix_f32 v5, v157, v229, 0 op_sel:[0,1,0] op_sel_hi:[0,1,0]
    v_fma_mix_f32 v6, v157, v229, 0 op_sel_hi:[0,1,0]
    v_fma_mix_f32 v157, v141, v229, v6 op_sel:[0,1,0] op_sel_hi:[0,1,0]
    v_fma_mix_f32 v141, v141, v229, -v5 op_sel_hi:[0,1,0]
    v_fma_mix_f32 v5, v158, v230, 0 op_sel:[0,1,0] op_sel_hi:[0,1,0]
    v_fma_mix_f32 v6, v158, v230, 0 op_sel_hi:[0,1,0]
    v_fma_mix_f32 v158, v142, v230, v6 op_sel:[0,1,0] op_sel_hi:[0,1,0]
    v_fma_mix_f32 v142, v142, v230, -v5 op_sel_hi:[0,1,0]
    v_fma_mix_f32 v5, v159, v231, 0 op_sel:[0,1,0] op_sel_hi:[0,1,0]
    v_fma_mix_f32 v6, v159, v231, 0 op_sel_hi:[0,1,0]
    v_fma_mix_f32 v159, v143, v231, v6 op_sel:[0,1,0] op_sel_hi:[0,1,0]
    v_fma_mix_f32 v143, v143, v231, -v5 op_sel_hi:[0,1,0]
    ds_read_b128 v[228:231], v7 offset:35840
    s_waitcnt lgkmcnt(1)
    v_fma_mix_f32 v5, v160, v224, 0 op_sel:[0,1,0] op_sel_hi:[0,1,0]
    v_fma_mix_f32 v6, v160, v224, 0 op_sel_hi:[0,1,0]
    v_fma_mix_f32 v160, v144, v224, v6 op_sel:[0,1,0] op_sel_hi:[0,1,0]
    v_fma_mix_f32 v144, v144, v224, -v5 op_sel_hi:[0,1,0]
    v_fma_mix_f32 v5, v161, v225, 0 op_sel:[0,1,0] op_sel_hi:[0,1,0]
    v_fma_mix_f32 v6, v161, v225, 0 op_sel_hi:[0,1,0]
    v_fma_mix_f32 v161, v145, v225, v6 op_sel:[0,1,0] op_sel_hi:[0,1,0]
    v_fma_mix_f32 v145, v145, v225, -v5 op_sel_hi:[0,1,0]
    v_fma_mix_f32 v5, v162, v226, 0 op_sel:[0,1,0] op_sel_hi:[0,1,0]
    v_fma_mix_f32 v6, v162, v226, 0 op_sel_hi:[0,1,0]
    v_fma_mix_f32 v162, v146, v226, v6 op_sel:[0,1,0] op_sel_hi:[0,1,0]
    v_fma_mix_f32 v146, v146, v226, -v5 op_sel_hi:[0,1,0]
    v_fma_mix_f32 v5, v163, v227, 0 op_sel:[0,1,0] op_sel_hi:[0,1,0]
    v_fma_mix_f32 v6, v163, v227, 0 op_sel_hi:[0,1,0]
    v_fma_mix_f32 v163, v147, v227, v6 op_sel:[0,1,0] op_sel_hi:[0,1,0]
    v_fma_mix_f32 v147, v147, v227, -v5 op_sel_hi:[0,1,0]
    s_cmp_eq_u32 s78, 1
    s_cbranch_scc1 K2T5
    s_mov_b32 m0, 122880
    s_nop 0
    buffer_load_dwordx4 v240, s[68:71], s59 offen lds
    s_add_u32 s59, s59, 327680
K2T5:
    ds_read_b128 v[224:227], v7 offset:36864
    s_waitcnt lgkmcnt(1)
    v_fma_mix_f32 v5, v164, v228, 0 op_sel:[0,1,0] op_sel_hi:[0,1,0]
    v_fma_mix_f32 v6, v164, v228, 0 op_sel_hi:[0,1,0]
    v_fma_mix_f32 v164, v148, v228, v6 op_sel:[0,1,0] op_sel_hi:[0,1,0]
    v_fma_mix_f32 v148, v148, v228, -v5 op_sel_hi:[0,1,0]
    v_fma_mix_f32 v5, v165, v229, 0 op_sel:[0,1,0] op_sel_hi:[0,1,0]
    v_fma_mix_f32 v6, v165, v229, 0 op_sel_hi:[0,1,0]
    v_fma_mix_f32 v165, v149, v229, v6 op_sel:[0,1,0] op_sel_hi:[0,1,0]
    v_fma_mix_f32 v149, v149, v229, -v5 op_sel_hi:[0,1,0]
    v_fma_mix_f32 v5, v166, v230, 0 op_sel:[0,1,0] op_sel_hi:[0,1,0]
    v_fma_mix_f32 v6, v166, v230, 0 op_sel_hi:[0,1,0]
    v_fma_mix_f32 v166, v150, v230, v6 op_sel:[0,1,0] op_sel_hi:[0,1,0]
    v_fma_mix_f32 v150, v150, v230, -v5 op_sel_hi:[0,1,0]
    v_fma_mix_f32 v5, v167, v231, 0 op_sel:[0,1,0] op_sel_hi:[0,1,0]
    v_fma_mix_f32 v6, v167, v231, 0 op_sel_hi:[0,1,0]
    v_fma_mix_f32 v167, v151, v231, v6 op_sel:[0,1,0] op_sel_hi:[0,1,0]
    v_fma_mix_f32 v151, v151, v231, -v5 op_sel_hi:[0,1,0]
    ds_read_b128 v[228:231], v7 offset:37888
    s_waitcnt lgkmcnt(1)
    v_fma_mix_f32 v5, v184, v224, 0 op_sel:[0,1,0] op_sel_hi:[0,1,0]
    v_fma_mix_f32 v6, v184, v224, 0 op_sel_hi:[0,1,0]
    v_fma_mix_f32 v184, v168, v224, v6 op_sel:[0,1,0] op_sel_hi:[0,1,0]
    v_fma_mix_f32 v168, v168, v224, -v5 op_sel_hi:[0,1,0]
    v_fma_mix_f32 v5, v185, v225, 0 op_sel:[0,1,0] op_sel_hi:[0,1,0]
    v_fma_mix_f32 v6, v185, v225, 0 op_sel_hi:[0,1,0]
    v_fma_mix_f32 v185, v169, v225, v6 op_sel:[0,1,0] op_sel_hi:[0,1,0]
    v_fma_mix_f32 v169, v169, v225, -v5 op_sel_hi:[0,1,0]
    v_fma_mix_f32 v5, v186, v226, 0 op_sel:[0,1,0] op_sel_hi:[0,1,0]
    v_fma_mix_f32 v6, v186, v226, 0 op_sel_hi:[0,1,0]
    v_fma_mix_f32 v186, v170, v226, v6 op_sel:[0,1,0] op_sel_hi:[0,1,0]
    v_fma_mix_f32 v170, v170, v226, -v5 op_sel_hi:[0,1,0]
    v_fma_mix_f32 v5, v187, v227, 0 op_sel:[0,1,0] op_sel_hi:[0,1,0]
    v_fma_mix_f32 v6, v187, v227, 0 op_sel_hi:[0,1,0]
    v_fma_mix_f32 v187, v171, v227, v6 op_sel:[0,1,0] op_sel_hi:[0,1,0]
    v_fma_mix_f32 v171, v171, v227, -v5 op_sel_hi:[0,1,0]
    s_cmp_eq_u32 s78, 1
    s_cbranch_scc1 K2T6
    s_mov_b32 m0, 122880
    s_nop 0
    buffer_load_dwordx4 v240, s[68:71], s59 offen lds
    s_add_u32 s59, s59, 327680
K2T6:
    ds_read_b128 v[224:227], v7 offset:38912
    s_waitcnt lgkmcnt(1)
    v_fma_mix_f32 v5, v188, v228, 0 op_sel:[0,1,0] op_sel_hi:[0,1,0]
    v_fma_mix_f32 v6, v188, v228, 0 op_sel_hi:[0,1,0]
    v_fma_mix_f32 v188, v172, v228, v6 op_sel:[0,1,0] op_sel_hi:[0,1,0]
    v_fma_mix_f32 v172, v172, v228, -v5 op_sel_hi:[0,1,0]
    v_fma_mix_f32 v5, v189, v229, 0 op_sel:[0,1,0] op_sel_hi:[0,1,0]
    v_fma_mix_f32 v6, v189, v229, 0 op_sel_hi:[0,1,0]
    v_fma_mix_f32 v189, v173, v229, v6 op_sel:[0,1,0] op_sel_hi:[0,1,0]
    v_fma_mix_f32 v173, v173, v229, -v5 op_sel_hi:[0,1,0]
    v_fma_mix_f32 v5, v190, v230, 0 op_sel:[0,1,0] op_sel_hi:[0,1,0]
    v_fma_mix_f32 v6, v190, v230, 0 op_sel_hi:[0,1,0]
    v_fma_mix_f32 v190, v174, v230, v6 op_sel:[0,1,0] op_sel_hi:[0,1,0]
    v_fma_mix_f32 v174, v174, v230, -v5 op_sel_hi:[0,1,0]
    v_fma_mix_f32 v5, v191, v231, 0 op_sel:[0,1,0] op_sel_hi:[0,1,0]
    v_fma_mix_f32 v6, v191, v231, 0 op_sel_hi:[0,1,0]
    v_fma_mix_f32 v191, v175, v231, v6 op_sel:[0,1,0] op_sel_hi:[0,1,0]
    v_fma_mix_f32 v175, v175, v231, -v5 op_sel_hi:[0,1,0]
    ds_read_b128 v[228:231], v7 offset:39936
    s_waitcnt lgkmcnt(1)
    v_fma_mix_f32 v5, v192, v224, 0 op_sel:[0,1,0] op_sel_hi:[0,1,0]
    v_fma_mix_f32 v6, v192, v224, 0 op_sel_hi:[0,1,0]
    v_fma_mix_f32 v192, v176, v224, v6 op_sel:[0,1,0] op_sel_hi:[0,1,0]
    v_fma_mix_f32 v176, v176, v224, -v5 op_sel_hi:[0,1,0]
    v_fma_mix_f32 v5, v193, v225, 0 op_sel:[0,1,0] op_sel_hi:[0,1,0]
    v_fma_mix_f32 v6, v193, v225, 0 op_sel_hi:[0,1,0]
    v_fma_mix_f32 v193, v177, v225, v6 op_sel:[0,1,0] op_sel_hi:[0,1,0]
    v_fma_mix_f32 v177, v177, v225, -v5 op_sel_hi:[0,1,0]
    v_fma_mix_f32 v5, v194, v226, 0 op_sel:[0,1,0] op_sel_hi:[0,1,0]
    v_fma_mix_f32 v6, v194, v226, 0 op_sel_hi:[0,1,0]
    v_fma_mix_f32 v194, v178, v226, v6 op_sel:[0,1,0] op_sel_hi:[0,1,0]
    v_fma_mix_f32 v178, v178, v226, -v5 op_sel_hi:[0,1,0]
    v_fma_mix_f32 v5, v195, v227, 0 op_sel:[0,1,0] op_sel_hi:[0,1,0]
    v_fma_mix_f32 v6, v195, v227, 0 op_sel_hi:[0,1,0]
    v_fma_mix_f32 v195, v179, v227, v6 op_sel:[0,1,0] op_sel_hi:[0,1,0]
    v_fma_mix_f32 v179, v179, v227, -v5 op_sel_hi:[0,1,0]
    s_cmp_eq_u32 s78, 1
    s_cbranch_scc1 K2T7
    s_mov_b32 m0, 122880
    s_nop 0
    buffer_load_dwordx4 v240, s[68:71], s59 offen lds
    s_add_u32 s59, s59, 327680
K2T7:
    s_waitcnt lgkmcnt(0)
    v_fma_mix_f32 v5, v196, v228, 0 op_sel:[0,1,0] op_sel_hi:[0,1,0]
    v_fma_mix_f32 v6, v196, v228, 0 op_sel_hi:[0,1,0]
    v_fma_mix_f32 v196, v180, v228, v6 op_sel:[0,1,0] op_sel_hi:[0,1,0]
    v_fma_mix_f32 v180, v180, v228, -v5 op_sel_hi:[0,1,0]
    v_fma_mix_f32 v5, v197, v229, 0 op_sel:[0,1,0] op_sel_hi:[0,1,0]
    v_fma_mix_f32 v6, v197, v229, 0 op_sel_hi:[0,1,0]
    v_fma_mix_f32 v197, v181, v229, v6 op_sel:[0,1,0] op_sel_hi:[0,1,0]
    v_fma_mix_f32 v181, v181, v229, -v5 op_sel_hi:[0,1,0]
    v_fma_mix_f32 v5, v198, v230, 0 op_sel:[0,1,0] op_sel_hi:[0,1,0]
    v_fma_mix_f32 v6, v198, v230, 0 op_sel_hi:[0,1,0]
    v_fma_mix_f32 v198, v182, v230, v6 op_sel:[0,1,0] op_sel_hi:[0,1,0]
    v_fma_mix_f32 v182, v182, v230, -v5 op_sel_hi:[0,1,0]
    v_fma_mix_f32 v5, v199, v231, 0 op_sel:[0,1,0] op_sel_hi:[0,1,0]
    v_fma_mix_f32 v6, v199, v231, 0 op_sel_hi:[0,1,0]
    v_fma_mix_f32 v199, v183, v231, v6 op_sel:[0,1,0] op_sel_hi:[0,1,0]
    v_fma_mix_f32 v183, v183, v231, -v5 op_sel_hi:[0,1,0]
    v_cvt_pk_bf16_f32 v8, v136, v137
    v_cvt_pk_bf16_f32 v9, v138, v139
    v_cvt_pk_bf16_f32 v10, v140, v141
    v_cvt_pk_bf16_f32 v11, v142, v143
    v_cvt_pk_bf16_f32 v12, v144, v145
    v_cvt_pk_bf16_f32 v13, v146, v147
    v_cvt_pk_bf16_f32 v14, v148, v149
    v_cvt_pk_bf16_f32 v15, v150, v151
    v_cvt_pk_bf16_f32 v16, v152, v153
    v_cvt_pk_bf16_f32 v17, v154, v155
    v_cvt_pk_bf16_f32 v18, v156, v157
    v_cvt_pk_bf16_f32 v19, v158, v159
    v_cvt_pk_bf16_f32 v20, v160, v161
    v_cvt_pk_bf16_f32 v21, v162, v163
    v_cvt_pk_bf16_f32 v22, v164, v165
    v_cvt_pk_bf16_f32 v23, v166, v167
    v_cvt_pk_bf16_f32 v24, v168, v169
    v_cvt_pk_bf16_f32 v25, v170, v171
    v_cvt_pk_bf16_f32 v26, v172, v173
    v_cvt_pk_bf16_f32 v27, v174, v175
    v_cvt_pk_bf16_f32 v28, v176, v177
    v_cvt_pk_bf16_f32 v29, v178, v179
    v_cvt_pk_bf16_f32 v30, v180, v181
    v_cvt_pk_bf16_f32 v31, v182, v183
    v_cvt_pk_bf16_f32 v32, v184, v185
    v_cvt_pk_bf16_f32 v33, v186, v187
    v_cvt_pk_bf16_f32 v34, v188, v189
    v_cvt_pk_bf16_f32 v35, v190, v191
    v_cvt_pk_bf16_f32 v36, v192, v193
    v_cvt_pk_bf16_f32 v37, v194, v195
    v_cvt_pk_bf16_f32 v38, v196, v197
    v_cvt_pk_bf16_f32 v39, v198, v199
    s_nop 1
    v_mfma_f32_32x32x16_bf16 v[72:87], v[200:203], v[8:11], 0
    v_mfma_f32_32x32x16_bf16 v[72:87], v[204:207], v[12:15], v[72:87]
    v_mfma_f32_32x32x16_bf16 v[72:87], v[208:211], v[16:19], v[72:87]
    v_mfma_f32_32x32x16_bf16 v[72:87], v[212:215], v[20:23], v[72:87]
    v_mfma_f32_32x32x16_bf16 v[104:119], v[200:203], v[24:27], 0
    v_mfma_f32_32x32x16_bf16 v[104:119], v[204:207], v[28:31], v[104:119]
    v_mfma_f32_32x32x16_bf16 v[104:119], v[208:211], v[32:35], v[104:119]
    v_mfma_f32_32x32x16_bf16 v[104:119], v[212:215], v[36:39], v[104:119]
    s_cmp_eq_u32 s78, 1
    s_cbranch_scc1 K2NIM
    v_mfma_f32_32x32x16_bf16 v[88:103], v[216:219], v[8:11], 0
    v_mfma_f32_32x32x16_bf16 v[88:103], v[220:223], v[12:15], v[88:103]
    v_mfma_f32_32x32x16_bf16 v[88:103], v[200:203], v[16:19], v[88:103]
    v_mfma_f32_32x32x16_bf16 v[88:103], v[204:207], v[20:23], v[88:103]
    v_mfma_f32_32x32x16_bf16 v[120:135], v[216:219], v[24:27], 0
    v_mfma_f32_32x32x16_bf16 v[120:135], v[220:223], v[28:31], v[120:135]
    v_mfma_f32_32x32x16_bf16 v[120:135], v[200:203], v[32:35], v[120:135]
    v_mfma_f32_32x32x16_bf16 v[120:135], v[204:207], v[36:39], v[120:135]
K2NIM:
    s_and_b32 s73, s72, 1
    s_mul_i32 s73, s73, 319
    s_add_u32 s74, s72, s73
    s_cmp_eq_u32 s72, 320
    s_cselect_b32 s74, 1, s74
    s_mul_i32 s74, s74, 4224
    s_add_u32 s74, s74, 10158080
    s_add_u32 s75, s74, 4224
    s_nop 7
    v_cvt_pk_bf16_f32 v8, v72, v104
    v_cvt_pk_bf16_f32 v9, v73, v105
    v_cvt_pk_bf16_f32 v10, v74, v106
    v_cvt_pk_bf16_f32 v11, v75, v107
    v_cvt_pk_bf16_f32 v12, v76, v108
    v_cvt_pk_bf16_f32 v13, v77, v109
    v_cvt_pk_bf16_f32 v14, v78, v110
    v_cvt_pk_bf16_f32 v15, v79, v111
    v_cvt_pk_bf16_f32 v16, v80, v112
    v_cvt_pk_bf16_f32 v17, v81, v113
    v_cvt_pk_bf16_f32 v18, v82, v114
    v_cvt_pk_bf16_f32 v19, v83, v115
    v_cvt_pk_bf16_f32 v20, v84, v116
    v_cvt_pk_bf16_f32 v21, v85, v117
    v_cvt_pk_bf16_f32 v22, v86, v118
    v_cvt_pk_bf16_f32 v23, v87, v119
    buffer_store_dword v8, v4, s[12:15], s74 offen offset:0 sc1
    buffer_store_dword v9, v4, s[12:15], s74 offen offset:128 sc1
    buffer_store_dword v10, v4, s[12:15], s74 offen offset:256 sc1
    buffer_store_dword v11, v4, s[12:15], s74 offen offset:384 sc1
    buffer_store_dword v12, v4, s[12:15], s74 offen offset:1024 sc1
    buffer_store_dword v13, v4, s[12:15], s74 offen offset:1152 sc1
    buffer_store_dword v14, v4, s[12:15], s74 offen offset:1280 sc1
    buffer_store_dword v15, v4, s[12:15], s74 offen offset:1408 sc1
    buffer_store_dword v16, v4, s[12:15], s74 offen offset:2048 sc1
    buffer_store_dword v17, v4, s[12:15], s74 offen offset:2176 sc1
    buffer_store_dword v18, v4, s[12:15], s74 offen offset:2304 sc1
    buffer_store_dword v19, v4, s[12:15], s74 offen offset:2432 sc1
    buffer_store_dword v20, v4, s[12:15], s74 offen offset:3072 sc1
    buffer_store_dword v21, v4, s[12:15], s74 offen offset:3200 sc1
    buffer_store_dword v22, v4, s[12:15], s74 offen offset:3328 sc1
    buffer_store_dword v23, v4, s[12:15], s74 offen offset:3456 sc1
    s_setprio 0
    s_cmp_eq_u32 s72, 320
    s_cbranch_scc1 K2_EPI_S
    s_cmp_eq_u32 s72, 0
    s_cbranch_scc1 K2_FFT_PF
    v_cvt_pk_bf16_f32 v24, v88, v120
    v_cvt_pk_bf16_f32 v25, v89, v121
    v_cvt_pk_bf16_f32 v26, v90, v122
    v_cvt_pk_bf16_f32 v27, v91, v123
    v_cvt_pk_bf16_f32 v28, v92, v124
    v_cvt_pk_bf16_f32 v29, v93, v125
    v_cvt_pk_bf16_f32 v30, v94, v126
    v_cvt_pk_bf16_f32 v31, v95, v127
    v_cvt_pk_bf16_f32 v32, v96, v128
    v_cvt_pk_bf16_f32 v33, v97, v129
    v_cvt_pk_bf16_f32 v34, v98, v130
    v_cvt_pk_bf16_f32 v35, v99, v131
    v_cvt_pk_bf16_f32 v36, v100, v132
    v_cvt_pk_bf16_f32 v37, v101, v133
    v_cvt_pk_bf16_f32 v38, v102, v134
    v_cvt_pk_bf16_f32 v39, v103, v135
    buffer_store_dword v24, v4, s[12:15], s75 offen offset:0 sc1
    buffer_store_dword v25, v4, s[12:15], s75 offen offset:128 sc1
    buffer_store_dword v26, v4, s[12:15], s75 offen offset:256 sc1
    buffer_store_dword v27, v4, s[12:15], s75 offen offset:384 sc1
    buffer_store_dword v28, v4, s[12:15], s75 offen offset:1024 sc1
    buffer_store_dword v29, v4, s[12:15], s75 offen offset:1152 sc1
    buffer_store_dword v30, v4, s[12:15], s75 offen offset:1280 sc1
    buffer_store_dword v31, v4, s[12:15], s75 offen offset:1408 sc1
    buffer_store_dword v32, v4, s[12:15], s75 offen offset:2048 sc1
    buffer_store_dword v33, v4, s[12:15], s75 offen offset:2176 sc1
    buffer_store_dword v34, v4, s[12:15], s75 offen offset:2304 sc1
    buffer_store_dword v35, v4, s[12:15], s75 offen offset:2432 sc1
    buffer_store_dword v36, v4, s[12:15], s75 offen offset:3072 sc1
    buffer_store_dword v37, v4, s[12:15], s75 offen offset:3200 sc1
    buffer_store_dword v38, v4, s[12:15], s75 offen offset:3328 sc1
    buffer_store_dword v39, v4, s[12:15], s75 offen offset:3456 sc1
K2_FFT_PF:
    s_sub_u32 s57, s26, 27
    s_lshl_b32 s57, s57, 3
    s_add_u32 s57, s57, s24
    s_cmp_ge_u32 s57, 20
    s_cbranch_scc1 K2_PFC3_END
    s_getpc_b64 s[52:53]
    s_add_u32 s52, s52, k3_kernel@rel32@lo+4
    s_addc_u32 s53, s53, k3_kernel@rel32@hi+12
    s_mov_b32 s48, s52
    s_and_b32 s49, s53, 0xffff
    s_mov_b32 s50, CODE_END-k3_kernel
    s_mov_b32 s51, 0x20000
    s_mov_b32 m0, 122880
    s_lshl_b32 s57, s57, 10
    buffer_load_dwordx4 v3, s[48:51], s57 offen lds
K2_PFC3_END:
    s_sub_u32 s59, s26, 27
    s_lshl_b32 s59, s59, 3
    s_add_u32 s59, s59, s24
    s_add_u32 s59, s59, 108
    s_branch K2_END
K2_END:
    s_endpgm
K2_OOB:
    s_endpgm
    .globl k3_kernel
    .p2align 8
    .type k3_kernel,@function
k3_kernel:
    s_cmp_ge_u32 s2, 256
    s_cbranch_scc1 K3_OOB
K3_ENTRY:
    s_load_dwordx4 s[4:7], s[0:1], 48
    s_load_dwordx2 s[28:29], s[0:1], 88
    s_load_dwordx2 s[30:31], s[0:1], 72
    v_lshrrev_b32 v1, 6, v0
    v_and_b32 v2, 63, v0
    s_and_b32 s25, s2, 7
    s_lshr_b32 s26, s2, 3
    v_readfirstlane_b32 s24, v1
    s_lshl_b32 s27, s25, 2
    s_lshr_b32 s32, s26, 3
    s_add_u32 s27, s27, s32
    s_and_b32 s32, s26, 7
    s_cmp_eq_u32 s24, 3
    s_cbranch_scc1 K3_APART
    s_cmp_ge_u32 s24, 4
    s_cbranch_scc1 K3_SPARE
    s_mul_i32 s36, s24, 22528
    v_lshrrev_b32 v13, 3, v2
    v_lshrrev_b32 v14, 1, v13
    v_and_b32 v14, 3, v14
    v_lshlrev_b32 v14, 1, v14
    v_and_b32 v15, 7, v2
    v_xor_b32 v14, v14, v15
    v_lshlrev_b32 v1, 4, v14
    v_lshlrev_b32 v13, 12, v13
    v_add_u32 v3, v13, v1
    v_lshlrev_b32 v4, 4, v2
    v_add_u32 v5, 55296, v4
    v_add_u32 v6, 110592, v4
    v_add_u32 v7, 165888, v4
    v_add_u32 v8, 221184, v4
    s_mul_i32 s38, s24, 1
    s_lshl_b32 s39, s38, 17
    s_lshl_b32 s40, s27, 7
    s_add_u32 s39, s39, s40
    s_mul_i32 s40, s32, 270
    s_add_u32 s40, s40, s38
    s_lshl_b32 s40, s40, 10
    s_add_u32 s40, s40, 7946240
    s_mul_i32 s44, s32, 18
    s_lshr_b32 s44, s44, 3
    s_waitcnt lgkmcnt(0)
    s_mov_b32 s12, s28
    s_and_b32 s13, s29, 0xffff
    s_mov_b32 s14, 13414400
    s_mov_b32 s15, 0x20000
    s_mov_b32 s8, s4
    s_and_b32 s9, s5, 0xffff
    s_mov_b32 s10, 7077888
    s_mov_b32 s11, 0x20000
    s_mul_i32 s42, s44, 393216
    s_mul_i32 s43, s44, 3072
    s_add_u32 s42, s42, s39
    s_add_u32 s43, s43, s40
    s_add_u32 m0, s36, 0
    s_nop 0
    buffer_load_dwordx4 v3, s[8:11], s42 offen lds
    s_add_u32 m0, s36, 1024
    s_add_u32 s41, s42, 32768
    buffer_load_dwordx4 v3, s[8:11], s41 offen lds
    s_add_u32 m0, s36, 2048
    s_add_u32 s41, s42, 65536
    buffer_load_dwordx4 v3, s[8:11], s41 offen lds
    s_add_u32 m0, s36, 3072
    s_add_u32 s41, s42, 98304
    buffer_load_dwordx4 v3, s[8:11], s41 offen lds
    buffer_load_dwordx4 v[112:115], v4, s[12:15], s43 offen
    buffer_load_dwordx4 v[116:119], v5, s[12:15], s43 offen
    buffer_load_dwordx4 v[120:123], v6, s[12:15], s43 offen
    buffer_load_dwordx4 v[124:127], v7, s[12:15], s43 offen
    buffer_load_dwordx4 v[128:131], v8, s[12:15], s43 offen
    s_add_u32 s44, s44, 1
    s_cmp_eq_u32 s44, 18
    s_cselect_b32 s44, 0, s44
    s_mul_i32 s42, s44, 393216
    s_mul_i32 s43, s44, 3072
    s_add_u32 s42, s42, s39
    s_add_u32 s43, s43, s40
    s_add_u32 m0, s36, 4096
    s_nop 0
    buffer_load_dwordx4 v3, s[8:11], s42 offen lds
    s_add_u32 m0, s36, 5120
    s_add_u32 s41, s42, 32768
    buffer_load_dwordx4 v3, s[8:11], s41 offen lds
    s_add_u32 m0, s36, 6144
    s_add_u32 s41, s42, 65536
    buffer_load_dwordx4 v3, s[8:11], s41 offen lds
    s_add_u32 m0, s36, 7168
    s_add_u32 s41, s42, 98304
    buffer_load_dwordx4 v3, s[8:11], s41 offen lds
    buffer_load_dwordx4 v[132:135], v4, s[12:15], s43 offen
    buffer_load_dwordx4 v[136:139], v5, s[12:15], s43 offen
    buffer_load_dwordx4 v[140:143], v6, s[12:15], s43 offen
    buffer_load_dwordx4 v[144:147], v7, s[12:15], s43 offen
    buffer_load_dwordx4 v[148:151], v8, s[12:15], s43 offen
    s_add_u32 s44, s44, 1
    s_cmp_eq_u32 s44, 18
    s_cselect_b32 s44, 0, s44
    v_lshrrev_b32 v13, 4, v2
    v_and_b32 v14, 15, v2
    v_lshrrev_b32 v15, 2, v14
    v_and_b32 v14, 3, v14
    v_lshl_add_u32 v13, v13, 2, v15
    v_lshrrev_b32 v15, 1, v13
    v_and_b32 v15, 3, v15
    v_lshlrev_b32 v13, 7, v13
    v_lshl_add_u32 v13, v14, 3, v13
    v_add_u32 v13, s36, v13
    v_xor_b32 v1, 0, v15
    v_lshl_add_u32 v9, v1, 5, v13
    v_xor_b32 v1, 1, v15
    v_lshl_add_u32 v10, v1, 5, v13
    v_xor_b32 v1, 2, v15
    v_lshl_add_u32 v11, v1, 5, v13
    v_xor_b32 v1, 3, v15
    v_lshl_add_u32 v12, v1, 5, v13
    s_mov_b32 s16, s6
    s_and_b32 s17, s7, 0xffff
    s_mov_b32 s18, 4096
    s_mov_b32 s19, 0x20000
    s_mov_b32 s20, s30
    s_and_b32 s21, s31, 0xffff
    s_mov_b32 s22, 2621440
    s_mov_b32 s23, 0x20000
    s_movk_i32 s45, 6554
    s_mul_i32 s46, s32, 80
    s_lshl_b32 s47, s27, 6
    s_mov_b32 s48, 7938048
    v_mov_b32 v200, v0
    v_mul_u32_u24 v201, s45, v200
    v_lshrrev_b32 v201, 16, v201
    v_mul_u32_u24 v202, 10, v201
    v_sub_u32 v202, v200, v202
    v_add_u32 v203, s47, v201
    v_lshlrev_b32 v204, 2, v203
    v_lshlrev_b32 v205, 1, v203
    buffer_load_dword v206, v204, s[12:15], s48 offen
    buffer_load_ushort v207, v205, s[16:19], 0 offen
    v_cmp_lt_u32 vcc, 4, v202
    v_add_u32 v200, 35, v202
    v_add_u32 v208, 1, v202
    v_cndmask_b32 v200, v202, v200, vcc
    v_cndmask_b32 v202, v202, v208, vcc
    v_cmp_eq_u32 vcc, 10, v202
    v_mov_b32 v208, 5
    s_nop 0
    v_cndmask_b32 v202, v202, v208, vcc
    v_lshrrev_b32 v208, 4, v201
    v_mul_u32_u24 v208, 5, v208
    v_lshrrev_b32 v209, 1, v202
    v_add_u32 v208, v208, v209
    v_mul_u32_u24 v208, 1088, v208
    v_and_b32 v209, 1, v202
    v_mul_u32_u24 v209, 544, v209
    v_add_u32 v208, v208, v209
    v_and_b32 v209, 15, v201
    v_lshl_add_u32 v208, v209, 4, v208
    v_add_u32 v209, 45056, v208
    v_mul_u32_u24 v210, 1280, v203
    v_lshl_add_u32 v210, v200, 4, v210
    v_lshrrev_b32 v212, 2, v0
    v_add_u32 v212, 512, v212
    v_mul_u32_u24 v213, s45, v212
    v_lshrrev_b32 v213, 16, v213
    v_mul_u32_u24 v214, 10, v213
    v_sub_u32 v214, v212, v214
    v_add_u32 v215, s47, v213
    v_lshlrev_b32 v216, 2, v215
    v_lshlrev_b32 v217, 1, v215
    buffer_load_dword v218, v216, s[12:15], s48 offen
    buffer_load_ushort v219, v217, s[16:19], 0 offen
    v_cmp_lt_u32 vcc, 4, v214
    v_add_u32 v212, 35, v214
    v_add_u32 v220, 1, v214
    v_cndmask_b32 v212, v214, v212, vcc
    v_cndmask_b32 v214, v214, v220, vcc
    v_cmp_eq_u32 vcc, 10, v214
    v_mov_b32 v220, 5
    s_nop 0
    v_cndmask_b32 v214, v214, v220, vcc
    v_lshrrev_b32 v220, 4, v213
    v_mul_u32_u24 v220, 5, v220
    v_lshrrev_b32 v221, 1, v214
    v_add_u32 v220, v220, v221
    v_mul_u32_u24 v220, 1088, v220
    v_and_b32 v221, 1, v214
    v_mul_u32_u24 v221, 544, v221
    v_add_u32 v220, v220, v221
    v_and_b32 v221, 15, v213
    v_lshl_add_u32 v220, v221, 4, v220
    v_add_u32 v221, 45056, v220
    v_mul_u32_u24 v222, 1280, v215
    v_lshl_add_u32 v222, v212, 4, v222
    v_and_b32 v216, 3, v0
    v_lshl_add_u32 v222, v216, 2, v222
    v_lshrrev_b32 v217, 1, v216
    v_mul_u32_u24 v217, 272, v217
    v_and_b32 v216, 1, v216
    v_lshl_add_u32 v217, v216, 3, v217
    v_add_u32 v220, v220, v217
    v_add_u32 v221, v221, v217
    s_waitcnt vmcnt(13)
    ds_read_b64_tr_b16 v[96:97], v9 offset:0
    ds_read_b64_tr_b16 v[98:99], v9 offset:2048
    ds_read_b64_tr_b16 v[100:101], v10 offset:0
    ds_read_b64_tr_b16 v[102:103], v10 offset:2048
    ds_read_b64_tr_b16 v[104:105], v11 offset:0
    ds_read_b64_tr_b16 v[106:107], v11 offset:2048
    ds_read_b64_tr_b16 v[108:109], v12 offset:0
    ds_read_b64_tr_b16 v[110:111], v12 offset:2048
    s_mul_i32 s42, s44, 393216
    s_mul_i32 s43, s44, 3072
    s_add_u32 s42, s42, s39
    s_add_u32 s43, s43, s40
    s_add_u32 m0, s36, 8192
    s_nop 0
    buffer_load_dwordx4 v3, s[8:11], s42 offen lds
    s_add_u32 m0, s36, 9216
    s_add_u32 s41, s42, 32768
    buffer_load_dwordx4 v3, s[8:11], s41 offen lds
    s_add_u32 m0, s36, 10240
    s_add_u32 s41, s42, 65536
    buffer_load_dwordx4 v3, s[8:11], s41 offen lds
    s_add_u32 m0, s36, 11264
    s_add_u32 s41, s42, 98304
    buffer_load_dwordx4 v3, s[8:11], s41 offen lds
    buffer_load_dwordx4 v[152:155], v4, s[12:15], s43 offen
    buffer_load_dwordx4 v[156:159], v5, s[12:15], s43 offen
    buffer_load_dwordx4 v[160:163], v6, s[12:15], s43 offen
    buffer_load_dwordx4 v[164:167], v7, s[12:15], s43 offen
    buffer_load_dwordx4 v[168:171], v8, s[12:15], s43 offen
    s_add_u32 s44, s44, 1
    s_cmp_eq_u32 s44, 18
    s_cselect_b32 s44, 0, s44
    s_waitcnt lgkmcnt(6)
    v_mfma_f32_16x16x32_bf16 v[16:19], v[112:115], v[96:99], 0
    v_mfma_f32_16x16x32_bf16 v[20:23], v[116:119], v[96:99], 0
    v_mfma_f32_16x16x32_bf16 v[24:27], v[120:123], v[96:99], 0
    v_mfma_f32_16x16x32_bf16 v[28:31], v[124:127], v[96:99], 0
    v_mfma_f32_16x16x32_bf16 v[32:35], v[128:131], v[96:99], 0
    s_waitcnt lgkmcnt(4)
    v_mfma_f32_16x16x32_bf16 v[36:39], v[112:115], v[100:103], 0
    v_mfma_f32_16x16x32_bf16 v[40:43], v[116:119], v[100:103], 0
    v_mfma_f32_16x16x32_bf16 v[44:47], v[120:123], v[100:103], 0
    v_mfma_f32_16x16x32_bf16 v[48:51], v[124:127], v[100:103], 0
    v_mfma_f32_16x16x32_bf16 v[52:55], v[128:131], v[100:103], 0
    s_waitcnt lgkmcnt(2)
    v_mfma_f32_16x16x32_bf16 v[56:59], v[112:115], v[104:107], 0
    v_mfma_f32_16x16x32_bf16 v[60:63], v[116:119], v[104:107], 0
    v_mfma_f32_16x16x32_bf16 v[64:67], v[120:123], v[104:107], 0
    v_mfma_f32_16x16x32_bf16 v[68:71], v[124:127], v[104:107], 0
    v_mfma_f32_16x16x32_bf16 v[72:75], v[128:131], v[104:107], 0
    s_waitcnt lgkmcnt(0)
    v_mfma_f32_16x16x32_bf16 v[76:79], v[112:115], v[108:111], 0
    v_mfma_f32_16x16x32_bf16 v[80:83], v[116:119], v[108:111], 0
    v_mfma_f32_16x16x32_bf16 v[84:87], v[120:123], v[108:111], 0
    v_mfma_f32_16x16x32_bf16 v[88:91], v[124:127], v[108:111], 0
    v_mfma_f32_16x16x32_bf16 v[92:95], v[128:131], v[108:111], 0
    s_waitcnt vmcnt(13)
    ds_read_b64_tr_b16 v[96:97], v9 offset:4096
    ds_read_b64_tr_b16 v[98:99], v9 offset:6144
    ds_read_b64_tr_b16 v[100:101], v10 offset:4096
    ds_read_b64_tr_b16 v[102:103], v10 offset:6144
    ds_read_b64_tr_b16 v[104:105], v11 offset:4096
    ds_read_b64_tr_b16 v[106:107], v11 offset:6144
    ds_read_b64_tr_b16 v[108:109], v12 offset:4096
    ds_read_b64_tr_b16 v[110:111], v12 offset:6144
    s_mul_i32 s42, s44, 393216
    s_mul_i32 s43, s44, 3072
    s_add_u32 s42, s42, s39
    s_add_u32 s43, s43, s40
    s_add_u32 m0, s36, 0
    s_nop 0
    buffer_load_dwordx4 v3, s[8:11], s42 offen lds
    s_add_u32 m0, s36, 1024
    s_add_u32 s41, s42, 32768
    buffer_load_dwordx4 v3, s[8:11], s41 offen lds
    s_add_u32 m0, s36, 2048
    s_add_u32 s41, s42, 65536
    buffer_load_dwordx4 v3, s[8:11], s41 offen lds
    s_add_u32 m0, s36, 3072
    s_add_u32 s41, s42, 98304
    buffer_load_dwordx4 v3, s[8:11], s41 offen lds
    buffer_load_dwordx4 v[112:115], v4, s[12:15], s43 offen
    buffer_load_dwordx4 v[116:119], v5, s[12:15], s43 offen
    buffer_load_dwordx4 v[120:123], v6, s[12:15], s43 offen
    buffer_load_dwordx4 v[124:127], v7, s[12:15], s43 offen
    buffer_load_dwordx4 v[128:131], v8, s[12:15], s43 offen
    s_add_u32 s44, s44, 1
    s_cmp_eq_u32 s44, 18
    s_cselect_b32 s44, 0, s44
    s_waitcnt lgkmcnt(6)
    v_mfma_f32_16x16x32_bf16 v[16:19], v[132:135], v[96:99], v[16:19]
    v_mfma_f32_16x16x32_bf16 v[20:23], v[136:139], v[96:99], v[20:23]
    v_mfma_f32_16x16x32_bf16 v[24:27], v[140:143], v[96:99], v[24:27]
    v_mfma_f32_16x16x32_bf16 v[28:31], v[144:147], v[96:99], v[28:31]
    v_mfma_f32_16x16x32_bf16 v[32:35], v[148:151], v[96:99], v[32:35]
    s_waitcnt lgkmcnt(4)
    v_mfma_f32_16x16x32_bf16 v[36:39], v[132:135], v[100:103], v[36:39]
    v_mfma_f32_16x16x32_bf16 v[40:43], v[136:139], v[100:103], v[40:43]
    v_mfma_f32_16x16x32_bf16 v[44:47], v[140:143], v[100:103], v[44:47]
    v_mfma_f32_16x16x32_bf16 v[48:51], v[144:147], v[100:103], v[48:51]
    v_mfma_f32_16x16x32_bf16 v[52:55], v[148:151], v[100:103], v[52:55]
    s_waitcnt lgkmcnt(2)
    v_mfma_f32_16x16x32_bf16 v[56:59], v[132:135], v[104:107], v[56:59]
    v_mfma_f32_16x16x32_bf16 v[60:63], v[136:139], v[104:107], v[60:63]
    v_mfma_f32_16x16x32_bf16 v[64:67], v[140:143], v[104:107], v[64:67]
    v_mfma_f32_16x16x32_bf16 v[68:71], v[144:147], v[104:107], v[68:71]
    v_mfma_f32_16x16x32_bf16 v[72:75], v[148:151], v[104:107], v[72:75]
    s_waitcnt lgkmcnt(0)
    v_mfma_f32_16x16x32_bf16 v[76:79], v[132:135], v[108:111], v[76:79]
    v_mfma_f32_16x16x32_bf16 v[80:83], v[136:139], v[108:111], v[80:83]
    v_mfma_f32_16x16x32_bf16 v[84:87], v[140:143], v[108:111], v[84:87]
    v_mfma_f32_16x16x32_bf16 v[88:91], v[144:147], v[108:111], v[88:91]
    v_mfma_f32_16x16x32_bf16 v[92:95], v[148:151], v[108:111], v[92:95]
    s_waitcnt vmcnt(9)
    ds_read_b64_tr_b16 v[96:97], v9 offset:8192
    ds_read_b64_tr_b16 v[98:99], v9 offset:10240
    ds_read_b64_tr_b16 v[100:101], v10 offset:8192
    ds_read_b64_tr_b16 v[102:103], v10 offset:10240
    ds_read_b64_tr_b16 v[104:105], v11 offset:8192
    ds_read_b64_tr_b16 v[106:107], v11 offset:10240
    ds_read_b64_tr_b16 v[108:109], v12 offset:8192
    ds_read_b64_tr_b16 v[110:111], v12 offset:10240
    s_mul_i32 s42, s44, 393216
    s_mul_i32 s43, s44, 3072
    s_add_u32 s42, s42, s39
    s_add_u32 s43, s43, s40
    s_add_u32 m0, s36, 4096
    s_nop 0
    buffer_load_dwordx4 v3, s[8:11], s42 offen lds
    s_add_u32 m0, s36, 5120
    s_add_u32 s41, s42, 32768
    buffer_load_dwordx4 v3, s[8:11], s41 offen lds
    s_add_u32 m0, s36, 6144
    s_add_u32 s41, s42, 65536
    buffer_load_dwordx4 v3, s[8:11], s41 offen lds
    s_add_u32 m0, s36, 7168
    s_add_u32 s41, s42, 98304
    buffer_load_dwordx4 v3, s[8:11], s41 offen lds
    buffer_load_dwordx4 v[132:135], v4, s[12:15], s43 offen
    buffer_load_dwordx4 v[136:139], v5, s[12:15], s43 offen
    buffer_load_dwordx4 v[140:143], v6, s[12:15], s43 offen
    buffer_load_dwordx4 v[144:147], v7, s[12:15], s43 offen
    buffer_load_dwordx4 v[148:151], v8, s[12:15], s43 offen
    s_add_u32 s44, s44, 1
    s_cmp_eq_u32 s44, 18
    s_cselect_b32 s44, 0, s44
    s_waitcnt lgkmcnt(6)
    v_mfma_f32_16x16x32_bf16 v[16:19], v[152:155], v[96:99], v[16:19]
    v_mfma_f32_16x16x32_bf16 v[20:23], v[156:159], v[96:99], v[20:23]
    v_mfma_f32_16x16x32_bf16 v[24:27], v[160:163], v[96:99], v[24:27]
    v_mfma_f32_16x16x32_bf16 v[28:31], v[164:167], v[96:99], v[28:31]
    v_mfma_f32_16x16x32_bf16 v[32:35], v[168:171], v[96:99], v[32:35]
    s_waitcnt lgkmcnt(4)
    v_mfma_f32_16x16x32_bf16 v[36:39], v[152:155], v[100:103], v[36:39]
    v_mfma_f32_16x16x32_bf16 v[40:43], v[156:159], v[100:103], v[40:43]
    v_mfma_f32_16x16x32_bf16 v[44:47], v[160:163], v[100:103], v[44:47]
    v_mfma_f32_16x16x32_bf16 v[48:51], v[164:167], v[100:103], v[48:51]
    v_mfma_f32_16x16x32_bf16 v[52:55], v[168:171], v[100:103], v[52:55]
    s_waitcnt lgkmcnt(2)
    v_mfma_f32_16x16x32_bf16 v[56:59], v[152:155], v[104:107], v[56:59]
    v_mfma_f32_16x16x32_bf16 v[60:63], v[156:159], v[104:107], v[60:63]
    v_mfma_f32_16x16x32_bf16 v[64:67], v[160:163], v[104:107], v[64:67]
    v_mfma_f32_16x16x32_bf16 v[68:71], v[164:167], v[104:107], v[68:71]
    v_mfma_f32_16x16x32_bf16 v[72:75], v[168:171], v[104:107], v[72:75]
    s_waitcnt lgkmcnt(0)
    v_mfma_f32_16x16x32_bf16 v[76:79], v[152:155], v[108:111], v[76:79]
    v_mfma_f32_16x16x32_bf16 v[80:83], v[156:159], v[108:111], v[80:83]
    v_mfma_f32_16x16x32_bf16 v[84:87], v[160:163], v[108:111], v[84:87]
    v_mfma_f32_16x16x32_bf16 v[88:91], v[164:167], v[108:111], v[88:91]
    v_mfma_f32_16x16x32_bf16 v[92:95], v[168:171], v[108:111], v[92:95]
    s_waitcnt vmcnt(9)
    ds_read_b64_tr_b16 v[96:97], v9 offset:0
    ds_read_b64_tr_b16 v[98:99], v9 offset:2048
    ds_read_b64_tr_b16 v[100:101], v10 offset:0
    ds_read_b64_tr_b16 v[102:103], v10 offset:2048
    ds_read_b64_tr_b16 v[104:105], v11 offset:0
    ds_read_b64_tr_b16 v[106:107], v11 offset:2048
    ds_read_b64_tr_b16 v[108:109], v12 offset:0
    ds_read_b64_tr_b16 v[110:111], v12 offset:2048
    s_mul_i32 s42, s44, 393216
    s_mul_i32 s43, s44, 3072
    s_add_u32 s42, s42, s39
    s_add_u32 s43, s43, s40
    s_add_u32 m0, s36, 8192
    s_nop 0
    buffer_load_dwordx4 v3, s[8:11], s42 offen lds
    s_add_u32 m0, s36, 9216
    s_add_u32 s41, s42, 32768
    buffer_load_dwordx4 v3, s[8:11], s41 offen lds
    s_add_u32 m0, s36, 10240
    s_add_u32 s41, s42, 65536
    buffer_load_dwordx4 v3, s[8:11], s41 offen lds
    s_add_u32 m0, s36, 11264
    s_add_u32 s41, s42, 98304
    buffer_load_dwordx4 v3, s[8:11], s41 offen lds
    buffer_load_dwordx4 v[152:155], v4, s[12:15], s43 offen
    buffer_load_dwordx4 v[156:159], v5, s[12:15], s43 offen
    buffer_load_dwordx4 v[160:163], v6, s[12:15], s43 offen
    buffer_load_dwordx4 v[164:167], v7, s[12:15], s43 offen
    buffer_load_dwordx4 v[168:171], v8, s[12:15], s43 offen
    s_add_u32 s44, s44, 1
    s_cmp_eq_u32 s44, 18
    s_cselect_b32 s44, 0, s44
    s_waitcnt lgkmcnt(6)
    v_mfma_f32_16x16x32_bf16 v[16:19], v[112:115], v[96:99], v[16:19]
    v_mfma_f32_16x16x32_bf16 v[20:23], v[116:119], v[96:99], v[20:23]
    v_mfma_f32_16x16x32_bf16 v[24:27], v[120:123], v[96:99], v[24:27]
    v_mfma_f32_16x16x32_bf16 v[28:31], v[124:127], v[96:99], v[28:31]
    v_mfma_f32_16x16x32_bf16 v[32:35], v[128:131], v[96:99], v[32:35]
    s_waitcnt lgkmcnt(4)
    v_mfma_f32_16x16x32_bf16 v[36:39], v[112:115], v[100:103], v[36:39]
    v_mfma_f32_16x16x32_bf16 v[40:43], v[116:119], v[100:103], v[40:43]
    v_mfma_f32_16x16x32_bf16 v[44:47], v[120:123], v[100:103], v[44:47]
    v_mfma_f32_16x16x32_bf16 v[48:51], v[124:127], v[100:103], v[48:51]
    v_mfma_f32_16x16x32_bf16 v[52:55], v[128:131], v[100:103], v[52:55]
    s_waitcnt lgkmcnt(2)
    v_mfma_f32_16x16x32_bf16 v[56:59], v[112:115], v[104:107], v[56:59]
    v_mfma_f32_16x16x32_bf16 v[60:63], v[116:119], v[104:107], v[60:63]
    v_mfma_f32_16x16x32_bf16 v[64:67], v[120:123], v[104:107], v[64:67]
    v_mfma_f32_16x16x32_bf16 v[68:71], v[124:127], v[104:107], v[68:71]
    v_mfma_f32_16x16x32_bf16 v[72:75], v[128:131], v[104:107], v[72:75]
    s_waitcnt lgkmcnt(0)
    v_mfma_f32_16x16x32_bf16 v[76:79], v[112:115], v[108:111], v[76:79]
    v_mfma_f32_16x16x32_bf16 v[80:83], v[116:119], v[108:111], v[80:83]
    v_mfma_f32_16x16x32_bf16 v[84:87], v[120:123], v[108:111], v[84:87]
    v_mfma_f32_16x16x32_bf16 v[88:91], v[124:127], v[108:111], v[88:91]
    v_mfma_f32_16x16x32_bf16 v[92:95], v[128:131], v[108:111], v[92:95]
    s_waitcnt vmcnt(9)
    ds_read_b64_tr_b16 v[96:97], v9 offset:4096
    ds_read_b64_tr_b16 v[98:99], v9 offset:6144
    ds_read_b64_tr_b16 v[100:101], v10 offset:4096
    ds_read_b64_tr_b16 v[102:103], v10 offset:6144
    ds_read_b64_tr_b16 v[104:105], v11 offset:4096
    ds_read_b64_tr_b16 v[106:107], v11 offset:6144
    ds_read_b64_tr_b16 v[108:109], v12 offset:4096
    ds_read_b64_tr_b16 v[110:111], v12 offset:6144
    s_mul_i32 s42, s44, 393216
    s_mul_i32 s43, s44, 3072
    s_add_u32 s42, s42, s39
    s_add_u32 s43, s43, s40
    s_add_u32 m0, s36, 0
    s_nop 0
    buffer_load_dwordx4 v3, s[8:11], s42 offen lds
    s_add_u32 m0, s36, 1024
    s_add_u32 s41, s42, 32768
    buffer_load_dwordx4 v3, s[8:11], s41 offen lds
    s_add_u32 m0, s36, 2048
    s_add_u32 s41, s42, 65536
    buffer_load_dwordx4 v3, s[8:11], s41 offen lds
    s_add_u32 m0, s36, 3072
    s_add_u32 s41, s42, 98304
    buffer_load_dwordx4 v3, s[8:11], s41 offen lds
    buffer_load_dwordx4 v[112:115], v4, s[12:15], s43 offen
    buffer_load_dwordx4 v[116:119], v5, s[12:15], s43 offen
    buffer_load_dwordx4 v[120:123], v6, s[12:15], s43 offen
    buffer_load_dwordx4 v[124:127], v7, s[12:15], s43 offen
    buffer_load_dwordx4 v[128:131], v8, s[12:15], s43 offen
    s_add_u32 s44, s44, 1
    s_cmp_eq_u32 s44, 18
    s_cselect_b32 s44, 0, s44
    s_waitcnt lgkmcnt(6)
    v_mfma_f32_16x16x32_bf16 v[16:19], v[132:135], v[96:99], v[16:19]
    v_mfma_f32_16x16x32_bf16 v[20:23], v[136:139], v[96:99], v[20:23]
    v_mfma_f32_16x16x32_bf16 v[24:27], v[140:143], v[96:99], v[24:27]
    v_mfma_f32_16x16x32_bf16 v[28:31], v[144:147], v[96:99], v[28:31]
    v_mfma_f32_16x16x32_bf16 v[32:35], v[148:151], v[96:99], v[32:35]
    s_waitcnt lgkmcnt(4)
    v_mfma_f32_16x16x32_bf16 v[36:39], v[132:135], v[100:103], v[36:39]
    v_mfma_f32_16x16x32_bf16 v[40:43], v[136:139], v[100:103], v[40:43]
    v_mfma_f32_16x16x32_bf16 v[44:47], v[140:143], v[100:103], v[44:47]
    v_mfma_f32_16x16x32_bf16 v[48:51], v[144:147], v[100:103], v[48:51]
    v_mfma_f32_16x16x32_bf16 v[52:55], v[148:151], v[100:103], v[52:55]
    s_waitcnt lgkmcnt(2)
    v_mfma_f32_16x16x32_bf16 v[56:59], v[132:135], v[104:107], v[56:59]
    v_mfma_f32_16x16x32_bf16 v[60:63], v[136:139], v[104:107], v[60:63]
    v_mfma_f32_16x16x32_bf16 v[64:67], v[140:143], v[104:107], v[64:67]
    v_mfma_f32_16x16x32_bf16 v[68:71], v[144:147], v[104:107], v[68:71]
    v_mfma_f32_16x16x32_bf16 v[72:75], v[148:151], v[104:107], v[72:75]
    s_waitcnt lgkmcnt(0)
    v_mfma_f32_16x16x32_bf16 v[76:79], v[132:135], v[108:111], v[76:79]
    v_mfma_f32_16x16x32_bf16 v[80:83], v[136:139], v[108:111], v[80:83]
    v_mfma_f32_16x16x32_bf16 v[84:87], v[140:143], v[108:111], v[84:87]
    v_mfma_f32_16x16x32_bf16 v[88:91], v[144:147], v[108:111], v[88:91]
    v_mfma_f32_16x16x32_bf16 v[92:95], v[148:151], v[108:111], v[92:95]
    s_waitcnt vmcnt(9)
    ds_read_b64_tr_b16 v[96:97], v9 offset:8192
    ds_read_b64_tr_b16 v[98:99], v9 offset:10240
    ds_read_b64_tr_b16 v[100:101], v10 offset:8192
    ds_read_b64_tr_b16 v[102:103], v10 offset:10240
    ds_read_b64_tr_b16 v[104:105], v11 offset:8192
    ds_read_b64_tr_b16 v[106:107], v11 offset:10240
    ds_read_b64_tr_b16 v[108:109], v12 offset:8192
    ds_read_b64_tr_b16 v[110:111], v12 offset:10240
    s_mul_i32 s42, s44, 393216
    s_mul_i32 s43, s44, 3072
    s_add_u32 s42, s42, s39
    s_add_u32 s43, s43, s40
    s_add_u32 m0, s36, 4096
    s_nop 0
    buffer_load_dwordx4 v3, s[8:11], s42 offen lds
    s_add_u32 m0, s36, 5120
    s_add_u32 s41, s42, 32768
    buffer_load_dwordx4 v3, s[8:11], s41 offen lds
    s_add_u32 m0, s36, 6144
    s_add_u32 s41, s42, 65536
    buffer_load_dwordx4 v3, s[8:11], s41 offen lds
    s_add_u32 m0, s36, 7168
    s_add_u32 s41, s42, 98304
    buffer_load_dwordx4 v3, s[8:11], s41 offen lds
    buffer_load_dwordx4 v[132:135], v4, s[12:15], s43 offen
    buffer_load_dwordx4 v[136:139], v5, s[12:15], s43 offen
    buffer_load_dwordx4 v[140:143], v6, s[12:15], s43 offen
    buffer_load_dwordx4 v[144:147], v7, s[12:15], s43 offen
    buffer_load_dwordx4 v[148:151], v8, s[12:15], s43 offen
    s_add_u32 s44, s44, 1
    s_cmp_eq_u32 s44, 18
    s_cselect_b32 s44, 0, s44
    s_waitcnt lgkmcnt(6)
    v_mfma_f32_16x16x32_bf16 v[16:19], v[152:155], v[96:99], v[16:19]
    v_mfma_f32_16x16x32_bf16 v[20:23], v[156:159], v[96:99], v[20:23]
    v_mfma_f32_16x16x32_bf16 v[24:27], v[160:163], v[96:99], v[24:27]
    v_mfma_f32_16x16x32_bf16 v[28:31], v[164:167], v[96:99], v[28:31]
    v_mfma_f32_16x16x32_bf16 v[32:35], v[168:171], v[96:99], v[32:35]
    s_waitcnt lgkmcnt(4)
    v_mfma_f32_16x16x32_bf16 v[36:39], v[152:155], v[100:103], v[36:39]
    v_mfma_f32_16x16x32_bf16 v[40:43], v[156:159], v[100:103], v[40:43]
    v_mfma_f32_16x16x32_bf16 v[44:47], v[160:163], v[100:103], v[44:47]
    v_mfma_f32_16x16x32_bf16 v[48:51], v[164:167], v[100:103], v[48:51]
    v_mfma_f32_16x16x32_bf16 v[52:55], v[168:171], v[100:103], v[52:55]
    s_waitcnt lgkmcnt(2)
    v_mfma_f32_16x16x32_bf16 v[56:59], v[152:155], v[104:107], v[56:59]
    v_mfma_f32_16x16x32_bf16 v[60:63], v[156:159], v[104:107], v[60:63]
    v_mfma_f32_16x16x32_bf16 v[64:67], v[160:163], v[104:107], v[64:67]
    v_mfma_f32_16x16x32_bf16 v[68:71], v[164:167], v[104:107], v[68:71]
    v_mfma_f32_16x16x32_bf16 v[72:75], v[168:171], v[104:107], v[72:75]
    s_waitcnt lgkmcnt(0)
    v_mfma_f32_16x16x32_bf16 v[76:79], v[152:155], v[108:111], v[76:79]
    v_mfma_f32_16x16x32_bf16 v[80:83], v[156:159], v[108:111], v[80:83]
    v_mfma_f32_16x16x32_bf16 v[84:87], v[160:163], v[108:111], v[84:87]
    v_mfma_f32_16x16x32_bf16 v[88:91], v[164:167], v[108:111], v[88:91]
    v_mfma_f32_16x16x32_bf16 v[92:95], v[168:171], v[108:111], v[92:95]
    s_waitcnt vmcnt(9)
    ds_read_b64_tr_b16 v[96:97], v9 offset:0
    ds_read_b64_tr_b16 v[98:99], v9 offset:2048
    ds_read_b64_tr_b16 v[100:101], v10 offset:0
    ds_read_b64_tr_b16 v[102:103], v10 offset:2048
    ds_read_b64_tr_b16 v[104:105], v11 offset:0
    ds_read_b64_tr_b16 v[106:107], v11 offset:2048
    ds_read_b64_tr_b16 v[108:109], v12 offset:0
    ds_read_b64_tr_b16 v[110:111], v12 offset:2048
    s_mul_i32 s42, s44, 393216
    s_mul_i32 s43, s44, 3072
    s_add_u32 s42, s42, s39
    s_add_u32 s43, s43, s40
    s_add_u32 m0, s36, 8192
    s_nop 0
    buffer_load_dwordx4 v3, s[8:11], s42 offen lds
    s_add_u32 m0, s36, 9216
    s_add_u32 s41, s42, 32768
    buffer_load_dwordx4 v3, s[8:11], s41 offen lds
    s_add_u32 m0, s36, 10240
    s_add_u32 s41, s42, 65536
    buffer_load_dwordx4 v3, s[8:11], s41 offen lds
    s_add_u32 m0, s36, 11264
    s_add_u32 s41, s42, 98304
    buffer_load_dwordx4 v3, s[8:11], s41 offen lds
    buffer_load_dwordx4 v[152:155], v4, s[12:15], s43 offen
    buffer_load_dwordx4 v[156:159], v5, s[12:15], s43 offen
    buffer_load_dwordx4 v[160:163], v6, s[12:15], s43 offen
    buffer_load_dwordx4 v[164:167], v7, s[12:15], s43 offen
    buffer_load_dwordx4 v[168:171], v8, s[12:15], s43 offen
    s_add_u32 s44, s44, 1
    s_cmp_eq_u32 s44, 18
    s_cselect_b32 s44, 0, s44
    s_waitcnt lgkmcnt(6)
    v_mfma_f32_16x16x32_bf16 v[16:19], v[112:115], v[96:99], v[16:19]
    v_mfma_f32_16x16x32_bf16 v[20:23], v[116:119], v[96:99], v[20:23]
    v_mfma_f32_16x16x32_bf16 v[24:27], v[120:123], v[96:99], v[24:27]
    v_mfma_f32_16x16x32_bf16 v[28:31], v[124:127], v[96:99], v[28:31]
    v_mfma_f32_16x16x32_bf16 v[32:35], v[128:131], v[96:99], v[32:35]
    s_waitcnt lgkmcnt(4)
    v_mfma_f32_16x16x32_bf16 v[36:39], v[112:115], v[100:103], v[36:39]
    v_mfma_f32_16x16x32_bf16 v[40:43], v[116:119], v[100:103], v[40:43]
    v_mfma_f32_16x16x32_bf16 v[44:47], v[120:123], v[100:103], v[44:47]
    v_mfma_f32_16x16x32_bf16 v[48:51], v[124:127], v[100:103], v[48:51]
    v_mfma_f32_16x16x32_bf16 v[52:55], v[128:131], v[100:103], v[52:55]
    s_waitcnt lgkmcnt(2)
    v_mfma_f32_16x16x32_bf16 v[56:59], v[112:115], v[104:107], v[56:59]
    v_mfma_f32_16x16x32_bf16 v[60:63], v[116:119], v[104:107], v[60:63]
    v_mfma_f32_16x16x32_bf16 v[64:67], v[120:123], v[104:107], v[64:67]
    v_mfma_f32_16x16x32_bf16 v[68:71], v[124:127], v[104:107], v[68:71]
    v_mfma_f32_16x16x32_bf16 v[72:75], v[128:131], v[104:107], v[72:75]
    s_waitcnt lgkmcnt(0)
    v_mfma_f32_16x16x32_bf16 v[76:79], v[112:115], v[108:111], v[76:79]
    v_mfma_f32_16x16x32_bf16 v[80:83], v[116:119], v[108:111], v[80:83]
    v_mfma_f32_16x16x32_bf16 v[84:87], v[120:123], v[108:111], v[84:87]
    v_mfma_f32_16x16x32_bf16 v[88:91], v[124:127], v[108:111], v[88:91]
    v_mfma_f32_16x16x32_bf16 v[92:95], v[128:131], v[108:111], v[92:95]
    s_waitcnt vmcnt(9)
    ds_read_b64_tr_b16 v[96:97], v9 offset:4096
    ds_read_b64_tr_b16 v[98:99], v9 offset:6144
    ds_read_b64_tr_b16 v[100:101], v10 offset:4096
    ds_read_b64_tr_b16 v[102:103], v10 offset:6144
    ds_read_b64_tr_b16 v[104:105], v11 offset:4096
    ds_read_b64_tr_b16 v[106:107], v11 offset:6144
    ds_read_b64_tr_b16 v[108:109], v12 offset:4096
    ds_read_b64_tr_b16 v[110:111], v12 offset:6144
    s_mul_i32 s42, s44, 393216
    s_mul_i32 s43, s44, 3072
    s_add_u32 s42, s42, s39
    s_add_u32 s43, s43, s40
    s_add_u32 m0, s36, 0
    s_nop 0
    buffer_load_dwordx4 v3, s[8:11], s42 offen lds
    s_add_u32 m0, s36, 1024
    s_add_u32 s41, s42, 32768
    buffer_load_dwordx4 v3, s[8:11], s41 offen lds
    s_add_u32 m0, s36, 2048
    s_add_u32 s41, s42, 65536
    buffer_load_dwordx4 v3, s[8:11], s41 offen lds
    s_add_u32 m0, s36, 3072
    s_add_u32 s41, s42, 98304
    buffer_load_dwordx4 v3, s[8:11], s41 offen lds
    buffer_load_dwordx4 v[112:115], v4, s[12:15], s43 offen
    buffer_load_dwordx4 v[116:119], v5, s[12:15], s43 offen
    buffer_load_dwordx4 v[120:123], v6, s[12:15], s43 offen
    buffer_load_dwordx4 v[124:127], v7, s[12:15], s43 offen
    buffer_load_dwordx4 v[128:131], v8, s[12:15], s43 offen
    s_add_u32 s44, s44, 1
    s_cmp_eq_u32 s44, 18
    s_cselect_b32 s44, 0, s44
    s_waitcnt lgkmcnt(6)
    v_mfma_f32_16x16x32_bf16 v[16:19], v[132:135], v[96:99], v[16:19]
    v_mfma_f32_16x16x32_bf16 v[20:23], v[136:139], v[96:99], v[20:23]
    v_mfma_f32_16x16x32_bf16 v[24:27], v[140:143], v[96:99], v[24:27]
    v_mfma_f32_16x16x32_bf16 v[28:31], v[144:147], v[96:99], v[28:31]
    v_mfma_f32_16x16x32_bf16 v[32:35], v[148:151], v[96:99], v[32:35]
    s_waitcnt lgkmcnt(4)
    v_mfma_f32_16x16x32_bf16 v[36:39], v[132:135], v[100:103], v[36:39]
    v_mfma_f32_16x16x32_bf16 v[40:43], v[136:139], v[100:103], v[40:43]
    v_mfma_f32_16x16x32_bf16 v[44:47], v[140:143], v[100:103], v[44:47]
    v_mfma_f32_16x16x32_bf16 v[48:51], v[144:147], v[100:103], v[48:51]
    v_mfma_f32_16x16x32_bf16 v[52:55], v[148:151], v[100:103], v[52:55]
    s_waitcnt lgkmcnt(2)
    v_mfma_f32_16x16x32_bf16 v[56:59], v[132:135], v[104:107], v[56:59]
    v_mfma_f32_16x16x32_bf16 v[60:63], v[136:139], v[104:107], v[60:63]
    v_mfma_f32_16x16x32_bf16 v[64:67], v[140:143], v[104:107], v[64:67]
    v_mfma_f32_16x16x32_bf16 v[68:71], v[144:147], v[104:107], v[68:71]
    v_mfma_f32_16x16x32_bf16 v[72:75], v[148:151], v[104:107], v[72:75]
    s_waitcnt lgkmcnt(0)
    v_mfma_f32_16x16x32_bf16 v[76:79], v[132:135], v[108:111], v[76:79]
    v_mfma_f32_16x16x32_bf16 v[80:83], v[136:139], v[108:111], v[80:83]
    v_mfma_f32_16x16x32_bf16 v[84:87], v[140:143], v[108:111], v[84:87]
    v_mfma_f32_16x16x32_bf16 v[88:91], v[144:147], v[108:111], v[88:91]
    v_mfma_f32_16x16x32_bf16 v[92:95], v[148:151], v[108:111], v[92:95]
    s_waitcnt vmcnt(9)
    ds_read_b64_tr_b16 v[96:97], v9 offset:8192
    ds_read_b64_tr_b16 v[98:99], v9 offset:10240
    ds_read_b64_tr_b16 v[100:101], v10 offset:8192
    ds_read_b64_tr_b16 v[102:103], v10 offset:10240
    ds_read_b64_tr_b16 v[104:105], v11 offset:8192
    ds_read_b64_tr_b16 v[106:107], v11 offset:10240
    ds_read_b64_tr_b16 v[108:109], v12 offset:8192
    ds_read_b64_tr_b16 v[110:111], v12 offset:10240
    s_mul_i32 s42, s44, 393216
    s_mul_i32 s43, s44, 3072
    s_add_u32 s42, s42, s39
    s_add_u32 s43, s43, s40
    s_add_u32 m0, s36, 4096
    s_nop 0
    buffer_load_dwordx4 v3, s[8:11], s42 offen lds
    s_add_u32 m0, s36, 5120
    s_add_u32 s41, s42, 32768
    buffer_load_dwordx4 v3, s[8:11], s41 offen lds
    s_add_u32 m0, s36, 6144
    s_add_u32 s41, s42, 65536
    buffer_load_dwordx4 v3, s[8:11], s41 offen lds
    s_add_u32 m0, s36, 7168
    s_add_u32 s41, s42, 98304
    buffer_load_dwordx4 v3, s[8:11], s41 offen lds
    buffer_load_dwordx4 v[132:135], v4, s[12:15], s43 offen
    buffer_load_dwordx4 v[136:139], v5, s[12:15], s43 offen
    buffer_load_dwordx4 v[140:143], v6, s[12:15], s43 offen
    buffer_load_dwordx4 v[144:147], v7, s[12:15], s43 offen
    buffer_load_dwordx4 v[148:151], v8, s[12:15], s43 offen
    s_add_u32 s44, s44, 1
    s_cmp_eq_u32 s44, 18
    s_cselect_b32 s44, 0, s44
    s_waitcnt lgkmcnt(6)
    v_mfma_f32_16x16x32_bf16 v[16:19], v[152:155], v[96:99], v[16:19]
    v_mfma_f32_16x16x32_bf16 v[20:23], v[156:159], v[96:99], v[20:23]
    v_mfma_f32_16x16x32_bf16 v[24:27], v[160:163], v[96:99], v[24:27]
    v_mfma_f32_16x16x32_bf16 v[28:31], v[164:167], v[96:99], v[28:31]
    v_mfma_f32_16x16x32_bf16 v[32:35], v[168:171], v[96:99], v[32:35]
    s_waitcnt lgkmcnt(4)
    v_mfma_f32_16x16x32_bf16 v[36:39], v[152:155], v[100:103], v[36:39]
    v_mfma_f32_16x16x32_bf16 v[40:43], v[156:159], v[100:103], v[40:43]
    v_mfma_f32_16x16x32_bf16 v[44:47], v[160:163], v[100:103], v[44:47]
    v_mfma_f32_16x16x32_bf16 v[48:51], v[164:167], v[100:103], v[48:51]
    v_mfma_f32_16x16x32_bf16 v[52:55], v[168:171], v[100:103], v[52:55]
    s_waitcnt lgkmcnt(2)
    v_mfma_f32_16x16x32_bf16 v[56:59], v[152:155], v[104:107], v[56:59]
    v_mfma_f32_16x16x32_bf16 v[60:63], v[156:159], v[104:107], v[60:63]
    v_mfma_f32_16x16x32_bf16 v[64:67], v[160:163], v[104:107], v[64:67]
    v_mfma_f32_16x16x32_bf16 v[68:71], v[164:167], v[104:107], v[68:71]
    v_mfma_f32_16x16x32_bf16 v[72:75], v[168:171], v[104:107], v[72:75]
    s_waitcnt lgkmcnt(0)
    v_mfma_f32_16x16x32_bf16 v[76:79], v[152:155], v[108:111], v[76:79]
    v_mfma_f32_16x16x32_bf16 v[80:83], v[156:159], v[108:111], v[80:83]
    v_mfma_f32_16x16x32_bf16 v[84:87], v[160:163], v[108:111], v[84:87]
    v_mfma_f32_16x16x32_bf16 v[88:91], v[164:167], v[108:111], v[88:91]
    v_mfma_f32_16x16x32_bf16 v[92:95], v[168:171], v[108:111], v[92:95]
    s_waitcnt vmcnt(9)
    ds_read_b64_tr_b16 v[96:97], v9 offset:0
    ds_read_b64_tr_b16 v[98:99], v9 offset:2048
    ds_read_b64_tr_b16 v[100:101], v10 offset:0
    ds_read_b64_tr_b16 v[102:103], v10 offset:2048
    ds_read_b64_tr_b16 v[104:105], v11 offset:0
    ds_read_b64_tr_b16 v[106:107], v11 offset:2048
    ds_read_b64_tr_b16 v[108:109], v12 offset:0
    ds_read_b64_tr_b16 v[110:111], v12 offset:2048
    s_mul_i32 s42, s44, 393216
    s_mul_i32 s43, s44, 3072
    s_add_u32 s42, s42, s39
    s_add_u32 s43, s43, s40
    s_add_u32 m0, s36, 8192
    s_nop 0
    buffer_load_dwordx4 v3, s[8:11], s42 offen lds
    s_add_u32 m0, s36, 9216
    s_add_u32 s41, s42, 32768
    buffer_load_dwordx4 v3, s[8:11], s41 offen lds
    s_add_u32 m0, s36, 10240
    s_add_u32 s41, s42, 65536
    buffer_load_dwordx4 v3, s[8:11], s41 offen lds
    s_add_u32 m0, s36, 11264
    s_add_u32 s41, s42, 98304
    buffer_load_dwordx4 v3, s[8:11], s41 offen lds
    buffer_load_dwordx4 v[152:155], v4, s[12:15], s43 offen
    buffer_load_dwordx4 v[156:159], v5, s[12:15], s43 offen
    buffer_load_dwordx4 v[160:163], v6, s[12:15], s43 offen
    buffer_load_dwordx4 v[164:167], v7, s[12:15], s43 offen
    buffer_load_dwordx4 v[168:171], v8, s[12:15], s43 offen
    s_add_u32 s44, s44, 1
    s_cmp_eq_u32 s44, 18
    s_cselect_b32 s44, 0, s44
    s_waitcnt lgkmcnt(6)
    v_mfma_f32_16x16x32_bf16 v[16:19], v[112:115], v[96:99], v[16:19]
    v_mfma_f32_16x16x32_bf16 v[20:23], v[116:119], v[96:99], v[20:23]
    v_mfma_f32_16x16x32_bf16 v[24:27], v[120:123], v[96:99], v[24:27]
    v_mfma_f32_16x16x32_bf16 v[28:31], v[124:127], v[96:99], v[28:31]
    v_mfma_f32_16x16x32_bf16 v[32:35], v[128:131], v[96:99], v[32:35]
    s_waitcnt lgkmcnt(4)
    v_mfma_f32_16x16x32_bf16 v[36:39], v[112:115], v[100:103], v[36:39]
    v_mfma_f32_16x16x32_bf16 v[40:43], v[116:119], v[100:103], v[40:43]
    v_mfma_f32_16x16x32_bf16 v[44:47], v[120:123], v[100:103], v[44:47]
    v_mfma_f32_16x16x32_bf16 v[48:51], v[124:127], v[100:103], v[48:51]
    v_mfma_f32_16x16x32_bf16 v[52:55], v[128:131], v[100:103], v[52:55]
    s_waitcnt lgkmcnt(2)
    v_mfma_f32_16x16x32_bf16 v[56:59], v[112:115], v[104:107], v[56:59]
    v_mfma_f32_16x16x32_bf16 v[60:63], v[116:119], v[104:107], v[60:63]
    v_mfma_f32_16x16x32_bf16 v[64:67], v[120:123], v[104:107], v[64:67]
    v_mfma_f32_16x16x32_bf16 v[68:71], v[124:127], v[104:107], v[68:71]
    v_mfma_f32_16x16x32_bf16 v[72:75], v[128:131], v[104:107], v[72:75]
    s_waitcnt lgkmcnt(0)
    v_mfma_f32_16x16x32_bf16 v[76:79], v[112:115], v[108:111], v[76:79]
    v_mfma_f32_16x16x32_bf16 v[80:83], v[116:119], v[108:111], v[80:83]
    v_mfma_f32_16x16x32_bf16 v[84:87], v[120:123], v[108:111], v[84:87]
    v_mfma_f32_16x16x32_bf16 v[88:91], v[124:127], v[108:111], v[88:91]
    v_mfma_f32_16x16x32_bf16 v[92:95], v[128:131], v[108:111], v[92:95]
    s_waitcnt vmcnt(9)
    ds_read_b64_tr_b16 v[96:97], v9 offset:4096
    ds_read_b64_tr_b16 v[98:99], v9 offset:6144
    ds_read_b64_tr_b16 v[100:101], v10 offset:4096
    ds_read_b64_tr_b16 v[102:103], v10 offset:6144
    ds_read_b64_tr_b16 v[104:105], v11 offset:4096
    ds_read_b64_tr_b16 v[106:107], v11 offset:6144
    ds_read_b64_tr_b16 v[108:109], v12 offset:4096
    ds_read_b64_tr_b16 v[110:111], v12 offset:6144
    s_mul_i32 s42, s44, 393216
    s_mul_i32 s43, s44, 3072
    s_add_u32 s42, s42, s39
    s_add_u32 s43, s43, s40
    s_add_u32 m0, s36, 0
    s_nop 0
    buffer_load_dwordx4 v3, s[8:11], s42 offen lds
    s_add_u32 m0, s36, 1024
    s_add_u32 s41, s42, 32768
    buffer_load_dwordx4 v3, s[8:11], s41 offen lds
    s_add_u32 m0, s36, 2048
    s_add_u32 s41, s42, 65536
    buffer_load_dwordx4 v3, s[8:11], s41 offen lds
    s_add_u32 m0, s36, 3072
    s_add_u32 s41, s42, 98304
    buffer_load_dwordx4 v3, s[8:11], s41 offen lds
    buffer_load_dwordx4 v[112:115], v4, s[12:15], s43 offen
    buffer_load_dwordx4 v[116:119], v5, s[12:15], s43 offen
    buffer_load_dwordx4 v[120:123], v6, s[12:15], s43 offen
    buffer_load_dwordx4 v[124:127], v7, s[12:15], s43 offen
    buffer_load_dwordx4 v[128:131], v8, s[12:15], s43 offen
    s_add_u32 s44, s44, 1
    s_cmp_eq_u32 s44, 18
    s_cselect_b32 s44, 0, s44
    s_waitcnt lgkmcnt(6)
    v_mfma_f32_16x16x32_bf16 v[16:19], v[132:135], v[96:99], v[16:19]
    v_mfma_f32_16x16x32_bf16 v[20:23], v[136:139], v[96:99], v[20:23]
    v_mfma_f32_16x16x32_bf16 v[24:27], v[140:143], v[96:99], v[24:27]
    v_mfma_f32_16x16x32_bf16 v[28:31], v[144:147], v[96:99], v[28:31]
    v_mfma_f32_16x16x32_bf16 v[32:35], v[148:151], v[96:99], v[32:35]
    s_waitcnt lgkmcnt(4)
    v_mfma_f32_16x16x32_bf16 v[36:39], v[132:135], v[100:103], v[36:39]
    v_mfma_f32_16x16x32_bf16 v[40:43], v[136:139], v[100:103], v[40:43]
    v_mfma_f32_16x16x32_bf16 v[44:47], v[140:143], v[100:103], v[44:47]
    v_mfma_f32_16x16x32_bf16 v[48:51], v[144:147], v[100:103], v[48:51]
    v_mfma_f32_16x16x32_bf16 v[52:55], v[148:151], v[100:103], v[52:55]
    s_waitcnt lgkmcnt(2)
    v_mfma_f32_16x16x32_bf16 v[56:59], v[132:135], v[104:107], v[56:59]
    v_mfma_f32_16x16x32_bf16 v[60:63], v[136:139], v[104:107], v[60:63]
    v_mfma_f32_16x16x32_bf16 v[64:67], v[140:143], v[104:107], v[64:67]
    v_mfma_f32_16x16x32_bf16 v[68:71], v[144:147], v[104:107], v[68:71]
    v_mfma_f32_16x16x32_bf16 v[72:75], v[148:151], v[104:107], v[72:75]
    s_waitcnt lgkmcnt(0)
    v_mfma_f32_16x16x32_bf16 v[76:79], v[132:135], v[108:111], v[76:79]
    v_mfma_f32_16x16x32_bf16 v[80:83], v[136:139], v[108:111], v[80:83]
    v_mfma_f32_16x16x32_bf16 v[84:87], v[140:143], v[108:111], v[84:87]
    v_mfma_f32_16x16x32_bf16 v[88:91], v[144:147], v[108:111], v[88:91]
    v_mfma_f32_16x16x32_bf16 v[92:95], v[148:151], v[108:111], v[92:95]
    s_waitcnt vmcnt(9)
    ds_read_b64_tr_b16 v[96:97], v9 offset:8192
    ds_read_b64_tr_b16 v[98:99], v9 offset:10240
    ds_read_b64_tr_b16 v[100:101], v10 offset:8192
    ds_read_b64_tr_b16 v[102:103], v10 offset:10240
    ds_read_b64_tr_b16 v[104:105], v11 offset:8192
    ds_read_b64_tr_b16 v[106:107], v11 offset:10240
    ds_read_b64_tr_b16 v[108:109], v12 offset:8192
    ds_read_b64_tr_b16 v[110:111], v12 offset:10240
    s_mul_i32 s42, s44, 393216
    s_mul_i32 s43, s44, 3072
    s_add_u32 s42, s42, s39
    s_add_u32 s43, s43, s40
    s_add_u32 m0, s36, 4096
    s_nop 0
    buffer_load_dwordx4 v3, s[8:11], s42 offen lds
    s_add_u32 m0, s36, 5120
    s_add_u32 s41, s42, 32768
    buffer_load_dwordx4 v3, s[8:11], s41 offen lds
    s_add_u32 m0, s36, 6144
    s_add_u32 s41, s42, 65536
    buffer_load_dwordx4 v3, s[8:11], s41 offen lds
    s_add_u32 m0, s36, 7168
    s_add_u32 s41, s42, 98304
    buffer_load_dwordx4 v3, s[8:11], s41 offen lds
    buffer_load_dwordx4 v[132:135], v4, s[12:15], s43 offen
    buffer_load_dwordx4 v[136:139], v5, s[12:15], s43 offen
    buffer_load_dwordx4 v[140:143], v6, s[12:15], s43 offen
    buffer_load_dwordx4 v[144:147], v7, s[12:15], s43 offen
    buffer_load_dwordx4 v[148:151], v8, s[12:15], s43 offen
    s_add_u32 s44, s44, 1
    s_cmp_eq_u32 s44, 18
    s_cselect_b32 s44, 0, s44
    s_waitcnt lgkmcnt(6)
    v_mfma_f32_16x16x32_bf16 v[16:19], v[152:155], v[96:99], v[16:19]
    v_mfma_f32_16x16x32_bf16 v[20:23], v[156:159], v[96:99], v[20:23]
    v_mfma_f32_16x16x32_bf16 v[24:27], v[160:163], v[96:99], v[24:27]
    v_mfma_f32_16x16x32_bf16 v[28:31], v[164:167], v[96:99], v[28:31]
    v_mfma_f32_16x16x32_bf16 v[32:35], v[168:171], v[96:99], v[32:35]
    s_waitcnt lgkmcnt(4)
    v_mfma_f32_16x16x32_bf16 v[36:39], v[152:155], v[100:103], v[36:39]
    v_mfma_f32_16x16x32_bf16 v[40:43], v[156:159], v[100:103], v[40:43]
    v_mfma_f32_16x16x32_bf16 v[44:47], v[160:163], v[100:103], v[44:47]
    v_mfma_f32_16x16x32_bf16 v[48:51], v[164:167], v[100:103], v[48:51]
    v_mfma_f32_16x16x32_bf16 v[52:55], v[168:171], v[100:103], v[52:55]
    s_waitcnt lgkmcnt(2)
    v_mfma_f32_16x16x32_bf16 v[56:59], v[152:155], v[104:107], v[56:59]
    v_mfma_f32_16x16x32_bf16 v[60:63], v[156:159], v[104:107], v[60:63]
    v_mfma_f32_16x16x32_bf16 v[64:67], v[160:163], v[104:107], v[64:67]
    v_mfma_f32_16x16x32_bf16 v[68:71], v[164:167], v[104:107], v[68:71]
    v_mfma_f32_16x16x32_bf16 v[72:75], v[168:171], v[104:107], v[72:75]
    s_waitcnt lgkmcnt(0)
    v_mfma_f32_16x16x32_bf16 v[76:79], v[152:155], v[108:111], v[76:79]
    v_mfma_f32_16x16x32_bf16 v[80:83], v[156:159], v[108:111], v[80:83]
    v_mfma_f32_16x16x32_bf16 v[84:87], v[160:163], v[108:111], v[84:87]
    v_mfma_f32_16x16x32_bf16 v[88:91], v[164:167], v[108:111], v[88:91]
    v_mfma_f32_16x16x32_bf16 v[92:95], v[168:171], v[108:111], v[92:95]
    s_waitcnt vmcnt(9)
    ds_read_b64_tr_b16 v[96:97], v9 offset:0
    ds_read_b64_tr_b16 v[98:99], v9 offset:2048
    ds_read_b64_tr_b16 v[100:101], v10 offset:0
    ds_read_b64_tr_b16 v[102:103], v10 offset:2048
    ds_read_b64_tr_b16 v[104:105], v11 offset:0
    ds_read_b64_tr_b16 v[106:107], v11 offset:2048
    ds_read_b64_tr_b16 v[108:109], v12 offset:0
    ds_read_b64_tr_b16 v[110:111], v12 offset:2048
    s_mul_i32 s42, s44, 393216
    s_mul_i32 s43, s44, 3072
    s_add_u32 s42, s42, s39
    s_add_u32 s43, s43, s40
    s_add_u32 m0, s36, 8192
    s_nop 0
    buffer_load_dwordx4 v3, s[8:11], s42 offen lds
    s_add_u32 m0, s36, 9216
    s_add_u32 s41, s42, 32768
    buffer_load_dwordx4 v3, s[8:11], s41 offen lds
    s_add_u32 m0, s36, 10240
    s_add_u32 s41, s42, 65536
    buffer_load_dwordx4 v3, s[8:11], s41 offen lds
    s_add_u32 m0, s36, 11264
    s_add_u32 s41, s42, 98304
    buffer_load_dwordx4 v3, s[8:11], s41 offen lds
    buffer_load_dwordx4 v[152:155], v4, s[12:15], s43 offen
    buffer_load_dwordx4 v[156:159], v5, s[12:15], s43 offen
    buffer_load_dwordx4 v[160:163], v6, s[12:15], s43 offen
    buffer_load_dwordx4 v[164:167], v7, s[12:15], s43 offen
    buffer_load_dwordx4 v[168:171], v8, s[12:15], s43 offen
    s_add_u32 s44, s44, 1
    s_cmp_eq_u32 s44, 18
    s_cselect_b32 s44, 0, s44
    s_waitcnt lgkmcnt(6)
    v_mfma_f32_16x16x32_bf16 v[16:19], v[112:115], v[96:99], v[16:19]
    v_mfma_f32_16x16x32_bf16 v[20:23], v[116:119], v[96:99], v[20:23]
    v_mfma_f32_16x16x32_bf16 v[24:27], v[120:123], v[96:99], v[24:27]
    v_mfma_f32_16x16x32_bf16 v[28:31], v[124:127], v[96:99], v[28:31]
    v_mfma_f32_16x16x32_bf16 v[32:35], v[128:131], v[96:99], v[32:35]
    s_waitcnt lgkmcnt(4)
    v_mfma_f32_16x16x32_bf16 v[36:39], v[112:115], v[100:103], v[36:39]
    v_mfma_f32_16x16x32_bf16 v[40:43], v[116:119], v[100:103], v[40:43]
    v_mfma_f32_16x16x32_bf16 v[44:47], v[120:123], v[100:103], v[44:47]
    v_mfma_f32_16x16x32_bf16 v[48:51], v[124:127], v[100:103], v[48:51]
    v_mfma_f32_16x16x32_bf16 v[52:55], v[128:131], v[100:103], v[52:55]
    s_waitcnt lgkmcnt(2)
    v_mfma_f32_16x16x32_bf16 v[56:59], v[112:115], v[104:107], v[56:59]
    v_mfma_f32_16x16x32_bf16 v[60:63], v[116:119], v[104:107], v[60:63]
    v_mfma_f32_16x16x32_bf16 v[64:67], v[120:123], v[104:107], v[64:67]
    v_mfma_f32_16x16x32_bf16 v[68:71], v[124:127], v[104:107], v[68:71]
    v_mfma_f32_16x16x32_bf16 v[72:75], v[128:131], v[104:107], v[72:75]
    s_waitcnt lgkmcnt(0)
    v_mfma_f32_16x16x32_bf16 v[76:79], v[112:115], v[108:111], v[76:79]
    v_mfma_f32_16x16x32_bf16 v[80:83], v[116:119], v[108:111], v[80:83]
    v_mfma_f32_16x16x32_bf16 v[84:87], v[120:123], v[108:111], v[84:87]
    v_mfma_f32_16x16x32_bf16 v[88:91], v[124:127], v[108:111], v[88:91]
    v_mfma_f32_16x16x32_bf16 v[92:95], v[128:131], v[108:111], v[92:95]
    s_waitcnt vmcnt(9)
    ds_read_b64_tr_b16 v[96:97], v9 offset:4096
    ds_read_b64_tr_b16 v[98:99], v9 offset:6144
    ds_read_b64_tr_b16 v[100:101], v10 offset:4096
    ds_read_b64_tr_b16 v[102:103], v10 offset:6144
    ds_read_b64_tr_b16 v[104:105], v11 offset:4096
    ds_read_b64_tr_b16 v[106:107], v11 offset:6144
    ds_read_b64_tr_b16 v[108:109], v12 offset:4096
    ds_read_b64_tr_b16 v[110:111], v12 offset:6144
    s_mul_i32 s42, s44, 393216
    s_mul_i32 s43, s44, 3072
    s_add_u32 s42, s42, s39
    s_add_u32 s43, s43, s40
    s_add_u32 m0, s36, 0
    s_nop 0
    buffer_load_dwordx4 v3, s[8:11], s42 offen lds
    s_add_u32 m0, s36, 1024
    s_add_u32 s41, s42, 32768
    buffer_load_dwordx4 v3, s[8:11], s41 offen lds
    s_add_u32 m0, s36, 2048
    s_add_u32 s41, s42, 65536
    buffer_load_dwordx4 v3, s[8:11], s41 offen lds
    s_add_u32 m0, s36, 3072
    s_add_u32 s41, s42, 98304
    buffer_load_dwordx4 v3, s[8:11], s41 offen lds
    buffer_load_dwordx4 v[112:115], v4, s[12:15], s43 offen
    buffer_load_dwordx4 v[116:119], v5, s[12:15], s43 offen
    buffer_load_dwordx4 v[120:123], v6, s[12:15], s43 offen
    buffer_load_dwordx4 v[124:127], v7, s[12:15], s43 offen
    buffer_load_dwordx4 v[128:131], v8, s[12:15], s43 offen
    s_add_u32 s44, s44, 1
    s_cmp_eq_u32 s44, 18
    s_cselect_b32 s44, 0, s44
    s_waitcnt lgkmcnt(6)
    v_mfma_f32_16x16x32_bf16 v[16:19], v[132:135], v[96:99], v[16:19]
    v_mfma_f32_16x16x32_bf16 v[20:23], v[136:139], v[96:99], v[20:23]
    v_mfma_f32_16x16x32_bf16 v[24:27], v[140:143], v[96:99], v[24:27]
    v_mfma_f32_16x16x32_bf16 v[28:31], v[144:147], v[96:99], v[28:31]
    v_mfma_f32_16x16x32_bf16 v[32:35], v[148:151], v[96:99], v[32:35]
    s_waitcnt lgkmcnt(4)
    v_mfma_f32_16x16x32_bf16 v[36:39], v[132:135], v[100:103], v[36:39]
    v_mfma_f32_16x16x32_bf16 v[40:43], v[136:139], v[100:103], v[40:43]
    v_mfma_f32_16x16x32_bf16 v[44:47], v[140:143], v[100:103], v[44:47]
    v_mfma_f32_16x16x32_bf16 v[48:51], v[144:147], v[100:103], v[48:51]
    v_mfma_f32_16x16x32_bf16 v[52:55], v[148:151], v[100:103], v[52:55]
    s_waitcnt lgkmcnt(2)
    v_mfma_f32_16x16x32_bf16 v[56:59], v[132:135], v[104:107], v[56:59]
    v_mfma_f32_16x16x32_bf16 v[60:63], v[136:139], v[104:107], v[60:63]
    v_mfma_f32_16x16x32_bf16 v[64:67], v[140:143], v[104:107], v[64:67]
    v_mfma_f32_16x16x32_bf16 v[68:71], v[144:147], v[104:107], v[68:71]
    v_mfma_f32_16x16x32_bf16 v[72:75], v[148:151], v[104:107], v[72:75]
    s_waitcnt lgkmcnt(0)
    v_mfma_f32_16x16x32_bf16 v[76:79], v[132:135], v[108:111], v[76:79]
    v_mfma_f32_16x16x32_bf16 v[80:83], v[136:139], v[108:111], v[80:83]
    v_mfma_f32_16x16x32_bf16 v[84:87], v[140:143], v[108:111], v[84:87]
    v_mfma_f32_16x16x32_bf16 v[88:91], v[144:147], v[108:111], v[88:91]
    v_mfma_f32_16x16x32_bf16 v[92:95], v[148:151], v[108:111], v[92:95]
    s_waitcnt vmcnt(9)
    ds_read_b64_tr_b16 v[96:97], v9 offset:8192
    ds_read_b64_tr_b16 v[98:99], v9 offset:10240
    ds_read_b64_tr_b16 v[100:101], v10 offset:8192
    ds_read_b64_tr_b16 v[102:103], v10 offset:10240
    ds_read_b64_tr_b16 v[104:105], v11 offset:8192
    ds_read_b64_tr_b16 v[106:107], v11 offset:10240
    ds_read_b64_tr_b16 v[108:109], v12 offset:8192
    ds_read_b64_tr_b16 v[110:111], v12 offset:10240
    s_mul_i32 s42, s44, 393216
    s_mul_i32 s43, s44, 3072
    s_add_u32 s42, s42, s39
    s_add_u32 s43, s43, s40
    s_add_u32 m0, s36, 4096
    s_nop 0
    buffer_load_dwordx4 v3, s[8:11], s42 offen lds
    s_add_u32 m0, s36, 5120
    s_add_u32 s41, s42, 32768
    buffer_load_dwordx4 v3, s[8:11], s41 offen lds
    s_add_u32 m0, s36, 6144
    s_add_u32 s41, s42, 65536
    buffer_load_dwordx4 v3, s[8:11], s41 offen lds
    s_add_u32 m0, s36, 7168
    s_add_u32 s41, s42, 98304
    buffer_load_dwordx4 v3, s[8:11], s41 offen lds
    buffer_load_dwordx4 v[132:135], v4, s[12:15], s43 offen
    buffer_load_dwordx4 v[136:139], v5, s[12:15], s43 offen
    buffer_load_dwordx4 v[140:143], v6, s[12:15], s43 offen
    buffer_load_dwordx4 v[144:147], v7, s[12:15], s43 offen
    buffer_load_dwordx4 v[148:151], v8, s[12:15], s43 offen
    s_add_u32 s44, s44, 1
    s_cmp_eq_u32 s44, 18
    s_cselect_b32 s44, 0, s44
    s_waitcnt lgkmcnt(6)
    v_mfma_f32_16x16x32_bf16 v[16:19], v[152:155], v[96:99], v[16:19]
    v_mfma_f32_16x16x32_bf16 v[20:23], v[156:159], v[96:99], v[20:23]
    v_mfma_f32_16x16x32_bf16 v[24:27], v[160:163], v[96:99], v[24:27]
    v_mfma_f32_16x16x32_bf16 v[28:31], v[164:167], v[96:99], v[28:31]
    v_mfma_f32_16x16x32_bf16 v[32:35], v[168:171], v[96:99], v[32:35]
    s_waitcnt lgkmcnt(4)
    v_mfma_f32_16x16x32_bf16 v[36:39], v[152:155], v[100:103], v[36:39]
    v_mfma_f32_16x16x32_bf16 v[40:43], v[156:159], v[100:103], v[40:43]
    v_mfma_f32_16x16x32_bf16 v[44:47], v[160:163], v[100:103], v[44:47]
    v_mfma_f32_16x16x32_bf16 v[48:51], v[164:167], v[100:103], v[48:51]
    v_mfma_f32_16x16x32_bf16 v[52:55], v[168:171], v[100:103], v[52:55]
    s_waitcnt lgkmcnt(2)
    v_mfma_f32_16x16x32_bf16 v[56:59], v[152:155], v[104:107], v[56:59]
    v_mfma_f32_16x16x32_bf16 v[60:63], v[156:159], v[104:107], v[60:63]
    v_mfma_f32_16x16x32_bf16 v[64:67], v[160:163], v[104:107], v[64:67]
    v_mfma_f32_16x16x32_bf16 v[68:71], v[164:167], v[104:107], v[68:71]
    v_mfma_f32_16x16x32_bf16 v[72:75], v[168:171], v[104:107], v[72:75]
    s_waitcnt lgkmcnt(0)
    v_mfma_f32_16x16x32_bf16 v[76:79], v[152:155], v[108:111], v[76:79]
    v_mfma_f32_16x16x32_bf16 v[80:83], v[156:159], v[108:111], v[80:83]
    v_mfma_f32_16x16x32_bf16 v[84:87], v[160:163], v[108:111], v[84:87]
    v_mfma_f32_16x16x32_bf16 v[88:91], v[164:167], v[108:111], v[88:91]
    v_mfma_f32_16x16x32_bf16 v[92:95], v[168:171], v[108:111], v[92:95]
    s_waitcnt vmcnt(9)
    ds_read_b64_tr_b16 v[96:97], v9 offset:0
    ds_read_b64_tr_b16 v[98:99], v9 offset:2048
    ds_read_b64_tr_b16 v[100:101], v10 offset:0
    ds_read_b64_tr_b16 v[102:103], v10 offset:2048
    ds_read_b64_tr_b16 v[104:105], v11 offset:0
    ds_read_b64_tr_b16 v[106:107], v11 offset:2048
    ds_read_b64_tr_b16 v[108:109], v12 offset:0
    ds_read_b64_tr_b16 v[110:111], v12 offset:2048
    s_mul_i32 s42, s44, 393216
    s_mul_i32 s43, s44, 3072
    s_add_u32 s42, s42, s39
    s_add_u32 s43, s43, s40
    s_add_u32 m0, s36, 8192
    s_nop 0
    buffer_load_dwordx4 v3, s[8:11], s42 offen lds
    s_add_u32 m0, s36, 9216
    s_add_u32 s41, s42, 32768
    buffer_load_dwordx4 v3, s[8:11], s41 offen lds
    s_add_u32 m0, s36, 10240
    s_add_u32 s41, s42, 65536
    buffer_load_dwordx4 v3, s[8:11], s41 offen lds
    s_add_u32 m0, s36, 11264
    s_add_u32 s41, s42, 98304
    buffer_load_dwordx4 v3, s[8:11], s41 offen lds
    buffer_load_dwordx4 v[152:155], v4, s[12:15], s43 offen
    buffer_load_dwordx4 v[156:159], v5, s[12:15], s43 offen
    buffer_load_dwordx4 v[160:163], v6, s[12:15], s43 offen
    buffer_load_dwordx4 v[164:167], v7, s[12:15], s43 offen
    buffer_load_dwordx4 v[168:171], v8, s[12:15], s43 offen
    s_add_u32 s44, s44, 1
    s_cmp_eq_u32 s44, 18
    s_cselect_b32 s44, 0, s44
    s_waitcnt lgkmcnt(6)
    v_mfma_f32_16x16x32_bf16 v[16:19], v[112:115], v[96:99], v[16:19]
    v_mfma_f32_16x16x32_bf16 v[20:23], v[116:119], v[96:99], v[20:23]
    v_mfma_f32_16x16x32_bf16 v[24:27], v[120:123], v[96:99], v[24:27]
    v_mfma_f32_16x16x32_bf16 v[28:31], v[124:127], v[96:99], v[28:31]
    v_mfma_f32_16x16x32_bf16 v[32:35], v[128:131], v[96:99], v[32:35]
    s_waitcnt lgkmcnt(4)
    v_mfma_f32_16x16x32_bf16 v[36:39], v[112:115], v[100:103], v[36:39]
    v_mfma_f32_16x16x32_bf16 v[40:43], v[116:119], v[100:103], v[40:43]
    v_mfma_f32_16x16x32_bf16 v[44:47], v[120:123], v[100:103], v[44:47]
    v_mfma_f32_16x16x32_bf16 v[48:51], v[124:127], v[100:103], v[48:51]
    v_mfma_f32_16x16x32_bf16 v[52:55], v[128:131], v[100:103], v[52:55]
    s_waitcnt lgkmcnt(2)
    v_mfma_f32_16x16x32_bf16 v[56:59], v[112:115], v[104:107], v[56:59]
    v_mfma_f32_16x16x32_bf16 v[60:63], v[116:119], v[104:107], v[60:63]
    v_mfma_f32_16x16x32_bf16 v[64:67], v[120:123], v[104:107], v[64:67]
    v_mfma_f32_16x16x32_bf16 v[68:71], v[124:127], v[104:107], v[68:71]
    v_mfma_f32_16x16x32_bf16 v[72:75], v[128:131], v[104:107], v[72:75]
    s_waitcnt lgkmcnt(0)
    v_mfma_f32_16x16x32_bf16 v[76:79], v[112:115], v[108:111], v[76:79]
    v_mfma_f32_16x16x32_bf16 v[80:83], v[116:119], v[108:111], v[80:83]
    v_mfma_f32_16x16x32_bf16 v[84:87], v[120:123], v[108:111], v[84:87]
    v_mfma_f32_16x16x32_bf16 v[88:91], v[124:127], v[108:111], v[88:91]
    v_mfma_f32_16x16x32_bf16 v[92:95], v[128:131], v[108:111], v[92:95]
    s_waitcnt vmcnt(9)
    ds_read_b64_tr_b16 v[96:97], v9 offset:4096
    ds_read_b64_tr_b16 v[98:99], v9 offset:6144
    ds_read_b64_tr_b16 v[100:101], v10 offset:4096
    ds_read_b64_tr_b16 v[102:103], v10 offset:6144
    ds_read_b64_tr_b16 v[104:105], v11 offset:4096
    ds_read_b64_tr_b16 v[106:107], v11 offset:6144
    ds_read_b64_tr_b16 v[108:109], v12 offset:4096
    ds_read_b64_tr_b16 v[110:111], v12 offset:6144
    s_waitcnt lgkmcnt(6)
    v_mfma_f32_16x16x32_bf16 v[16:19], v[132:135], v[96:99], v[16:19]
    v_mfma_f32_16x16x32_bf16 v[20:23], v[136:139], v[96:99], v[20:23]
    v_mfma_f32_16x16x32_bf16 v[24:27], v[140:143], v[96:99], v[24:27]
    v_mfma_f32_16x16x32_bf16 v[28:31], v[144:147], v[96:99], v[28:31]
    v_mfma_f32_16x16x32_bf16 v[32:35], v[148:151], v[96:99], v[32:35]
    s_waitcnt lgkmcnt(4)
    v_mfma_f32_16x16x32_bf16 v[36:39], v[132:135], v[100:103], v[36:39]
    v_mfma_f32_16x16x32_bf16 v[40:43], v[136:139], v[100:103], v[40:43]
    v_mfma_f32_16x16x32_bf16 v[44:47], v[140:143], v[100:103], v[44:47]
    v_mfma_f32_16x16x32_bf16 v[48:51], v[144:147], v[100:103], v[48:51]
    v_mfma_f32_16x16x32_bf16 v[52:55], v[148:151], v[100:103], v[52:55]
    s_waitcnt lgkmcnt(2)
    v_mfma_f32_16x16x32_bf16 v[56:59], v[132:135], v[104:107], v[56:59]
    v_mfma_f32_16x16x32_bf16 v[60:63], v[136:139], v[104:107], v[60:63]
    v_mfma_f32_16x16x32_bf16 v[64:67], v[140:143], v[104:107], v[64:67]
    v_mfma_f32_16x16x32_bf16 v[68:71], v[144:147], v[104:107], v[68:71]
    v_mfma_f32_16x16x32_bf16 v[72:75], v[148:151], v[104:107], v[72:75]
    s_waitcnt lgkmcnt(0)
    v_mfma_f32_16x16x32_bf16 v[76:79], v[132:135], v[108:111], v[76:79]
    v_mfma_f32_16x16x32_bf16 v[80:83], v[136:139], v[108:111], v[80:83]
    v_mfma_f32_16x16x32_bf16 v[84:87], v[140:143], v[108:111], v[84:87]
    v_mfma_f32_16x16x32_bf16 v[88:91], v[144:147], v[108:111], v[88:91]
    v_mfma_f32_16x16x32_bf16 v[92:95], v[148:151], v[108:111], v[92:95]
    s_waitcnt vmcnt(0)
    ds_read_b64_tr_b16 v[96:97], v9 offset:8192
    ds_read_b64_tr_b16 v[98:99], v9 offset:10240
    ds_read_b64_tr_b16 v[100:101], v10 offset:8192
    ds_read_b64_tr_b16 v[102:103], v10 offset:10240
    ds_read_b64_tr_b16 v[104:105], v11 offset:8192
    ds_read_b64_tr_b16 v[106:107], v11 offset:10240
    ds_read_b64_tr_b16 v[108:109], v12 offset:8192
    ds_read_b64_tr_b16 v[110:111], v12 offset:10240
    s_waitcnt lgkmcnt(6)
    v_mfma_f32_16x16x32_bf16 v[16:19], v[152:155], v[96:99], v[16:19]
    v_mfma_f32_16x16x32_bf16 v[20:23], v[156:159], v[96:99], v[20:23]
    v_mfma_f32_16x16x32_bf16 v[24:27], v[160:163], v[96:99], v[24:27]
    v_mfma_f32_16x16x32_bf16 v[28:31], v[164:167], v[96:99], v[28:31]
    v_mfma_f32_16x16x32_bf16 v[32:35], v[168:171], v[96:99], v[32:35]
    s_waitcnt lgkmcnt(4)
    v_mfma_f32_16x16x32_bf16 v[36:39], v[152:155], v[100:103], v[36:39]
    v_mfma_f32_16x16x32_bf16 v[40:43], v[156:159], v[100:103], v[40:43]
    v_mfma_f32_16x16x32_bf16 v[44:47], v[160:163], v[100:103], v[44:47]
    v_mfma_f32_16x16x32_bf16 v[48:51], v[164:167], v[100:103], v[48:51]
    v_mfma_f32_16x16x32_bf16 v[52:55], v[168:171], v[100:103], v[52:55]
    s_waitcnt lgkmcnt(2)
    v_mfma_f32_16x16x32_bf16 v[56:59], v[152:155], v[104:107], v[56:59]
    v_mfma_f32_16x16x32_bf16 v[60:63], v[156:159], v[104:107], v[60:63]
    v_mfma_f32_16x16x32_bf16 v[64:67], v[160:163], v[104:107], v[64:67]
    v_mfma_f32_16x16x32_bf16 v[68:71], v[164:167], v[104:107], v[68:71]
    v_mfma_f32_16x16x32_bf16 v[72:75], v[168:171], v[104:107], v[72:75]
    s_waitcnt lgkmcnt(0)
    v_mfma_f32_16x16x32_bf16 v[76:79], v[152:155], v[108:111], v[76:79]
    v_mfma_f32_16x16x32_bf16 v[80:83], v[156:159], v[108:111], v[80:83]
    v_mfma_f32_16x16x32_bf16 v[84:87], v[160:163], v[108:111], v[84:87]
    v_mfma_f32_16x16x32_bf16 v[88:91], v[164:167], v[108:111], v[88:91]
    v_mfma_f32_16x16x32_bf16 v[92:95], v[168:171], v[108:111], v[92:95]
    s_branch K3_WPART
K3_APART:
    s_mul_i32 s36, s24, 22528
    v_lshrrev_b32 v13, 3, v2
    v_lshrrev_b32 v14, 1, v13
    v_and_b32 v14, 3, v14
    v_lshlrev_b32 v14, 1, v14
    v_and_b32 v15, 7, v2
    v_xor_b32 v14, v14, v15
    v_lshlrev_b32 v1, 4, v14
    v_lshlrev_b32 v13, 12, v13
    v_add_u32 v3, v13, v1
    v_lshlrev_b32 v4, 4, v2
    v_lshrrev_b32 v13, 3, v2
    v_mul_u32_u24 v13, 128, v13
    v_add_u32 v3, v3, v13
    v_add_u32 v5, 20480, v4
    v_add_u32 v6, 40960, v4
    s_lshl_b32 s39, s27, 7
    s_add_u32 s39, s39, 10158080
    s_mul_i32 s40, s32, 61440
    s_add_u32 s40, s40, 12910592
    s_mov_b32 s44, 0
    s_waitcnt lgkmcnt(0)
    s_mov_b32 s12, s28
    s_and_b32 s13, s29, 0xffff
    s_mov_b32 s14, 13414400
    s_mov_b32 s15, 0x20000
    s_mov_b32 s8, s4
    s_and_b32 s9, s5, 0xffff
    s_mov_b32 s10, 7077888
    s_mov_b32 s11, 0x20000
    s_add_u32 m0, s36, 0
    s_add_u32 s41, s39, 0
    buffer_load_dwordx4 v3, s[12:15], s41 offen lds
    s_add_u32 m0, s36, 1024
    s_add_u32 s41, s39, 33792
    buffer_load_dwordx4 v3, s[12:15], s41 offen lds
    s_add_u32 m0, s36, 2048
    s_add_u32 s41, s39, 67584
    buffer_load_dwordx4 v3, s[12:15], s41 offen lds
    s_add_u32 m0, s36, 3072
    s_add_u32 s41, s39, 101376
    buffer_load_dwordx4 v3, s[12:15], s41 offen lds
    buffer_load_dwordx4 v[128:131], v4, s[12:15], s40 offen
    buffer_load_dwordx4 v[132:135], v5, s[12:15], s40 offen
    buffer_load_dwordx4 v[136:139], v6, s[12:15], s40 offen
    s_add_u32 m0, s36, 4096
    s_add_u32 s41, s39, 135168
    buffer_load_dwordx4 v3, s[12:15], s41 offen lds
    s_add_u32 m0, s36, 5120
    s_add_u32 s41, s39, 168960
    buffer_load_dwordx4 v3, s[12:15], s41 offen lds
    s_add_u32 m0, s36, 6144
    s_add_u32 s41, s39, 202752
    buffer_load_dwordx4 v3, s[12:15], s41 offen lds
    s_add_u32 m0, s36, 7168
    s_add_u32 s41, s39, 236544
    buffer_load_dwordx4 v3, s[12:15], s41 offen lds
    buffer_load_dwordx4 v[140:143], v4, s[12:15], s40 offen offset:1024
    buffer_load_dwordx4 v[144:147], v5, s[12:15], s40 offen offset:1024
    buffer_load_dwordx4 v[148:151], v6, s[12:15], s40 offen offset:1024
    s_add_u32 m0, s36, 8192
    s_add_u32 s41, s39, 270336
    buffer_load_dwordx4 v3, s[12:15], s41 offen lds
    s_add_u32 m0, s36, 9216
    s_add_u32 s41, s39, 304128
    buffer_load_dwordx4 v3, s[12:15], s41 offen lds
    s_add_u32 m0, s36, 10240
    s_add_u32 s41, s39, 337920
    buffer_load_dwordx4 v3, s[12:15], s41 offen lds
    s_add_u32 m0, s36, 11264
    s_add_u32 s41, s39, 371712
    buffer_load_dwordx4 v3, s[12:15], s41 offen lds
    buffer_load_dwordx4 v[152:155], v4, s[12:15], s40 offen offset:2048
    buffer_load_dwordx4 v[156:159], v5, s[12:15], s40 offen offset:2048
    buffer_load_dwordx4 v[160:163], v6, s[12:15], s40 offen offset:2048
    v_lshrrev_b32 v13, 4, v2
    v_and_b32 v14, 15, v2
    v_lshrrev_b32 v15, 2, v14
    v_and_b32 v14, 3, v14
    v_lshl_add_u32 v13, v13, 2, v15
    v_lshrrev_b32 v15, 1, v13
    v_and_b32 v15, 3, v15
    v_lshlrev_b32 v13, 7, v13
    v_lshl_add_u32 v13, v14, 3, v13
    v_add_u32 v13, s36, v13
    v_xor_b32 v1, 0, v15
    v_lshl_add_u32 v9, v1, 5, v13
    v_xor_b32 v1, 1, v15
    v_lshl_add_u32 v10, v1, 5, v13
    v_xor_b32 v1, 2, v15
    v_lshl_add_u32 v11, v1, 5, v13
    v_xor_b32 v1, 3, v15
    v_lshl_add_u32 v12, v1, 5, v13
    s_mov_b32 s16, s6
    s_and_b32 s17, s7, 0xffff
    s_mov_b32 s18, 4096
    s_mov_b32 s19, 0x20000
    s_mov_b32 s20, s30
    s_and_b32 s21, s31, 0xffff
    s_mov_b32 s22, 2621440
    s_mov_b32 s23, 0x20000
    s_movk_i32 s45, 6554
    s_mul_i32 s46, s32, 80
    s_lshl_b32 s47, s27, 6
    s_mov_b32 s48, 7938048
    v_mov_b32 v200, v0
    v_mul_u32_u24 v201, s45, v200
    v_lshrrev_b32 v201, 16, v201
    v_mul_u32_u24 v202, 10, v201
    v_sub_u32 v202, v200, v202
    v_add_u32 v203, s47, v201
    v_lshlrev_b32 v204, 2, v203
    v_lshlrev_b32 v205, 1, v203
    buffer_load_dword v206, v204, s[12:15], s48 offen
    buffer_load_ushort v207, v205, s[16:19], 0 offen
    v_cmp_lt_u32 vcc, 4, v202
    v_add_u32 v200, 35, v202
    v_add_u32 v208, 1, v202
    v_cndmask_b32 v200, v202, v200, vcc
    v_cndmask_b32 v202, v202, v208, vcc
    v_cmp_eq_u32 vcc, 10, v202
    v_mov_b32 v208, 5
    s_nop 0
    v_cndmask_b32 v202, v202, v208, vcc
    v_lshrrev_b32 v208, 4, v201
    v_mul_u32_u24 v208, 5, v208
    v_lshrrev_b32 v209, 1, v202
    v_add_u32 v208, v208, v209
    v_mul_u32_u24 v208, 1088, v208
    v_and_b32 v209, 1, v202
    v_mul_u32_u24 v209, 544, v209
    v_add_u32 v208, v208, v209
    v_and_b32 v209, 15, v201
    v_lshl_add_u32 v208, v209, 4, v208
    v_add_u32 v209, 45056, v208
    v_mul_u32_u24 v210, 1280, v203
    v_lshl_add_u32 v210, v200, 4, v210
    v_lshrrev_b32 v212, 2, v0
    v_add_u32 v212, 512, v212
    v_mul_u32_u24 v213, s45, v212
    v_lshrrev_b32 v213, 16, v213
    v_mul_u32_u24 v214, 10, v213
    v_sub_u32 v214, v212, v214
    v_add_u32 v215, s47, v213
    v_lshlrev_b32 v216, 2, v215
    v_lshlrev_b32 v217, 1, v215
    buffer_load_dword v218, v216, s[12:15], s48 offen
    buffer_load_ushort v219, v217, s[16:19], 0 offen
    v_cmp_lt_u32 vcc, 4, v214
    v_add_u32 v212, 35, v214
    v_add_u32 v220, 1, v214
    v_cndmask_b32 v212, v214, v212, vcc
    v_cndmask_b32 v214, v214, v220, vcc
    v_cmp_eq_u32 vcc, 10, v214
    v_mov_b32 v220, 5
    s_nop 0
    v_cndmask_b32 v214, v214, v220, vcc
    v_lshrrev_b32 v220, 4, v213
    v_mul_u32_u24 v220, 5, v220
    v_lshrrev_b32 v221, 1, v214
    v_add_u32 v220, v220, v221
    v_mul_u32_u24 v220, 1088, v220
    v_and_b32 v221, 1, v214
    v_mul_u32_u24 v221, 544, v221
    v_add_u32 v220, v220, v221
    v_and_b32 v221, 15, v213
    v_lshl_add_u32 v220, v221, 4, v220
    v_add_u32 v221, 45056, v220
    v_mul_u32_u24 v222, 1280, v215
    v_lshl_add_u32 v222, v212, 4, v222
    v_and_b32 v216, 3, v0
    v_lshl_add_u32 v222, v216, 2, v222
    v_lshrrev_b32 v217, 1, v216
    v_mul_u32_u24 v217, 272, v217
    v_and_b32 v216, 1, v216
    v_lshl_add_u32 v217, v216, 3, v217
    v_add_u32 v220, v220, v217
    v_add_u32 v221, v221, v217
    s_waitcnt vmcnt(18)
    ds_read_b64_tr_b16 v[112:113], v9 offset:0
    ds_read_b64_tr_b16 v[114:115], v9 offset:2048
    ds_read_b64_tr_b16 v[116:117], v10 offset:0
    ds_read_b64_tr_b16 v[118:119], v10 offset:2048
    ds_read_b64_tr_b16 v[120:121], v11 offset:0
    ds_read_b64_tr_b16 v[122:123], v11 offset:2048
    ds_read_b64_tr_b16 v[124:125], v12 offset:0
    ds_read_b64_tr_b16 v[126:127], v12 offset:2048
    s_add_u32 m0, s36, 12288
    s_add_u32 s41, s39, 405504
    buffer_load_dwordx4 v3, s[12:15], s41 offen lds
    s_add_u32 m0, s36, 13312
    s_add_u32 s41, s39, 439296
    buffer_load_dwordx4 v3, s[12:15], s41 offen lds
    s_add_u32 m0, s36, 14336
    s_add_u32 s41, s39, 473088
    buffer_load_dwordx4 v3, s[12:15], s41 offen lds
    s_add_u32 m0, s36, 15360
    s_add_u32 s41, s39, 506880
    buffer_load_dwordx4 v3, s[12:15], s41 offen lds
    buffer_load_dwordx4 v[164:167], v4, s[12:15], s40 offen offset:3072
    buffer_load_dwordx4 v[168:171], v5, s[12:15], s40 offen offset:3072
    buffer_load_dwordx4 v[172:175], v6, s[12:15], s40 offen offset:3072
    s_waitcnt lgkmcnt(6)
    v_mfma_f32_16x16x32_bf16 v[16:19], v[128:131], v[112:115], 0
    v_mfma_f32_16x16x32_bf16 v[20:23], v[132:135], v[112:115], 0
    v_mfma_f32_16x16x32_bf16 v[24:27], v[136:139], v[112:115], 0
    s_waitcnt lgkmcnt(4)
    v_mfma_f32_16x16x32_bf16 v[28:31], v[128:131], v[116:119], 0
    v_mfma_f32_16x16x32_bf16 v[32:35], v[132:135], v[116:119], 0
    v_mfma_f32_16x16x32_bf16 v[36:39], v[136:139], v[116:119], 0
    s_waitcnt lgkmcnt(2)
    v_mfma_f32_16x16x32_bf16 v[40:43], v[128:131], v[120:123], 0
    v_mfma_f32_16x16x32_bf16 v[44:47], v[132:135], v[120:123], 0
    v_mfma_f32_16x16x32_bf16 v[48:51], v[136:139], v[120:123], 0
    s_waitcnt lgkmcnt(0)
    v_mfma_f32_16x16x32_bf16 v[52:55], v[128:131], v[124:127], 0
    v_mfma_f32_16x16x32_bf16 v[56:59], v[132:135], v[124:127], 0
    v_mfma_f32_16x16x32_bf16 v[60:63], v[136:139], v[124:127], 0
    s_waitcnt vmcnt(18)
    ds_read_b64_tr_b16 v[112:113], v9 offset:4096
    ds_read_b64_tr_b16 v[114:115], v9 offset:6144
    ds_read_b64_tr_b16 v[116:117], v10 offset:4096
    ds_read_b64_tr_b16 v[118:119], v10 offset:6144
    ds_read_b64_tr_b16 v[120:121], v11 offset:4096
    ds_read_b64_tr_b16 v[122:123], v11 offset:6144
    ds_read_b64_tr_b16 v[124:125], v12 offset:4096
    ds_read_b64_tr_b16 v[126:127], v12 offset:6144
    s_add_u32 m0, s36, 0
    s_add_u32 s41, s39, 540672
    buffer_load_dwordx4 v3, s[12:15], s41 offen lds
    s_add_u32 m0, s36, 1024
    s_add_u32 s41, s39, 574464
    buffer_load_dwordx4 v3, s[12:15], s41 offen lds
    s_add_u32 m0, s36, 2048
    s_add_u32 s41, s39, 608256
    buffer_load_dwordx4 v3, s[12:15], s41 offen lds
    s_add_u32 m0, s36, 3072
    s_add_u32 s41, s39, 642048
    buffer_load_dwordx4 v3, s[12:15], s41 offen lds
    s_add_u32 s40, s40, 4096
    buffer_load_dwordx4 v[128:131], v4, s[12:15], s40 offen
    buffer_load_dwordx4 v[132:135], v5, s[12:15], s40 offen
    buffer_load_dwordx4 v[136:139], v6, s[12:15], s40 offen
    s_waitcnt lgkmcnt(6)
    v_mfma_f32_16x16x32_bf16 v[16:19], v[140:143], v[112:115], v[16:19]
    v_mfma_f32_16x16x32_bf16 v[20:23], v[144:147], v[112:115], v[20:23]
    v_mfma_f32_16x16x32_bf16 v[24:27], v[148:151], v[112:115], v[24:27]
    s_waitcnt lgkmcnt(4)
    v_mfma_f32_16x16x32_bf16 v[28:31], v[140:143], v[116:119], v[28:31]
    v_mfma_f32_16x16x32_bf16 v[32:35], v[144:147], v[116:119], v[32:35]
    v_mfma_f32_16x16x32_bf16 v[36:39], v[148:151], v[116:119], v[36:39]
    s_waitcnt lgkmcnt(2)
    v_mfma_f32_16x16x32_bf16 v[40:43], v[140:143], v[120:123], v[40:43]
    v_mfma_f32_16x16x32_bf16 v[44:47], v[144:147], v[120:123], v[44:47]
    v_mfma_f32_16x16x32_bf16 v[48:51], v[148:151], v[120:123], v[48:51]
    s_waitcnt lgkmcnt(0)
    v_mfma_f32_16x16x32_bf16 v[52:55], v[140:143], v[124:127], v[52:55]
    v_mfma_f32_16x16x32_bf16 v[56:59], v[144:147], v[124:127], v[56:59]
    v_mfma_f32_16x16x32_bf16 v[60:63], v[148:151], v[124:127], v[60:63]
    s_waitcnt vmcnt(18)
    ds_read_b64_tr_b16 v[112:113], v9 offset:8192
    ds_read_b64_tr_b16 v[114:115], v9 offset:10240
    ds_read_b64_tr_b16 v[116:117], v10 offset:8192
    ds_read_b64_tr_b16 v[118:119], v10 offset:10240
    ds_read_b64_tr_b16 v[120:121], v11 offset:8192
    ds_read_b64_tr_b16 v[122:123], v11 offset:10240
    ds_read_b64_tr_b16 v[124:125], v12 offset:8192
    ds_read_b64_tr_b16 v[126:127], v12 offset:10240
    s_add_u32 m0, s36, 4096
    s_add_u32 s41, s39, 675840
    buffer_load_dwordx4 v3, s[12:15], s41 offen lds
    s_add_u32 m0, s36, 5120
    s_add_u32 s41, s39, 709632
    buffer_load_dwordx4 v3, s[12:15], s41 offen lds
    s_add_u32 m0, s36, 6144
    s_add_u32 s41, s39, 743424
    buffer_load_dwordx4 v3, s[12:15], s41 offen lds
    s_add_u32 m0, s36, 7168
    s_add_u32 s41, s39, 777216
    buffer_load_dwordx4 v3, s[12:15], s41 offen lds
    buffer_load_dwordx4 v[140:143], v4, s[12:15], s40 offen offset:1024
    buffer_load_dwordx4 v[144:147], v5, s[12:15], s40 offen offset:1024
    buffer_load_dwordx4 v[148:151], v6, s[12:15], s40 offen offset:1024
    s_waitcnt lgkmcnt(6)
    v_mfma_f32_16x16x32_bf16 v[16:19], v[152:155], v[112:115], v[16:19]
    v_mfma_f32_16x16x32_bf16 v[20:23], v[156:159], v[112:115], v[20:23]
    v_mfma_f32_16x16x32_bf16 v[24:27], v[160:163], v[112:115], v[24:27]
    s_waitcnt lgkmcnt(4)
    v_mfma_f32_16x16x32_bf16 v[28:31], v[152:155], v[116:119], v[28:31]
    v_mfma_f32_16x16x32_bf16 v[32:35], v[156:159], v[116:119], v[32:35]
    v_mfma_f32_16x16x32_bf16 v[36:39], v[160:163], v[116:119], v[36:39]
    s_waitcnt lgkmcnt(2)
    v_mfma_f32_16x16x32_bf16 v[40:43], v[152:155], v[120:123], v[40:43]
    v_mfma_f32_16x16x32_bf16 v[44:47], v[156:159], v[120:123], v[44:47]
    v_mfma_f32_16x16x32_bf16 v[48:51], v[160:163], v[120:123], v[48:51]
    s_waitcnt lgkmcnt(0)
    v_mfma_f32_16x16x32_bf16 v[52:55], v[152:155], v[124:127], v[52:55]
    v_mfma_f32_16x16x32_bf16 v[56:59], v[156:159], v[124:127], v[56:59]
    v_mfma_f32_16x16x32_bf16 v[60:63], v[160:163], v[124:127], v[60:63]
    s_waitcnt vmcnt(14)
    ds_read_b64_tr_b16 v[112:113], v9 offset:12288
    ds_read_b64_tr_b16 v[114:115], v9 offset:14336
    ds_read_b64_tr_b16 v[116:117], v10 offset:12288
    ds_read_b64_tr_b16 v[118:119], v10 offset:14336
    ds_read_b64_tr_b16 v[120:121], v11 offset:12288
    ds_read_b64_tr_b16 v[122:123], v11 offset:14336
    ds_read_b64_tr_b16 v[124:125], v12 offset:12288
    ds_read_b64_tr_b16 v[126:127], v12 offset:14336
    s_add_u32 m0, s36, 8192
    s_add_u32 s41, s39, 811008
    buffer_load_dwordx4 v3, s[12:15], s41 offen lds
    s_add_u32 m0, s36, 9216
    s_add_u32 s41, s39, 844800
    buffer_load_dwordx4 v3, s[12:15], s41 offen lds
    s_add_u32 m0, s36, 10240
    s_add_u32 s41, s39, 878592
    buffer_load_dwordx4 v3, s[12:15], s41 offen lds
    s_add_u32 m0, s36, 11264
    s_add_u32 s41, s39, 912384
    buffer_load_dwordx4 v3, s[12:15], s41 offen lds
    buffer_load_dwordx4 v[152:155], v4, s[12:15], s40 offen offset:2048
    buffer_load_dwordx4 v[156:159], v5, s[12:15], s40 offen offset:2048
    buffer_load_dwordx4 v[160:163], v6, s[12:15], s40 offen offset:2048
    s_waitcnt lgkmcnt(6)
    v_mfma_f32_16x16x32_bf16 v[16:19], v[164:167], v[112:115], v[16:19]
    v_mfma_f32_16x16x32_bf16 v[20:23], v[168:171], v[112:115], v[20:23]
    v_mfma_f32_16x16x32_bf16 v[24:27], v[172:175], v[112:115], v[24:27]
    s_waitcnt lgkmcnt(4)
    v_mfma_f32_16x16x32_bf16 v[28:31], v[164:167], v[116:119], v[28:31]
    v_mfma_f32_16x16x32_bf16 v[32:35], v[168:171], v[116:119], v[32:35]
    v_mfma_f32_16x16x32_bf16 v[36:39], v[172:175], v[116:119], v[36:39]
    s_waitcnt lgkmcnt(2)
    v_mfma_f32_16x16x32_bf16 v[40:43], v[164:167], v[120:123], v[40:43]
    v_mfma_f32_16x16x32_bf16 v[44:47], v[168:171], v[120:123], v[44:47]
    v_mfma_f32_16x16x32_bf16 v[48:51], v[172:175], v[120:123], v[48:51]
    s_waitcnt lgkmcnt(0)
    v_mfma_f32_16x16x32_bf16 v[52:55], v[164:167], v[124:127], v[52:55]
    v_mfma_f32_16x16x32_bf16 v[56:59], v[168:171], v[124:127], v[56:59]
    v_mfma_f32_16x16x32_bf16 v[60:63], v[172:175], v[124:127], v[60:63]
    s_waitcnt vmcnt(14)
    ds_read_b64_tr_b16 v[112:113], v9 offset:0
    ds_read_b64_tr_b16 v[114:115], v9 offset:2048
    ds_read_b64_tr_b16 v[116:117], v10 offset:0
    ds_read_b64_tr_b16 v[118:119], v10 offset:2048
    ds_read_b64_tr_b16 v[120:121], v11 offset:0
    ds_read_b64_tr_b16 v[122:123], v11 offset:2048
    ds_read_b64_tr_b16 v[124:125], v12 offset:0
    ds_read_b64_tr_b16 v[126:127], v12 offset:2048
    s_add_u32 m0, s36, 12288
    s_add_u32 s41, s39, 946176
    buffer_load_dwordx4 v3, s[12:15], s41 offen lds
    s_add_u32 m0, s36, 13312
    s_add_u32 s41, s39, 979968
    buffer_load_dwordx4 v3, s[12:15], s41 offen lds
    s_add_u32 m0, s36, 14336
    s_add_u32 s41, s39, 1013760
    buffer_load_dwordx4 v3, s[12:15], s41 offen lds
    s_add_u32 m0, s36, 15360
    s_add_u32 s41, s39, 1047552
    buffer_load_dwordx4 v3, s[12:15], s41 offen lds
    buffer_load_dwordx4 v[164:167], v4, s[12:15], s40 offen offset:3072
    buffer_load_dwordx4 v[168:171], v5, s[12:15], s40 offen offset:3072
    buffer_load_dwordx4 v[172:175], v6, s[12:15], s40 offen offset:3072
    s_waitcnt lgkmcnt(6)
    v_mfma_f32_16x16x32_bf16 v[16:19], v[128:131], v[112:115], v[16:19]
    v_mfma_f32_16x16x32_bf16 v[20:23], v[132:135], v[112:115], v[20:23]
    v_mfma_f32_16x16x32_bf16 v[24:27], v[136:139], v[112:115], v[24:27]
    s_waitcnt lgkmcnt(4)
    v_mfma_f32_16x16x32_bf16 v[28:31], v[128:131], v[116:119], v[28:31]
    v_mfma_f32_16x16x32_bf16 v[32:35], v[132:135], v[116:119], v[32:35]
    v_mfma_f32_16x16x32_bf16 v[36:39], v[136:139], v[116:119], v[36:39]
    s_waitcnt lgkmcnt(2)
    v_mfma_f32_16x16x32_bf16 v[40:43], v[128:131], v[120:123], v[40:43]
    v_mfma_f32_16x16x32_bf16 v[44:47], v[132:135], v[120:123], v[44:47]
    v_mfma_f32_16x16x32_bf16 v[48:51], v[136:139], v[120:123], v[48:51]
    s_waitcnt lgkmcnt(0)
    v_mfma_f32_16x16x32_bf16 v[52:55], v[128:131], v[124:127], v[52:55]
    v_mfma_f32_16x16x32_bf16 v[56:59], v[132:135], v[124:127], v[56:59]
    v_mfma_f32_16x16x32_bf16 v[60:63], v[136:139], v[124:127], v[60:63]
    s_waitcnt vmcnt(14)
    ds_read_b64_tr_b16 v[112:113], v9 offset:4096
    ds_read_b64_tr_b16 v[114:115], v9 offset:6144
    ds_read_b64_tr_b16 v[116:117], v10 offset:4096
    ds_read_b64_tr_b16 v[118:119], v10 offset:6144
    ds_read_b64_tr_b16 v[120:121], v11 offset:4096
    ds_read_b64_tr_b16 v[122:123], v11 offset:6144
    ds_read_b64_tr_b16 v[124:125], v12 offset:4096
    ds_read_b64_tr_b16 v[126:127], v12 offset:6144
    s_add_u32 m0, s36, 0
    s_add_u32 s41, s39, 1081344
    buffer_load_dwordx4 v3, s[12:15], s41 offen lds
    s_add_u32 m0, s36, 1024
    s_add_u32 s41, s39, 1115136
    buffer_load_dwordx4 v3, s[12:15], s41 offen lds
    s_add_u32 m0, s36, 2048
    s_add_u32 s41, s39, 1148928
    buffer_load_dwordx4 v3, s[12:15], s41 offen lds
    s_add_u32 m0, s36, 3072
    s_add_u32 s41, s39, 1182720
    buffer_load_dwordx4 v3, s[12:15], s41 offen lds
    s_add_u32 s40, s40, 4096
    buffer_load_dwordx4 v[128:131], v4, s[12:15], s40 offen
    buffer_load_dwordx4 v[132:135], v5, s[12:15], s40 offen
    buffer_load_dwordx4 v[136:139], v6, s[12:15], s40 offen
    s_waitcnt lgkmcnt(6)
    v_mfma_f32_16x16x32_bf16 v[16:19], v[140:143], v[112:115], v[16:19]
    v_mfma_f32_16x16x32_bf16 v[20:23], v[144:147], v[112:115], v[20:23]
    v_mfma_f32_16x16x32_bf16 v[24:27], v[148:151], v[112:115], v[24:27]
    s_waitcnt lgkmcnt(4)
    v_mfma_f32_16x16x32_bf16 v[28:31], v[140:143], v[116:119], v[28:31]
    v_mfma_f32_16x16x32_bf16 v[32:35], v[144:147], v[116:119], v[32:35]
    v_mfma_f32_16x16x32_bf16 v[36:39], v[148:151], v[116:119], v[36:39]
    s_waitcnt lgkmcnt(2)
    v_mfma_f32_16x16x32_bf16 v[40:43], v[140:143], v[120:123], v[40:43]
    v_mfma_f32_16x16x32_bf16 v[44:47], v[144:147], v[120:123], v[44:47]
    v_mfma_f32_16x16x32_bf16 v[48:51], v[148:151], v[120:123], v[48:51]
    s_waitcnt lgkmcnt(0)
    v_mfma_f32_16x16x32_bf16 v[52:55], v[140:143], v[124:127], v[52:55]
    v_mfma_f32_16x16x32_bf16 v[56:59], v[144:147], v[124:127], v[56:59]
    v_mfma_f32_16x16x32_bf16 v[60:63], v[148:151], v[124:127], v[60:63]
    s_waitcnt vmcnt(14)
    ds_read_b64_tr_b16 v[112:113], v9 offset:8192
    ds_read_b64_tr_b16 v[114:115], v9 offset:10240
    ds_read_b64_tr_b16 v[116:117], v10 offset:8192
    ds_read_b64_tr_b16 v[118:119], v10 offset:10240
    ds_read_b64_tr_b16 v[120:121], v11 offset:8192
    ds_read_b64_tr_b16 v[122:123], v11 offset:10240
    ds_read_b64_tr_b16 v[124:125], v12 offset:8192
    ds_read_b64_tr_b16 v[126:127], v12 offset:10240
    s_add_u32 m0, s36, 4096
    s_add_u32 s41, s39, 1216512
    buffer_load_dwordx4 v3, s[12:15], s41 offen lds
    s_add_u32 m0, s36, 5120
    s_add_u32 s41, s39, 1250304
    buffer_load_dwordx4 v3, s[12:15], s41 offen lds
    s_add_u32 m0, s36, 6144
    s_add_u32 s41, s39, 1284096
    buffer_load_dwordx4 v3, s[12:15], s41 offen lds
    s_add_u32 m0, s36, 7168
    s_add_u32 s41, s39, 1317888
    buffer_load_dwordx4 v3, s[12:15], s41 offen lds
    buffer_load_dwordx4 v[140:143], v4, s[12:15], s40 offen offset:1024
    buffer_load_dwordx4 v[144:147], v5, s[12:15], s40 offen offset:1024
    buffer_load_dwordx4 v[148:151], v6, s[12:15], s40 offen offset:1024
    s_waitcnt lgkmcnt(6)
    v_mfma_f32_16x16x32_bf16 v[16:19], v[152:155], v[112:115], v[16:19]
    v_mfma_f32_16x16x32_bf16 v[20:23], v[156:159], v[112:115], v[20:23]
    v_mfma_f32_16x16x32_bf16 v[24:27], v[160:163], v[112:115], v[24:27]
    s_waitcnt lgkmcnt(4)
    v_mfma_f32_16x16x32_bf16 v[28:31], v[152:155], v[116:119], v[28:31]
    v_mfma_f32_16x16x32_bf16 v[32:35], v[156:159], v[116:119], v[32:35]
    v_mfma_f32_16x16x32_bf16 v[36:39], v[160:163], v[116:119], v[36:39]
    s_waitcnt lgkmcnt(2)
    v_mfma_f32_16x16x32_bf16 v[40:43], v[152:155], v[120:123], v[40:43]
    v_mfma_f32_16x16x32_bf16 v[44:47], v[156:159], v[120:123], v[44:47]
    v_mfma_f32_16x16x32_bf16 v[48:51], v[160:163], v[120:123], v[48:51]
    s_waitcnt lgkmcnt(0)
    v_mfma_f32_16x16x32_bf16 v[52:55], v[152:155], v[124:127], v[52:55]
    v_mfma_f32_16x16x32_bf16 v[56:59], v[156:159], v[124:127], v[56:59]
    v_mfma_f32_16x16x32_bf16 v[60:63], v[160:163], v[124:127], v[60:63]
    s_waitcnt vmcnt(14)
    ds_read_b64_tr_b16 v[112:113], v9 offset:12288
    ds_read_b64_tr_b16 v[114:115], v9 offset:14336
    ds_read_b64_tr_b16 v[116:117], v10 offset:12288
    ds_read_b64_tr_b16 v[118:119], v10 offset:14336
    ds_read_b64_tr_b16 v[120:121], v11 offset:12288
    ds_read_b64_tr_b16 v[122:123], v11 offset:14336
    ds_read_b64_tr_b16 v[124:125], v12 offset:12288
    ds_read_b64_tr_b16 v[126:127], v12 offset:14336
    s_add_u32 m0, s36, 8192
    s_add_u32 s41, s39, 1351680
    buffer_load_dwordx4 v3, s[12:15], s41 offen lds
    s_add_u32 m0, s36, 9216
    s_add_u32 s41, s39, 1385472
    buffer_load_dwordx4 v3, s[12:15], s41 offen lds
    s_add_u32 m0, s36, 10240
    s_add_u32 s41, s39, 1419264
    buffer_load_dwordx4 v3, s[12:15], s41 offen lds
    s_add_u32 m0, s36, 11264
    s_add_u32 s41, s39, 1453056
    buffer_load_dwordx4 v3, s[12:15], s41 offen lds
    buffer_load_dwordx4 v[152:155], v4, s[12:15], s40 offen offset:2048
    buffer_load_dwordx4 v[156:159], v5, s[12:15], s40 offen offset:2048
    buffer_load_dwordx4 v[160:163], v6, s[12:15], s40 offen offset:2048
    s_waitcnt lgkmcnt(6)
    v_mfma_f32_16x16x32_bf16 v[16:19], v[164:167], v[112:115], v[16:19]
    v_mfma_f32_16x16x32_bf16 v[20:23], v[168:171], v[112:115], v[20:23]
    v_mfma_f32_16x16x32_bf16 v[24:27], v[172:175], v[112:115], v[24:27]
    s_waitcnt lgkmcnt(4)
    v_mfma_f32_16x16x32_bf16 v[28:31], v[164:167], v[116:119], v[28:31]
    v_mfma_f32_16x16x32_bf16 v[32:35], v[168:171], v[116:119], v[32:35]
    v_mfma_f32_16x16x32_bf16 v[36:39], v[172:175], v[116:119], v[36:39]
    s_waitcnt lgkmcnt(2)
    v_mfma_f32_16x16x32_bf16 v[40:43], v[164:167], v[120:123], v[40:43]
    v_mfma_f32_16x16x32_bf16 v[44:47], v[168:171], v[120:123], v[44:47]
    v_mfma_f32_16x16x32_bf16 v[48:51], v[172:175], v[120:123], v[48:51]
    s_waitcnt lgkmcnt(0)
    v_mfma_f32_16x16x32_bf16 v[52:55], v[164:167], v[124:127], v[52:55]
    v_mfma_f32_16x16x32_bf16 v[56:59], v[168:171], v[124:127], v[56:59]
    v_mfma_f32_16x16x32_bf16 v[60:63], v[172:175], v[124:127], v[60:63]
    s_waitcnt vmcnt(14)
    ds_read_b64_tr_b16 v[112:113], v9 offset:0
    ds_read_b64_tr_b16 v[114:115], v9 offset:2048
    ds_read_b64_tr_b16 v[116:117], v10 offset:0
    ds_read_b64_tr_b16 v[118:119], v10 offset:2048
    ds_read_b64_tr_b16 v[120:121], v11 offset:0
    ds_read_b64_tr_b16 v[122:123], v11 offset:2048
    ds_read_b64_tr_b16 v[124:125], v12 offset:0
    ds_read_b64_tr_b16 v[126:127], v12 offset:2048
    s_add_u32 m0, s36, 12288
    s_add_u32 s41, s39, 1486848
    buffer_load_dwordx4 v3, s[12:15], s41 offen lds
    s_add_u32 m0, s36, 13312
    s_add_u32 s41, s39, 1520640
    buffer_load_dwordx4 v3, s[12:15], s41 offen lds
    s_add_u32 m0, s36, 14336
    s_add_u32 s41, s39, 1554432
    buffer_load_dwordx4 v3, s[12:15], s41 offen lds
    s_add_u32 m0, s36, 15360
    s_add_u32 s41, s39, 1588224
    buffer_load_dwordx4 v3, s[12:15], s41 offen lds
    buffer_load_dwordx4 v[164:167], v4, s[12:15], s40 offen offset:3072
    buffer_load_dwordx4 v[168:171], v5, s[12:15], s40 offen offset:3072
    buffer_load_dwordx4 v[172:175], v6, s[12:15], s40 offen offset:3072
    s_waitcnt lgkmcnt(6)
    v_mfma_f32_16x16x32_bf16 v[16:19], v[128:131], v[112:115], v[16:19]
    v_mfma_f32_16x16x32_bf16 v[20:23], v[132:135], v[112:115], v[20:23]
    v_mfma_f32_16x16x32_bf16 v[24:27], v[136:139], v[112:115], v[24:27]
    s_waitcnt lgkmcnt(4)
    v_mfma_f32_16x16x32_bf16 v[28:31], v[128:131], v[116:119], v[28:31]
    v_mfma_f32_16x16x32_bf16 v[32:35], v[132:135], v[116:119], v[32:35]
    v_mfma_f32_16x16x32_bf16 v[36:39], v[136:139], v[116:119], v[36:39]
    s_waitcnt lgkmcnt(2)
    v_mfma_f32_16x16x32_bf16 v[40:43], v[128:131], v[120:123], v[40:43]
    v_mfma_f32_16x16x32_bf16 v[44:47], v[132:135], v[120:123], v[44:47]
    v_mfma_f32_16x16x32_bf16 v[48:51], v[136:139], v[120:123], v[48:51]
    s_waitcnt lgkmcnt(0)
    v_mfma_f32_16x16x32_bf16 v[52:55], v[128:131], v[124:127], v[52:55]
    v_mfma_f32_16x16x32_bf16 v[56:59], v[132:135], v[124:127], v[56:59]
    v_mfma_f32_16x16x32_bf16 v[60:63], v[136:139], v[124:127], v[60:63]
    s_waitcnt vmcnt(14)
    ds_read_b64_tr_b16 v[112:113], v9 offset:4096
    ds_read_b64_tr_b16 v[114:115], v9 offset:6144
    ds_read_b64_tr_b16 v[116:117], v10 offset:4096
    ds_read_b64_tr_b16 v[118:119], v10 offset:6144
    ds_read_b64_tr_b16 v[120:121], v11 offset:4096
    ds_read_b64_tr_b16 v[122:123], v11 offset:6144
    ds_read_b64_tr_b16 v[124:125], v12 offset:4096
    ds_read_b64_tr_b16 v[126:127], v12 offset:6144
    s_add_u32 m0, s36, 0
    s_add_u32 s41, s39, 1622016
    buffer_load_dwordx4 v3, s[12:15], s41 offen lds
    s_add_u32 m0, s36, 1024
    s_add_u32 s41, s39, 1655808
    buffer_load_dwordx4 v3, s[12:15], s41 offen lds
    s_add_u32 m0, s36, 2048
    s_add_u32 s41, s39, 1689600
    buffer_load_dwordx4 v3, s[12:15], s41 offen lds
    s_add_u32 m0, s36, 3072
    s_add_u32 s41, s39, 1723392
    buffer_load_dwordx4 v3, s[12:15], s41 offen lds
    s_add_u32 s40, s40, 4096
    buffer_load_dwordx4 v[128:131], v4, s[12:15], s40 offen
    buffer_load_dwordx4 v[132:135], v5, s[12:15], s40 offen
    buffer_load_dwordx4 v[136:139], v6, s[12:15], s40 offen
    s_waitcnt lgkmcnt(6)
    v_mfma_f32_16x16x32_bf16 v[16:19], v[140:143], v[112:115], v[16:19]
    v_mfma_f32_16x16x32_bf16 v[20:23], v[144:147], v[112:115], v[20:23]
    v_mfma_f32_16x16x32_bf16 v[24:27], v[148:151], v[112:115], v[24:27]
    s_waitcnt lgkmcnt(4)
    v_mfma_f32_16x16x32_bf16 v[28:31], v[140:143], v[116:119], v[28:31]
    v_mfma_f32_16x16x32_bf16 v[32:35], v[144:147], v[116:119], v[32:35]
    v_mfma_f32_16x16x32_bf16 v[36:39], v[148:151], v[116:119], v[36:39]
    s_waitcnt lgkmcnt(2)
    v_mfma_f32_16x16x32_bf16 v[40:43], v[140:143], v[120:123], v[40:43]
    v_mfma_f32_16x16x32_bf16 v[44:47], v[144:147], v[120:123], v[44:47]
    v_mfma_f32_16x16x32_bf16 v[48:51], v[148:151], v[120:123], v[48:51]
    s_waitcnt lgkmcnt(0)
    v_mfma_f32_16x16x32_bf16 v[52:55], v[140:143], v[124:127], v[52:55]
    v_mfma_f32_16x16x32_bf16 v[56:59], v[144:147], v[124:127], v[56:59]
    v_mfma_f32_16x16x32_bf16 v[60:63], v[148:151], v[124:127], v[60:63]
    s_waitcnt vmcnt(14)
    ds_read_b64_tr_b16 v[112:113], v9 offset:8192
    ds_read_b64_tr_b16 v[114:115], v9 offset:10240
    ds_read_b64_tr_b16 v[116:117], v10 offset:8192
    ds_read_b64_tr_b16 v[118:119], v10 offset:10240
    ds_read_b64_tr_b16 v[120:121], v11 offset:8192
    ds_read_b64_tr_b16 v[122:123], v11 offset:10240
    ds_read_b64_tr_b16 v[124:125], v12 offset:8192
    ds_read_b64_tr_b16 v[126:127], v12 offset:10240
    s_add_u32 m0, s36, 4096
    s_add_u32 s41, s39, 1757184
    buffer_load_dwordx4 v3, s[12:15], s41 offen lds
    s_add_u32 m0, s36, 5120
    s_add_u32 s41, s39, 1790976
    buffer_load_dwordx4 v3, s[12:15], s41 offen lds
    s_add_u32 m0, s36, 6144
    s_add_u32 s41, s39, 1824768
    buffer_load_dwordx4 v3, s[12:15], s41 offen lds
    s_add_u32 m0, s36, 7168
    s_add_u32 s41, s39, 1858560
    buffer_load_dwordx4 v3, s[12:15], s41 offen lds
    buffer_load_dwordx4 v[140:143], v4, s[12:15], s40 offen offset:1024
    buffer_load_dwordx4 v[144:147], v5, s[12:15], s40 offen offset:1024
    buffer_load_dwordx4 v[148:151], v6, s[12:15], s40 offen offset:1024
    s_waitcnt lgkmcnt(6)
    v_mfma_f32_16x16x32_bf16 v[64:67], v[152:155], v[112:115], 0
    v_mfma_f32_16x16x32_bf16 v[68:71], v[156:159], v[112:115], 0
    v_mfma_f32_16x16x32_bf16 v[72:75], v[160:163], v[112:115], 0
    s_waitcnt lgkmcnt(4)
    v_mfma_f32_16x16x32_bf16 v[76:79], v[152:155], v[116:119], 0
    v_mfma_f32_16x16x32_bf16 v[80:83], v[156:159], v[116:119], 0
    v_mfma_f32_16x16x32_bf16 v[84:87], v[160:163], v[116:119], 0
    s_waitcnt lgkmcnt(2)
    v_mfma_f32_16x16x32_bf16 v[88:91], v[152:155], v[120:123], 0
    v_mfma_f32_16x16x32_bf16 v[92:95], v[156:159], v[120:123], 0
    v_mfma_f32_16x16x32_bf16 v[96:99], v[160:163], v[120:123], 0
    s_waitcnt lgkmcnt(0)
    v_mfma_f32_16x16x32_bf16 v[100:103], v[152:155], v[124:127], 0
    v_mfma_f32_16x16x32_bf16 v[104:107], v[156:159], v[124:127], 0
    v_mfma_f32_16x16x32_bf16 v[108:111], v[160:163], v[124:127], 0
    s_waitcnt vmcnt(14)
    ds_read_b64_tr_b16 v[112:113], v9 offset:12288
    ds_read_b64_tr_b16 v[114:115], v9 offset:14336
    ds_read_b64_tr_b16 v[116:117], v10 offset:12288
    ds_read_b64_tr_b16 v[118:119], v10 offset:14336
    ds_read_b64_tr_b16 v[120:121], v11 offset:12288
    ds_read_b64_tr_b16 v[122:123], v11 offset:14336
    ds_read_b64_tr_b16 v[124:125], v12 offset:12288
    ds_read_b64_tr_b16 v[126:127], v12 offset:14336
    s_add_u32 m0, s36, 8192
    s_add_u32 s41, s39, 1892352
    buffer_load_dwordx4 v3, s[12:15], s41 offen lds
    s_add_u32 m0, s36, 9216
    s_add_u32 s41, s39, 1926144
    buffer_load_dwordx4 v3, s[12:15], s41 offen lds
    s_add_u32 m0, s36, 10240
    s_add_u32 s41, s39, 1959936
    buffer_load_dwordx4 v3, s[12:15], s41 offen lds
    s_add_u32 m0, s36, 11264
    s_add_u32 s41, s39, 1993728
    buffer_load_dwordx4 v3, s[12:15], s41 offen lds
    buffer_load_dwordx4 v[152:155], v4, s[12:15], s40 offen offset:2048
    buffer_load_dwordx4 v[156:159], v5, s[12:15], s40 offen offset:2048
    buffer_load_dwordx4 v[160:163], v6, s[12:15], s40 offen offset:2048
    s_waitcnt lgkmcnt(6)
    v_mfma_f32_16x16x32_bf16 v[64:67], v[164:167], v[112:115], v[64:67]
    v_mfma_f32_16x16x32_bf16 v[68:71], v[168:171], v[112:115], v[68:71]
    v_mfma_f32_16x16x32_bf16 v[72:75], v[172:175], v[112:115], v[72:75]
    s_waitcnt lgkmcnt(4)
    v_mfma_f32_16x16x32_bf16 v[76:79], v[164:167], v[116:119], v[76:79]
    v_mfma_f32_16x16x32_bf16 v[80:83], v[168:171], v[116:119], v[80:83]
    v_mfma_f32_16x16x32_bf16 v[84:87], v[172:175], v[116:119], v[84:87]
    s_waitcnt lgkmcnt(2)
    v_mfma_f32_16x16x32_bf16 v[88:91], v[164:167], v[120:123], v[88:91]
    v_mfma_f32_16x16x32_bf16 v[92:95], v[168:171], v[120:123], v[92:95]
    v_mfma_f32_16x16x32_bf16 v[96:99], v[172:175], v[120:123], v[96:99]
    s_waitcnt lgkmcnt(0)
    v_mfma_f32_16x16x32_bf16 v[100:103], v[164:167], v[124:127], v[100:103]
    v_mfma_f32_16x16x32_bf16 v[104:107], v[168:171], v[124:127], v[104:107]
    v_mfma_f32_16x16x32_bf16 v[108:111], v[172:175], v[124:127], v[108:111]
    s_waitcnt vmcnt(14)
    ds_read_b64_tr_b16 v[112:113], v9 offset:0
    ds_read_b64_tr_b16 v[114:115], v9 offset:2048
    ds_read_b64_tr_b16 v[116:117], v10 offset:0
    ds_read_b64_tr_b16 v[118:119], v10 offset:2048
    ds_read_b64_tr_b16 v[120:121], v11 offset:0
    ds_read_b64_tr_b16 v[122:123], v11 offset:2048
    ds_read_b64_tr_b16 v[124:125], v12 offset:0
    ds_read_b64_tr_b16 v[126:127], v12 offset:2048
    s_add_u32 m0, s36, 12288
    s_add_u32 s41, s39, 2027520
    buffer_load_dwordx4 v3, s[12:15], s41 offen lds
    s_add_u32 m0, s36, 13312
    s_add_u32 s41, s39, 2061312
    buffer_load_dwordx4 v3, s[12:15], s41 offen lds
    s_add_u32 m0, s36, 14336
    s_add_u32 s41, s39, 2095104
    buffer_load_dwordx4 v3, s[12:15], s41 offen lds
    s_add_u32 m0, s36, 15360
    s_add_u32 s41, s39, 2128896
    buffer_load_dwordx4 v3, s[12:15], s41 offen lds
    buffer_load_dwordx4 v[164:167], v4, s[12:15], s40 offen offset:3072
    buffer_load_dwordx4 v[168:171], v5, s[12:15], s40 offen offset:3072
    buffer_load_dwordx4 v[172:175], v6, s[12:15], s40 offen offset:3072
    s_waitcnt lgkmcnt(6)
    v_mfma_f32_16x16x32_bf16 v[64:67], v[128:131], v[112:115], v[64:67]
    v_mfma_f32_16x16x32_bf16 v[68:71], v[132:135], v[112:115], v[68:71]
    v_mfma_f32_16x16x32_bf16 v[72:75], v[136:139], v[112:115], v[72:75]
    s_waitcnt lgkmcnt(4)
    v_mfma_f32_16x16x32_bf16 v[76:79], v[128:131], v[116:119], v[76:79]
    v_mfma_f32_16x16x32_bf16 v[80:83], v[132:135], v[116:119], v[80:83]
    v_mfma_f32_16x16x32_bf16 v[84:87], v[136:139], v[116:119], v[84:87]
    s_waitcnt lgkmcnt(2)
    v_mfma_f32_16x16x32_bf16 v[88:91], v[128:131], v[120:123], v[88:91]
    v_mfma_f32_16x16x32_bf16 v[92:95], v[132:135], v[120:123], v[92:95]
    v_mfma_f32_16x16x32_bf16 v[96:99], v[136:139], v[120:123], v[96:99]
    s_waitcnt lgkmcnt(0)
    v_mfma_f32_16x16x32_bf16 v[100:103], v[128:131], v[124:127], v[100:103]
    v_mfma_f32_16x16x32_bf16 v[104:107], v[132:135], v[124:127], v[104:107]
    v_mfma_f32_16x16x32_bf16 v[108:111], v[136:139], v[124:127], v[108:111]
    s_waitcnt vmcnt(14)
    ds_read_b64_tr_b16 v[112:113], v9 offset:4096
    ds_read_b64_tr_b16 v[114:115], v9 offset:6144
    ds_read_b64_tr_b16 v[116:117], v10 offset:4096
    ds_read_b64_tr_b16 v[118:119], v10 offset:6144
    ds_read_b64_tr_b16 v[120:121], v11 offset:4096
    ds_read_b64_tr_b16 v[122:123], v11 offset:6144
    ds_read_b64_tr_b16 v[124:125], v12 offset:4096
    ds_read_b64_tr_b16 v[126:127], v12 offset:6144
    s_add_u32 m0, s36, 0
    s_add_u32 s41, s39, 2162688
    buffer_load_dwordx4 v3, s[12:15], s41 offen lds
    s_add_u32 m0, s36, 1024
    s_add_u32 s41, s39, 2196480
    buffer_load_dwordx4 v3, s[12:15], s41 offen lds
    s_add_u32 m0, s36, 2048
    s_add_u32 s41, s39, 2230272
    buffer_load_dwordx4 v3, s[12:15], s41 offen lds
    s_add_u32 m0, s36, 3072
    s_add_u32 s41, s39, 2264064
    buffer_load_dwordx4 v3, s[12:15], s41 offen lds
    s_add_u32 s40, s40, 4096
    buffer_load_dwordx4 v[128:131], v4, s[12:15], s40 offen
    buffer_load_dwordx4 v[132:135], v5, s[12:15], s40 offen
    buffer_load_dwordx4 v[136:139], v6, s[12:15], s40 offen
    s_waitcnt lgkmcnt(6)
    v_mfma_f32_16x16x32_bf16 v[64:67], v[140:143], v[112:115], v[64:67]
    v_mfma_f32_16x16x32_bf16 v[68:71], v[144:147], v[112:115], v[68:71]
    v_mfma_f32_16x16x32_bf16 v[72:75], v[148:151], v[112:115], v[72:75]
    s_waitcnt lgkmcnt(4)
    v_mfma_f32_16x16x32_bf16 v[76:79], v[140:143], v[116:119], v[76:79]
    v_mfma_f32_16x16x32_bf16 v[80:83], v[144:147], v[116:119], v[80:83]
    v_mfma_f32_16x16x32_bf16 v[84:87], v[148:151], v[116:119], v[84:87]
    s_waitcnt lgkmcnt(2)
    v_mfma_f32_16x16x32_bf16 v[88:91], v[140:143], v[120:123], v[88:91]
    v_mfma_f32_16x16x32_bf16 v[92:95], v[144:147], v[120:123], v[92:95]
    v_mfma_f32_16x16x32_bf16 v[96:99], v[148:151], v[120:123], v[96:99]
    s_waitcnt lgkmcnt(0)
    v_mfma_f32_16x16x32_bf16 v[100:103], v[140:143], v[124:127], v[100:103]
    v_mfma_f32_16x16x32_bf16 v[104:107], v[144:147], v[124:127], v[104:107]
    v_mfma_f32_16x16x32_bf16 v[108:111], v[148:151], v[124:127], v[108:111]
    s_waitcnt vmcnt(14)
    ds_read_b64_tr_b16 v[112:113], v9 offset:8192
    ds_read_b64_tr_b16 v[114:115], v9 offset:10240
    ds_read_b64_tr_b16 v[116:117], v10 offset:8192
    ds_read_b64_tr_b16 v[118:119], v10 offset:10240
    ds_read_b64_tr_b16 v[120:121], v11 offset:8192
    ds_read_b64_tr_b16 v[122:123], v11 offset:10240
    ds_read_b64_tr_b16 v[124:125], v12 offset:8192
    ds_read_b64_tr_b16 v[126:127], v12 offset:10240
    s_add_u32 m0, s36, 4096
    s_add_u32 s41, s39, 2297856
    buffer_load_dwordx4 v3, s[12:15], s41 offen lds
    s_add_u32 m0, s36, 5120
    s_add_u32 s41, s39, 2331648
    buffer_load_dwordx4 v3, s[12:15], s41 offen lds
    s_add_u32 m0, s36, 6144
    s_add_u32 s41, s39, 2365440
    buffer_load_dwordx4 v3, s[12:15], s41 offen lds
    s_add_u32 m0, s36, 7168
    s_add_u32 s41, s39, 2399232
    buffer_load_dwordx4 v3, s[12:15], s41 offen lds
    buffer_load_dwordx4 v[140:143], v4, s[12:15], s40 offen offset:1024
    buffer_load_dwordx4 v[144:147], v5, s[12:15], s40 offen offset:1024
    buffer_load_dwordx4 v[148:151], v6, s[12:15], s40 offen offset:1024
    s_waitcnt lgkmcnt(6)
    v_mfma_f32_16x16x32_bf16 v[64:67], v[152:155], v[112:115], v[64:67]
    v_mfma_f32_16x16x32_bf16 v[68:71], v[156:159], v[112:115], v[68:71]
    v_mfma_f32_16x16x32_bf16 v[72:75], v[160:163], v[112:115], v[72:75]
    s_waitcnt lgkmcnt(4)
    v_mfma_f32_16x16x32_bf16 v[76:79], v[152:155], v[116:119], v[76:79]
    v_mfma_f32_16x16x32_bf16 v[80:83], v[156:159], v[116:119], v[80:83]
    v_mfma_f32_16x16x32_bf16 v[84:87], v[160:163], v[116:119], v[84:87]
    s_waitcnt lgkmcnt(2)
    v_mfma_f32_16x16x32_bf16 v[88:91], v[152:155], v[120:123], v[88:91]
    v_mfma_f32_16x16x32_bf16 v[92:95], v[156:159], v[120:123], v[92:95]
    v_mfma_f32_16x16x32_bf16 v[96:99], v[160:163], v[120:123], v[96:99]
    s_waitcnt lgkmcnt(0)
    v_mfma_f32_16x16x32_bf16 v[100:103], v[152:155], v[124:127], v[100:103]
    v_mfma_f32_16x16x32_bf16 v[104:107], v[156:159], v[124:127], v[104:107]
    v_mfma_f32_16x16x32_bf16 v[108:111], v[160:163], v[124:127], v[108:111]
    s_waitcnt vmcnt(14)
    ds_read_b64_tr_b16 v[112:113], v9 offset:12288
    ds_read_b64_tr_b16 v[114:115], v9 offset:14336
    ds_read_b64_tr_b16 v[116:117], v10 offset:12288
    ds_read_b64_tr_b16 v[118:119], v10 offset:14336
    ds_read_b64_tr_b16 v[120:121], v11 offset:12288
    ds_read_b64_tr_b16 v[122:123], v11 offset:14336
    ds_read_b64_tr_b16 v[124:125], v12 offset:12288
    ds_read_b64_tr_b16 v[126:127], v12 offset:14336
    s_add_u32 m0, s36, 8192
    s_add_u32 s41, s39, 2433024
    buffer_load_dwordx4 v3, s[12:15], s41 offen lds
    s_add_u32 m0, s36, 9216
    s_add_u32 s41, s39, 2466816
    buffer_load_dwordx4 v3, s[12:15], s41 offen lds
    s_add_u32 m0, s36, 10240
    s_add_u32 s41, s39, 2500608
    buffer_load_dwordx4 v3, s[12:15], s41 offen lds
    s_add_u32 m0, s36, 11264
    s_add_u32 s41, s39, 2534400
    buffer_load_dwordx4 v3, s[12:15], s41 offen lds
    buffer_load_dwordx4 v[152:155], v4, s[12:15], s40 offen offset:2048
    buffer_load_dwordx4 v[156:159], v5, s[12:15], s40 offen offset:2048
    buffer_load_dwordx4 v[160:163], v6, s[12:15], s40 offen offset:2048
    s_waitcnt lgkmcnt(6)
    v_mfma_f32_16x16x32_bf16 v[64:67], v[164:167], v[112:115], v[64:67]
    v_mfma_f32_16x16x32_bf16 v[68:71], v[168:171], v[112:115], v[68:71]
    v_mfma_f32_16x16x32_bf16 v[72:75], v[172:175], v[112:115], v[72:75]
    s_waitcnt lgkmcnt(4)
    v_mfma_f32_16x16x32_bf16 v[76:79], v[164:167], v[116:119], v[76:79]
    v_mfma_f32_16x16x32_bf16 v[80:83], v[168:171], v[116:119], v[80:83]
    v_mfma_f32_16x16x32_bf16 v[84:87], v[172:175], v[116:119], v[84:87]
    s_waitcnt lgkmcnt(2)
    v_mfma_f32_16x16x32_bf16 v[88:91], v[164:167], v[120:123], v[88:91]
    v_mfma_f32_16x16x32_bf16 v[92:95], v[168:171], v[120:123], v[92:95]
    v_mfma_f32_16x16x32_bf16 v[96:99], v[172:175], v[120:123], v[96:99]
    s_waitcnt lgkmcnt(0)
    v_mfma_f32_16x16x32_bf16 v[100:103], v[164:167], v[124:127], v[100:103]
    v_mfma_f32_16x16x32_bf16 v[104:107], v[168:171], v[124:127], v[104:107]
    v_mfma_f32_16x16x32_bf16 v[108:111], v[172:175], v[124:127], v[108:111]
    s_waitcnt vmcnt(14)
    ds_read_b64_tr_b16 v[112:113], v9 offset:0
    ds_read_b64_tr_b16 v[114:115], v9 offset:2048
    ds_read_b64_tr_b16 v[116:117], v10 offset:0
    ds_read_b64_tr_b16 v[118:119], v10 offset:2048
    ds_read_b64_tr_b16 v[120:121], v11 offset:0
    ds_read_b64_tr_b16 v[122:123], v11 offset:2048
    ds_read_b64_tr_b16 v[124:125], v12 offset:0
    ds_read_b64_tr_b16 v[126:127], v12 offset:2048
    s_add_u32 m0, s36, 12288
    s_add_u32 s41, s39, 2568192
    buffer_load_dwordx4 v3, s[12:15], s41 offen lds
    s_add_u32 m0, s36, 13312
    s_add_u32 s41, s39, 2601984
    buffer_load_dwordx4 v3, s[12:15], s41 offen lds
    s_add_u32 m0, s36, 14336
    s_add_u32 s41, s39, 2635776
    buffer_load_dwordx4 v3, s[12:15], s41 offen lds
    s_add_u32 m0, s36, 15360
    s_add_u32 s41, s39, 2669568
    buffer_load_dwordx4 v3, s[12:15], s41 offen lds
    buffer_load_dwordx4 v[164:167], v4, s[12:15], s40 offen offset:3072
    buffer_load_dwordx4 v[168:171], v5, s[12:15], s40 offen offset:3072
    buffer_load_dwordx4 v[172:175], v6, s[12:15], s40 offen offset:3072
    s_waitcnt lgkmcnt(6)
    v_mfma_f32_16x16x32_bf16 v[64:67], v[128:131], v[112:115], v[64:67]
    v_mfma_f32_16x16x32_bf16 v[68:71], v[132:135], v[112:115], v[68:71]
    v_mfma_f32_16x16x32_bf16 v[72:75], v[136:139], v[112:115], v[72:75]
    s_waitcnt lgkmcnt(4)
    v_mfma_f32_16x16x32_bf16 v[76:79], v[128:131], v[116:119], v[76:79]
    v_mfma_f32_16x16x32_bf16 v[80:83], v[132:135], v[116:119], v[80:83]
    v_mfma_f32_16x16x32_bf16 v[84:87], v[136:139], v[116:119], v[84:87]
    s_waitcnt lgkmcnt(2)
    v_mfma_f32_16x16x32_bf16 v[88:91], v[128:131], v[120:123], v[88:91]
    v_mfma_f32_16x16x32_bf16 v[92:95], v[132:135], v[120:123], v[92:95]
    v_mfma_f32_16x16x32_bf16 v[96:99], v[136:139], v[120:123], v[96:99]
    s_waitcnt lgkmcnt(0)
    v_mfma_f32_16x16x32_bf16 v[100:103], v[128:131], v[124:127], v[100:103]
    v_mfma_f32_16x16x32_bf16 v[104:107], v[132:135], v[124:127], v[104:107]
    v_mfma_f32_16x16x32_bf16 v[108:111], v[136:139], v[124:127], v[108:111]
    s_waitcnt vmcnt(14)
    ds_read_b64_tr_b16 v[112:113], v9 offset:4096
    ds_read_b64_tr_b16 v[114:115], v9 offset:6144
    ds_read_b64_tr_b16 v[116:117], v10 offset:4096
    ds_read_b64_tr_b16 v[118:119], v10 offset:6144
    ds_read_b64_tr_b16 v[120:121], v11 offset:4096
    ds_read_b64_tr_b16 v[122:123], v11 offset:6144
    ds_read_b64_tr_b16 v[124:125], v12 offset:4096
    ds_read_b64_tr_b16 v[126:127], v12 offset:6144
    s_waitcnt lgkmcnt(6)
    v_mfma_f32_16x16x32_bf16 v[64:67], v[140:143], v[112:115], v[64:67]
    v_mfma_f32_16x16x32_bf16 v[68:71], v[144:147], v[112:115], v[68:71]
    v_mfma_f32_16x16x32_bf16 v[72:75], v[148:151], v[112:115], v[72:75]
    s_waitcnt lgkmcnt(4)
    v_mfma_f32_16x16x32_bf16 v[76:79], v[140:143], v[116:119], v[76:79]
    v_mfma_f32_16x16x32_bf16 v[80:83], v[144:147], v[116:119], v[80:83]
    v_mfma_f32_16x16x32_bf16 v[84:87], v[148:151], v[116:119], v[84:87]
    s_waitcnt lgkmcnt(2)
    v_mfma_f32_16x16x32_bf16 v[88:91], v[140:143], v[120:123], v[88:91]
    v_mfma_f32_16x16x32_bf16 v[92:95], v[144:147], v[120:123], v[92:95]
    v_mfma_f32_16x16x32_bf16 v[96:99], v[148:151], v[120:123], v[96:99]
    s_waitcnt lgkmcnt(0)
    v_mfma_f32_16x16x32_bf16 v[100:103], v[140:143], v[124:127], v[100:103]
    v_mfma_f32_16x16x32_bf16 v[104:107], v[144:147], v[124:127], v[104:107]
    v_mfma_f32_16x16x32_bf16 v[108:111], v[148:151], v[124:127], v[108:111]
    s_waitcnt vmcnt(7)
    ds_read_b64_tr_b16 v[112:113], v9 offset:8192
    ds_read_b64_tr_b16 v[114:115], v9 offset:10240
    ds_read_b64_tr_b16 v[116:117], v10 offset:8192
    ds_read_b64_tr_b16 v[118:119], v10 offset:10240
    ds_read_b64_tr_b16 v[120:121], v11 offset:8192
    ds_read_b64_tr_b16 v[122:123], v11 offset:10240
    ds_read_b64_tr_b16 v[124:125], v12 offset:8192
    ds_read_b64_tr_b16 v[126:127], v12 offset:10240
    s_waitcnt lgkmcnt(6)
    v_mfma_f32_16x16x32_bf16 v[64:67], v[152:155], v[112:115], v[64:67]
    v_mfma_f32_16x16x32_bf16 v[68:71], v[156:159], v[112:115], v[68:71]
    v_mfma_f32_16x16x32_bf16 v[72:75], v[160:163], v[112:115], v[72:75]
    s_waitcnt lgkmcnt(4)
    v_mfma_f32_16x16x32_bf16 v[76:79], v[152:155], v[116:119], v[76:79]
    v_mfma_f32_16x16x32_bf16 v[80:83], v[156:159], v[116:119], v[80:83]
    v_mfma_f32_16x16x32_bf16 v[84:87], v[160:163], v[116:119], v[84:87]
    s_waitcnt lgkmcnt(2)
    v_mfma_f32_16x16x32_bf16 v[88:91], v[152:155], v[120:123], v[88:91]
    v_mfma_f32_16x16x32_bf16 v[92:95], v[156:159], v[120:123], v[92:95]
    v_mfma_f32_16x16x32_bf16 v[96:99], v[160:163], v[120:123], v[96:99]
    s_waitcnt lgkmcnt(0)
    v_mfma_f32_16x16x32_bf16 v[100:103], v[152:155], v[124:127], v[100:103]
    v_mfma_f32_16x16x32_bf16 v[104:107], v[156:159], v[124:127], v[104:107]
    v_mfma_f32_16x16x32_bf16 v[108:111], v[160:163], v[124:127], v[108:111]
    s_waitcnt vmcnt(0)
    ds_read_b64_tr_b16 v[112:113], v9 offset:12288
    ds_read_b64_tr_b16 v[114:115], v9 offset:14336
    ds_read_b64_tr_b16 v[116:117], v10 offset:12288
    ds_read_b64_tr_b16 v[118:119], v10 offset:14336
    ds_read_b64_tr_b16 v[120:121], v11 offset:12288
    ds_read_b64_tr_b16 v[122:123], v11 offset:14336
    ds_read_b64_tr_b16 v[124:125], v12 offset:12288
    ds_read_b64_tr_b16 v[126:127], v12 offset:14336
    s_waitcnt lgkmcnt(6)
    v_mfma_f32_16x16x32_bf16 v[64:67], v[164:167], v[112:115], v[64:67]
    v_mfma_f32_16x16x32_bf16 v[68:71], v[168:171], v[112:115], v[68:71]
    v_mfma_f32_16x16x32_bf16 v[72:75], v[172:175], v[112:115], v[72:75]
    s_waitcnt lgkmcnt(4)
    v_mfma_f32_16x16x32_bf16 v[76:79], v[164:167], v[116:119], v[76:79]
    v_mfma_f32_16x16x32_bf16 v[80:83], v[168:171], v[116:119], v[80:83]
    v_mfma_f32_16x16x32_bf16 v[84:87], v[172:175], v[116:119], v[84:87]
    s_waitcnt lgkmcnt(2)
    v_mfma_f32_16x16x32_bf16 v[88:91], v[164:167], v[120:123], v[88:91]
    v_mfma_f32_16x16x32_bf16 v[92:95], v[168:171], v[120:123], v[92:95]
    v_mfma_f32_16x16x32_bf16 v[96:99], v[172:175], v[120:123], v[96:99]
    s_waitcnt lgkmcnt(0)
    v_mfma_f32_16x16x32_bf16 v[100:103], v[164:167], v[124:127], v[100:103]
    v_mfma_f32_16x16x32_bf16 v[104:107], v[168:171], v[124:127], v[104:107]
    v_mfma_f32_16x16x32_bf16 v[108:111], v[172:175], v[124:127], v[108:111]
    v_lshrrev_b32 v1, 4, v2
    v_mul_u32_u24 v1, 272, v1
    v_and_b32 v3, 15, v2
    v_lshl_add_u32 v1, v3, 4, v1
    v_add_u32 v1, s36, v1
    v_mov_b32 v4, 1.0
    v_mov_b32 v5, -1.0
    v_cmp_gt_u32 vcc, 32, v2
    s_nop 1
    v_cndmask_b32 v4, v5, v4, vcc
    s_nop 4
    v_add_f32 v128, v16, v64
    v_add_f32 v132, v20, v68
    v_fma_f32 v136, v72, v4, v24
    v_sub_f32 v140, v16, v64
    v_sub_f32 v144, v20, v68
    v_add_f32 v129, v17, v65
    v_add_f32 v133, v21, v69
    v_fma_f32 v137, v73, v4, v25
    v_sub_f32 v141, v17, v65
    v_sub_f32 v145, v21, v69
    v_add_f32 v130, v18, v66
    v_add_f32 v134, v22, v70
    v_fma_f32 v138, v74, v4, v26
    v_sub_f32 v142, v18, v66
    v_sub_f32 v146, v22, v70
    v_add_f32 v131, v19, v67
    v_add_f32 v135, v23, v71
    v_fma_f32 v139, v75, v4, v27
    v_sub_f32 v143, v19, v67
    v_sub_f32 v147, v23, v71
    ds_write_b128 v1, v[128:131] offset:0
    ds_write_b128 v1, v[132:135] offset:1088
    ds_write_b128 v1, v[136:139] offset:2176
    ds_write_b128 v1, v[140:143] offset:3264
    ds_write_b128 v1, v[144:147] offset:4352
    v_add_f32 v148, v28, v76
    v_add_f32 v152, v32, v80
    v_fma_f32 v156, v84, v4, v36
    v_sub_f32 v160, v28, v76
    v_sub_f32 v164, v32, v80
    v_add_f32 v149, v29, v77
    v_add_f32 v153, v33, v81
    v_fma_f32 v157, v85, v4, v37
    v_sub_f32 v161, v29, v77
    v_sub_f32 v165, v33, v81
    v_add_f32 v150, v30, v78
    v_add_f32 v154, v34, v82
    v_fma_f32 v158, v86, v4, v38
    v_sub_f32 v162, v30, v78
    v_sub_f32 v166, v34, v82
    v_add_f32 v151, v31, v79
    v_add_f32 v155, v35, v83
    v_fma_f32 v159, v87, v4, v39
    v_sub_f32 v163, v31, v79
    v_sub_f32 v167, v35, v83
    ds_write_b128 v1, v[148:151] offset:5440
    ds_write_b128 v1, v[152:155] offset:6528
    ds_write_b128 v1, v[156:159] offset:7616
    ds_write_b128 v1, v[160:163] offset:8704
    ds_write_b128 v1, v[164:167] offset:9792
    s_waitcnt lgkmcnt(5)
    v_add_f32 v128, v40, v88
    v_add_f32 v132, v44, v92
    v_fma_f32 v136, v96, v4, v48
    v_sub_f32 v140, v40, v88
    v_sub_f32 v144, v44, v92
    v_add_f32 v129, v41, v89
    v_add_f32 v133, v45, v93
    v_fma_f32 v137, v97, v4, v49
    v_sub_f32 v141, v41, v89
    v_sub_f32 v145, v45, v93
    v_add_f32 v130, v42, v90
    v_add_f32 v134, v46, v94
    v_fma_f32 v138, v98, v4, v50
    v_sub_f32 v142, v42, v90
    v_sub_f32 v146, v46, v94
    v_add_f32 v131, v43, v91
    v_add_f32 v135, v47, v95
    v_fma_f32 v139, v99, v4, v51
    v_sub_f32 v143, v43, v91
    v_sub_f32 v147, v47, v95
    ds_write_b128 v1, v[128:131] offset:10880
    ds_write_b128 v1, v[132:135] offset:11968
    ds_write_b128 v1, v[136:139] offset:13056
    ds_write_b128 v1, v[140:143] offset:14144
    ds_write_b128 v1, v[144:147] offset:15232
    s_waitcnt lgkmcnt(5)
    v_add_f32 v148, v52, v100
    v_add_f32 v152, v56, v104
    v_fma_f32 v156, v108, v4, v60
    v_sub_f32 v160, v52, v100
    v_sub_f32 v164, v56, v104
    v_add_f32 v149, v53, v101
    v_add_f32 v153, v57, v105
    v_fma_f32 v157, v109, v4, v61
    v_sub_f32 v161, v53, v101
    v_sub_f32 v165, v57, v105
    v_add_f32 v150, v54, v102
    v_add_f32 v154, v58, v106
    v_fma_f32 v158, v110, v4, v62
    v_sub_f32 v162, v54, v102
    v_sub_f32 v166, v58, v106
    v_add_f32 v151, v55, v103
    v_add_f32 v155, v59, v107
    v_fma_f32 v159, v111, v4, v63
    v_sub_f32 v163, v55, v103
    v_sub_f32 v167, v59, v107
    ds_write_b128 v1, v[148:151] offset:16320
    ds_write_b128 v1, v[152:155] offset:17408
    ds_write_b128 v1, v[156:159] offset:18496
    ds_write_b128 v1, v[160:163] offset:19584
    ds_write_b128 v1, v[164:167] offset:20672
    s_branch K3_EPI
K3_WPART:
    v_lshrrev_b32 v1, 4, v2
    v_mul_u32_u24 v1, 272, v1
    v_and_b32 v3, 15, v2
    v_lshl_add_u32 v1, v3, 4, v1
    v_add_u32 v1, s36, v1
    s_nop 4
    ds_write_b128 v1, v[16:19] offset:0
    ds_write_b128 v1, v[20:23] offset:1088
    ds_write_b128 v1, v[24:27] offset:2176
    ds_write_b128 v1, v[28:31] offset:3264
    ds_write_b128 v1, v[32:35] offset:4352
    ds_write_b128 v1, v[36:39] offset:5440
    ds_write_b128 v1, v[40:43] offset:6528
    ds_write_b128 v1, v[44:47] offset:7616
    ds_write_b128 v1, v[48:51] offset:8704
    ds_write_b128 v1, v[52:55] offset:9792
    ds_write_b128 v1, v[56:59] offset:10880
    ds_write_b128 v1, v[60:63] offset:11968
    ds_write_b128 v1, v[64:67] offset:13056
    ds_write_b128 v1, v[68:71] offset:14144
    ds_write_b128 v1, v[72:75] offset:15232
    ds_write_b128 v1, v[76:79] offset:16320
    ds_write_b128 v1, v[80:83] offset:17408
    ds_write_b128 v1, v[84:87] offset:18496
    ds_write_b128 v1, v[88:91] offset:19584
    ds_write_b128 v1, v[92:95] offset:20672
    s_branch K3_EPI
K3_SPARE:
    s_waitcnt lgkmcnt(0)
    s_mov_b32 s12, s28
    s_and_b32 s13, s29, 0xffff
    s_mov_b32 s14, 13414400
    s_mov_b32 s15, 0x20000
    s_mov_b32 s8, s4
    s_and_b32 s9, s5, 0xffff
    s_mov_b32 s10, 7077888
    s_mov_b32 s11, 0x20000
    s_mov_b32 s16, s6
    s_and_b32 s17, s7, 0xffff
    s_mov_b32 s18, 4096
    s_mov_b32 s19, 0x20000
    s_mov_b32 s20, s30
    s_and_b32 s21, s31, 0xffff
    s_mov_b32 s22, 2621440
    s_mov_b32 s23, 0x20000
    s_movk_i32 s45, 6554
    s_mul_i32 s46, s32, 80
    s_lshl_b32 s47, s27, 6
    s_mov_b32 s48, 7938048
    v_mov_b32 v200, v0
    v_mul_u32_u24 v201, s45, v200
    v_lshrrev_b32 v201, 16, v201
    v_mul_u32_u24 v202, 10, v201
    v_sub_u32 v202, v200, v202
    v_add_u32 v203, s47, v201
    v_lshlrev_b32 v204, 2, v203
    v_lshlrev_b32 v205, 1, v203
    buffer_load_dword v206, v204, s[12:15], s48 offen
    buffer_load_ushort v207, v205, s[16:19], 0 offen
    v_cmp_lt_u32 vcc, 4, v202
    v_add_u32 v200, 35, v202
    v_add_u32 v208, 1, v202
    v_cndmask_b32 v200, v202, v200, vcc
    v_cndmask_b32 v202, v202, v208, vcc
    v_cmp_eq_u32 vcc, 10, v202
    v_mov_b32 v208, 5
    s_nop 0
    v_cndmask_b32 v202, v202, v208, vcc
    v_lshrrev_b32 v208, 4, v201
    v_mul_u32_u24 v208, 5, v208
    v_lshrrev_b32 v209, 1, v202
    v_add_u32 v208, v208, v209
    v_mul_u32_u24 v208, 1088, v208
    v_and_b32 v209, 1, v202
    v_mul_u32_u24 v209, 544, v209
    v_add_u32 v208, v208, v209
    v_and_b32 v209, 15, v201
    v_lshl_add_u32 v208, v209, 4, v208
    v_add_u32 v209, 45056, v208
    v_mul_u32_u24 v210, 1280, v203
    v_lshl_add_u32 v210, v200, 4, v210
    v_lshrrev_b32 v212, 2, v0
    v_add_u32 v212, 512, v212
    v_mul_u32_u24 v213, s45, v212
    v_lshrrev_b32 v213, 16, v213
    v_mul_u32_u24 v214, 10, v213
    v_sub_u32 v214, v212, v214
    v_add_u32 v215, s47, v213
    v_lshlrev_b32 v216, 2, v215
    v_lshlrev_b32 v217, 1, v215
    buffer_load_dword v218, v216, s[12:15], s48 offen
    buffer_load_ushort v219, v217, s[16:19], 0 offen
    v_cmp_lt_u32 vcc, 4, v214
    v_add_u32 v212, 35, v214
    v_add_u32 v220, 1, v214
    v_cndmask_b32 v212, v214, v212, vcc
    v_cndmask_b32 v214, v214, v220, vcc
    v_cmp_eq_u32 vcc, 10, v214
    v_mov_b32 v220, 5
    s_nop 0
    v_cndmask_b32 v214, v214, v220, vcc
    v_lshrrev_b32 v220, 4, v213
    v_mul_u32_u24 v220, 5, v220
    v_lshrrev_b32 v221, 1, v214
    v_add_u32 v220, v220, v221
    v_mul_u32_u24 v220, 1088, v220
    v_and_b32 v221, 1, v214
    v_mul_u32_u24 v221, 544, v221
    v_add_u32 v220, v220, v221
    v_and_b32 v221, 15, v213
    v_lshl_add_u32 v220, v221, 4, v220
    v_add_u32 v221, 45056, v220
    v_mul_u32_u24 v222, 1280, v215
    v_lshl_add_u32 v222, v212, 4, v222
    v_and_b32 v216, 3, v0
    v_lshl_add_u32 v222, v216, 2, v222
    v_lshrrev_b32 v217, 1, v216
    v_mul_u32_u24 v217, 272, v217
    v_and_b32 v216, 1, v216
    v_lshl_add_u32 v217, v216, 3, v217
    v_add_u32 v220, v220, v217
    v_add_u32 v221, v221, v217
K3_EPI:
    s_mov_b32 s43, 0xffff0000
    s_mov_b32 s44, 0x3e4ccccd
    s_waitcnt lgkmcnt(0)
    s_barrier
    ds_read_b128 v[32:35], v208 offset:0
    ds_read_b128 v[36:39], v208 offset:272
    ds_read_b128 v[40:43], v208 offset:22528
    ds_read_b128 v[44:47], v208 offset:22800
    ds_read_b128 v[48:51], v209 offset:0
    ds_read_b128 v[52:55], v209 offset:272
    ds_read_b128 v[56:59], v209 offset:22528
    ds_read_b128 v[60:63], v209 offset:22800
    ds_read_b64 v[64:65], v220 offset:0
    ds_read_b64 v[66:67], v220 offset:22528
    ds_read_b64 v[68:69], v221 offset:0
    ds_read_b64 v[70:71], v221 offset:22528
    s_waitcnt vmcnt(0) lgkmcnt(4)
K3_MATH:
    v_add_f32 v32, v32, v40
    v_add_f32 v33, v33, v41
    v_add_f32 v34, v34, v42
    v_add_f32 v35, v35, v43
    v_add_f32 v36, v36, v44
    v_add_f32 v37, v37, v45
    v_add_f32 v38, v38, v46
    v_add_f32 v39, v39, v47
    v_add_f32 v32, v32, v48
    v_add_f32 v33, v33, v49
    v_add_f32 v34, v34, v50
    v_add_f32 v35, v35, v51
    v_add_f32 v36, v36, v52
    v_add_f32 v37, v37, v53
    v_add_f32 v38, v38, v54
    v_add_f32 v39, v39, v55
    v_lshlrev_b32 v207, 16, v207
    v_sub_f32 v211, 1.0, v206
    v_cvt_pk_bf16_f32 v211, v211, v211
    v_and_b32 v211, s43, v211
    v_mul_f32 v56, s44, v56
    v_mul_f32 v57, s44, v57
    v_mul_f32 v58, s44, v58
    v_mul_f32 v59, s44, v59
    v_mul_f32 v60, s44, v60
    v_mul_f32 v61, s44, v61
    v_mul_f32 v62, s44, v62
    v_mul_f32 v63, s44, v63
    v_cvt_pk_bf16_f32 v40, v32, v33
    v_cvt_pk_bf16_f32 v41, v34, v35
    v_cvt_pk_bf16_f32 v42, v36, v37
    v_cvt_pk_bf16_f32 v43, v38, v39
    v_lshlrev_b32 v32, 16, v40
    v_and_b32 v33, s43, v40
    v_lshlrev_b32 v34, 16, v41
    v_and_b32 v35, s43, v41
    v_lshlrev_b32 v36, 16, v42
    v_and_b32 v37, s43, v42
    v_lshlrev_b32 v38, 16, v43
    v_and_b32 v39, s43, v43
    v_cvt_pk_bf16_f32 v44, v56, v57
    v_cvt_pk_bf16_f32 v45, v58, v59
    v_cvt_pk_bf16_f32 v46, v60, v61
    v_cvt_pk_bf16_f32 v47, v62, v63
    v_lshlrev_b32 v56, 16, v44
    v_and_b32 v57, s43, v44
    v_lshlrev_b32 v58, 16, v45
    v_and_b32 v59, s43, v45
    v_lshlrev_b32 v60, 16, v46
    v_and_b32 v61, s43, v46
    v_lshlrev_b32 v62, 16, v47
    v_and_b32 v63, s43, v47
    v_add_f32 v32, v32, v207
    v_add_f32 v33, v33, v207
    v_add_f32 v34, v34, v207
    v_add_f32 v35, v35, v207
    v_add_f32 v36, v36, v207
    v_add_f32 v37, v37, v207
    v_add_f32 v38, v38, v207
    v_add_f32 v39, v39, v207
    v_mul_f32 v56, v56, v206
    v_mul_f32 v57, v57, v206
    v_mul_f32 v58, v58, v206
    v_mul_f32 v59, v59, v206
    v_mul_f32 v60, v60, v206
    v_mul_f32 v61, v61, v206
    v_mul_f32 v62, v62, v206
    v_mul_f32 v63, v63, v206
    v_cvt_pk_bf16_f32 v40, v32, v33
    v_cvt_pk_bf16_f32 v41, v34, v35
    v_cvt_pk_bf16_f32 v42, v36, v37
    v_cvt_pk_bf16_f32 v43, v38, v39
    v_lshlrev_b32 v32, 16, v40
    v_and_b32 v33, s43, v40
    v_lshlrev_b32 v34, 16, v41
    v_and_b32 v35, s43, v41
    v_lshlrev_b32 v36, 16, v42
    v_and_b32 v37, s43, v42
    v_lshlrev_b32 v38, 16, v43
    v_and_b32 v39, s43, v43
    v_cvt_pk_bf16_f32 v44, v56, v57
    v_cvt_pk_bf16_f32 v45, v58, v59
    v_cvt_pk_bf16_f32 v46, v60, v61
    v_cvt_pk_bf16_f32 v47, v62, v63
    v_lshlrev_b32 v56, 16, v44
    v_and_b32 v57, s43, v44
    v_lshlrev_b32 v58, 16, v45
    v_and_b32 v59, s43, v45
    v_lshlrev_b32 v60, 16, v46
    v_and_b32 v61, s43, v46
    v_lshlrev_b32 v62, 16, v47
    v_and_b32 v63, s43, v47
    v_mul_f32 v32, v32, v211
    v_mul_f32 v33, v33, v211
    v_mul_f32 v34, v34, v211
    v_mul_f32 v35, v35, v211
    v_mul_f32 v36, v36, v211
    v_mul_f32 v37, v37, v211
    v_mul_f32 v38, v38, v211
    v_mul_f32 v39, v39, v211
    v_cvt_pk_bf16_f32 v40, v32, v33
    v_cvt_pk_bf16_f32 v41, v34, v35
    v_cvt_pk_bf16_f32 v42, v36, v37
    v_cvt_pk_bf16_f32 v43, v38, v39
    v_lshlrev_b32 v32, 16, v40
    v_and_b32 v33, s43, v40
    v_lshlrev_b32 v34, 16, v41
    v_and_b32 v35, s43, v41
    v_lshlrev_b32 v36, 16, v42
    v_and_b32 v37, s43, v42
    v_lshlrev_b32 v38, 16, v43
    v_and_b32 v39, s43, v43
    v_add_f32 v32, v32, v56
    v_add_f32 v33, v33, v57
    v_add_f32 v34, v34, v58
    v_add_f32 v35, v35, v59
    v_add_f32 v36, v36, v60
    v_add_f32 v37, v37, v61
    v_add_f32 v38, v38, v62
    v_add_f32 v39, v39, v63
    v_cvt_pk_bf16_f32 v40, v32, v33
    v_cvt_pk_bf16_f32 v41, v34, v35
    v_cvt_pk_bf16_f32 v42, v36, v37
    v_cvt_pk_bf16_f32 v43, v38, v39
    buffer_store_dwordx4 v[40:43], v210, s[20:23], s46 offen
    s_waitcnt lgkmcnt(0)
    v_add_f32 v64, v64, v66
    v_add_f32 v65, v65, v67
    v_add_f32 v64, v64, v68
    v_add_f32 v65, v65, v69
    v_lshlrev_b32 v219, 16, v219
    v_sub_f32 v223, 1.0, v218
    v_cvt_pk_bf16_f32 v223, v223, v223
    v_and_b32 v223, s43, v223
    v_mul_f32 v70, s44, v70
    v_mul_f32 v71, s44, v71
    v_cvt_pk_bf16_f32 v72, v64, v65
    v_lshlrev_b32 v64, 16, v72
    v_and_b32 v65, s43, v72
    v_cvt_pk_bf16_f32 v72, v70, v71
    v_lshlrev_b32 v70, 16, v72
    v_and_b32 v71, s43, v72
    v_add_f32 v64, v64, v219
    v_add_f32 v65, v65, v219
    v_mul_f32 v70, v70, v218
    v_mul_f32 v71, v71, v218
    v_cvt_pk_bf16_f32 v72, v64, v65
    v_lshlrev_b32 v64, 16, v72
    v_and_b32 v65, s43, v72
    v_cvt_pk_bf16_f32 v72, v70, v71
    v_lshlrev_b32 v70, 16, v72
    v_and_b32 v71, s43, v72
    v_mul_f32 v64, v64, v223
    v_mul_f32 v65, v65, v223
    v_cvt_pk_bf16_f32 v72, v64, v65
    v_lshlrev_b32 v64, 16, v72
    v_and_b32 v65, s43, v72
    v_add_f32 v64, v64, v70
    v_add_f32 v65, v65, v71
    v_cvt_pk_bf16_f32 v72, v64, v65
    buffer_store_dword v72, v222, s[20:23], s46 offen
K3_END:
    s_endpgm
K3_OOB:
    s_endpgm
CODE_END:
.section .rodata,"a"
    .p2align 6
    .amdhsa_kernel k1_kernel
    .amdhsa_next_free_vgpr 128
    .amdhsa_next_free_sgpr 102
    .amdhsa_accum_offset 128
    .amdhsa_group_segment_fixed_size 0
    .amdhsa_kernarg_size 96
    .amdhsa_user_sgpr_count 2
    .amdhsa_user_sgpr_kernarg_segment_ptr 1
    .amdhsa_system_sgpr_workgroup_id_x 1
    .end_amdhsa_kernel
    .p2align 6
    .amdhsa_kernel k2_kernel
    .amdhsa_next_free_vgpr 256
    .amdhsa_next_free_sgpr 102
    .amdhsa_accum_offset 256
    .amdhsa_group_segment_fixed_size 0
    .amdhsa_kernarg_size 96
    .amdhsa_user_sgpr_count 2
    .amdhsa_user_sgpr_kernarg_segment_ptr 1
    .amdhsa_system_sgpr_workgroup_id_x 1
    .end_amdhsa_kernel
    .p2align 6
    .amdhsa_kernel k3_kernel
    .amdhsa_next_free_vgpr 256
    .amdhsa_next_free_sgpr 102
    .amdhsa_accum_offset 256
    .amdhsa_group_segment_fixed_size 0
    .amdhsa_kernarg_size 96
    .amdhsa_user_sgpr_count 2
    .amdhsa_user_sgpr_kernarg_segment_ptr 1
    .amdhsa_system_sgpr_workgroup_id_x 1
    .end_amdhsa_kernel
.p2align 8
.type table1,@object
table1:
.long 0x3f803f80,0x3f803f80,0x3f803f80,0x3f803f80,0x3f7b3f80,0x3f553f6d,0x3f0e3f35,0x3e483ec4,0x3f6d3f80,0x3ec43f35,0xbec40000,0xbf6dbf35,0x3f553f80,0xbe483ec4,0xbf7bbf35,0xbf0ebf6d
.long 0x3f353f80,0xbf350000,0xbf35bf80,0x3f350000,0x3f0e3f80,0xbf7bbec4,0x3e48bf35,0x3f553f6d,0x3ec43f80,0xbf6dbf35,0x3f6d0000,0xbec43f35,0x3e483f80,0xbf0ebf6d,0x3f553f35,0xbf7bbec4
.long 0x3f80,0xbf80,0x3f80,0xbf80,0xbe483f80,0x3f0ebf6d,0xbf553f35,0x3f7bbec4,0xbec43f80,0x3f6dbf35,0xbf6d0000,0x3ec43f35,0xbf0e3f80,0x3f7bbec4,0xbe48bf35,0xbf553f6d
.long 0xbf353f80,0x3f350000,0x3f35bf80,0xbf350000,0xbf553f80,0x3e483ec4,0x3f7bbf35,0x3f0ebf6d,0xbf6d3f80,0xbec43f35,0x3ec40000,0x3f6dbf35,0xbf7b3f80,0xbf553f6d,0xbf0e3f35,0xbe483ec4
.long 0xbf803f80,0xbf803f80,0xbf803f80,0xbf803f80,0xbf7b3f80,0xbf553f6d,0xbf0e3f35,0xbe483ec4,0xbf6d3f80,0xbec43f35,0x3ec40000,0x3f6dbf35,0xbf553f80,0x3e483ec4,0x3f7bbf35,0x3f0ebf6d
.long 0xbf353f80,0x3f350000,0x3f35bf80,0xbf350000,0xbf0e3f80,0x3f7bbec4,0xbe48bf35,0xbf553f6d,0xbec43f80,0x3f6dbf35,0xbf6d0000,0x3ec43f35,0xbe483f80,0x3f0ebf6d,0xbf553f35,0x3f7bbec4
.long 0x3f80,0xbf80,0x3f80,0xbf80,0x3e483f80,0xbf0ebf6d,0x3f553f35,0xbf7bbec4,0x3ec43f80,0xbf6dbf35,0x3f6d0000,0xbec43f35,0x3f0e3f80,0xbf7bbec4,0x3e48bf35,0x3f553f6d
.long 0x3f353f80,0xbf350000,0xbf35bf80,0x3f350000,0x3f553f80,0xbe483ec4,0xbf7bbf35,0xbf0ebf6d,0x3f6d3f80,0x3ec43f35,0xbec40000,0xbf6dbf35,0x3f7b3f80,0x3f553f6d,0x3f0e3f35,0x3e483ec4
.long 0x3f803f80,0x3f803f80,0x3f803f80,0x3f803f80,0xbe480000,0xbf0ebec4,0xbf55bf35,0xbf7bbf6d,0xbf6dbf80,0xbec4bf35,0x3ec40000,0x3f6d3f35,0x3f0e0000,0x3f7b3f6d,0x3e483f35,0xbf55bec4
.long 0x3f353f80,0xbf350000,0xbf35bf80,0x3f350000,0xbf550000,0xbe48bf6d,0x3f7b3f35,0xbf0e3ec4,0xbec4bf80,0x3f6d3f35,0xbf6d0000,0x3ec4bf35,0x3f7b0000,0xbf553ec4,0x3f0ebf35,0xbe483f6d
.long 0x3f80,0xbf80,0x3f80,0xbf80,0xbf7b0000,0x3f553ec4,0xbf0ebf35,0x3e483f6d,0x3ec4bf80,0xbf6d3f35,0x3f6d0000,0xbec4bf35,0x3f550000,0x3e48bf6d,0xbf7b3f35,0x3f0e3ec4
.long 0xbf353f80,0x3f350000,0x3f35bf80,0xbf350000,0xbf0e0000,0xbf7b3f6d,0xbe483f35,0x3f55bec4,0x3f6dbf80,0x3ec4bf35,0xbec40000,0xbf6d3f35,0x3e480000,0x3f0ebec4,0x3f55bf35,0x3f7bbf6d
.long 0xbf803f80,0xbf803f80,0xbf803f80,0xbf803f80,0x3e480000,0x3f0ebec4,0x3f55bf35,0x3f7bbf6d,0x3f6dbf80,0x3ec4bf35,0xbec40000,0xbf6d3f35,0xbf0e0000,0xbf7b3f6d,0xbe483f35,0x3f55bec4
.long 0xbf353f80,0x3f350000,0x3f35bf80,0xbf350000,0x3f550000,0x3e48bf6d,0xbf7b3f35,0x3f0e3ec4,0x3ec4bf80,0xbf6d3f35,0x3f6d0000,0xbec4bf35,0xbf7b0000,0x3f553ec4,0xbf0ebf35,0x3e483f6d
.long 0x3f80,0xbf80,0x3f80,0xbf80,0x3f7b0000,0xbf553ec4,0x3f0ebf35,0xbe483f6d,0xbec4bf80,0x3f6d3f35,0xbf6d0000,0x3ec4bf35,0xbf550000,0xbe48bf6d,0x3f7b3f35,0xbf0e3ec4
.long 0x3f353f80,0xbf350000,0xbf35bf80,0x3f350000,0x3f0e0000,0x3f7b3f6d,0x3e483f35,0xbf55bec4,0xbf6dbf80,0xbec4bf35,0x3ec40000,0x3f6d3f35,0xbe480000,0xbf0ebec4,0xbf55bf35,0xbf7bbf6d
.long 0x80008000,0x80008000,0x80008000,0x80008000,0xbe488000,0xbf0ebec4,0xbf55bf35,0xbf7bbf6d,0xbec48000,0xbf6dbf35,0xbf6dbf80,0xbec4bf35,0xbf0e8000,0xbf7bbf6d,0xbe48bf35,0x3f553ec4
.long 0xbf358000,0xbf35bf80,0x3f358000,0x3f353f80,0xbf558000,0xbe48bf6d,0x3f7b3f35,0xbf0e3ec4,0xbf6d8000,0x3ec4bf35,0x3ec43f80,0xbf6dbf35,0xbf7b8000,0x3f55bec4,0xbf0e3f35,0x3e48bf6d
.long 0xbf808000,0x3f808000,0xbf808000,0x3f808000,0xbf7b8000,0x3f553ec4,0xbf0ebf35,0x3e483f6d,0xbf6d8000,0x3ec43f35,0x3ec4bf80,0xbf6d3f35,0xbf558000,0xbe483f6d,0x3f7bbf35,0xbf0ebec4
.long 0xbf358000,0xbf353f80,0x3f358000,0x3f35bf80,0xbf0e8000,0xbf7b3f6d,0xbe483f35,0x3f55bec4,0xbec48000,0xbf6d3f35,0xbf6d3f80,0xbec43f35,0xbe488000,0xbf0e3ec4,0xbf553f35,0xbf7b3f6d
.long 0x80008000,0x80008000,0x80008000,0x80008000,0x3e488000,0x3f0ebec4,0x3f55bf35,0x3f7bbf6d,0x3ec48000,0x3f6dbf35,0x3f6dbf80,0x3ec4bf35,0x3f0e8000,0x3f7bbf6d,0x3e48bf35,0xbf553ec4
.long 0x3f358000,0x3f35bf80,0xbf358000,0xbf353f80,0x3f558000,0x3e48bf6d,0xbf7b3f35,0x3f0e3ec4,0x3f6d8000,0xbec4bf35,0xbec43f80,0x3f6dbf35,0x3f7b8000,0xbf55bec4,0x3f0e3f35,0xbe48bf6d
.long 0x3f808000,0xbf808000,0x3f808000,0xbf808000,0x3f7b8000,0xbf553ec4,0x3f0ebf35,0xbe483f6d,0x3f6d8000,0xbec43f35,0xbec4bf80,0x3f6d3f35,0x3f558000,0x3e483f6d,0xbf7bbf35,0x3f0ebec4
.long 0x3f358000,0x3f353f80,0xbf358000,0xbf35bf80,0x3f0e8000,0x3f7b3f6d,0x3e483f35,0xbf55bec4,0x3ec48000,0x3f6d3f35,0x3f6d3f80,0x3ec43f35,0x3e488000,0x3f0e3ec4,0x3f553f35,0x3f7b3f6d
.long 0x80008000,0x80008000,0x80008000,0x80008000,0xbf7bbf80,0xbf55bf6d,0xbf0ebf35,0xbe48bec4,0x3ec48000,0x3f6d3f35,0x3f6d3f80,0x3ec43f35,0x3f553f80,0xbe483ec4,0xbf7bbf35,0xbf0ebf6d
.long 0xbf358000,0xbf35bf80,0x3f358000,0x3f353f80,0xbf0ebf80,0x3f7b3ec4,0xbe483f35,0xbf55bf6d,0x3f6d8000,0xbec43f35,0xbec4bf80,0x3f6d3f35,0x3e483f80,0xbf0ebf6d,0x3f553f35,0xbf7bbec4
.long 0xbf808000,0x3f808000,0xbf808000,0x3f808000,0x3e48bf80,0xbf0e3f6d,0x3f55bf35,0xbf7b3ec4,0x3f6d8000,0xbec4bf35,0xbec43f80,0x3f6dbf35,0xbf0e3f80,0x3f7bbec4,0xbe48bf35,0xbf553f6d
.long 0xbf358000,0xbf353f80,0x3f358000,0x3f35bf80,0x3f55bf80,0xbe48bec4,0xbf7b3f35,0xbf0e3f6d,0x3ec48000,0x3f6dbf35,0x3f6dbf80,0x3ec4bf35,0xbf7b3f80,0xbf553f6d,0xbf0e3f35,0xbe483ec4
.long 0x80008000,0x80008000,0x80008000,0x80008000,0x3f7bbf80,0x3f55bf6d,0x3f0ebf35,0x3e48bec4,0xbec48000,0xbf6d3f35,0xbf6d3f80,0xbec43f35,0xbf553f80,0x3e483ec4,0x3f7bbf35,0x3f0ebf6d
.long 0x3f358000,0x3f35bf80,0xbf358000,0xbf353f80,0x3f0ebf80,0xbf7b3ec4,0x3e483f35,0x3f55bf6d,0xbf6d8000,0x3ec43f35,0x3ec4bf80,0xbf6d3f35,0xbe483f80,0x3f0ebf6d,0xbf553f35,0x3f7bbec4
.long 0x3f808000,0xbf808000,0x3f808000,0xbf808000,0xbe48bf80,0x3f0e3f6d,0xbf55bf35,0x3f7b3ec4,0xbf6d8000,0x3ec4bf35,0x3ec43f80,0xbf6dbf35,0x3f0e3f80,0xbf7bbec4,0x3e48bf35,0x3f553f6d
.long 0x3f358000,0x3f353f80,0xbf358000,0xbf35bf80,0xbf55bf80,0x3e48bec4,0x3f7b3f35,0x3f0e3f6d,0xbec48000,0xbf6dbf35,0xbf6dbf80,0xbec4bf35,0x3f7b3f80,0x3f553f6d,0x3f0e3f35,0x3e483ec4
.long 0x3f803f80,0x3f803f80,0x3f803f80,0x3f803f80,0xbf7bbf80,0xbf55bf6d,0xbf0ebf35,0xbe48bec4,0x3f6d3f80,0x3ec43f35,0xbec40000,0xbf6dbf35,0xbf55bf80,0x3e48bec4,0x3f7b3f35,0x3f0e3f6d
.long 0x3f353f80,0xbf350000,0xbf35bf80,0x3f350000,0xbf0ebf80,0x3f7b3ec4,0xbe483f35,0xbf55bf6d,0x3ec43f80,0xbf6dbf35,0x3f6d0000,0xbec43f35,0xbe48bf80,0x3f0e3f6d,0xbf55bf35,0x3f7b3ec4
.long 0x3f80,0xbf80,0x3f80,0xbf80,0x3e48bf80,0xbf0e3f6d,0x3f55bf35,0xbf7b3ec4,0xbec43f80,0x3f6dbf35,0xbf6d0000,0x3ec43f35,0x3f0ebf80,0xbf7b3ec4,0x3e483f35,0x3f55bf6d
.long 0xbf353f80,0x3f350000,0x3f35bf80,0xbf350000,0x3f55bf80,0xbe48bec4,0xbf7b3f35,0xbf0e3f6d,0xbf6d3f80,0xbec43f35,0x3ec40000,0x3f6dbf35,0x3f7bbf80,0x3f55bf6d,0x3f0ebf35,0x3e48bec4
.long 0xbf803f80,0xbf803f80,0xbf803f80,0xbf803f80,0x3f7bbf80,0x3f55bf6d,0x3f0ebf35,0x3e48bec4,0xbf6d3f80,0xbec43f35,0x3ec40000,0x3f6dbf35,0x3f55bf80,0xbe48bec4,0xbf7b3f35,0xbf0e3f6d
.long 0xbf353f80,0x3f350000,0x3f35bf80,0xbf350000,0x3f0ebf80,0xbf7b3ec4,0x3e483f35,0x3f55bf6d,0xbec43f80,0x3f6dbf35,0xbf6d0000,0x3ec43f35,0x3e48bf80,0xbf0e3f6d,0x3f55bf35,0xbf7b3ec4
.long 0x3f80,0xbf80,0x3f80,0xbf80,0xbe48bf80,0x3f0e3f6d,0xbf55bf35,0x3f7b3ec4,0x3ec43f80,0xbf6dbf35,0x3f6d0000,0xbec43f35,0xbf0ebf80,0x3f7b3ec4,0xbe483f35,0xbf55bf6d
.long 0x3f353f80,0xbf350000,0xbf35bf80,0x3f350000,0xbf55bf80,0x3e48bec4,0x3f7b3f35,0x3f0e3f6d,0x3f6d3f80,0x3ec43f35,0xbec40000,0xbf6dbf35,0xbf7bbf80,0xbf55bf6d,0xbf0ebf35,0xbe48bec4
.long 0x3f803f80,0x3f803f80,0x3f803f80,0x3f803f80,0x3e480000,0x3f0e3ec4,0x3f553f35,0x3f7b3f6d,0xbf6dbf80,0xbec4bf35,0x3ec40000,0x3f6d3f35,0xbf0e0000,0xbf7bbf6d,0xbe48bf35,0x3f553ec4
.long 0x3f353f80,0xbf350000,0xbf35bf80,0x3f350000,0x3f550000,0x3e483f6d,0xbf7bbf35,0x3f0ebec4,0xbec4bf80,0x3f6d3f35,0xbf6d0000,0x3ec4bf35,0xbf7b0000,0x3f55bec4,0xbf0e3f35,0x3e48bf6d
.long 0x3f80,0xbf80,0x3f80,0xbf80,0x3f7b0000,0xbf55bec4,0x3f0e3f35,0xbe48bf6d,0x3ec4bf80,0xbf6d3f35,0x3f6d0000,0xbec4bf35,0xbf550000,0xbe483f6d,0x3f7bbf35,0xbf0ebec4
.long 0xbf353f80,0x3f350000,0x3f35bf80,0xbf350000,0x3f0e0000,0x3f7bbf6d,0x3e48bf35,0xbf553ec4,0x3f6dbf80,0x3ec4bf35,0xbec40000,0xbf6d3f35,0xbe480000,0xbf0e3ec4,0xbf553f35,0xbf7b3f6d
.long 0xbf803f80,0xbf803f80,0xbf803f80,0xbf803f80,0xbe480000,0xbf0e3ec4,0xbf553f35,0xbf7b3f6d,0x3f6dbf80,0x3ec4bf35,0xbec40000,0xbf6d3f35,0x3f0e0000,0x3f7bbf6d,0x3e48bf35,0xbf553ec4
.long 0xbf353f80,0x3f350000,0x3f35bf80,0xbf350000,0xbf550000,0xbe483f6d,0x3f7bbf35,0xbf0ebec4,0x3ec4bf80,0xbf6d3f35,0x3f6d0000,0xbec4bf35,0x3f7b0000,0xbf55bec4,0x3f0e3f35,0xbe48bf6d
.long 0x3f80,0xbf80,0x3f80,0xbf80,0xbf7b0000,0x3f55bec4,0xbf0e3f35,0x3e48bf6d,0xbec4bf80,0x3f6d3f35,0xbf6d0000,0x3ec4bf35,0x3f550000,0x3e483f6d,0xbf7bbf35,0x3f0ebec4
.long 0x3f353f80,0xbf350000,0xbf35bf80,0x3f350000,0xbf0e0000,0xbf7bbf6d,0xbe48bf35,0x3f553ec4,0xbf6dbf80,0xbec4bf35,0x3ec40000,0x3f6d3f35,0x3e480000,0x3f0e3ec4,0x3f553f35,0x3f7b3f6d
.long 0x80008000,0x80008000,0x80008000,0x80008000,0x3e488000,0x3f0e3ec4,0x3f553f35,0x3f7b3f6d,0xbec48000,0xbf6dbf35,0xbf6dbf80,0xbec4bf35,0x3f0e8000,0x3f7b3f6d,0x3e483f35,0xbf55bec4
.long 0xbf358000,0xbf35bf80,0x3f358000,0x3f353f80,0x3f558000,0x3e483f6d,0xbf7bbf35,0x3f0ebec4,0xbf6d8000,0x3ec4bf35,0x3ec43f80,0xbf6dbf35,0x3f7b8000,0xbf553ec4,0x3f0ebf35,0xbe483f6d
.long 0xbf808000,0x3f808000,0xbf808000,0x3f808000,0x3f7b8000,0xbf55bec4,0x3f0e3f35,0xbe48bf6d,0xbf6d8000,0x3ec43f35,0x3ec4bf80,0xbf6d3f35,0x3f558000,0x3e48bf6d,0xbf7b3f35,0x3f0e3ec4
.long 0xbf358000,0xbf353f80,0x3f358000,0x3f35bf80,0x3f0e8000,0x3f7bbf6d,0x3e48bf35,0xbf553ec4,0xbec48000,0xbf6d3f35,0xbf6d3f80,0xbec43f35,0x3e488000,0x3f0ebec4,0x3f55bf35,0x3f7bbf6d
.long 0x80008000,0x80008000,0x80008000,0x80008000,0xbe488000,0xbf0e3ec4,0xbf553f35,0xbf7b3f6d,0x3ec48000,0x3f6dbf35,0x3f6dbf80,0x3ec4bf35,0xbf0e8000,0xbf7b3f6d,0xbe483f35,0x3f55bec4
.long 0x3f358000,0x3f35bf80,0xbf358000,0xbf353f80,0xbf558000,0xbe483f6d,0x3f7bbf35,0xbf0ebec4,0x3f6d8000,0xbec4bf35,0xbec43f80,0x3f6dbf35,0xbf7b8000,0x3f553ec4,0xbf0ebf35,0x3e483f6d
.long 0x3f808000,0xbf808000,0x3f808000,0xbf808000,0xbf7b8000,0x3f55bec4,0xbf0e3f35,0x3e48bf6d,0x3f6d8000,0xbec43f35,0xbec4bf80,0x3f6d3f35,0xbf558000,0xbe48bf6d,0x3f7b3f35,0xbf0e3ec4
.long 0x3f358000,0x3f353f80,0xbf358000,0xbf35bf80,0xbf0e8000,0xbf7bbf6d,0xbe48bf35,0x3f553ec4,0x3ec48000,0x3f6d3f35,0x3f6d3f80,0x3ec43f35,0xbe488000,0xbf0ebec4,0xbf55bf35,0xbf7bbf6d
.long 0x80008000,0x80008000,0x80008000,0x80008000,0x3f7b3f80,0x3f553f6d,0x3f0e3f35,0x3e483ec4,0x3ec48000,0x3f6d3f35,0x3f6d3f80,0x3ec43f35,0xbf55bf80,0x3e48bec4,0x3f7b3f35,0x3f0e3f6d
.long 0xbf358000,0xbf35bf80,0x3f358000,0x3f353f80,0x3f0e3f80,0xbf7bbec4,0x3e48bf35,0x3f553f6d,0x3f6d8000,0xbec43f35,0xbec4bf80,0x3f6d3f35,0xbe48bf80,0x3f0e3f6d,0xbf55bf35,0x3f7b3ec4
.long 0xbf808000,0x3f808000,0xbf808000,0x3f808000,0xbe483f80,0x3f0ebf6d,0xbf553f35,0x3f7bbec4,0x3f6d8000,0xbec4bf35,0xbec43f80,0x3f6dbf35,0x3f0ebf80,0xbf7b3ec4,0x3e483f35,0x3f55bf6d
.long 0xbf358000,0xbf353f80,0x3f358000,0x3f35bf80,0xbf553f80,0x3e483ec4,0x3f7bbf35,0x3f0ebf6d,0x3ec48000,0x3f6dbf35,0x3f6dbf80,0x3ec4bf35,0x3f7bbf80,0x3f55bf6d,0x3f0ebf35,0x3e48bec4
.long 0x80008000,0x80008000,0x80008000,0x80008000,0xbf7b3f80,0xbf553f6d,0xbf0e3f35,0xbe483ec4,0xbec48000,0xbf6d3f35,0xbf6d3f80,0xbec43f35,0x3f55bf80,0xbe48bec4,0xbf7b3f35,0xbf0e3f6d
.long 0x3f358000,0x3f35bf80,0xbf358000,0xbf353f80,0xbf0e3f80,0x3f7bbec4,0xbe48bf35,0xbf553f6d,0xbf6d8000,0x3ec43f35,0x3ec4bf80,0xbf6d3f35,0x3e48bf80,0xbf0e3f6d,0x3f55bf35,0xbf7b3ec4
.long 0x3f808000,0xbf808000,0x3f808000,0xbf808000,0x3e483f80,0xbf0ebf6d,0x3f553f35,0xbf7bbec4,0xbf6d8000,0x3ec4bf35,0x3ec43f80,0xbf6dbf35,0xbf0ebf80,0x3f7b3ec4,0xbe483f35,0xbf55bf6d
.long 0x3f358000,0x3f353f80,0xbf358000,0xbf35bf80,0x3f553f80,0xbe483ec4,0xbf7bbf35,0xbf0ebf6d,0xbec48000,0xbf6dbf35,0xbf6dbf80,0xbec4bf35,0xbf7bbf80,0xbf55bf6d,0xbf0ebf35,0xbe48bec4
.long 0x3f803f80,0x3f803f80,0x3f803f80,0x3f803f80,0x3f733f80,0x3f163f4f,0xbf73bf4f,0xbf73bf80,0x3f4f3f80,0xbe9e3e9e,0x3f4f3e9e,0x3f4f3f80,0x3f163f80,0xbf73be9e,0xbf163e9e,0xbf16bf80
.long 0x3e9e3f80,0xbf4fbf4f,0x3e9ebf4f,0x3e9e3f80,0x3f80,0xbf80,0x3f80,0xbf80,0xbe9e3f80,0x3f4fbf4f,0xbe9ebf4f,0xbe9e3f80,0xbf163f80,0x3f73be9e,0x3f163e9e,0x3f16bf80
.long 0xbf4f3f80,0x3e9e3e9e,0xbf4f3e9e,0xbf4f3f80,0xbf733f80,0xbf163f4f,0x3f73bf4f,0x3f73bf80,0xbf803f80,0xbf803f80,0xbf803f80,0xbf803f80,0x0,0x0,0x0,0x0
.long 0x0,0x0,0x0,0x0,0x0,0x0,0x0,0x0,0x0,0x0,0x0,0x0,0x0,0x0,0x0,0x0
.long 0x80008000,0x80008000,0x80008000,0x80008000,0xbe9e8000,0xbf4fbf16,0xbe9ebf16,0x3e9e8000,0xbf168000,0xbf73bf73,0x3f163f73,0xbf168000,0xbf4f8000,0xbe9ebf73,0xbf4fbf73,0x3f4f8000
.long 0xbf738000,0x3f16bf16,0x3f733f16,0xbf738000,0xbf808000,0x3f808000,0xbf808000,0x3f808000,0xbf738000,0x3f163f16,0x3f73bf16,0xbf738000,0xbf4f8000,0xbe9e3f73,0xbf4f3f73,0x3f4f8000
.long 0xbf168000,0xbf733f73,0x3f16bf73,0xbf168000,0xbe9e8000,0xbf4f3f16,0xbe9e3f16,0x3e9e8000,0x80008000,0x80008000,0x80008000,0x80008000,0x0,0x0,0x0,0x0
.long 0x0,0x0,0x0,0x0,0x0,0x0,0x0,0x0,0x0,0x0,0x0,0x0,0x0,0x0,0x0,0x0
.long 0x3f803f80,0x3f803f80,0x3f803f80,0x3f803f80,0x3e9e,0xbf16be9e,0xbf16bf4f,0xbe9e,0xbf80bf4f,0xbe9ebf4f,0xbe9e3e9e,0xbf80bf4f,0xbf4f,0x3f733f4f,0x3f733e9e,0x3f4f
.long 0x3f803e9e,0xbf4f3e9e,0xbf4fbf4f,0x3f803e9e,0x3f80,0xbf80,0x3f80,0xbf80,0xbf803e9e,0x3f4f3e9e,0x3f4fbf4f,0xbf803e9e,0xbf4f,0xbf733f4f,0xbf733e9e,0x3f4f
.long 0x3f80bf4f,0x3e9ebf4f,0x3e9e3e9e,0x3f80bf4f,0x3e9e,0x3f16be9e,0x3f16bf4f,0xbe9e,0xbf803f80,0xbf803f80,0xbf803f80,0xbf803f80,0x0,0x0,0x0,0x0
.long 0x0,0x0,0x0,0x0,0x0,0x0,0x0,0x0,0x0,0x0,0x0,0x0,0x0,0x0,0x0,0x0
.long 0x80008000,0x80008000,0x80008000,0x80008000,0xbf80bf73,0xbf4fbf73,0x3f4f3f16,0x3f803f73,0x8000bf16,0x3f733f16,0xbf73bf73,0x8000bf16,0x3f803f16,0xbe9e3f16,0x3e9e3f73,0xbf80bf16
.long 0x80003f73,0xbf16bf73,0x3f16bf16,0x80003f73,0xbf808000,0x3f808000,0xbf808000,0x3f808000,0x8000bf73,0xbf163f73,0x3f163f16,0x8000bf73,0x3f80bf16,0xbe9ebf16,0x3e9ebf73,0xbf803f16
.long 0x80003f16,0x3f73bf16,0xbf733f73,0x80003f16,0xbf803f73,0xbf4f3f73,0x3f4fbf16,0x3f80bf73,0x80008000,0x80008000,0x80008000,0x80008000,0x0,0x0,0x0,0x0
.long 0x0,0x0,0x0,0x0,0x0,0x0,0x0,0x0,0x0,0x0,0x0,0x0,0x0,0x0,0x0,0x0
.long 0x3f803f80,0x3f803f80,0x0,0x0,0x3f163e9e,0x3f733f4f,0x0,0x0,0xbe9ebf4f,0x3f4f3e9e,0x0,0x0,0xbf73bf4f,0x3f16be9e,0x0,0x0
.long 0xbf4f3e9e,0x3e9ebf4f,0x0,0x0,0x3f80,0xbf80,0x0,0x0,0x3f4f3e9e,0xbe9ebf4f,0x0,0x0,0x3f73bf4f,0xbf16be9e,0x0,0x0
.long 0x3e9ebf4f,0xbf4f3e9e,0x0,0x0,0xbf163e9e,0xbf733f4f,0x0,0x0,0xbf803f80,0xbf803f80,0x0,0x0,0x0,0x0,0x0,0x0
.long 0x0,0x0,0x0,0x0,0x0,0x0,0x0,0x0,0x0,0x0,0x0,0x0,0x0,0x0,0x0,0x0
.long 0x80008000,0x80008000,0x0,0x0,0x3f4f3f73,0x3e9e3f16,0x0,0x0,0x3f733f16,0x3f163f73,0x0,0x0,0x3e9ebf16,0x3f4f3f73,0x0,0x0
.long 0xbf16bf73,0x3f733f16,0x0,0x0,0xbf808000,0x3f808000,0x0,0x0,0xbf163f73,0x3f73bf16,0x0,0x0,0x3e9e3f16,0x3f4fbf73,0x0,0x0
.long 0x3f73bf16,0x3f16bf73,0x0,0x0,0x3f4fbf73,0x3e9ebf16,0x0,0x0,0x80008000,0x80008000,0x0,0x0,0x0,0x0,0x0,0x0
.long 0x0,0x0,0x0,0x0,0x0,0x0,0x0,0x0,0x0,0x0,0x0,0x0,0x0,0x0,0x0,0x0
.long 0x0,0x0,0x0,0x0,0x0,0x0,0x0,0x0,0x0,0x0,0x0,0x0,0x0,0x0,0x0,0x0
.long 0x0,0x0,0x0,0x0,0x0,0x0,0x0,0x0,0x0,0x0,0x0,0x0,0x0,0x0,0x0,0x0
.long 0x0,0x0,0x0,0x0,0x0,0x0,0x0,0x0,0x0,0x0,0x0,0x0,0x0,0x0,0x0,0x0
.long 0x0,0x0,0x0,0x0,0x0,0x0,0x0,0x0,0x0,0x0,0x0,0x0,0x0,0x0,0x0,0x0
.long 0x0,0x0,0x0,0x0,0x0,0x0,0x0,0x0,0x0,0x0,0x0,0x0,0x0,0x0,0x0,0x0
.long 0x0,0x0,0x0,0x0,0x0,0x0,0x0,0x0,0x0,0x0,0x0,0x0,0x0,0x0,0x0,0x0
.long 0x0,0x0,0x0,0x0,0x0,0x0,0x0,0x0,0x0,0x0,0x0,0x0,0x0,0x0,0x0,0x0
.long 0x0,0x0,0x0,0x0,0x0,0x0,0x0,0x0,0x0,0x0,0x0,0x0,0x0,0x0,0x0,0x0
.long 0x0,0x0,0x0,0x0,0x3e9e0000,0x3f4f3f16,0x3e9e3f16,0xbe9e0000,0x3f160000,0x3f733f73,0xbf16bf73,0x3f160000,0x3f4f0000,0x3e9e3f73,0x3f4f3f73,0xbf4f0000
.long 0x3f730000,0xbf163f16,0xbf73bf16,0x3f730000,0x3f800000,0xbf800000,0x3f800000,0xbf800000,0x3f730000,0xbf16bf16,0xbf733f16,0x3f730000,0x3f4f0000,0x3e9ebf73,0x3f4fbf73,0xbf4f0000
.long 0x3f160000,0x3f73bf73,0xbf163f73,0x3f160000,0x3e9e0000,0x3f4fbf16,0x3e9ebf16,0xbe9e0000,0x0,0x0,0x0,0x0,0x0,0x0,0x0,0x0
.long 0x0,0x0,0x0,0x0,0x0,0x0,0x0,0x0,0x0,0x0,0x0,0x0,0x0,0x0,0x0,0x0
.long 0x3f803f80,0x3f803f80,0x3f803f80,0x3f803f80,0x3f733f80,0x3f163f4f,0xbf73bf4f,0xbf73bf80,0x3f4f3f80,0xbe9e3e9e,0x3f4f3e9e,0x3f4f3f80,0x3f163f80,0xbf73be9e,0xbf163e9e,0xbf16bf80
.long 0x3e9e3f80,0xbf4fbf4f,0x3e9ebf4f,0x3e9e3f80,0x3f80,0xbf80,0x3f80,0xbf80,0xbe9e3f80,0x3f4fbf4f,0xbe9ebf4f,0xbe9e3f80,0xbf163f80,0x3f73be9e,0x3f163e9e,0x3f16bf80
.long 0xbf4f3f80,0x3e9e3e9e,0xbf4f3e9e,0xbf4f3f80,0xbf733f80,0xbf163f4f,0x3f73bf4f,0x3f73bf80,0xbf803f80,0xbf803f80,0xbf803f80,0xbf803f80,0x0,0x0,0x0,0x0
.long 0x0,0x0,0x0,0x0,0x0,0x0,0x0,0x0,0x0,0x0,0x0,0x0,0x0,0x0,0x0,0x0
.long 0x0,0x0,0x0,0x0,0x3f803f73,0x3f4f3f73,0xbf4fbf16,0xbf80bf73,0x3f16,0xbf73bf16,0x3f733f73,0x3f16,0xbf80bf16,0x3e9ebf16,0xbe9ebf73,0x3f803f16
.long 0xbf73,0x3f163f73,0xbf163f16,0xbf73,0x3f800000,0xbf800000,0x3f800000,0xbf800000,0x3f73,0x3f16bf73,0xbf16bf16,0x3f73,0xbf803f16,0x3e9e3f16,0xbe9e3f73,0x3f80bf16
.long 0xbf16,0xbf733f16,0x3f73bf73,0xbf16,0x3f80bf73,0x3f4fbf73,0xbf4f3f16,0xbf803f73,0x0,0x0,0x0,0x0,0x0,0x0,0x0,0x0
.long 0x0,0x0,0x0,0x0,0x0,0x0,0x0,0x0,0x0,0x0,0x0,0x0,0x0,0x0,0x0,0x0
.long 0x3f803f80,0x3f803f80,0x3f803f80,0x3f803f80,0x3e9e,0xbf16be9e,0xbf16bf4f,0xbe9e,0xbf80bf4f,0xbe9ebf4f,0xbe9e3e9e,0xbf80bf4f,0xbf4f,0x3f733f4f,0x3f733e9e,0x3f4f
.long 0x3f803e9e,0xbf4f3e9e,0xbf4fbf4f,0x3f803e9e,0x3f80,0xbf80,0x3f80,0xbf80,0xbf803e9e,0x3f4f3e9e,0x3f4fbf4f,0xbf803e9e,0xbf4f,0xbf733f4f,0xbf733e9e,0x3f4f
.long 0x3f80bf4f,0x3e9ebf4f,0x3e9e3e9e,0x3f80bf4f,0x3e9e,0x3f16be9e,0x3f16bf4f,0xbe9e,0xbf803f80,0xbf803f80,0xbf803f80,0xbf803f80,0x0,0x0,0x0,0x0
.long 0x0,0x0,0x0,0x0,0x0,0x0,0x0,0x0,0x0,0x0,0x0,0x0,0x0,0x0,0x0,0x0
.long 0x0,0x0,0x0,0x0,0xbf4fbf73,0xbe9ebf16,0x0,0x0,0xbf73bf16,0xbf16bf73,0x0,0x0,0xbe9e3f16,0xbf4fbf73,0x0,0x0
.long 0x3f163f73,0xbf73bf16,0x0,0x0,0x3f800000,0xbf800000,0x0,0x0,0x3f16bf73,0xbf733f16,0x0,0x0,0xbe9ebf16,0xbf4f3f73,0x0,0x0
.long 0xbf733f16,0xbf163f73,0x0,0x0,0xbf4f3f73,0xbe9e3f16,0x0,0x0,0x0,0x0,0x0,0x0,0x0,0x0,0x0,0x0
.long 0x0,0x0,0x0,0x0,0x0,0x0,0x0,0x0,0x0,0x0,0x0,0x0,0x0,0x0,0x0,0x0
.long 0x3f803f80,0x3f803f80,0x0,0x0,0x3f163e9e,0x3f733f4f,0x0,0x0,0xbe9ebf4f,0x3f4f3e9e,0x0,0x0,0xbf73bf4f,0x3f16be9e,0x0,0x0
.long 0xbf4f3e9e,0x3e9ebf4f,0x0,0x0,0x3f80,0xbf80,0x0,0x0,0x3f4f3e9e,0xbe9ebf4f,0x0,0x0,0x3f73bf4f,0xbf16be9e,0x0,0x0
.long 0x3e9ebf4f,0xbf4f3e9e,0x0,0x0,0xbf163e9e,0xbf733f4f,0x0,0x0,0xbf803f80,0xbf803f80,0x0,0x0,0x0,0x0,0x0,0x0
.long 0x0,0x0,0x0,0x0,0x0,0x0,0x0,0x0,0x0,0x0,0x0,0x0,0x0,0x0,0x0,0x0
.long 0x0,0x0,0x0,0x0,0x0,0x0,0x0,0x0,0x0,0x0,0x0,0x0,0x0,0x0,0x0,0x0
.long 0x0,0x0,0x0,0x0,0x0,0x0,0x0,0x0,0x0,0x0,0x0,0x0,0x0,0x0,0x0,0x0
.long 0x0,0x0,0x0,0x0,0x0,0x0,0x0,0x0,0x0,0x0,0x0,0x0,0x0,0x0,0x0,0x0
.long 0x0,0x0,0x0,0x0,0x0,0x0,0x0,0x0,0x0,0x0,0x0,0x0,0x0,0x0,0x0,0x0
.long 0x0,0x0,0x0,0x0,0x0,0x0,0x0,0x0,0x0,0x0,0x0,0x0,0x0,0x0,0x0,0x0
.long 0x0,0x0,0x0,0x0,0x0,0x0,0x0,0x0,0x0,0x0,0x0,0x0,0x0,0x0,0x0,0x0
.long 0x0,0x0,0x0,0x0,0x0,0x0,0x0,0x0,0x0,0x0,0x0,0x0,0x0,0x0,0x0,0x0
.long 0x0,0x0,0x0,0x0,0x0,0x0,0x0,0x0,0x0,0x0,0x0,0x0,0x0,0x0,0x0,0x0
.long 0x80003c00,0x80003c00,0x80003c00,0x80003c00,0x80003c00,0xa1073c00,0xa5073c00,0xa78a3bff,0x80003c00,0xa5073c00,0xa9063bfe,0xab893bfc,0x80003c00,0xa78a3bff,0xab893bfc,0xada63bf8
.long 0x80003c00,0xa9063bfe,0xad053bfa,0xaf863bf2,0x80003c00,0xaa483bfe,0xae463bf6,0xb0b23bea,0x80003c00,0xab893bfc,0xaf863bf2,0xb1a03be0,0x80003c00,0xac653bfb,0xb0623bed,0xb28d3bd5
.long 0x80003c00,0xad053bfa,0xb1023be7,0xb3783bc7,0x80003c00,0xada63bf8,0xb1a03be0,0xb4313bb8,0x80003c00,0xae463bf6,0xb23e3bd9,0xb4a53ba8,0x80003c00,0xaee63bf4,0xb2dc3bd0,0xb5183b95
.long 0x80003c00,0xaf863bf2,0xb3783bc7,0xb58a3b81,0x80003c00,0xb0133bef,0xb40a3bbe,0xb5fa3b6c,0x80003c00,0xb0623bed,0xb4583bb3,0xb6693b54,0x80003c00,0xb0b23bea,0xb4a53ba8,0xb6d73b3b
.long 0x80003c00,0xb1023be7,0xb4f23b9c,0xb7443b21,0x80003c00,0xb1513be4,0xb53e3b8f,0xb7ae3b05,0x80003c00,0xb1a03be0,0xb58a3b81,0xb80c3ae7,0x80003c00,0xb1ef3bdc,0xb5d53b73,0xb83f3ac8
.long 0x80003c00,0xb23e3bd9,0xb61f3b64,0xb8723aa7,0x80003c00,0xb28d3bd5,0xb6693b54,0xb8a33a85,0x80003c00,0xb2dc3bd0,0xb6b33b44,0xb8d43a61,0x80003c00,0xb32a3bcc,0xb6fc3b33,0xb9043a3c
.long 0x80003c00,0xb3783bc7,0xb7443b21,0xb9323a15,0x80003c00,0xb3c63bc3,0xb78b3b0e,0xb95f39ed,0x80003c00,0xb40a3bbe,0xb7d13afb,0xb98b39c4,0x80003c00,0xb4313bb8,0xb80c3ae7,0xb9b6399a
.long 0x80003c00,0xb4583bb3,0xb82e3ad2,0xb9e0396e,0x80003c00,0xb47e3bae,0xb8503abd,0xba083941,0x80003c00,0xb4a53ba8,0xb8723aa7,0xba2f3913,0x80003c00,0xb4cb3ba2,0xb8933a90,0xba5538e4
.long 0x80003c00,0x80003c00,0x80003c00,0x80003c00,0xa9063bfe,0xaa483bfe,0xab893bfc,0xac653bfb,0xad053bfa,0xae463bf6,0xaf863bf2,0xb0623bed,0xaf863bf2,0xb0b23bea,0xb1a03be0,0xb28d3bd5
.long 0xb1023be7,0xb23e3bd9,0xb3783bc7,0xb4583bb3,0xb23e3bd9,0xb3c63bc3,0xb4a53ba8,0xb5643b88,0xb3783bc7,0xb4a53ba8,0xb58a3b81,0xb6693b54,0xb4583bb3,0xb5643b88,0xb6693b54,0xb7673b18
.long 0xb4f23b9c,0xb61f3b64,0xb7443b21,0xb82e3ad2,0xb58a3b81,0xb6d73b3b,0xb80c3ae7,0xb8a33a85,0xb61f3b64,0xb78b3b0e,0xb8723aa7,0xb9133a2f,0xb6b33b44,0xb81d3add,0xb8d43a61,0xb97d39d2
.long 0xb7443b21,0xb8723aa7,0xb9323a15,0xb9e0396e,0xb7d13afb,0xb8c43a6d,0xb98b39c4,0xba3c3904,0xb82e3ad2,0xb9133a2f,0xb9e0396e,0xba903893,0xb8723aa7,0xb95f39ed,0xba2f3913,0xbadd381d
.long 0xb8b43a79,0xb9a839a8,0xba7938b4,0xbb213744,0xb8f43a48,0xb9ed395f,0xbabd3850,0xbb5c3645,0xb9323a15,0xba2f3913,0xbafb37d1,0xbb8f353e,0xb96e39e0,0xba6d38c4,0xbb3336fc,0xbbb83431
.long 0xb9a839a8,0xbaa73872,0xbb64361f,0xbbd9323e,0xb9e0396e,0xbadd381d,0xbb8f353e,0xbbef3013,0xba153932,0xbb0e378b,0xbbb33458,0xbbfc2b89,0xba4838f4,0xbb3b36d7,0xbbd032dc,0xbc00a107
.long 0xba7938b4,0xbb64361f,0xbbe73102,0xbbfaad05,0xbaa73872,0xbb883564,0xbbf62e46,0xbbeab0b2,0xbad2382e,0xbba834a5,0xbbfe2906,0xbbd0b2dc,0xbafb37d1,0xbbc333c6,0xbc00a507,0xbbaeb47e
.long 0xbb213744,0xbbd9323e,0xbbfaad05,0xbb81b58a,0xbb4436b3,0xbbea30b2,0xbbedb062,0xbb4cb68e,0xbb64361f,0xbbf62e46,0xbbd9b23e,0xbb0eb78b,0xbb81358a,0xbbfe2a48,0xbbbeb40a,0xbac8b83f
.long 0x80003c00,0x80003c00,0x80003c00,0x80003c00,0xad053bfa,0xada63bf8,0xae463bf6,0xaee63bf4,0xb1023be7,0xb1a03be0,0xb23e3bd9,0xb2dc3bd0,0xb3783bc7,0xb4313bb8,0xb4a53ba8,0xb5183b95
.long 0xb4f23b9c,0xb58a3b81,0xb61f3b64,0xb6b33b44,0xb61f3b64,0xb6d73b3b,0xb78b3b0e,0xb81d3add,0xb7443b21,0xb80c3ae7,0xb8723aa7,0xb8d43a61,0xb82e3ad2,0xb8a33a85,0xb9133a2f,0xb97d39d2
.long 0xb8b43a79,0xb9323a15,0xb9a839a8,0xba153932,0xb9323a15,0xb9b6399a,0xba2f3913,0xba9c3882,0xb9a839a8,0xba2f3913,0xbaa73872,0xbb0e378b,0xba153932,0xba9c3882,0xbb0e378b,0xbb6c35fa
.long 0xba7938b4,0xbafb37d1,0xbb64361f,0xbbb33458,0xbad2382e,0xbb4c368e,0xbba834a5,0xbbe43151,0xbb213744,0xbb8f353e,0xbbd9323e,0xbbfc2b89,0xbb64361f,0xbbc333c6,0xbbf62e46,0xbbfeaa48
.long 0xbb9c34f2,0xbbe73102,0xbc000000,0xbbe7b102,0xbbc73378,0xbbfb2c65,0xbbf6ae46,0xbbb8b431,0xbbe73102,0xbc00a507,0xbbd9b23e,0xbb73b5d5,0xbbfa2d05,0xbbf4aee6,0xbba8b4a5,0xbb18b767
.long 0xbc000000,0xbbd9b23e,0xbb64b61f,0xbaa7b872,0xbbfaad05,0xbbaeb47e,0xbb0eb78b,0xba22b923,0xbbe7b102,0xbb73b5d5,0xbaa7b872,0xb98bb9c4,0xbbc7b378,0xbb2ab720,0xba2fb913,0xb8e4ba55
.long 0xbb9cb4f2,0xbad2b82e,0xb9a8b9a8,0xb82ebad2,0xbb64b61f,0xba6db8c4,0xb913ba2f,0xb6d7bb3b,0xbb21b744,0xb9fbb950,0xb872baa7,0xb53ebb8f,0xbad2b82e,0xb97db9d2,0xb78bbb0e,0xb32abbcc
.long 0xba79b8b4,0xb8f4ba48,0xb61fbb64,0xaf86bbf2,0xba15b932,0xb861bab2,0xb4a5bba8,0xa107bc00,0xb9a8b9a8,0xb78bbb0e,0xb23ebbd9,0x2e46bbf6,0xb932ba15,0xb645bb5c,0xae46bbf6,0x328dbbd5
.long 0x80003c00,0x80003c00,0x80003c00,0x80003c00,0xaf863bf2,0xb0133bef,0xb0623bed,0xb0b23bea,0xb3783bc7,0xb40a3bbe,0xb4583bb3,0xb4a53ba8,0xb58a3b81,0xb5fa3b6c,0xb6693b54,0xb6d73b3b
.long 0xb7443b21,0xb7d13afb,0xb82e3ad2,0xb8723aa7,0xb8723aa7,0xb8c43a6d,0xb9133a2f,0xb95f39ed,0xb9323a15,0xb98b39c4,0xb9e0396e,0xba2f3913,0xb9e0396e,0xba3c3904,0xba903893,0xbadd381d
.long 0xba7938b4,0xbad2382e,0xbb213744,0xbb64361f,0xbafb37d1,0xbb4c368e,0xbb8f353e,0xbbc333c6,0xbb64361f,0xbba834a5,0xbbd9323e,0xbbf62e46,0xbbb33458,0xbbe43151,0xbbfc2b89,0xbbfeaa48
.long 0xbbe73102,0xbbfe2906,0xbbfaad05,0xbbd9b23e,0xbbfe2906,0xbbf8ada6,0xbbd0b2dc,0xbb88b564,0xbbfaad05,0xbbd0b2dc,0xbb81b58a,0xbb0eb78b,0xbbd9b23e,0xbb88b564,0xbb0eb78b,0xba6db8c4
.long 0xbb9cb4f2,0xbb21b744,0xba79b8b4,0xb9a8b9a8,0xbb44b6b3,0xba9cb882,0xb9c4b98b,0xb8c4ba6d,0xbad2b82e,0xb9fbb950,0xb8f4ba48,0xb78bbb0e,0xba48b8f4,0xb941ba08,0xb80cbae7,0xb564bb88
.long 0xb9a8b9a8,0xb872baa7,0xb61fbb64,0xb23ebbd9,0xb8f4ba48,0xb720bb2a,0xb40abbbe,0xaa48bbfe,0xb82ebad2,0xb53ebb8f,0xaf86bbf2,0x2e46bbf6,0xb6b3bb44,0xb28dbbd5,0x2507bc00,0x33c6bbc3
.long 0xb4f2bb9c,0xad05bbfa,0x3102bbe7,0x361fbb64,0xb23ebbd9,0x2a48bbfe,0x34a5bba8,0x381dbadd,0xad05bbfa,0x31a0bbe0,0x36b3bb44,0x3913ba2f,0x2906bbfe,0x34cbbba2,0x3850babd,0x39edb95f
.long 0x3102bbe7,0x36b3bb44,0x3932ba15,0x3aa7b872,0x3458bbb3,0x383fbac8,0x39fbb950,0x3b3bb6d7,0x361fbb64,0x3913ba2f,0x3aa7b872,0x3ba8b4a5,0x37d1bafb,0x39d2b97d,0x3b33b6fc,0x3beab0b2
.long 0x80003c00,0x80003c00,0x80003c00,0x80003c00,0xb1023be7,0xb1513be4,0xb1a03be0,0xb1ef3bdc,0xb4f23b9c,0xb53e3b8f,0xb58a3b81,0xb5d53b73,0xb7443b21,0xb7ae3b05,0xb80c3ae7,0xb83f3ac8
.long 0xb8b43a79,0xb8f43a48,0xb9323a15,0xb96e39e0,0xb9a839a8,0xb9ed395f,0xba2f3913,0xba6d38c4,0xba7938b4,0xbabd3850,0xbafb37d1,0xbb3336fc,0xbb213744,0xbb5c3645,0xbb8f353e,0xbbb83431
.long 0xbb9c34f2,0xbbc73378,0xbbe73102,0xbbfa2d05,0xbbe73102,0xbbfb2c65,0xbc00a507,0xbbf4aee6,0xbc000000,0xbbf6ae46,0xbbd9b23e,0xbba8b4a5,0xbbe7b102,0xbbb8b431,0xbb73b5d5,0xbb18b767
.long 0xbb9cb4f2,0xbb44b6b3,0xbad2b82e,0xba48b8f4,0xbb21b744,0xba9cb882,0xb9fbb950,0xb941ba08,0xba79b8b4,0xb9c4b98b,0xb8f4ba48,0xb80cbae7,0xb9a8b9a8,0xb8c4ba6d,0xb78bbb0e,0xb564bb88
.long 0xb8b4ba79,0xb744bb21,0xb4f2bb9c,0xb102bbe7,0xb744bb21,0xb4cbbba2,0xb062bbed,0x278abbff,0xb4f2bb9c,0xb062bbed,0x2906bbfe,0x32dcbbd0,0xb102bbe7,0x278abbff,0x32dcbbd0,0x3645bb5c
.long 0x8000bc00,0x323ebbd9,0x361fbb64,0x3872baa7,0x3102bbe7,0x35afbb7a,0x3850babd,0x399ab9b6,0x34f2bb9c,0x380cbae7,0x396eb9e0,0x3a90b893,0x3744bb21,0x3923ba22,0x3a61b8d4,0x3b4cb68e
.long 0x38b4ba79,0x3a15b932,0x3b21b744,0x3bc7b378,0x39a8b9a8,0x3addb81d,0x3ba8b4a5,0x3bfeaa48,0x3a79b8b4,0x3b73b5d5,0x3bf2af86,0x3bed3062,0x3b21b744,0x3bd5b28d,0x3bfc2b89,0x3b953518
.long 0x3b9cb4f2,0x3bfea906,0x3bc73378,0x3afb37d1,0x3be7b102,0x3bef3013,0x3b543669,0x3a223923,0x3c000000,0x3ba834a5,0x3aa73872,0x39133a2f,0x3be73102,0x3b2a3720,0x39c4398b,0x37ae3b05
.long 0x80003c00,0x80003c00,0x80003c00,0x80003c00,0xb23e3bd9,0xb28d3bd5,0xb2dc3bd0,0xb32a3bcc,0xb61f3b64,0xb6693b54,0xb6b33b44,0xb6fc3b33,0xb8723aa7,0xb8a33a85,0xb8d43a61,0xb9043a3c
.long 0xb9a839a8,0xb9e0396e,0xba153932,0xba4838f4,0xbaa73872,0xbadd381d,0xbb0e378b,0xbb3b36d7,0xbb64361f,0xbb8f353e,0xbbb33458,0xbbd032dc,0xbbd9323e,0xbbef3013,0xbbfc2b89,0xbc00a107
.long 0xbc000000,0xbbfaad05,0xbbe7b102,0xbbc7b378,0xbbd9b23e,0xbbaeb47e,0xbb73b5d5,0xbb2ab720,0xbb64b61f,0xbb0eb78b,0xbaa7b872,0xba2fb913,0xbaa7b872,0xba22b923,0xb98bb9c4,0xb8e4ba55
.long 0xb9a8b9a8,0xb8f4ba48,0xb82ebad2,0xb6b3bb44,0xb872baa7,0xb720bb2a,0xb53ebb8f,0xb28dbbd5,0xb61fbb64,0xb40abbbe,0xaf86bbf2,0x2507bc00,0xb23ebbd9,0xaa48bbfe,0x2e46bbf6,0x33c6bbc3
.long 0x8000bc00,0x3102bbe7,0x34f2bb9c,0x3744bb21,0x323ebbd9,0x35afbb7a,0x380cbae7,0x3923ba22,0x361fbb64,0x3850babd,0x396eb9e0,0x3a61b8d4,0x3872baa7,0x399ab9b6,0x3a90b893,0x3b4cb68e
.long 0x39a8b9a8,0x3aa7b872,0x3b64b61f,0x3bd9b23e,0x3aa7b872,0x3b6cb5fa,0x3be0b1a0,0x3bff278a,0x3b64b61f,0x3be0b1a0,0x3bfe2906,0x3bbe340a,0x3bd9b23e,0x3bff278a,0x3bbe340a,0x3b183767
.long 0x3c000000,0x3bc73378,0x3b213744,0x3a153932,0x3bd9323e,0x3b3b36d7,0x3a2f3913,0x38c43a6d,0x3b64361f,0x3a6138d4,0x38f43a48,0x36693b54,0x3aa73872,0x39413a08,0x36fc3b33,0x31ef3bdc
.long 0x39a839a8,0x37d13afb,0x33783bc7,0xa9063bfe,0x38723aa7,0x34cb3ba2,0x25073c00,0xb4313bb8,0x361f3b64,0x2e463bf6,0xb23e3bd9,0xb78b3b0e,0x323e3bd9,0xaee63bf4,0xb6693b54,0xb9413a08
.size table1, 11264
.p2align 8
.type table2,@object
table2:
.long 0x3f803f80,0x3f803f80,0x3f803f80,0x3f803f80,0x3f7b3f80,0x3f553f6d,0xbe480000,0xbf0ebec4,0x3f6d3f80,0x3ec43f35,0xbf6dbf80,0xbec4bf35,0x3f553f80,0xbe483ec4,0x3f0e0000,0x3f7b3f6d
.long 0x3f353f80,0xbf350000,0x3f353f80,0xbf350000,0x3f0e3f80,0xbf7bbec4,0xbf550000,0xbe48bf6d,0x3ec43f80,0xbf6dbf35,0xbec4bf80,0x3f6d3f35,0x3e483f80,0xbf0ebf6d,0x3f7b0000,0xbf553ec4
.long 0x3f80,0xbf80,0x3f80,0xbf80,0xbe483f80,0x3f0ebf6d,0xbf7b0000,0x3f553ec4,0xbec43f80,0x3f6dbf35,0x3ec4bf80,0xbf6d3f35,0xbf0e3f80,0x3f7bbec4,0x3f550000,0x3e48bf6d
.long 0xbf353f80,0x3f350000,0xbf353f80,0x3f350000,0xbf553f80,0x3e483ec4,0xbf0e0000,0xbf7b3f6d,0xbf6d3f80,0xbec43f35,0x3f6dbf80,0x3ec4bf35,0xbf7b3f80,0xbf553f6d,0x3e480000,0x3f0ebec4
.long 0xbf803f80,0xbf803f80,0xbf803f80,0xbf803f80,0xbf7b3f80,0xbf553f6d,0x3e480000,0x3f0ebec4,0xbf6d3f80,0xbec43f35,0x3f6dbf80,0x3ec4bf35,0xbf553f80,0x3e483ec4,0xbf0e0000,0xbf7b3f6d
.long 0xbf353f80,0x3f350000,0xbf353f80,0x3f350000,0xbf0e3f80,0x3f7bbec4,0x3f550000,0x3e48bf6d,0xbec43f80,0x3f6dbf35,0x3ec4bf80,0xbf6d3f35,0xbe483f80,0x3f0ebf6d,0xbf7b0000,0x3f553ec4
.long 0x3f80,0xbf80,0x3f80,0xbf80,0x3e483f80,0xbf0ebf6d,0x3f7b0000,0xbf553ec4,0x3ec43f80,0xbf6dbf35,0xbec4bf80,0x3f6d3f35,0x3f0e3f80,0xbf7bbec4,0xbf550000,0xbe48bf6d
.long 0x3f353f80,0xbf350000,0x3f353f80,0xbf350000,0x3f553f80,0xbe483ec4,0x3f0e0000,0x3f7b3f6d,0x3f6d3f80,0x3ec43f35,0xbf6dbf80,0xbec4bf35,0x3f7b3f80,0x3f553f6d,0xbe480000,0xbf0ebec4
.long 0x3f803f80,0x3f803f80,0x3f803f80,0x3f803f80,0x3f0e3f35,0x3e483ec4,0xbf55bf35,0xbf7bbf6d,0xbec40000,0xbf6dbf35,0x3ec40000,0x3f6d3f35,0xbf7bbf35,0xbf0ebf6d,0x3e483f35,0xbf55bec4
.long 0xbf35bf80,0x3f350000,0xbf35bf80,0x3f350000,0x3e48bf35,0x3f553f6d,0x3f7b3f35,0xbf0e3ec4,0x3f6d0000,0xbec43f35,0xbf6d0000,0x3ec4bf35,0x3f553f35,0xbf7bbec4,0x3f0ebf35,0xbe483f6d
.long 0x3f80,0xbf80,0x3f80,0xbf80,0xbf553f35,0x3f7bbec4,0xbf0ebf35,0x3e483f6d,0xbf6d0000,0x3ec43f35,0x3f6d0000,0xbec4bf35,0xbe48bf35,0xbf553f6d,0xbf7b3f35,0x3f0e3ec4
.long 0x3f35bf80,0xbf350000,0x3f35bf80,0xbf350000,0x3f7bbf35,0x3f0ebf6d,0xbe483f35,0x3f55bec4,0x3ec40000,0x3f6dbf35,0xbec40000,0xbf6d3f35,0xbf0e3f35,0xbe483ec4,0x3f55bf35,0x3f7bbf6d
.long 0xbf803f80,0xbf803f80,0xbf803f80,0xbf803f80,0xbf0e3f35,0xbe483ec4,0x3f55bf35,0x3f7bbf6d,0x3ec40000,0x3f6dbf35,0xbec40000,0xbf6d3f35,0x3f7bbf35,0x3f0ebf6d,0xbe483f35,0x3f55bec4
.long 0x3f35bf80,0xbf350000,0x3f35bf80,0xbf350000,0xbe48bf35,0xbf553f6d,0xbf7b3f35,0x3f0e3ec4,0xbf6d0000,0x3ec43f35,0x3f6d0000,0xbec4bf35,0xbf553f35,0x3f7bbec4,0xbf0ebf35,0x3e483f6d
.long 0x3f80,0xbf80,0x3f80,0xbf80,0x3f553f35,0xbf7bbec4,0x3f0ebf35,0xbe483f6d,0x3f6d0000,0xbec43f35,0xbf6d0000,0x3ec4bf35,0x3e48bf35,0x3f553f6d,0x3f7b3f35,0xbf0e3ec4
.long 0xbf35bf80,0x3f350000,0xbf35bf80,0x3f350000,0xbf7bbf35,0xbf0ebf6d,0x3e483f35,0xbf55bec4,0xbec40000,0xbf6dbf35,0x3ec40000,0x3f6d3f35,0x3f0e3f35,0x3e483ec4,0xbf55bf35,0xbf7bbf6d
.long 0x3f803f80,0x3f803f80,0x3f803f80,0x3f803f80,0xbf7bbf80,0xbf55bf6d,0x3e480000,0x3f0e3ec4,0x3f6d3f80,0x3ec43f35,0xbf6dbf80,0xbec4bf35,0xbf55bf80,0x3e48bec4,0xbf0e0000,0xbf7bbf6d
.long 0x3f353f80,0xbf350000,0x3f353f80,0xbf350000,0xbf0ebf80,0x3f7b3ec4,0x3f550000,0x3e483f6d,0x3ec43f80,0xbf6dbf35,0xbec4bf80,0x3f6d3f35,0xbe48bf80,0x3f0e3f6d,0xbf7b0000,0x3f55bec4
.long 0x3f80,0xbf80,0x3f80,0xbf80,0x3e48bf80,0xbf0e3f6d,0x3f7b0000,0xbf55bec4,0xbec43f80,0x3f6dbf35,0x3ec4bf80,0xbf6d3f35,0x3f0ebf80,0xbf7b3ec4,0xbf550000,0xbe483f6d
.long 0xbf353f80,0x3f350000,0xbf353f80,0x3f350000,0x3f55bf80,0xbe48bec4,0x3f0e0000,0x3f7bbf6d,0xbf6d3f80,0xbec43f35,0x3f6dbf80,0x3ec4bf35,0x3f7bbf80,0x3f55bf6d,0xbe480000,0xbf0e3ec4
.long 0xbf803f80,0xbf803f80,0xbf803f80,0xbf803f80,0x3f7bbf80,0x3f55bf6d,0xbe480000,0xbf0e3ec4,0xbf6d3f80,0xbec43f35,0x3f6dbf80,0x3ec4bf35,0x3f55bf80,0xbe48bec4,0x3f0e0000,0x3f7bbf6d
.long 0xbf353f80,0x3f350000,0xbf353f80,0x3f350000,0x3f0ebf80,0xbf7b3ec4,0xbf550000,0xbe483f6d,0xbec43f80,0x3f6dbf35,0x3ec4bf80,0xbf6d3f35,0x3e48bf80,0xbf0e3f6d,0x3f7b0000,0xbf55bec4
.long 0x3f80,0xbf80,0x3f80,0xbf80,0xbe48bf80,0x3f0e3f6d,0xbf7b0000,0x3f55bec4,0x3ec43f80,0xbf6dbf35,0xbec4bf80,0x3f6d3f35,0xbf0ebf80,0x3f7b3ec4,0x3f550000,0x3e483f6d
.long 0x3f353f80,0xbf350000,0x3f353f80,0xbf350000,0xbf55bf80,0x3e48bec4,0xbf0e0000,0xbf7bbf6d,0x3f6d3f80,0x3ec43f35,0xbf6dbf80,0xbec4bf35,0xbf7bbf80,0xbf55bf6d,0x3e480000,0x3f0e3ec4
.long 0x3f803f80,0x3f803f80,0x3f803f80,0x3f803f80,0xbf0ebf35,0xbe48bec4,0x3f553f35,0x3f7b3f6d,0xbec40000,0xbf6dbf35,0x3ec40000,0x3f6d3f35,0x3f7b3f35,0x3f0e3f6d,0xbe48bf35,0x3f553ec4
.long 0xbf35bf80,0x3f350000,0xbf35bf80,0x3f350000,0xbe483f35,0xbf55bf6d,0xbf7bbf35,0x3f0ebec4,0x3f6d0000,0xbec43f35,0xbf6d0000,0x3ec4bf35,0xbf55bf35,0x3f7b3ec4,0xbf0e3f35,0x3e48bf6d
.long 0x3f80,0xbf80,0x3f80,0xbf80,0x3f55bf35,0xbf7b3ec4,0x3f0e3f35,0xbe48bf6d,0xbf6d0000,0x3ec43f35,0x3f6d0000,0xbec4bf35,0x3e483f35,0x3f55bf6d,0x3f7bbf35,0xbf0ebec4
.long 0x3f35bf80,0xbf350000,0x3f35bf80,0xbf350000,0xbf7b3f35,0xbf0e3f6d,0x3e48bf35,0xbf553ec4,0x3ec40000,0x3f6dbf35,0xbec40000,0xbf6d3f35,0x3f0ebf35,0x3e48bec4,0xbf553f35,0xbf7b3f6d
.long 0xbf803f80,0xbf803f80,0xbf803f80,0xbf803f80,0x3f0ebf35,0x3e48bec4,0xbf553f35,0xbf7b3f6d,0x3ec40000,0x3f6dbf35,0xbec40000,0xbf6d3f35,0xbf7b3f35,0xbf0e3f6d,0x3e48bf35,0xbf553ec4
.long 0x3f35bf80,0xbf350000,0x3f35bf80,0xbf350000,0x3e483f35,0x3f55bf6d,0x3f7bbf35,0xbf0ebec4,0xbf6d0000,0x3ec43f35,0x3f6d0000,0xbec4bf35,0x3f55bf35,0xbf7b3ec4,0x3f0e3f35,0xbe48bf6d
.long 0x3f80,0xbf80,0x3f80,0xbf80,0xbf55bf35,0x3f7b3ec4,0xbf0e3f35,0x3e48bf6d,0x3f6d0000,0xbec43f35,0xbf6d0000,0x3ec4bf35,0xbe483f35,0xbf55bf6d,0xbf7bbf35,0x3f0ebec4
.long 0xbf35bf80,0x3f350000,0xbf35bf80,0x3f350000,0x3f7b3f35,0x3f0e3f6d,0xbe48bf35,0x3f553ec4,0xbec40000,0xbf6dbf35,0x3ec40000,0x3f6d3f35,0xbf0ebf35,0xbe48bec4,0x3f553f35,0x3f7b3f6d
.long 0x80008000,0x80008000,0x80008000,0x80008000,0xbe488000,0xbf0ebec4,0xbf7bbf80,0xbf55bf6d,0xbec48000,0xbf6dbf35,0x3ec48000,0x3f6d3f35,0xbf0e8000,0xbf7bbf6d,0x3f553f80,0xbe483ec4
.long 0xbf358000,0xbf35bf80,0xbf358000,0xbf35bf80,0xbf558000,0xbe48bf6d,0xbf0ebf80,0x3f7b3ec4,0xbf6d8000,0x3ec4bf35,0x3f6d8000,0xbec43f35,0xbf7b8000,0x3f55bec4,0x3e483f80,0xbf0ebf6d
.long 0xbf808000,0x3f808000,0xbf808000,0x3f808000,0xbf7b8000,0x3f553ec4,0x3e48bf80,0xbf0e3f6d,0xbf6d8000,0x3ec43f35,0x3f6d8000,0xbec4bf35,0xbf558000,0xbe483f6d,0xbf0e3f80,0x3f7bbec4
.long 0xbf358000,0xbf353f80,0xbf358000,0xbf353f80,0xbf0e8000,0xbf7b3f6d,0x3f55bf80,0xbe48bec4,0xbec48000,0xbf6d3f35,0x3ec48000,0x3f6dbf35,0xbe488000,0xbf0e3ec4,0xbf7b3f80,0xbf553f6d
.long 0x80008000,0x80008000,0x80008000,0x80008000,0x3e488000,0x3f0ebec4,0x3f7bbf80,0x3f55bf6d,0x3ec48000,0x3f6dbf35,0xbec48000,0xbf6d3f35,0x3f0e8000,0x3f7bbf6d,0xbf553f80,0x3e483ec4
.long 0x3f358000,0x3f35bf80,0x3f358000,0x3f35bf80,0x3f558000,0x3e48bf6d,0x3f0ebf80,0xbf7b3ec4,0x3f6d8000,0xbec4bf35,0xbf6d8000,0x3ec43f35,0x3f7b8000,0xbf55bec4,0xbe483f80,0x3f0ebf6d
.long 0x3f808000,0xbf808000,0x3f808000,0xbf808000,0x3f7b8000,0xbf553ec4,0xbe48bf80,0x3f0e3f6d,0x3f6d8000,0xbec43f35,0xbf6d8000,0x3ec4bf35,0x3f558000,0x3e483f6d,0x3f0e3f80,0xbf7bbec4
.long 0x3f358000,0x3f353f80,0x3f358000,0x3f353f80,0x3f0e8000,0x3f7b3f6d,0xbf55bf80,0x3e48bec4,0x3ec48000,0x3f6d3f35,0xbec48000,0xbf6dbf35,0x3e488000,0x3f0e3ec4,0x3f7b3f80,0x3f553f6d
.long 0x80008000,0x80008000,0x80008000,0x80008000,0xbf55bf35,0xbf7bbf6d,0xbf0ebf35,0xbe48bec4,0xbf6dbf80,0xbec4bf35,0x3f6d3f80,0x3ec43f35,0xbe48bf35,0x3f553ec4,0xbf7bbf35,0xbf0ebf6d
.long 0x3f358000,0x3f353f80,0x3f358000,0x3f353f80,0x3f7b3f35,0xbf0e3ec4,0xbe483f35,0xbf55bf6d,0x3ec43f80,0xbf6dbf35,0xbec4bf80,0x3f6d3f35,0xbf0e3f35,0x3e48bf6d,0x3f553f35,0xbf7bbec4
.long 0xbf808000,0x3f808000,0xbf808000,0x3f808000,0xbf0ebf35,0x3e483f6d,0x3f55bf35,0xbf7b3ec4,0x3ec4bf80,0xbf6d3f35,0xbec43f80,0x3f6dbf35,0x3f7bbf35,0xbf0ebec4,0xbe48bf35,0xbf553f6d
.long 0x3f358000,0x3f35bf80,0x3f358000,0x3f35bf80,0xbe483f35,0x3f55bec4,0xbf7b3f35,0xbf0e3f6d,0xbf6d3f80,0xbec43f35,0x3f6dbf80,0x3ec4bf35,0xbf553f35,0xbf7b3f6d,0xbf0e3f35,0xbe483ec4
.long 0x80008000,0x80008000,0x80008000,0x80008000,0x3f55bf35,0x3f7bbf6d,0x3f0ebf35,0x3e48bec4,0x3f6dbf80,0x3ec4bf35,0xbf6d3f80,0xbec43f35,0x3e48bf35,0xbf553ec4,0x3f7bbf35,0x3f0ebf6d
.long 0xbf358000,0xbf353f80,0xbf358000,0xbf353f80,0xbf7b3f35,0x3f0e3ec4,0x3e483f35,0x3f55bf6d,0xbec43f80,0x3f6dbf35,0x3ec4bf80,0xbf6d3f35,0x3f0e3f35,0xbe48bf6d,0xbf553f35,0x3f7bbec4
.long 0x3f808000,0xbf808000,0x3f808000,0xbf808000,0x3f0ebf35,0xbe483f6d,0xbf55bf35,0x3f7b3ec4,0xbec4bf80,0x3f6d3f35,0x3ec43f80,0xbf6dbf35,0xbf7bbf35,0x3f0ebec4,0x3e48bf35,0x3f553f6d
.long 0xbf358000,0xbf35bf80,0xbf358000,0xbf35bf80,0x3e483f35,0xbf55bec4,0x3f7b3f35,0x3f0e3f6d,0x3f6d3f80,0x3ec43f35,0xbf6dbf80,0xbec4bf35,0x3f553f35,0x3f7b3f6d,0x3f0e3f35,0x3e483ec4
.long 0x80008000,0x80008000,0x80008000,0x80008000,0x3e488000,0x3f0e3ec4,0x3f7b3f80,0x3f553f6d,0xbec48000,0xbf6dbf35,0x3ec48000,0x3f6d3f35,0x3f0e8000,0x3f7b3f6d,0xbf55bf80,0x3e48bec4
.long 0xbf358000,0xbf35bf80,0xbf358000,0xbf35bf80,0x3f558000,0x3e483f6d,0x3f0e3f80,0xbf7bbec4,0xbf6d8000,0x3ec4bf35,0x3f6d8000,0xbec43f35,0x3f7b8000,0xbf553ec4,0xbe48bf80,0x3f0e3f6d
.long 0xbf808000,0x3f808000,0xbf808000,0x3f808000,0x3f7b8000,0xbf55bec4,0xbe483f80,0x3f0ebf6d,0xbf6d8000,0x3ec43f35,0x3f6d8000,0xbec4bf35,0x3f558000,0x3e48bf6d,0x3f0ebf80,0xbf7b3ec4
.long 0xbf358000,0xbf353f80,0xbf358000,0xbf353f80,0x3f0e8000,0x3f7bbf6d,0xbf553f80,0x3e483ec4,0xbec48000,0xbf6d3f35,0x3ec48000,0x3f6dbf35,0x3e488000,0x3f0ebec4,0x3f7bbf80,0x3f55bf6d
.long 0x80008000,0x80008000,0x80008000,0x80008000,0xbe488000,0xbf0e3ec4,0xbf7b3f80,0xbf553f6d,0x3ec48000,0x3f6dbf35,0xbec48000,0xbf6d3f35,0xbf0e8000,0xbf7b3f6d,0x3f55bf80,0xbe48bec4
.long 0x3f358000,0x3f35bf80,0x3f358000,0x3f35bf80,0xbf558000,0xbe483f6d,0xbf0e3f80,0x3f7bbec4,0x3f6d8000,0xbec4bf35,0xbf6d8000,0x3ec43f35,0xbf7b8000,0x3f553ec4,0x3e48bf80,0xbf0e3f6d
.long 0x3f808000,0xbf808000,0x3f808000,0xbf808000,0xbf7b8000,0x3f55bec4,0x3e483f80,0xbf0ebf6d,0x3f6d8000,0xbec43f35,0xbf6d8000,0x3ec4bf35,0xbf558000,0xbe48bf6d,0xbf0ebf80,0x3f7b3ec4
.long 0x3f358000,0x3f353f80,0x3f358000,0x3f353f80,0xbf0e8000,0xbf7bbf6d,0x3f553f80,0xbe483ec4,0x3ec48000,0x3f6d3f35,0xbec48000,0xbf6dbf35,0xbe488000,0xbf0ebec4,0xbf7bbf80,0xbf55bf6d
.long 0x80008000,0x80008000,0x80008000,0x80008000,0x3f553f35,0x3f7b3f6d,0x3f0e3f35,0x3e483ec4,0xbf6dbf80,0xbec4bf35,0x3f6d3f80,0x3ec43f35,0x3e483f35,0xbf55bec4,0x3f7b3f35,0x3f0e3f6d
.long 0x3f358000,0x3f353f80,0x3f358000,0x3f353f80,0xbf7bbf35,0x3f0ebec4,0x3e48bf35,0x3f553f6d,0x3ec43f80,0xbf6dbf35,0xbec4bf80,0x3f6d3f35,0x3f0ebf35,0xbe483f6d,0xbf55bf35,0x3f7b3ec4
.long 0xbf808000,0x3f808000,0xbf808000,0x3f808000,0x3f0e3f35,0xbe48bf6d,0xbf553f35,0x3f7bbec4,0x3ec4bf80,0xbf6d3f35,0xbec43f80,0x3f6dbf35,0xbf7b3f35,0x3f0e3ec4,0x3e483f35,0x3f55bf6d
.long 0x3f358000,0x3f35bf80,0x3f358000,0x3f35bf80,0x3e48bf35,0xbf553ec4,0x3f7bbf35,0x3f0ebf6d,0xbf6d3f80,0xbec43f35,0x3f6dbf80,0x3ec4bf35,0x3f55bf35,0x3f7bbf6d,0x3f0ebf35,0x3e48bec4
.long 0x80008000,0x80008000,0x80008000,0x80008000,0xbf553f35,0xbf7b3f6d,0xbf0e3f35,0xbe483ec4,0x3f6dbf80,0x3ec4bf35,0xbf6d3f80,0xbec43f35,0xbe483f35,0x3f55bec4,0xbf7b3f35,0xbf0e3f6d
.long 0xbf358000,0xbf353f80,0xbf358000,0xbf353f80,0x3f7bbf35,0xbf0ebec4,0xbe48bf35,0xbf553f6d,0xbec43f80,0x3f6dbf35,0x3ec4bf80,0xbf6d3f35,0xbf0ebf35,0x3e483f6d,0x3f55bf35,0xbf7b3ec4
.long 0x3f808000,0xbf808000,0x3f808000,0xbf808000,0xbf0e3f35,0x3e48bf6d,0x3f553f35,0xbf7bbec4,0xbec4bf80,0x3f6d3f35,0x3ec43f80,0xbf6dbf35,0x3f7b3f35,0xbf0e3ec4,0xbe483f35,0xbf55bf6d
.long 0xbf358000,0xbf35bf80,0xbf358000,0xbf35bf80,0xbe48bf35,0x3f553ec4,0xbf7bbf35,0xbf0ebf6d,0x3f6d3f80,0x3ec43f35,0xbf6dbf80,0xbec4bf35,0xbf55bf35,0xbf7bbf6d,0xbf0ebf35,0xbe48bec4
.long 0x0,0x0,0x0,0x0,0x3e480000,0x3f0e3ec4,0x3f7b3f80,0x3f553f6d,0x3ec40000,0x3f6d3f35,0xbec40000,0xbf6dbf35,0x3f0e0000,0x3f7b3f6d,0xbf55bf80,0x3e48bec4
.long 0x3f350000,0x3f353f80,0x3f350000,0x3f353f80,0x3f550000,0x3e483f6d,0x3f0e3f80,0xbf7bbec4,0x3f6d0000,0xbec43f35,0xbf6d0000,0x3ec4bf35,0x3f7b0000,0xbf553ec4,0xbe48bf80,0x3f0e3f6d
.long 0x3f800000,0xbf800000,0x3f800000,0xbf800000,0x3f7b0000,0xbf55bec4,0xbe483f80,0x3f0ebf6d,0x3f6d0000,0xbec4bf35,0xbf6d0000,0x3ec43f35,0x3f550000,0x3e48bf6d,0x3f0ebf80,0xbf7b3ec4
.long 0x3f350000,0x3f35bf80,0x3f350000,0x3f35bf80,0x3f0e0000,0x3f7bbf6d,0xbf553f80,0x3e483ec4,0x3ec40000,0x3f6dbf35,0xbec40000,0xbf6d3f35,0x3e480000,0x3f0ebec4,0x3f7bbf80,0x3f55bf6d
.long 0x0,0x0,0x0,0x0,0xbe480000,0xbf0e3ec4,0xbf7b3f80,0xbf553f6d,0xbec40000,0xbf6d3f35,0x3ec40000,0x3f6dbf35,0xbf0e0000,0xbf7b3f6d,0x3f55bf80,0xbe48bec4
.long 0xbf350000,0xbf353f80,0xbf350000,0xbf353f80,0xbf550000,0xbe483f6d,0xbf0e3f80,0x3f7bbec4,0xbf6d0000,0x3ec43f35,0x3f6d0000,0xbec4bf35,0xbf7b0000,0x3f553ec4,0x3e48bf80,0xbf0e3f6d
.long 0xbf800000,0x3f800000,0xbf800000,0x3f800000,0xbf7b0000,0x3f55bec4,0x3e483f80,0xbf0ebf6d,0xbf6d0000,0x3ec4bf35,0x3f6d0000,0xbec43f35,0xbf550000,0xbe48bf6d,0xbf0ebf80,0x3f7b3ec4
.long 0xbf350000,0xbf35bf80,0xbf350000,0xbf35bf80,0xbf0e0000,0xbf7bbf6d,0x3f553f80,0xbe483ec4,0xbec40000,0xbf6dbf35,0x3ec40000,0x3f6d3f35,0xbe480000,0xbf0ebec4,0xbf7bbf80,0xbf55bf6d
.long 0x0,0x0,0x0,0x0,0x3f553f35,0x3f7b3f6d,0x3f0e3f35,0x3e483ec4,0x3f6d3f80,0x3ec43f35,0xbf6dbf80,0xbec4bf35,0x3e483f35,0xbf55bec4,0x3f7b3f35,0x3f0e3f6d
.long 0xbf350000,0xbf35bf80,0xbf350000,0xbf35bf80,0xbf7bbf35,0x3f0ebec4,0x3e48bf35,0x3f553f6d,0xbec4bf80,0x3f6d3f35,0x3ec43f80,0xbf6dbf35,0x3f0ebf35,0xbe483f6d,0xbf55bf35,0x3f7b3ec4
.long 0x3f800000,0xbf800000,0x3f800000,0xbf800000,0x3f0e3f35,0xbe48bf6d,0xbf553f35,0x3f7bbec4,0xbec43f80,0x3f6dbf35,0x3ec4bf80,0xbf6d3f35,0xbf7b3f35,0x3f0e3ec4,0x3e483f35,0x3f55bf6d
.long 0xbf350000,0xbf353f80,0xbf350000,0xbf353f80,0x3e48bf35,0xbf553ec4,0x3f7bbf35,0x3f0ebf6d,0x3f6dbf80,0x3ec4bf35,0xbf6d3f80,0xbec43f35,0x3f55bf35,0x3f7bbf6d,0x3f0ebf35,0x3e48bec4
.long 0x0,0x0,0x0,0x0,0xbf553f35,0xbf7b3f6d,0xbf0e3f35,0xbe483ec4,0xbf6d3f80,0xbec43f35,0x3f6dbf80,0x3ec4bf35,0xbe483f35,0x3f55bec4,0xbf7b3f35,0xbf0e3f6d
.long 0x3f350000,0x3f35bf80,0x3f350000,0x3f35bf80,0x3f7bbf35,0xbf0ebec4,0xbe48bf35,0xbf553f6d,0x3ec4bf80,0xbf6d3f35,0xbec43f80,0x3f6dbf35,0xbf0ebf35,0x3e483f6d,0x3f55bf35,0xbf7b3ec4
.long 0xbf800000,0x3f800000,0xbf800000,0x3f800000,0xbf0e3f35,0x3e48bf6d,0x3f553f35,0xbf7bbec4,0x3ec43f80,0xbf6dbf35,0xbec4bf80,0x3f6d3f35,0x3f7b3f35,0xbf0e3ec4,0xbe483f35,0xbf55bf6d
.long 0x3f350000,0x3f353f80,0x3f350000,0x3f353f80,0xbe48bf35,0x3f553ec4,0xbf7bbf35,0xbf0ebf6d,0xbf6dbf80,0xbec4bf35,0x3f6d3f80,0x3ec43f35,0xbf55bf35,0xbf7bbf6d,0xbf0ebf35,0xbe48bec4
.long 0x0,0x0,0x0,0x0,0xbe480000,0xbf0ebec4,0xbf7bbf80,0xbf55bf6d,0x3ec40000,0x3f6d3f35,0xbec40000,0xbf6dbf35,0xbf0e0000,0xbf7bbf6d,0x3f553f80,0xbe483ec4
.long 0x3f350000,0x3f353f80,0x3f350000,0x3f353f80,0xbf550000,0xbe48bf6d,0xbf0ebf80,0x3f7b3ec4,0x3f6d0000,0xbec43f35,0xbf6d0000,0x3ec4bf35,0xbf7b0000,0x3f55bec4,0x3e483f80,0xbf0ebf6d
.long 0x3f800000,0xbf800000,0x3f800000,0xbf800000,0xbf7b0000,0x3f553ec4,0x3e48bf80,0xbf0e3f6d,0x3f6d0000,0xbec4bf35,0xbf6d0000,0x3ec43f35,0xbf550000,0xbe483f6d,0xbf0e3f80,0x3f7bbec4
.long 0x3f350000,0x3f35bf80,0x3f350000,0x3f35bf80,0xbf0e0000,0xbf7b3f6d,0x3f55bf80,0xbe48bec4,0x3ec40000,0x3f6dbf35,0xbec40000,0xbf6d3f35,0xbe480000,0xbf0e3ec4,0xbf7b3f80,0xbf553f6d
.long 0x0,0x0,0x0,0x0,0x3e480000,0x3f0ebec4,0x3f7bbf80,0x3f55bf6d,0xbec40000,0xbf6d3f35,0x3ec40000,0x3f6dbf35,0x3f0e0000,0x3f7bbf6d,0xbf553f80,0x3e483ec4
.long 0xbf350000,0xbf353f80,0xbf350000,0xbf353f80,0x3f550000,0x3e48bf6d,0x3f0ebf80,0xbf7b3ec4,0xbf6d0000,0x3ec43f35,0x3f6d0000,0xbec4bf35,0x3f7b0000,0xbf55bec4,0xbe483f80,0x3f0ebf6d
.long 0xbf800000,0x3f800000,0xbf800000,0x3f800000,0x3f7b0000,0xbf553ec4,0xbe48bf80,0x3f0e3f6d,0xbf6d0000,0x3ec4bf35,0x3f6d0000,0xbec43f35,0x3f550000,0x3e483f6d,0x3f0e3f80,0xbf7bbec4
.long 0xbf350000,0xbf35bf80,0xbf350000,0xbf35bf80,0x3f0e0000,0x3f7b3f6d,0xbf55bf80,0x3e48bec4,0xbec40000,0xbf6dbf35,0x3ec40000,0x3f6d3f35,0x3e480000,0x3f0e3ec4,0x3f7b3f80,0x3f553f6d
.long 0x0,0x0,0x0,0x0,0xbf55bf35,0xbf7bbf6d,0xbf0ebf35,0xbe48bec4,0x3f6d3f80,0x3ec43f35,0xbf6dbf80,0xbec4bf35,0xbe48bf35,0x3f553ec4,0xbf7bbf35,0xbf0ebf6d
.long 0xbf350000,0xbf35bf80,0xbf350000,0xbf35bf80,0x3f7b3f35,0xbf0e3ec4,0xbe483f35,0xbf55bf6d,0xbec4bf80,0x3f6d3f35,0x3ec43f80,0xbf6dbf35,0xbf0e3f35,0x3e48bf6d,0x3f553f35,0xbf7bbec4
.long 0x3f800000,0xbf800000,0x3f800000,0xbf800000,0xbf0ebf35,0x3e483f6d,0x3f55bf35,0xbf7b3ec4,0xbec43f80,0x3f6dbf35,0x3ec4bf80,0xbf6d3f35,0x3f7bbf35,0xbf0ebec4,0xbe48bf35,0xbf553f6d
.long 0xbf350000,0xbf353f80,0xbf350000,0xbf353f80,0xbe483f35,0x3f55bec4,0xbf7b3f35,0xbf0e3f6d,0x3f6dbf80,0x3ec4bf35,0xbf6d3f80,0xbec43f35,0xbf553f35,0xbf7b3f6d,0xbf0e3f35,0xbe483ec4
.long 0x0,0x0,0x0,0x0,0x3f55bf35,0x3f7bbf6d,0x3f0ebf35,0x3e48bec4,0xbf6d3f80,0xbec43f35,0x3f6dbf80,0x3ec4bf35,0x3e48bf35,0xbf553ec4,0x3f7bbf35,0x3f0ebf6d
.long 0x3f350000,0x3f35bf80,0x3f350000,0x3f35bf80,0xbf7b3f35,0x3f0e3ec4,0x3e483f35,0x3f55bf6d,0x3ec4bf80,0xbf6d3f35,0xbec43f80,0x3f6dbf35,0x3f0e3f35,0xbe48bf6d,0xbf553f35,0x3f7bbec4
.long 0xbf800000,0x3f800000,0xbf800000,0x3f800000,0x3f0ebf35,0xbe483f6d,0xbf55bf35,0x3f7b3ec4,0x3ec43f80,0xbf6dbf35,0xbec4bf80,0x3f6d3f35,0xbf7bbf35,0x3f0ebec4,0x3e48bf35,0x3f553f6d
.long 0x3f350000,0x3f353f80,0x3f350000,0x3f353f80,0x3e483f35,0xbf55bec4,0x3f7b3f35,0x3f0e3f6d,0xbf6dbf80,0xbec4bf35,0x3f6d3f80,0x3ec43f35,0x3f553f35,0x3f7b3f6d,0x3f0e3f35,0x3e483ec4
.long 0x3f803f80,0x3f803f80,0x3f803f80,0x3f803f80,0x3f7b3f80,0x3f0e3f35,0xbe480000,0xbf55bf35,0x3f6d3f80,0xbec40000,0xbf6dbf80,0x3ec40000,0x3f553f80,0xbf7bbf35,0x3f0e0000,0x3e483f35
.long 0x3f353f80,0xbf35bf80,0x3f353f80,0xbf35bf80,0x3f0e3f80,0x3e48bf35,0xbf550000,0x3f7b3f35,0x3ec43f80,0x3f6d0000,0xbec4bf80,0xbf6d0000,0x3e483f80,0x3f553f35,0x3f7b0000,0x3f0ebf35
.long 0x3f80,0x3f80,0x3f80,0x3f80,0xbe483f80,0xbf553f35,0xbf7b0000,0xbf0ebf35,0xbec43f80,0xbf6d0000,0x3ec4bf80,0x3f6d0000,0xbf0e3f80,0xbe48bf35,0x3f550000,0xbf7b3f35
.long 0xbf353f80,0x3f35bf80,0xbf353f80,0x3f35bf80,0xbf553f80,0x3f7bbf35,0xbf0e0000,0xbe483f35,0xbf6d3f80,0x3ec40000,0x3f6dbf80,0xbec40000,0xbf7b3f80,0xbf0e3f35,0x3e480000,0x3f55bf35
.long 0xbf803f80,0xbf803f80,0xbf803f80,0xbf803f80,0xbf7b3f80,0xbf0e3f35,0x3e480000,0x3f55bf35,0xbf6d3f80,0x3ec40000,0x3f6dbf80,0xbec40000,0xbf553f80,0x3f7bbf35,0xbf0e0000,0xbe483f35
.long 0xbf353f80,0x3f35bf80,0xbf353f80,0x3f35bf80,0xbf0e3f80,0xbe48bf35,0x3f550000,0xbf7b3f35,0xbec43f80,0xbf6d0000,0x3ec4bf80,0x3f6d0000,0xbe483f80,0xbf553f35,0xbf7b0000,0xbf0ebf35
.long 0x3f80,0x3f80,0x3f80,0x3f80,0x3e483f80,0x3f553f35,0x3f7b0000,0x3f0ebf35,0x3ec43f80,0x3f6d0000,0xbec4bf80,0xbf6d0000,0x3f0e3f80,0x3e48bf35,0xbf550000,0x3f7b3f35
.long 0x3f353f80,0xbf35bf80,0x3f353f80,0xbf35bf80,0x3f553f80,0xbf7bbf35,0x3f0e0000,0x3e483f35,0x3f6d3f80,0xbec40000,0xbf6dbf80,0x3ec40000,0x3f7b3f80,0x3f0e3f35,0xbe480000,0xbf55bf35
.long 0x3f803f80,0x3f803f80,0x3f803f80,0x3f803f80,0x3f553f6d,0x3e483ec4,0xbf0ebec4,0xbf7bbf6d,0x3ec43f35,0xbf6dbf35,0xbec4bf35,0x3f6d3f35,0xbe483ec4,0xbf0ebf6d,0x3f7b3f6d,0xbf55bec4
.long 0xbf350000,0x3f350000,0xbf350000,0x3f350000,0xbf7bbec4,0x3f553f6d,0xbe48bf6d,0xbf0e3ec4,0xbf6dbf35,0xbec43f35,0x3f6d3f35,0x3ec4bf35,0xbf0ebf6d,0xbf7bbec4,0xbf553ec4,0xbe483f6d
.long 0xbf80,0xbf80,0xbf80,0xbf80,0x3f0ebf6d,0x3f7bbec4,0x3f553ec4,0x3e483f6d,0x3f6dbf35,0x3ec43f35,0xbf6d3f35,0xbec4bf35,0x3f7bbec4,0xbf553f6d,0x3e48bf6d,0x3f0e3ec4
.long 0x3f350000,0xbf350000,0x3f350000,0xbf350000,0x3e483ec4,0x3f0ebf6d,0xbf7b3f6d,0x3f55bec4,0xbec43f35,0x3f6dbf35,0x3ec4bf35,0xbf6d3f35,0xbf553f6d,0xbe483ec4,0x3f0ebec4,0x3f7bbf6d
.long 0xbf803f80,0xbf803f80,0xbf803f80,0xbf803f80,0xbf553f6d,0xbe483ec4,0x3f0ebec4,0x3f7bbf6d,0xbec43f35,0x3f6dbf35,0x3ec4bf35,0xbf6d3f35,0x3e483ec4,0x3f0ebf6d,0xbf7b3f6d,0x3f55bec4
.long 0x3f350000,0xbf350000,0x3f350000,0xbf350000,0x3f7bbec4,0xbf553f6d,0x3e48bf6d,0x3f0e3ec4,0x3f6dbf35,0x3ec43f35,0xbf6d3f35,0xbec4bf35,0x3f0ebf6d,0x3f7bbec4,0x3f553ec4,0x3e483f6d
.long 0xbf80,0xbf80,0xbf80,0xbf80,0xbf0ebf6d,0xbf7bbec4,0xbf553ec4,0xbe483f6d,0xbf6dbf35,0xbec43f35,0x3f6d3f35,0x3ec4bf35,0xbf7bbec4,0x3f553f6d,0xbe48bf6d,0xbf0e3ec4
.long 0xbf350000,0x3f350000,0xbf350000,0x3f350000,0xbe483ec4,0xbf0ebf6d,0x3f7b3f6d,0xbf55bec4,0x3ec43f35,0xbf6dbf35,0xbec4bf35,0x3f6d3f35,0x3f553f6d,0x3e483ec4,0xbf0ebec4,0xbf7bbf6d
.long 0x3f803f80,0x3f803f80,0x3f803f80,0x3f803f80,0xbf7bbf80,0xbf0ebf35,0x3e480000,0x3f553f35,0x3f6d3f80,0xbec40000,0xbf6dbf80,0x3ec40000,0xbf55bf80,0x3f7b3f35,0xbf0e0000,0xbe48bf35
.long 0x3f353f80,0xbf35bf80,0x3f353f80,0xbf35bf80,0xbf0ebf80,0xbe483f35,0x3f550000,0xbf7bbf35,0x3ec43f80,0x3f6d0000,0xbec4bf80,0xbf6d0000,0xbe48bf80,0xbf55bf35,0xbf7b0000,0xbf0e3f35
.long 0x3f80,0x3f80,0x3f80,0x3f80,0x3e48bf80,0x3f55bf35,0x3f7b0000,0x3f0e3f35,0xbec43f80,0xbf6d0000,0x3ec4bf80,0x3f6d0000,0x3f0ebf80,0x3e483f35,0xbf550000,0x3f7bbf35
.long 0xbf353f80,0x3f35bf80,0xbf353f80,0x3f35bf80,0x3f55bf80,0xbf7b3f35,0x3f0e0000,0x3e48bf35,0xbf6d3f80,0x3ec40000,0x3f6dbf80,0xbec40000,0x3f7bbf80,0x3f0ebf35,0xbe480000,0xbf553f35
.long 0xbf803f80,0xbf803f80,0xbf803f80,0xbf803f80,0x3f7bbf80,0x3f0ebf35,0xbe480000,0xbf553f35,0xbf6d3f80,0x3ec40000,0x3f6dbf80,0xbec40000,0x3f55bf80,0xbf7b3f35,0x3f0e0000,0x3e48bf35
.long 0xbf353f80,0x3f35bf80,0xbf353f80,0x3f35bf80,0x3f0ebf80,0x3e483f35,0xbf550000,0x3f7bbf35,0xbec43f80,0xbf6d0000,0x3ec4bf80,0x3f6d0000,0x3e48bf80,0x3f55bf35,0x3f7b0000,0x3f0e3f35
.long 0x3f80,0x3f80,0x3f80,0x3f80,0xbe48bf80,0xbf55bf35,0xbf7b0000,0xbf0e3f35,0x3ec43f80,0x3f6d0000,0xbec4bf80,0xbf6d0000,0xbf0ebf80,0xbe483f35,0x3f550000,0xbf7bbf35
.long 0x3f353f80,0xbf35bf80,0x3f353f80,0xbf35bf80,0xbf55bf80,0x3f7b3f35,0xbf0e0000,0xbe48bf35,0x3f6d3f80,0xbec40000,0xbf6dbf80,0x3ec40000,0xbf7bbf80,0xbf0ebf35,0x3e480000,0x3f553f35
.long 0x3f803f80,0x3f803f80,0x3f803f80,0x3f803f80,0xbf55bf6d,0xbe48bec4,0x3f0e3ec4,0x3f7b3f6d,0x3ec43f35,0xbf6dbf35,0xbec4bf35,0x3f6d3f35,0x3e48bec4,0x3f0e3f6d,0xbf7bbf6d,0x3f553ec4
.long 0xbf350000,0x3f350000,0xbf350000,0x3f350000,0x3f7b3ec4,0xbf55bf6d,0x3e483f6d,0x3f0ebec4,0xbf6dbf35,0xbec43f35,0x3f6d3f35,0x3ec4bf35,0x3f0e3f6d,0x3f7b3ec4,0x3f55bec4,0x3e48bf6d
.long 0xbf80,0xbf80,0xbf80,0xbf80,0xbf0e3f6d,0xbf7b3ec4,0xbf55bec4,0xbe48bf6d,0x3f6dbf35,0x3ec43f35,0xbf6d3f35,0xbec4bf35,0xbf7b3ec4,0x3f55bf6d,0xbe483f6d,0xbf0ebec4
.long 0x3f350000,0xbf350000,0x3f350000,0xbf350000,0xbe48bec4,0xbf0e3f6d,0x3f7bbf6d,0xbf553ec4,0xbec43f35,0x3f6dbf35,0x3ec4bf35,0xbf6d3f35,0x3f55bf6d,0x3e48bec4,0xbf0e3ec4,0xbf7b3f6d
.long 0xbf803f80,0xbf803f80,0xbf803f80,0xbf803f80,0x3f55bf6d,0x3e48bec4,0xbf0e3ec4,0xbf7b3f6d,0xbec43f35,0x3f6dbf35,0x3ec4bf35,0xbf6d3f35,0xbe48bec4,0xbf0e3f6d,0x3f7bbf6d,0xbf553ec4
.long 0x3f350000,0xbf350000,0x3f350000,0xbf350000,0xbf7b3ec4,0x3f55bf6d,0xbe483f6d,0xbf0ebec4,0x3f6dbf35,0x3ec43f35,0xbf6d3f35,0xbec4bf35,0xbf0e3f6d,0xbf7b3ec4,0xbf55bec4,0xbe48bf6d
.long 0xbf80,0xbf80,0xbf80,0xbf80,0x3f0e3f6d,0x3f7b3ec4,0x3f55bec4,0x3e48bf6d,0xbf6dbf35,0xbec43f35,0x3f6d3f35,0x3ec4bf35,0x3f7b3ec4,0xbf55bf6d,0x3e483f6d,0x3f0ebec4
.long 0xbf350000,0x3f350000,0xbf350000,0x3f350000,0x3e48bec4,0x3f0e3f6d,0xbf7bbf6d,0x3f553ec4,0x3ec43f35,0xbf6dbf35,0xbec4bf35,0x3f6d3f35,0xbf55bf6d,0xbe48bec4,0x3f0e3ec4,0x3f7b3f6d
.long 0x80008000,0x80008000,0x80008000,0x80008000,0xbe488000,0xbf55bf35,0xbf7bbf80,0xbf0ebf35,0xbec48000,0xbf6dbf80,0x3ec48000,0x3f6d3f80,0xbf0e8000,0xbe48bf35,0x3f553f80,0xbf7bbf35
.long 0xbf358000,0x3f358000,0xbf358000,0x3f358000,0xbf558000,0x3f7b3f35,0xbf0ebf80,0xbe483f35,0xbf6d8000,0x3ec43f80,0x3f6d8000,0xbec4bf80,0xbf7b8000,0xbf0e3f35,0x3e483f80,0x3f553f35
.long 0xbf808000,0xbf808000,0xbf808000,0xbf808000,0xbf7b8000,0xbf0ebf35,0x3e48bf80,0x3f55bf35,0xbf6d8000,0x3ec4bf80,0x3f6d8000,0xbec43f80,0xbf558000,0x3f7bbf35,0xbf0e3f80,0xbe48bf35
.long 0xbf358000,0x3f358000,0xbf358000,0x3f358000,0xbf0e8000,0xbe483f35,0x3f55bf80,0xbf7b3f35,0xbec48000,0xbf6d3f80,0x3ec48000,0x3f6dbf80,0xbe488000,0xbf553f35,0xbf7b3f80,0xbf0e3f35
.long 0x80008000,0x80008000,0x80008000,0x80008000,0x3e488000,0x3f55bf35,0x3f7bbf80,0x3f0ebf35,0x3ec48000,0x3f6dbf80,0xbec48000,0xbf6d3f80,0x3f0e8000,0x3e48bf35,0xbf553f80,0x3f7bbf35
.long 0x3f358000,0xbf358000,0x3f358000,0xbf358000,0x3f558000,0xbf7b3f35,0x3f0ebf80,0x3e483f35,0x3f6d8000,0xbec43f80,0xbf6d8000,0x3ec4bf80,0x3f7b8000,0x3f0e3f35,0xbe483f80,0xbf553f35
.long 0x3f808000,0x3f808000,0x3f808000,0x3f808000,0x3f7b8000,0x3f0ebf35,0xbe48bf80,0xbf55bf35,0x3f6d8000,0xbec4bf80,0xbf6d8000,0x3ec43f80,0x3f558000,0xbf7bbf35,0x3f0e3f80,0x3e48bf35
.long 0x3f358000,0xbf358000,0x3f358000,0xbf358000,0x3f0e8000,0x3e483f35,0xbf55bf80,0x3f7b3f35,0x3ec48000,0x3f6d3f80,0xbec48000,0xbf6dbf80,0x3e488000,0x3f553f35,0x3f7b3f80,0x3f0e3f35
.long 0x80008000,0x80008000,0x80008000,0x80008000,0xbf0ebec4,0xbf7bbf6d,0xbf55bf6d,0xbe48bec4,0xbf6dbf35,0xbec4bf35,0x3f6d3f35,0x3ec43f35,0xbf7bbf6d,0x3f553ec4,0xbe483ec4,0xbf0ebf6d
.long 0xbf35bf80,0x3f353f80,0xbf35bf80,0x3f353f80,0xbe48bf6d,0xbf0e3ec4,0x3f7b3ec4,0xbf55bf6d,0x3ec4bf35,0xbf6dbf35,0xbec43f35,0x3f6d3f35,0x3f55bec4,0x3e48bf6d,0xbf0ebf6d,0xbf7bbec4
.long 0x3f808000,0x3f808000,0x3f808000,0x3f808000,0x3f553ec4,0x3e483f6d,0xbf0e3f6d,0xbf7b3ec4,0x3ec43f35,0xbf6d3f35,0xbec4bf35,0x3f6dbf35,0xbe483f6d,0xbf0ebec4,0x3f7bbec4,0xbf553f6d
.long 0xbf353f80,0x3f35bf80,0xbf353f80,0x3f35bf80,0xbf7b3f6d,0x3f55bec4,0xbe48bec4,0xbf0e3f6d,0xbf6d3f35,0xbec43f35,0x3f6dbf35,0x3ec4bf35,0xbf0e3ec4,0xbf7b3f6d,0xbf553f6d,0xbe483ec4
.long 0x80008000,0x80008000,0x80008000,0x80008000,0x3f0ebec4,0x3f7bbf6d,0x3f55bf6d,0x3e48bec4,0x3f6dbf35,0x3ec4bf35,0xbf6d3f35,0xbec43f35,0x3f7bbf6d,0xbf553ec4,0x3e483ec4,0x3f0ebf6d
.long 0x3f35bf80,0xbf353f80,0x3f35bf80,0xbf353f80,0x3e48bf6d,0x3f0e3ec4,0xbf7b3ec4,0x3f55bf6d,0xbec4bf35,0x3f6dbf35,0x3ec43f35,0xbf6d3f35,0xbf55bec4,0xbe48bf6d,0x3f0ebf6d,0x3f7bbec4
.long 0xbf808000,0xbf808000,0xbf808000,0xbf808000,0xbf553ec4,0xbe483f6d,0x3f0e3f6d,0x3f7b3ec4,0xbec43f35,0x3f6d3f35,0x3ec4bf35,0xbf6dbf35,0x3e483f6d,0x3f0ebec4,0xbf7bbec4,0x3f553f6d
.long 0x3f353f80,0xbf35bf80,0x3f353f80,0xbf35bf80,0x3f7b3f6d,0xbf55bec4,0x3e48bec4,0x3f0e3f6d,0x3f6d3f35,0x3ec43f35,0xbf6dbf35,0xbec4bf35,0x3f0e3ec4,0x3f7b3f6d,0x3f553f6d,0x3e483ec4
.long 0x80008000,0x80008000,0x80008000,0x80008000,0x3e488000,0x3f553f35,0x3f7b3f80,0x3f0e3f35,0xbec48000,0xbf6dbf80,0x3ec48000,0x3f6d3f80,0x3f0e8000,0x3e483f35,0xbf55bf80,0x3f7b3f35
.long 0xbf358000,0x3f358000,0xbf358000,0x3f358000,0x3f558000,0xbf7bbf35,0x3f0e3f80,0x3e48bf35,0xbf6d8000,0x3ec43f80,0x3f6d8000,0xbec4bf80,0x3f7b8000,0x3f0ebf35,0xbe48bf80,0xbf55bf35
.long 0xbf808000,0xbf808000,0xbf808000,0xbf808000,0x3f7b8000,0x3f0e3f35,0xbe483f80,0xbf553f35,0xbf6d8000,0x3ec4bf80,0x3f6d8000,0xbec43f80,0x3f558000,0xbf7b3f35,0x3f0ebf80,0x3e483f35
.long 0xbf358000,0x3f358000,0xbf358000,0x3f358000,0x3f0e8000,0x3e48bf35,0xbf553f80,0x3f7bbf35,0xbec48000,0xbf6d3f80,0x3ec48000,0x3f6dbf80,0x3e488000,0x3f55bf35,0x3f7bbf80,0x3f0ebf35
.long 0x80008000,0x80008000,0x80008000,0x80008000,0xbe488000,0xbf553f35,0xbf7b3f80,0xbf0e3f35,0x3ec48000,0x3f6dbf80,0xbec48000,0xbf6d3f80,0xbf0e8000,0xbe483f35,0x3f55bf80,0xbf7b3f35
.long 0x3f358000,0xbf358000,0x3f358000,0xbf358000,0xbf558000,0x3f7bbf35,0xbf0e3f80,0xbe48bf35,0x3f6d8000,0xbec43f80,0xbf6d8000,0x3ec4bf80,0xbf7b8000,0xbf0ebf35,0x3e48bf80,0x3f55bf35
.long 0x3f808000,0x3f808000,0x3f808000,0x3f808000,0xbf7b8000,0xbf0e3f35,0x3e483f80,0x3f553f35,0x3f6d8000,0xbec4bf80,0xbf6d8000,0x3ec43f80,0xbf558000,0x3f7b3f35,0xbf0ebf80,0xbe483f35
.long 0x3f358000,0xbf358000,0x3f358000,0xbf358000,0xbf0e8000,0xbe48bf35,0x3f553f80,0xbf7bbf35,0x3ec48000,0x3f6d3f80,0xbec48000,0xbf6dbf80,0xbe488000,0xbf55bf35,0xbf7bbf80,0xbf0ebf35
.long 0x80008000,0x80008000,0x80008000,0x80008000,0x3f0e3ec4,0x3f7b3f6d,0x3f553f6d,0x3e483ec4,0xbf6dbf35,0xbec4bf35,0x3f6d3f35,0x3ec43f35,0x3f7b3f6d,0xbf55bec4,0x3e48bec4,0x3f0e3f6d
.long 0xbf35bf80,0x3f353f80,0xbf35bf80,0x3f353f80,0x3e483f6d,0x3f0ebec4,0xbf7bbec4,0x3f553f6d,0x3ec4bf35,0xbf6dbf35,0xbec43f35,0x3f6d3f35,0xbf553ec4,0xbe483f6d,0x3f0e3f6d,0x3f7b3ec4
.long 0x3f808000,0x3f808000,0x3f808000,0x3f808000,0xbf55bec4,0xbe48bf6d,0x3f0ebf6d,0x3f7bbec4,0x3ec43f35,0xbf6d3f35,0xbec4bf35,0x3f6dbf35,0x3e48bf6d,0x3f0e3ec4,0xbf7b3ec4,0x3f55bf6d
.long 0xbf353f80,0x3f35bf80,0xbf353f80,0x3f35bf80,0x3f7bbf6d,0xbf553ec4,0x3e483ec4,0x3f0ebf6d,0xbf6d3f35,0xbec43f35,0x3f6dbf35,0x3ec4bf35,0x3f0ebec4,0x3f7bbf6d,0x3f55bf6d,0x3e48bec4
.long 0x80008000,0x80008000,0x80008000,0x80008000,0xbf0e3ec4,0xbf7b3f6d,0xbf553f6d,0xbe483ec4,0x3f6dbf35,0x3ec4bf35,0xbf6d3f35,0xbec43f35,0xbf7b3f6d,0x3f55bec4,0xbe48bec4,0xbf0e3f6d
.long 0x3f35bf80,0xbf353f80,0x3f35bf80,0xbf353f80,0xbe483f6d,0xbf0ebec4,0x3f7bbec4,0xbf553f6d,0xbec4bf35,0x3f6dbf35,0x3ec43f35,0xbf6d3f35,0x3f553ec4,0x3e483f6d,0xbf0e3f6d,0xbf7b3ec4
.long 0xbf808000,0xbf808000,0xbf808000,0xbf808000,0x3f55bec4,0x3e48bf6d,0xbf0ebf6d,0xbf7bbec4,0xbec43f35,0x3f6d3f35,0x3ec4bf35,0xbf6dbf35,0xbe48bf6d,0xbf0e3ec4,0x3f7b3ec4,0xbf55bf6d
.long 0x3f353f80,0xbf35bf80,0x3f353f80,0xbf35bf80,0xbf7bbf6d,0x3f553ec4,0xbe483ec4,0xbf0ebf6d,0x3f6d3f35,0x3ec43f35,0xbf6dbf35,0xbec4bf35,0xbf0ebec4,0xbf7bbf6d,0xbf55bf6d,0xbe48bec4
.long 0x0,0x0,0x0,0x0,0x3e480000,0x3f553f35,0x3f7b3f80,0x3f0e3f35,0x3ec40000,0x3f6d3f80,0xbec40000,0xbf6dbf80,0x3f0e0000,0x3e483f35,0xbf55bf80,0x3f7b3f35
.long 0x3f350000,0xbf350000,0x3f350000,0xbf350000,0x3f550000,0xbf7bbf35,0x3f0e3f80,0x3e48bf35,0x3f6d0000,0xbec4bf80,0xbf6d0000,0x3ec43f80,0x3f7b0000,0x3f0ebf35,0xbe48bf80,0xbf55bf35
.long 0x3f800000,0x3f800000,0x3f800000,0x3f800000,0x3f7b0000,0x3f0e3f35,0xbe483f80,0xbf553f35,0x3f6d0000,0xbec43f80,0xbf6d0000,0x3ec4bf80,0x3f550000,0xbf7b3f35,0x3f0ebf80,0x3e483f35
.long 0x3f350000,0xbf350000,0x3f350000,0xbf350000,0x3f0e0000,0x3e48bf35,0xbf553f80,0x3f7bbf35,0x3ec40000,0x3f6dbf80,0xbec40000,0xbf6d3f80,0x3e480000,0x3f55bf35,0x3f7bbf80,0x3f0ebf35
.long 0x0,0x0,0x0,0x0,0xbe480000,0xbf553f35,0xbf7b3f80,0xbf0e3f35,0xbec40000,0xbf6d3f80,0x3ec40000,0x3f6dbf80,0xbf0e0000,0xbe483f35,0x3f55bf80,0xbf7b3f35
.long 0xbf350000,0x3f350000,0xbf350000,0x3f350000,0xbf550000,0x3f7bbf35,0xbf0e3f80,0xbe48bf35,0xbf6d0000,0x3ec4bf80,0x3f6d0000,0xbec43f80,0xbf7b0000,0xbf0ebf35,0x3e48bf80,0x3f55bf35
.long 0xbf800000,0xbf800000,0xbf800000,0xbf800000,0xbf7b0000,0xbf0e3f35,0x3e483f80,0x3f553f35,0xbf6d0000,0x3ec43f80,0x3f6d0000,0xbec4bf80,0xbf550000,0x3f7b3f35,0xbf0ebf80,0xbe483f35
.long 0xbf350000,0x3f350000,0xbf350000,0x3f350000,0xbf0e0000,0xbe48bf35,0x3f553f80,0xbf7bbf35,0xbec40000,0xbf6dbf80,0x3ec40000,0x3f6d3f80,0xbe480000,0xbf55bf35,0xbf7bbf80,0xbf0ebf35
.long 0x0,0x0,0x0,0x0,0x3f0e3ec4,0x3f7b3f6d,0x3f553f6d,0x3e483ec4,0x3f6d3f35,0x3ec43f35,0xbf6dbf35,0xbec4bf35,0x3f7b3f6d,0xbf55bec4,0x3e48bec4,0x3f0e3f6d
.long 0x3f353f80,0xbf35bf80,0x3f353f80,0xbf35bf80,0x3e483f6d,0x3f0ebec4,0xbf7bbec4,0x3f553f6d,0xbec43f35,0x3f6d3f35,0x3ec4bf35,0xbf6dbf35,0xbf553ec4,0xbe483f6d,0x3f0e3f6d,0x3f7b3ec4
.long 0xbf800000,0xbf800000,0xbf800000,0xbf800000,0xbf55bec4,0xbe48bf6d,0x3f0ebf6d,0x3f7bbec4,0xbec4bf35,0x3f6dbf35,0x3ec43f35,0xbf6d3f35,0x3e48bf6d,0x3f0e3ec4,0xbf7b3ec4,0x3f55bf6d
.long 0x3f35bf80,0xbf353f80,0x3f35bf80,0xbf353f80,0x3f7bbf6d,0xbf553ec4,0x3e483ec4,0x3f0ebf6d,0x3f6dbf35,0x3ec4bf35,0xbf6d3f35,0xbec43f35,0x3f0ebec4,0x3f7bbf6d,0x3f55bf6d,0x3e48bec4
.long 0x0,0x0,0x0,0x0,0xbf0e3ec4,0xbf7b3f6d,0xbf553f6d,0xbe483ec4,0xbf6d3f35,0xbec43f35,0x3f6dbf35,0x3ec4bf35,0xbf7b3f6d,0x3f55bec4,0xbe48bec4,0xbf0e3f6d
.long 0xbf353f80,0x3f35bf80,0xbf353f80,0x3f35bf80,0xbe483f6d,0xbf0ebec4,0x3f7bbec4,0xbf553f6d,0x3ec43f35,0xbf6d3f35,0xbec4bf35,0x3f6dbf35,0x3f553ec4,0x3e483f6d,0xbf0e3f6d,0xbf7b3ec4
.long 0x3f800000,0x3f800000,0x3f800000,0x3f800000,0x3f55bec4,0x3e48bf6d,0xbf0ebf6d,0xbf7bbec4,0x3ec4bf35,0xbf6dbf35,0xbec43f35,0x3f6d3f35,0xbe48bf6d,0xbf0e3ec4,0x3f7b3ec4,0xbf55bf6d
.long 0xbf35bf80,0x3f353f80,0xbf35bf80,0x3f353f80,0xbf7bbf6d,0x3f553ec4,0xbe483ec4,0xbf0ebf6d,0xbf6dbf35,0xbec4bf35,0x3f6d3f35,0x3ec43f35,0xbf0ebec4,0xbf7bbf6d,0xbf55bf6d,0xbe48bec4
.long 0x0,0x0,0x0,0x0,0xbe480000,0xbf55bf35,0xbf7bbf80,0xbf0ebf35,0x3ec40000,0x3f6d3f80,0xbec40000,0xbf6dbf80,0xbf0e0000,0xbe48bf35,0x3f553f80,0xbf7bbf35
.long 0x3f350000,0xbf350000,0x3f350000,0xbf350000,0xbf550000,0x3f7b3f35,0xbf0ebf80,0xbe483f35,0x3f6d0000,0xbec4bf80,0xbf6d0000,0x3ec43f80,0xbf7b0000,0xbf0e3f35,0x3e483f80,0x3f553f35
.long 0x3f800000,0x3f800000,0x3f800000,0x3f800000,0xbf7b0000,0xbf0ebf35,0x3e48bf80,0x3f55bf35,0x3f6d0000,0xbec43f80,0xbf6d0000,0x3ec4bf80,0xbf550000,0x3f7bbf35,0xbf0e3f80,0xbe48bf35
.long 0x3f350000,0xbf350000,0x3f350000,0xbf350000,0xbf0e0000,0xbe483f35,0x3f55bf80,0xbf7b3f35,0x3ec40000,0x3f6dbf80,0xbec40000,0xbf6d3f80,0xbe480000,0xbf553f35,0xbf7b3f80,0xbf0e3f35
.long 0x0,0x0,0x0,0x0,0x3e480000,0x3f55bf35,0x3f7bbf80,0x3f0ebf35,0xbec40000,0xbf6d3f80,0x3ec40000,0x3f6dbf80,0x3f0e0000,0x3e48bf35,0xbf553f80,0x3f7bbf35
.long 0xbf350000,0x3f350000,0xbf350000,0x3f350000,0x3f550000,0xbf7b3f35,0x3f0ebf80,0x3e483f35,0xbf6d0000,0x3ec4bf80,0x3f6d0000,0xbec43f80,0x3f7b0000,0x3f0e3f35,0xbe483f80,0xbf553f35
.long 0xbf800000,0xbf800000,0xbf800000,0xbf800000,0x3f7b0000,0x3f0ebf35,0xbe48bf80,0xbf55bf35,0xbf6d0000,0x3ec43f80,0x3f6d0000,0xbec4bf80,0x3f550000,0xbf7bbf35,0x3f0e3f80,0x3e48bf35
.long 0xbf350000,0x3f350000,0xbf350000,0x3f350000,0x3f0e0000,0x3e483f35,0xbf55bf80,0x3f7b3f35,0xbec40000,0xbf6dbf80,0x3ec40000,0x3f6d3f80,0x3e480000,0x3f553f35,0x3f7b3f80,0x3f0e3f35
.long 0x0,0x0,0x0,0x0,0xbf0ebec4,0xbf7bbf6d,0xbf55bf6d,0xbe48bec4,0x3f6d3f35,0x3ec43f35,0xbf6dbf35,0xbec4bf35,0xbf7bbf6d,0x3f553ec4,0xbe483ec4,0xbf0ebf6d
.long 0x3f353f80,0xbf35bf80,0x3f353f80,0xbf35bf80,0xbe48bf6d,0xbf0e3ec4,0x3f7b3ec4,0xbf55bf6d,0xbec43f35,0x3f6d3f35,0x3ec4bf35,0xbf6dbf35,0x3f55bec4,0x3e48bf6d,0xbf0ebf6d,0xbf7bbec4
.long 0xbf800000,0xbf800000,0xbf800000,0xbf800000,0x3f553ec4,0x3e483f6d,0xbf0e3f6d,0xbf7b3ec4,0xbec4bf35,0x3f6dbf35,0x3ec43f35,0xbf6d3f35,0xbe483f6d,0xbf0ebec4,0x3f7bbec4,0xbf553f6d
.long 0x3f35bf80,0xbf353f80,0x3f35bf80,0xbf353f80,0xbf7b3f6d,0x3f55bec4,0xbe48bec4,0xbf0e3f6d,0x3f6dbf35,0x3ec4bf35,0xbf6d3f35,0xbec43f35,0xbf0e3ec4,0xbf7b3f6d,0xbf553f6d,0xbe483ec4
.long 0x0,0x0,0x0,0x0,0x3f0ebec4,0x3f7bbf6d,0x3f55bf6d,0x3e48bec4,0xbf6d3f35,0xbec43f35,0x3f6dbf35,0x3ec4bf35,0x3f7bbf6d,0xbf553ec4,0x3e483ec4,0x3f0ebf6d
.long 0xbf353f80,0x3f35bf80,0xbf353f80,0x3f35bf80,0x3e48bf6d,0x3f0e3ec4,0xbf7b3ec4,0x3f55bf6d,0x3ec43f35,0xbf6d3f35,0xbec4bf35,0x3f6dbf35,0xbf55bec4,0xbe48bf6d,0x3f0ebf6d,0x3f7bbec4
.long 0x3f800000,0x3f800000,0x3f800000,0x3f800000,0xbf553ec4,0xbe483f6d,0x3f0e3f6d,0x3f7b3ec4,0x3ec4bf35,0xbf6dbf35,0xbec43f35,0x3f6d3f35,0x3e483f6d,0x3f0ebec4,0xbf7bbec4,0x3f553f6d
.long 0xbf35bf80,0x3f353f80,0xbf35bf80,0x3f353f80,0x3f7b3f6d,0xbf55bec4,0x3e48bec4,0x3f0e3f6d,0xbf6dbf35,0xbec4bf35,0x3f6d3f35,0x3ec43f35,0x3f0e3ec4,0x3f7b3f6d,0x3f553f6d,0x3e483ec4
.long 0x3f803f80,0x3f803f80,0x3f803f80,0x3f803f80,0x3f753f7f,0x3ef13f22,0xbe95bdc9,0xbf62bf46,0x3f553f7b,0xbf0ebe48,0xbf55bf7b,0x3f0e3e48,0x3f223f75,0xbf7fbf62,0x3f463e95,0xbdc93ef1
.long 0x3ec43f6d,0xbec4bf6d,0x3ec43f6d,0xbec4bf6d,0x3dc93f62,0x3f22be95,0xbf7fbef1,0x3f463f75,0xbe483f55,0x3f7b3f0e,0x3e48bf55,0xbf7bbf0e,0xbef13f46,0x3e953f7f,0x3f623f22,0x3f75bdc9
.long 0xbf353f35,0xbf353f35,0xbf353f35,0xbf353f35,0xbf623f22,0xbf75bdc9,0xbef1bf46,0x3e95bf7f,0xbf7b3f0e,0xbe48bf55,0x3f7bbf0e,0x3e483f55,0xbf7f3ef1,0x3f46bf75,0xbdc93f62,0xbf22be95
.long 0xbf6d3ec4,0x3f6dbec4,0xbf6d3ec4,0x3f6dbec4,0xbf463e95,0x3dc93ef1,0x3f22bf75,0xbf7f3f62,0xbf0e3e48,0xbf553f7b,0x3f0ebe48,0x3f55bf7b,0xbe953dc9,0xbf623f46,0xbf753f7f,0xbef13f22
.long 0x0,0x0,0x0,0x0,0x3e95bdc9,0x3f62bf46,0x3f75bf7f,0x3ef1bf22,0x3f0ebe48,0x3f55bf7b,0xbf0e3e48,0xbf553f7b,0x3f46be95,0xbdc9bef1,0xbf223f75,0x3f7fbf62
.long 0x3f6dbec4,0xbf6d3ec4,0x3f6dbec4,0xbf6d3ec4,0x3f7fbef1,0xbf463f75,0x3dc9bf62,0x3f223e95,0x3f7bbf0e,0x3e483f55,0xbf7b3f0e,0xbe48bf55,0x3f62bf22,0x3f753dc9,0x3ef13f46,0xbe953f7f
.long 0x3f35bf35,0x3f35bf35,0x3f35bf35,0x3f35bf35,0x3ef1bf46,0xbe95bf7f,0xbf62bf22,0xbf753dc9,0x3e48bf55,0xbf7bbf0e,0xbe483f55,0x3f7b3f0e,0xbdc9bf62,0xbf223e95,0x3f7f3ef1,0xbf46bf75
.long 0xbec4bf6d,0x3ec43f6d,0xbec4bf6d,0x3ec43f6d,0xbf22bf75,0x3f7f3f62,0xbf46be95,0x3dc9bef1,0xbf55bf7b,0x3f0e3e48,0x3f553f7b,0xbf0ebe48,0xbf75bf7f,0xbef1bf22,0x3e953dc9,0x3f623f46
.long 0x3f803f80,0x3f803f80,0x3f803f80,0x3f803f80,0x3f463f62,0x3dc93e95,0xbf22bef1,0xbf7fbf75,0x3e483f0e,0xbf7bbf55,0xbe48bf0e,0x3f7b3f55,0xbef13dc9,0xbe95bf46,0x3f623f7f,0xbf75bf22
.long 0xbf6dbec4,0x3f6d3ec4,0xbf6dbec4,0x3f6d3ec4,0xbf75bf46,0x3ef13f7f,0x3e95bf22,0xbf62bdc9,0xbf0ebf7b,0xbf553e48,0x3f0e3f7b,0x3f55be48,0x3dc9bf75,0xbf22bf62,0xbf7fbe95,0xbf463ef1
.long 0x3f35bf35,0x3f35bf35,0x3f35bf35,0x3f35bf35,0x3f7fbe95,0x3f463ef1,0x3dc93f75,0xbf223f62,0x3f553e48,0xbf0e3f7b,0xbf55be48,0x3f0ebf7b,0x3e953f22,0xbf623dc9,0x3f75bf46,0xbef13f7f
.long 0xbec43f6d,0x3ec4bf6d,0xbec43f6d,0x3ec4bf6d,0xbf623f7f,0x3f75bf22,0xbef1bdc9,0xbe953f46,0xbf7b3f55,0xbe483f0e,0x3f7bbf55,0x3e48bf0e,0xbf223ef1,0xbf7f3f75,0xbf463f62,0xbdc93e95
.long 0x0,0x0,0x0,0x0,0x3f22bef1,0x3f7fbf75,0x3f46bf62,0x3dc9be95,0x3f7bbf55,0x3e48bf0e,0xbf7b3f55,0xbe483f0e,0x3f62bf7f,0xbf753f22,0x3ef13dc9,0x3e95bf46
.long 0x3ec4bf6d,0xbec43f6d,0x3ec4bf6d,0xbec43f6d,0xbe95bf22,0x3f62bdc9,0xbf753f46,0x3ef1bf7f,0xbf55be48,0x3f0ebf7b,0x3f553e48,0xbf0e3f7b,0xbf7f3e95,0xbf46bef1,0xbdc9bf75,0x3f22bf62
.long 0xbf353f35,0xbf353f35,0xbf353f35,0xbf353f35,0xbdc93f75,0x3f223f62,0x3f7f3e95,0x3f46bef1,0x3f0e3f7b,0x3f55be48,0xbf0ebf7b,0xbf553e48,0x3f753f46,0xbef1bf7f,0xbe953f22,0x3f623dc9
.long 0x3f6d3ec4,0xbf6dbec4,0x3f6d3ec4,0xbf6dbec4,0x3ef1bdc9,0x3e953f46,0xbf62bf7f,0x3f753f22,0xbe48bf0e,0x3f7b3f55,0x3e483f0e,0xbf7bbf55,0xbf46bf62,0xbdc9be95,0x3f223ef1,0x3f7f3f75
.long 0x3f803f80,0x3f803f80,0x3f803f80,0x3f803f80,0xbf75bf7f,0xbef1bf22,0x3e953dc9,0x3f623f46,0x3f553f7b,0xbf0ebe48,0xbf55bf7b,0x3f0e3e48,0xbf22bf75,0x3f7f3f62,0xbf46be95,0x3dc9bef1
.long 0x3ec43f6d,0xbec4bf6d,0x3ec43f6d,0xbec4bf6d,0xbdc9bf62,0xbf223e95,0x3f7f3ef1,0xbf46bf75,0xbe483f55,0x3f7b3f0e,0x3e48bf55,0xbf7bbf0e,0x3ef1bf46,0xbe95bf7f,0xbf62bf22,0xbf753dc9
.long 0xbf353f35,0xbf353f35,0xbf353f35,0xbf353f35,0x3f62bf22,0x3f753dc9,0x3ef13f46,0xbe953f7f,0xbf7b3f0e,0xbe48bf55,0x3f7bbf0e,0x3e483f55,0x3f7fbef1,0xbf463f75,0x3dc9bf62,0x3f223e95
.long 0xbf6d3ec4,0x3f6dbec4,0xbf6d3ec4,0x3f6dbec4,0x3f46be95,0xbdc9bef1,0xbf223f75,0x3f7fbf62,0xbf0e3e48,0xbf553f7b,0x3f0ebe48,0x3f55bf7b,0x3e95bdc9,0x3f62bf46,0x3f75bf7f,0x3ef1bf22
.long 0x0,0x0,0x0,0x0,0xbe953dc9,0xbf623f46,0xbf753f7f,0xbef13f22,0x3f0ebe48,0x3f55bf7b,0xbf0e3e48,0xbf553f7b,0xbf463e95,0x3dc93ef1,0x3f22bf75,0xbf7f3f62
.long 0x3f6dbec4,0xbf6d3ec4,0x3f6dbec4,0xbf6d3ec4,0xbf7f3ef1,0x3f46bf75,0xbdc93f62,0xbf22be95,0x3f7bbf0e,0x3e483f55,0xbf7b3f0e,0xbe48bf55,0xbf623f22,0xbf75bdc9,0xbef1bf46,0x3e95bf7f
.long 0x3f35bf35,0x3f35bf35,0x3f35bf35,0x3f35bf35,0xbef13f46,0x3e953f7f,0x3f623f22,0x3f75bdc9,0x3e48bf55,0xbf7bbf0e,0xbe483f55,0x3f7b3f0e,0x3dc93f62,0x3f22be95,0xbf7fbef1,0x3f463f75
.long 0xbec4bf6d,0x3ec43f6d,0xbec4bf6d,0x3ec43f6d,0x3f223f75,0xbf7fbf62,0x3f463e95,0xbdc93ef1,0xbf55bf7b,0x3f0e3e48,0x3f553f7b,0xbf0ebe48,0x3f753f7f,0x3ef13f22,0xbe95bdc9,0xbf62bf46
.long 0x3f803f80,0x3f803f80,0x3f803f80,0x3f803f80,0xbf46bf62,0xbdc9be95,0x3f223ef1,0x3f7f3f75,0x3e483f0e,0xbf7bbf55,0xbe48bf0e,0x3f7b3f55,0x3ef1bdc9,0x3e953f46,0xbf62bf7f,0x3f753f22
.long 0xbf6dbec4,0x3f6d3ec4,0xbf6dbec4,0x3f6d3ec4,0x3f753f46,0xbef1bf7f,0xbe953f22,0x3f623dc9,0xbf0ebf7b,0xbf553e48,0x3f0e3f7b,0x3f55be48,0xbdc93f75,0x3f223f62,0x3f7f3e95,0x3f46bef1
.long 0x3f35bf35,0x3f35bf35,0x3f35bf35,0x3f35bf35,0xbf7f3e95,0xbf46bef1,0xbdc9bf75,0x3f22bf62,0x3f553e48,0xbf0e3f7b,0xbf55be48,0x3f0ebf7b,0xbe95bf22,0x3f62bdc9,0xbf753f46,0x3ef1bf7f
.long 0xbec43f6d,0x3ec4bf6d,0xbec43f6d,0x3ec4bf6d,0x3f62bf7f,0xbf753f22,0x3ef13dc9,0x3e95bf46,0xbf7b3f55,0xbe483f0e,0x3f7bbf55,0x3e48bf0e,0x3f22bef1,0x3f7fbf75,0x3f46bf62,0x3dc9be95
.long 0x0,0x0,0x0,0x0,0xbf223ef1,0xbf7f3f75,0xbf463f62,0xbdc93e95,0x3f7bbf55,0x3e48bf0e,0xbf7b3f55,0xbe483f0e,0xbf623f7f,0x3f75bf22,0xbef1bdc9,0xbe953f46
.long 0x3ec4bf6d,0xbec43f6d,0x3ec4bf6d,0xbec43f6d,0x3e953f22,0xbf623dc9,0x3f75bf46,0xbef13f7f,0xbf55be48,0x3f0ebf7b,0x3f553e48,0xbf0e3f7b,0x3f7fbe95,0x3f463ef1,0x3dc93f75,0xbf223f62
.long 0xbf353f35,0xbf353f35,0xbf353f35,0xbf353f35,0x3dc9bf75,0xbf22bf62,0xbf7fbe95,0xbf463ef1,0x3f0e3f7b,0x3f55be48,0xbf0ebf7b,0xbf553e48,0xbf75bf46,0x3ef13f7f,0x3e95bf22,0xbf62bdc9
.long 0x3f6d3ec4,0xbf6dbec4,0x3f6d3ec4,0xbf6dbec4,0xbef13dc9,0xbe95bf46,0x3f623f7f,0xbf75bf22,0xbe48bf0e,0x3f7b3f55,0x3e483f0e,0xbf7bbf55,0x3f463f62,0x3dc93e95,0xbf22bef1,0xbf7fbf75
.long 0x80008000,0x80008000,0x80008000,0x80008000,0xbe95bdc9,0xbf62bf46,0xbf75bf7f,0xbef1bf22,0xbf0ebe48,0xbf55bf7b,0x3f0e3e48,0x3f553f7b,0xbf46be95,0x3dc9bef1,0x3f223f75,0xbf7fbf62
.long 0xbf6dbec4,0x3f6d3ec4,0xbf6dbec4,0x3f6d3ec4,0xbf7fbef1,0x3f463f75,0xbdc9bf62,0xbf223e95,0xbf7bbf0e,0xbe483f55,0x3f7b3f0e,0x3e48bf55,0xbf62bf22,0xbf753dc9,0xbef13f46,0x3e953f7f
.long 0xbf35bf35,0xbf35bf35,0xbf35bf35,0xbf35bf35,0xbef1bf46,0x3e95bf7f,0x3f62bf22,0x3f753dc9,0xbe48bf55,0x3f7bbf0e,0x3e483f55,0xbf7b3f0e,0x3dc9bf62,0x3f223e95,0xbf7f3ef1,0x3f46bf75
.long 0x3ec4bf6d,0xbec43f6d,0x3ec4bf6d,0xbec43f6d,0x3f22bf75,0xbf7f3f62,0x3f46be95,0xbdc9bef1,0x3f55bf7b,0xbf0e3e48,0xbf553f7b,0x3f0ebe48,0x3f75bf7f,0x3ef1bf22,0xbe953dc9,0xbf623f46
.long 0x3f80bf80,0x3f80bf80,0x3f80bf80,0x3f80bf80,0x3f75bf7f,0x3ef1bf22,0xbe953dc9,0xbf623f46,0x3f55bf7b,0xbf0e3e48,0xbf553f7b,0x3f0ebe48,0x3f22bf75,0xbf7f3f62,0x3f46be95,0xbdc9bef1
.long 0x3ec4bf6d,0xbec43f6d,0x3ec4bf6d,0xbec43f6d,0x3dc9bf62,0x3f223e95,0xbf7f3ef1,0x3f46bf75,0xbe48bf55,0x3f7bbf0e,0x3e483f55,0xbf7b3f0e,0xbef1bf46,0x3e95bf7f,0x3f62bf22,0x3f753dc9
.long 0xbf35bf35,0xbf35bf35,0xbf35bf35,0xbf35bf35,0xbf62bf22,0xbf753dc9,0xbef13f46,0x3e953f7f,0xbf7bbf0e,0xbe483f55,0x3f7b3f0e,0x3e48bf55,0xbf7fbef1,0x3f463f75,0xbdc9bf62,0xbf223e95
.long 0xbf6dbec4,0x3f6d3ec4,0xbf6dbec4,0x3f6d3ec4,0xbf46be95,0x3dc9bef1,0x3f223f75,0xbf7fbf62,0xbf0ebe48,0xbf55bf7b,0x3f0e3e48,0x3f553f7b,0xbe95bdc9,0xbf62bf46,0xbf75bf7f,0xbef1bf22
.long 0x80008000,0x80008000,0x80008000,0x80008000,0xbf22bef1,0xbf7fbf75,0xbf46bf62,0xbdc9be95,0xbf7bbf55,0xbe48bf0e,0x3f7b3f55,0x3e483f0e,0xbf62bf7f,0x3f753f22,0xbef13dc9,0xbe95bf46
.long 0xbec4bf6d,0x3ec43f6d,0xbec4bf6d,0x3ec43f6d,0x3e95bf22,0xbf62bdc9,0x3f753f46,0xbef1bf7f,0x3f55be48,0xbf0ebf7b,0xbf553e48,0x3f0e3f7b,0x3f7f3e95,0x3f46bef1,0x3dc9bf75,0xbf22bf62
.long 0x3f353f35,0x3f353f35,0x3f353f35,0x3f353f35,0x3dc93f75,0xbf223f62,0xbf7f3e95,0xbf46bef1,0xbf0e3f7b,0xbf55be48,0x3f0ebf7b,0x3f553e48,0xbf753f46,0x3ef1bf7f,0x3e953f22,0xbf623dc9
.long 0xbf6d3ec4,0x3f6dbec4,0xbf6d3ec4,0x3f6dbec4,0xbef1bdc9,0xbe953f46,0x3f62bf7f,0xbf753f22,0x3e48bf0e,0xbf7b3f55,0xbe483f0e,0x3f7bbf55,0x3f46bf62,0x3dc9be95,0xbf223ef1,0xbf7f3f75
.long 0x3f80bf80,0x3f80bf80,0x3f80bf80,0x3f80bf80,0x3f46bf62,0x3dc9be95,0xbf223ef1,0xbf7f3f75,0x3e48bf0e,0xbf7b3f55,0xbe483f0e,0x3f7bbf55,0xbef1bdc9,0xbe953f46,0x3f62bf7f,0xbf753f22
.long 0xbf6d3ec4,0x3f6dbec4,0xbf6d3ec4,0x3f6dbec4,0xbf753f46,0x3ef1bf7f,0x3e953f22,0xbf623dc9,0xbf0e3f7b,0xbf55be48,0x3f0ebf7b,0x3f553e48,0x3dc93f75,0xbf223f62,0xbf7f3e95,0xbf46bef1
.long 0x3f353f35,0x3f353f35,0x3f353f35,0x3f353f35,0x3f7f3e95,0x3f46bef1,0x3dc9bf75,0xbf22bf62,0x3f55be48,0xbf0ebf7b,0xbf553e48,0x3f0e3f7b,0x3e95bf22,0xbf62bdc9,0x3f753f46,0xbef1bf7f
.long 0xbec4bf6d,0x3ec43f6d,0xbec4bf6d,0x3ec43f6d,0xbf62bf7f,0x3f753f22,0xbef13dc9,0xbe95bf46,0xbf7bbf55,0xbe48bf0e,0x3f7b3f55,0x3e483f0e,0xbf22bef1,0xbf7fbf75,0xbf46bf62,0xbdc9be95
.long 0x80008000,0x80008000,0x80008000,0x80008000,0x3e953dc9,0x3f623f46,0x3f753f7f,0x3ef13f22,0xbf0ebe48,0xbf55bf7b,0x3f0e3e48,0x3f553f7b,0x3f463e95,0xbdc93ef1,0xbf22bf75,0x3f7f3f62
.long 0xbf6dbec4,0x3f6d3ec4,0xbf6dbec4,0x3f6d3ec4,0x3f7f3ef1,0xbf46bf75,0x3dc93f62,0x3f22be95,0xbf7bbf0e,0xbe483f55,0x3f7b3f0e,0x3e48bf55,0x3f623f22,0x3f75bdc9,0x3ef1bf46,0xbe95bf7f
.long 0xbf35bf35,0xbf35bf35,0xbf35bf35,0xbf35bf35,0x3ef13f46,0xbe953f7f,0xbf623f22,0xbf75bdc9,0xbe48bf55,0x3f7bbf0e,0x3e483f55,0xbf7b3f0e,0xbdc93f62,0xbf22be95,0x3f7fbef1,0xbf463f75
.long 0x3ec4bf6d,0xbec43f6d,0x3ec4bf6d,0xbec43f6d,0xbf223f75,0x3f7fbf62,0xbf463e95,0x3dc93ef1,0x3f55bf7b,0xbf0e3e48,0xbf553f7b,0x3f0ebe48,0xbf753f7f,0xbef13f22,0x3e95bdc9,0x3f62bf46
.long 0x3f80bf80,0x3f80bf80,0x3f80bf80,0x3f80bf80,0xbf753f7f,0xbef13f22,0x3e95bdc9,0x3f62bf46,0x3f55bf7b,0xbf0e3e48,0xbf553f7b,0x3f0ebe48,0xbf223f75,0x3f7fbf62,0xbf463e95,0x3dc93ef1
.long 0x3ec4bf6d,0xbec43f6d,0x3ec4bf6d,0xbec43f6d,0xbdc93f62,0xbf22be95,0x3f7fbef1,0xbf463f75,0xbe48bf55,0x3f7bbf0e,0x3e483f55,0xbf7b3f0e,0x3ef13f46,0xbe953f7f,0xbf623f22,0xbf75bdc9
.long 0xbf35bf35,0xbf35bf35,0xbf35bf35,0xbf35bf35,0x3f623f22,0x3f75bdc9,0x3ef1bf46,0xbe95bf7f,0xbf7bbf0e,0xbe483f55,0x3f7b3f0e,0x3e48bf55,0x3f7f3ef1,0xbf46bf75,0x3dc93f62,0x3f22be95
.long 0xbf6dbec4,0x3f6d3ec4,0xbf6dbec4,0x3f6d3ec4,0x3f463e95,0xbdc93ef1,0xbf22bf75,0x3f7f3f62,0xbf0ebe48,0xbf55bf7b,0x3f0e3e48,0x3f553f7b,0x3e953dc9,0x3f623f46,0x3f753f7f,0x3ef13f22
.long 0x80008000,0x80008000,0x80008000,0x80008000,0x3f223ef1,0x3f7f3f75,0x3f463f62,0x3dc93e95,0xbf7bbf55,0xbe48bf0e,0x3f7b3f55,0x3e483f0e,0x3f623f7f,0xbf75bf22,0x3ef1bdc9,0x3e953f46
.long 0xbec4bf6d,0x3ec43f6d,0xbec4bf6d,0x3ec43f6d,0xbe953f22,0x3f623dc9,0xbf75bf46,0x3ef13f7f,0x3f55be48,0xbf0ebf7b,0xbf553e48,0x3f0e3f7b,0xbf7fbe95,0xbf463ef1,0xbdc93f75,0x3f223f62
.long 0x3f353f35,0x3f353f35,0x3f353f35,0x3f353f35,0xbdc9bf75,0x3f22bf62,0x3f7fbe95,0x3f463ef1,0xbf0e3f7b,0xbf55be48,0x3f0ebf7b,0x3f553e48,0x3f75bf46,0xbef13f7f,0xbe95bf22,0x3f62bdc9
.long 0xbf6d3ec4,0x3f6dbec4,0xbf6d3ec4,0x3f6dbec4,0x3ef13dc9,0x3e95bf46,0xbf623f7f,0x3f75bf22,0x3e48bf0e,0xbf7b3f55,0xbe483f0e,0x3f7bbf55,0xbf463f62,0xbdc93e95,0x3f22bef1,0x3f7fbf75
.long 0x3f80bf80,0x3f80bf80,0x3f80bf80,0x3f80bf80,0xbf463f62,0xbdc93e95,0x3f22bef1,0x3f7fbf75,0x3e48bf0e,0xbf7b3f55,0xbe483f0e,0x3f7bbf55,0x3ef13dc9,0x3e95bf46,0xbf623f7f,0x3f75bf22
.long 0xbf6d3ec4,0x3f6dbec4,0xbf6d3ec4,0x3f6dbec4,0x3f75bf46,0xbef13f7f,0xbe95bf22,0x3f62bdc9,0xbf0e3f7b,0xbf55be48,0x3f0ebf7b,0x3f553e48,0xbdc9bf75,0x3f22bf62,0x3f7fbe95,0x3f463ef1
.long 0x3f353f35,0x3f353f35,0x3f353f35,0x3f353f35,0xbf7fbe95,0xbf463ef1,0xbdc93f75,0x3f223f62,0x3f55be48,0xbf0ebf7b,0xbf553e48,0x3f0e3f7b,0xbe953f22,0x3f623dc9,0xbf75bf46,0x3ef13f7f
.long 0xbec4bf6d,0x3ec43f6d,0xbec4bf6d,0x3ec43f6d,0x3f623f7f,0xbf75bf22,0x3ef1bdc9,0x3e953f46,0xbf7bbf55,0xbe48bf0e,0x3f7b3f55,0x3e483f0e,0x3f223ef1,0x3f7f3f75,0x3f463f62,0x3dc93e95
.long 0x0,0x0,0x0,0x0,0x3e953dc9,0x3f623f46,0x3f753f7f,0x3ef13f22,0x3f0e3e48,0x3f553f7b,0xbf0ebe48,0xbf55bf7b,0x3f463e95,0xbdc93ef1,0xbf22bf75,0x3f7f3f62
.long 0x3f6d3ec4,0xbf6dbec4,0x3f6d3ec4,0xbf6dbec4,0x3f7f3ef1,0xbf46bf75,0x3dc93f62,0x3f22be95,0x3f7b3f0e,0x3e48bf55,0xbf7bbf0e,0xbe483f55,0x3f623f22,0x3f75bdc9,0x3ef1bf46,0xbe95bf7f
.long 0x3f353f35,0x3f353f35,0x3f353f35,0x3f353f35,0x3ef13f46,0xbe953f7f,0xbf623f22,0xbf75bdc9,0x3e483f55,0xbf7b3f0e,0xbe48bf55,0x3f7bbf0e,0xbdc93f62,0xbf22be95,0x3f7fbef1,0xbf463f75
.long 0xbec43f6d,0x3ec4bf6d,0xbec43f6d,0x3ec4bf6d,0xbf223f75,0x3f7fbf62,0xbf463e95,0x3dc93ef1,0xbf553f7b,0x3f0ebe48,0x3f55bf7b,0xbf0e3e48,0xbf753f7f,0xbef13f22,0x3e95bdc9,0x3f62bf46
.long 0xbf803f80,0xbf803f80,0xbf803f80,0xbf803f80,0xbf753f7f,0xbef13f22,0x3e95bdc9,0x3f62bf46,0xbf553f7b,0x3f0ebe48,0x3f55bf7b,0xbf0e3e48,0xbf223f75,0x3f7fbf62,0xbf463e95,0x3dc93ef1
.long 0xbec43f6d,0x3ec4bf6d,0xbec43f6d,0x3ec4bf6d,0xbdc93f62,0xbf22be95,0x3f7fbef1,0xbf463f75,0x3e483f55,0xbf7b3f0e,0xbe48bf55,0x3f7bbf0e,0x3ef13f46,0xbe953f7f,0xbf623f22,0xbf75bdc9
.long 0x3f353f35,0x3f353f35,0x3f353f35,0x3f353f35,0x3f623f22,0x3f75bdc9,0x3ef1bf46,0xbe95bf7f,0x3f7b3f0e,0x3e48bf55,0xbf7bbf0e,0xbe483f55,0x3f7f3ef1,0xbf46bf75,0x3dc93f62,0x3f22be95
.long 0x3f6d3ec4,0xbf6dbec4,0x3f6d3ec4,0xbf6dbec4,0x3f463e95,0xbdc93ef1,0xbf22bf75,0x3f7f3f62,0x3f0e3e48,0x3f553f7b,0xbf0ebe48,0xbf55bf7b,0x3e953dc9,0x3f623f46,0x3f753f7f,0x3ef13f22
.long 0x0,0x0,0x0,0x0,0x3f223ef1,0x3f7f3f75,0x3f463f62,0x3dc93e95,0x3f7b3f55,0x3e483f0e,0xbf7bbf55,0xbe48bf0e,0x3f623f7f,0xbf75bf22,0x3ef1bdc9,0x3e953f46
.long 0x3ec43f6d,0xbec4bf6d,0x3ec43f6d,0xbec4bf6d,0xbe953f22,0x3f623dc9,0xbf75bf46,0x3ef13f7f,0xbf553e48,0x3f0e3f7b,0x3f55be48,0xbf0ebf7b,0xbf7fbe95,0xbf463ef1,0xbdc93f75,0x3f223f62
.long 0xbf35bf35,0xbf35bf35,0xbf35bf35,0xbf35bf35,0xbdc9bf75,0x3f22bf62,0x3f7fbe95,0x3f463ef1,0x3f0ebf7b,0x3f553e48,0xbf0e3f7b,0xbf55be48,0x3f75bf46,0xbef13f7f,0xbe95bf22,0x3f62bdc9
.long 0x3f6dbec4,0xbf6d3ec4,0x3f6dbec4,0xbf6d3ec4,0x3ef13dc9,0x3e95bf46,0xbf623f7f,0x3f75bf22,0xbe483f0e,0x3f7bbf55,0x3e48bf0e,0xbf7b3f55,0xbf463f62,0xbdc93e95,0x3f22bef1,0x3f7fbf75
.long 0xbf803f80,0xbf803f80,0xbf803f80,0xbf803f80,0xbf463f62,0xbdc93e95,0x3f22bef1,0x3f7fbf75,0xbe483f0e,0x3f7bbf55,0x3e48bf0e,0xbf7b3f55,0x3ef13dc9,0x3e95bf46,0xbf623f7f,0x3f75bf22
.long 0x3f6dbec4,0xbf6d3ec4,0x3f6dbec4,0xbf6d3ec4,0x3f75bf46,0xbef13f7f,0xbe95bf22,0x3f62bdc9,0x3f0ebf7b,0x3f553e48,0xbf0e3f7b,0xbf55be48,0xbdc9bf75,0x3f22bf62,0x3f7fbe95,0x3f463ef1
.long 0xbf35bf35,0xbf35bf35,0xbf35bf35,0xbf35bf35,0xbf7fbe95,0xbf463ef1,0xbdc93f75,0x3f223f62,0xbf553e48,0x3f0e3f7b,0x3f55be48,0xbf0ebf7b,0xbe953f22,0x3f623dc9,0xbf75bf46,0x3ef13f7f
.long 0x3ec43f6d,0xbec4bf6d,0x3ec43f6d,0xbec4bf6d,0x3f623f7f,0xbf75bf22,0x3ef1bdc9,0x3e953f46,0x3f7b3f55,0x3e483f0e,0xbf7bbf55,0xbe48bf0e,0x3f223ef1,0x3f7f3f75,0x3f463f62,0x3dc93e95
.long 0x0,0x0,0x0,0x0,0xbe95bdc9,0xbf62bf46,0xbf75bf7f,0xbef1bf22,0x3f0e3e48,0x3f553f7b,0xbf0ebe48,0xbf55bf7b,0xbf46be95,0x3dc9bef1,0x3f223f75,0xbf7fbf62
.long 0x3f6d3ec4,0xbf6dbec4,0x3f6d3ec4,0xbf6dbec4,0xbf7fbef1,0x3f463f75,0xbdc9bf62,0xbf223e95,0x3f7b3f0e,0x3e48bf55,0xbf7bbf0e,0xbe483f55,0xbf62bf22,0xbf753dc9,0xbef13f46,0x3e953f7f
.long 0x3f353f35,0x3f353f35,0x3f353f35,0x3f353f35,0xbef1bf46,0x3e95bf7f,0x3f62bf22,0x3f753dc9,0x3e483f55,0xbf7b3f0e,0xbe48bf55,0x3f7bbf0e,0x3dc9bf62,0x3f223e95,0xbf7f3ef1,0x3f46bf75
.long 0xbec43f6d,0x3ec4bf6d,0xbec43f6d,0x3ec4bf6d,0x3f22bf75,0xbf7f3f62,0x3f46be95,0xbdc9bef1,0xbf553f7b,0x3f0ebe48,0x3f55bf7b,0xbf0e3e48,0x3f75bf7f,0x3ef1bf22,0xbe953dc9,0xbf623f46
.long 0xbf803f80,0xbf803f80,0xbf803f80,0xbf803f80,0x3f75bf7f,0x3ef1bf22,0xbe953dc9,0xbf623f46,0xbf553f7b,0x3f0ebe48,0x3f55bf7b,0xbf0e3e48,0x3f22bf75,0xbf7f3f62,0x3f46be95,0xbdc9bef1
.long 0xbec43f6d,0x3ec4bf6d,0xbec43f6d,0x3ec4bf6d,0x3dc9bf62,0x3f223e95,0xbf7f3ef1,0x3f46bf75,0x3e483f55,0xbf7b3f0e,0xbe48bf55,0x3f7bbf0e,0xbef1bf46,0x3e95bf7f,0x3f62bf22,0x3f753dc9
.long 0x3f353f35,0x3f353f35,0x3f353f35,0x3f353f35,0xbf62bf22,0xbf753dc9,0xbef13f46,0x3e953f7f,0x3f7b3f0e,0x3e48bf55,0xbf7bbf0e,0xbe483f55,0xbf7fbef1,0x3f463f75,0xbdc9bf62,0xbf223e95
.long 0x3f6d3ec4,0xbf6dbec4,0x3f6d3ec4,0xbf6dbec4,0xbf46be95,0x3dc9bef1,0x3f223f75,0xbf7fbf62,0x3f0e3e48,0x3f553f7b,0xbf0ebe48,0xbf55bf7b,0xbe95bdc9,0xbf62bf46,0xbf75bf7f,0xbef1bf22
.long 0x0,0x0,0x0,0x0,0xbf22bef1,0xbf7fbf75,0xbf46bf62,0xbdc9be95,0x3f7b3f55,0x3e483f0e,0xbf7bbf55,0xbe48bf0e,0xbf62bf7f,0x3f753f22,0xbef13dc9,0xbe95bf46
.long 0x3ec43f6d,0xbec4bf6d,0x3ec43f6d,0xbec4bf6d,0x3e95bf22,0xbf62bdc9,0x3f753f46,0xbef1bf7f,0xbf553e48,0x3f0e3f7b,0x3f55be48,0xbf0ebf7b,0x3f7f3e95,0x3f46bef1,0x3dc9bf75,0xbf22bf62
.long 0xbf35bf35,0xbf35bf35,0xbf35bf35,0xbf35bf35,0x3dc93f75,0xbf223f62,0xbf7f3e95,0xbf46bef1,0x3f0ebf7b,0x3f553e48,0xbf0e3f7b,0xbf55be48,0xbf753f46,0x3ef1bf7f,0x3e953f22,0xbf623dc9
.long 0x3f6dbec4,0xbf6d3ec4,0x3f6dbec4,0xbf6d3ec4,0xbef1bdc9,0xbe953f46,0x3f62bf7f,0xbf753f22,0xbe483f0e,0x3f7bbf55,0x3e48bf0e,0xbf7b3f55,0x3f46bf62,0x3dc9be95,0xbf223ef1,0xbf7f3f75
.long 0xbf803f80,0xbf803f80,0xbf803f80,0xbf803f80,0x3f46bf62,0x3dc9be95,0xbf223ef1,0xbf7f3f75,0xbe483f0e,0x3f7bbf55,0x3e48bf0e,0xbf7b3f55,0xbef1bdc9,0xbe953f46,0x3f62bf7f,0xbf753f22
.long 0x3f6dbec4,0xbf6d3ec4,0x3f6dbec4,0xbf6d3ec4,0xbf753f46,0x3ef1bf7f,0x3e953f22,0xbf623dc9,0x3f0ebf7b,0x3f553e48,0xbf0e3f7b,0xbf55be48,0x3dc93f75,0xbf223f62,0xbf7f3e95,0xbf46bef1
.long 0xbf35bf35,0xbf35bf35,0xbf35bf35,0xbf35bf35,0x3f7f3e95,0x3f46bef1,0x3dc9bf75,0xbf22bf62,0xbf553e48,0x3f0e3f7b,0x3f55be48,0xbf0ebf7b,0x3e95bf22,0xbf62bdc9,0x3f753f46,0xbef1bf7f
.long 0x3ec43f6d,0xbec4bf6d,0x3ec43f6d,0xbec4bf6d,0xbf62bf7f,0x3f753f22,0xbef13dc9,0xbe95bf46,0x3f7b3f55,0x3e483f0e,0xbf7bbf55,0xbe48bf0e,0xbf22bef1,0xbf7fbf75,0xbf46bf62,0xbdc9be95
.long 0x3f7f3f80,0x3f753f7b,0x3f223f35,0x3ef13f0e,0x3f753f80,0x3f223f55,0xbf62bf35,0xbf7fbf7b,0x3f623f80,0x3dc93f0e,0xbe95bf35,0x3f223e48,0x3f463f80,0xbef13e48,0x3f7f3f35,0x3e953f55
.long 0x3f223f80,0xbf62be48,0xbdc93f35,0xbf75bf55,0x3ef13f80,0xbf7fbf0e,0xbf75bf35,0x3f46be48,0x3e953f80,0xbf46bf55,0x3ef1bf35,0x3dc93f7b,0x3dc93f80,0xbe95bf7b,0x3f463f35,0xbf62bf0e
.long 0xbdc93f80,0x3e95bf7b,0xbf463f35,0x3f62bf0e,0xbe953f80,0x3f46bf55,0xbef1bf35,0xbdc93f7b,0xbef13f80,0x3f7fbf0e,0x3f75bf35,0xbf46be48,0xbf223f80,0x3f62be48,0x3dc93f35,0x3f75bf55
.long 0xbf463f80,0x3ef13e48,0xbf7f3f35,0xbe953f55,0xbf623f80,0xbdc93f0e,0x3e95bf35,0xbf223e48,0xbf753f80,0xbf223f55,0x3f62bf35,0x3f7fbf7b,0xbf7f3f80,0xbf753f7b,0xbf223f35,0xbef13f0e
.long 0xbf7f3f80,0xbf753f7b,0xbf223f35,0xbef13f0e,0xbf753f80,0xbf223f55,0x3f62bf35,0x3f7fbf7b,0xbf623f80,0xbdc93f0e,0x3e95bf35,0xbf223e48,0xbf463f80,0x3ef13e48,0xbf7f3f35,0xbe953f55
.long 0xbf223f80,0x3f62be48,0x3dc93f35,0x3f75bf55,0xbef13f80,0x3f7fbf0e,0x3f75bf35,0xbf46be48,0xbe953f80,0x3f46bf55,0xbef1bf35,0xbdc93f7b,0xbdc93f80,0x3e95bf7b,0xbf463f35,0x3f62bf0e
.long 0x3dc93f80,0xbe95bf7b,0x3f463f35,0xbf62bf0e,0x3e953f80,0xbf46bf55,0x3ef1bf35,0x3dc93f7b,0x3ef13f80,0xbf7fbf0e,0xbf75bf35,0x3f46be48,0x3f223f80,0xbf62be48,0xbdc93f35,0xbf75bf55
.long 0x3f463f80,0xbef13e48,0x3f7f3f35,0x3e953f55,0x3f623f80,0x3dc93f0e,0xbe95bf35,0x3f223e48,0x3f753f80,0x3f223f55,0xbf62bf35,0xbf7fbf7b,0x3f7f3f80,0x3f753f7b,0x3f223f35,0x3ef13f0e
.long 0x3f623f6d,0x3f463f55,0x3e953ec4,0x3dc93e48,0x3dc93ec4,0xbef1be48,0xbf46bf6d,0xbe95bf0e,0xbf46bec4,0xbf75bf7b,0x3f7f3f6d,0x3ef13f55,0xbf75bf6d,0x3dc9bf0e,0xbf62bec4,0xbf22bf7b
.long 0xbe95bf6d,0x3f7f3f0e,0x3ef1bec4,0x3f463f7b,0x3f22bec4,0x3e953f7b,0x3dc93f6d,0xbf62bf55,0x3f7f3ec4,0xbf623e48,0xbf22bf6d,0x3f753f0e,0x3ef13f6d,0xbf22bf55,0x3f753ec4,0xbf7fbe48
.long 0xbef13f6d,0x3f22bf55,0xbf753ec4,0x3f7fbe48,0xbf7f3ec4,0x3f623e48,0x3f22bf6d,0xbf753f0e,0xbf22bec4,0xbe953f7b,0xbdc93f6d,0x3f62bf55,0x3e95bf6d,0xbf7f3f0e,0xbef1bec4,0xbf463f7b
.long 0x3f75bf6d,0xbdc9bf0e,0x3f62bec4,0x3f22bf7b,0x3f46bec4,0x3f75bf7b,0xbf7f3f6d,0xbef13f55,0xbdc93ec4,0x3ef1be48,0x3f46bf6d,0x3e95bf0e,0xbf623f6d,0xbf463f55,0xbe953ec4,0xbdc93e48
.long 0xbf623f6d,0xbf463f55,0xbe953ec4,0xbdc93e48,0xbdc93ec4,0x3ef1be48,0x3f46bf6d,0x3e95bf0e,0x3f46bec4,0x3f75bf7b,0xbf7f3f6d,0xbef13f55,0x3f75bf6d,0xbdc9bf0e,0x3f62bec4,0x3f22bf7b
.long 0x3e95bf6d,0xbf7f3f0e,0xbef1bec4,0xbf463f7b,0xbf22bec4,0xbe953f7b,0xbdc93f6d,0x3f62bf55,0xbf7f3ec4,0x3f623e48,0x3f22bf6d,0xbf753f0e,0xbef13f6d,0x3f22bf55,0xbf753ec4,0x3f7fbe48
.long 0x3ef13f6d,0xbf22bf55,0x3f753ec4,0xbf7fbe48,0x3f7f3ec4,0xbf623e48,0xbf22bf6d,0x3f753f0e,0x3f22bec4,0x3e953f7b,0x3dc93f6d,0xbf62bf55,0xbe95bf6d,0x3f7f3f0e,0x3ef1bec4,0x3f463f7b
.long 0xbf75bf6d,0x3dc9bf0e,0xbf62bec4,0xbf22bf7b,0xbf46bec4,0xbf75bf7b,0x3f7f3f6d,0x3ef13f55,0x3dc93ec4,0xbef1be48,0xbf46bf6d,0xbe95bf0e,0x3f623f6d,0x3f463f55,0x3e953ec4,0x3dc93e48
.long 0xbdc90000,0xbe95be48,0xbf46bf35,0xbf62bf55,0x3e950000,0x3f463f0e,0x3ef13f35,0xbdc93e48,0xbef10000,0xbf7fbf55,0x3f753f35,0x3f463f7b,0x3f220000,0x3f623f7b,0xbdc9bf35,0x3f753f0e
.long 0xbf460000,0xbef1bf7b,0xbf7fbf35,0x3e95bf0e,0x3f620000,0xbdc93f55,0xbe953f35,0xbf22bf7b,0xbf750000,0x3f22bf0e,0x3f623f35,0xbf7fbe48,0x3f7f0000,0xbf753e48,0x3f22bf35,0xbef13f55
.long 0xbf7f0000,0x3f753e48,0xbf22bf35,0x3ef13f55,0x3f750000,0xbf22bf0e,0xbf623f35,0x3f7fbe48,0xbf620000,0x3dc93f55,0x3e953f35,0x3f22bf7b,0x3f460000,0x3ef1bf7b,0x3f7fbf35,0xbe95bf0e
.long 0xbf220000,0xbf623f7b,0x3dc9bf35,0xbf753f0e,0x3ef10000,0x3f7fbf55,0xbf753f35,0xbf463f7b,0xbe950000,0xbf463f0e,0xbef13f35,0x3dc93e48,0x3dc90000,0x3e95be48,0x3f46bf35,0x3f62bf55
.long 0x3dc90000,0x3e95be48,0x3f46bf35,0x3f62bf55,0xbe950000,0xbf463f0e,0xbef13f35,0x3dc93e48,0x3ef10000,0x3f7fbf55,0xbf753f35,0xbf463f7b,0xbf220000,0xbf623f7b,0x3dc9bf35,0xbf753f0e
.long 0x3f460000,0x3ef1bf7b,0x3f7fbf35,0xbe95bf0e,0xbf620000,0x3dc93f55,0x3e953f35,0x3f22bf7b,0x3f750000,0xbf22bf0e,0xbf623f35,0x3f7fbe48,0xbf7f0000,0x3f753e48,0xbf22bf35,0x3ef13f55
.long 0x3f7f0000,0xbf753e48,0x3f22bf35,0xbef13f55,0xbf750000,0x3f22bf0e,0x3f623f35,0xbf7fbe48,0x3f620000,0xbdc93f55,0xbe953f35,0xbf22bf7b,0xbf460000,0xbef1bf7b,0xbf7fbf35,0x3e95bf0e
.long 0x3f220000,0x3f623f7b,0xbdc9bf35,0x3f753f0e,0xbef10000,0xbf7fbf55,0x3f753f35,0x3f463f7b,0x3e950000,0x3f463f0e,0x3ef13f35,0xbdc93e48,0xbdc90000,0xbe95be48,0xbf46bf35,0xbf62bf55
.long 0xbef1bec4,0xbf22bf0e,0xbf75bf6d,0xbf7fbf7b,0x3f7f3f6d,0x3f623f7b,0xbf22bec4,0xbf75bf55,0xbf22bf6d,0x3e95be48,0xbdc93ec4,0xbf62bf0e,0xbe953ec4,0xbf7fbf55,0x3ef13f6d,0xbf46be48
.long 0x3f753ec4,0x3dc93f55,0x3f623f6d,0xbf223e48,0xbf46bf6d,0x3f753e48,0x3f7f3ec4,0xbef13f0e,0xbdc93f6d,0xbef1bf7b,0x3f46bec4,0xbe953f55,0x3f62bec4,0xbf463f0e,0x3e95bf6d,0xbdc93f7b
.long 0xbf62bec4,0x3f463f0e,0xbe95bf6d,0x3dc93f7b,0x3dc93f6d,0x3ef1bf7b,0xbf46bec4,0x3e953f55,0x3f46bf6d,0xbf753e48,0xbf7f3ec4,0x3ef13f0e,0xbf753ec4,0xbdc93f55,0xbf623f6d,0x3f223e48
.long 0x3e953ec4,0x3f7fbf55,0xbef13f6d,0x3f46be48,0x3f22bf6d,0xbe95be48,0x3dc93ec4,0x3f62bf0e,0xbf7f3f6d,0xbf623f7b,0x3f22bec4,0x3f75bf55,0x3ef1bec4,0x3f22bf0e,0x3f75bf6d,0x3f7fbf7b
.long 0x3ef1bec4,0x3f22bf0e,0x3f75bf6d,0x3f7fbf7b,0xbf7f3f6d,0xbf623f7b,0x3f22bec4,0x3f75bf55,0x3f22bf6d,0xbe95be48,0x3dc93ec4,0x3f62bf0e,0x3e953ec4,0x3f7fbf55,0xbef13f6d,0x3f46be48
.long 0xbf753ec4,0xbdc93f55,0xbf623f6d,0x3f223e48,0x3f46bf6d,0xbf753e48,0xbf7f3ec4,0x3ef13f0e,0x3dc93f6d,0x3ef1bf7b,0xbf46bec4,0x3e953f55,0xbf62bec4,0x3f463f0e,0xbe95bf6d,0x3dc93f7b
.long 0x3f62bec4,0xbf463f0e,0x3e95bf6d,0xbdc93f7b,0xbdc93f6d,0xbef1bf7b,0x3f46bec4,0xbe953f55,0xbf46bf6d,0x3f753e48,0x3f7f3ec4,0xbef13f0e,0x3f753ec4,0x3dc93f55,0x3f623f6d,0xbf223e48
.long 0xbe953ec4,0xbf7fbf55,0x3ef13f6d,0xbf46be48,0xbf22bf6d,0x3e95be48,0xbdc93ec4,0xbf62bf0e,0x3f7f3f6d,0x3f623f7b,0xbf22bec4,0xbf75bf55,0xbef1bec4,0xbf22bf0e,0xbf75bf6d,0xbf7fbf7b
.long 0x3dc90000,0x3e953e48,0x3f463f35,0x3f623f55,0x3e950000,0x3f463f0e,0x3ef13f35,0xbdc93e48,0x3ef10000,0x3f7f3f55,0xbf75bf35,0xbf46bf7b,0x3f220000,0x3f623f7b,0xbdc9bf35,0x3f753f0e
.long 0x3f460000,0x3ef13f7b,0x3f7f3f35,0xbe953f0e,0x3f620000,0xbdc93f55,0xbe953f35,0xbf22bf7b,0x3f750000,0xbf223f0e,0xbf62bf35,0x3f7f3e48,0x3f7f0000,0xbf753e48,0x3f22bf35,0xbef13f55
.long 0x3f7f0000,0xbf75be48,0x3f223f35,0xbef1bf55,0x3f750000,0xbf22bf0e,0xbf623f35,0x3f7fbe48,0x3f620000,0xbdc9bf55,0xbe95bf35,0xbf223f7b,0x3f460000,0x3ef1bf7b,0x3f7fbf35,0xbe95bf0e
.long 0x3f220000,0x3f62bf7b,0xbdc93f35,0x3f75bf0e,0x3ef10000,0x3f7fbf55,0xbf753f35,0xbf463f7b,0x3e950000,0x3f46bf0e,0x3ef1bf35,0xbdc9be48,0x3dc90000,0x3e95be48,0x3f46bf35,0x3f62bf55
.long 0xbdc90000,0xbe953e48,0xbf463f35,0xbf623f55,0xbe950000,0xbf463f0e,0xbef13f35,0x3dc93e48,0xbef10000,0xbf7f3f55,0x3f75bf35,0x3f46bf7b,0xbf220000,0xbf623f7b,0x3dc9bf35,0xbf753f0e
.long 0xbf460000,0xbef13f7b,0xbf7f3f35,0x3e953f0e,0xbf620000,0x3dc93f55,0x3e953f35,0x3f22bf7b,0xbf750000,0x3f223f0e,0x3f62bf35,0xbf7f3e48,0xbf7f0000,0x3f753e48,0xbf22bf35,0x3ef13f55
.long 0xbf7f0000,0x3f75be48,0xbf223f35,0x3ef1bf55,0xbf750000,0x3f22bf0e,0x3f623f35,0xbf7fbe48,0xbf620000,0x3dc9bf55,0x3e95bf35,0x3f223f7b,0xbf460000,0xbef1bf7b,0xbf7fbf35,0x3e95bf0e
.long 0xbf220000,0xbf62bf7b,0x3dc93f35,0xbf75bf0e,0xbef10000,0xbf7fbf55,0x3f753f35,0x3f463f7b,0xbe950000,0xbf46bf0e,0xbef1bf35,0x3dc9be48,0xbdc90000,0xbe95be48,0xbf46bf35,0xbf62bf55
.long 0x3ef13ec4,0x3f223f0e,0x3f753f6d,0x3f7f3f7b,0x3f7f3f6d,0x3f623f7b,0xbf22bec4,0xbf75bf55,0x3f223f6d,0xbe953e48,0x3dc9bec4,0x3f623f0e,0xbe953ec4,0xbf7fbf55,0x3ef13f6d,0xbf46be48
.long 0xbf75bec4,0xbdc9bf55,0xbf62bf6d,0x3f22be48,0xbf46bf6d,0x3f753e48,0x3f7f3ec4,0xbef13f0e,0x3dc9bf6d,0x3ef13f7b,0xbf463ec4,0x3e95bf55,0x3f62bec4,0xbf463f0e,0x3e95bf6d,0xbdc93f7b
.long 0x3f623ec4,0xbf46bf0e,0x3e953f6d,0xbdc9bf7b,0x3dc93f6d,0x3ef1bf7b,0xbf46bec4,0x3e953f55,0xbf463f6d,0x3f75be48,0x3f7fbec4,0xbef1bf0e,0xbf753ec4,0xbdc93f55,0xbf623f6d,0x3f223e48
.long 0xbe95bec4,0xbf7f3f55,0x3ef1bf6d,0xbf463e48,0x3f22bf6d,0xbe95be48,0x3dc93ec4,0x3f62bf0e,0x3f7fbf6d,0x3f62bf7b,0xbf223ec4,0xbf753f55,0x3ef1bec4,0x3f22bf0e,0x3f75bf6d,0x3f7fbf7b
.long 0xbef13ec4,0xbf223f0e,0xbf753f6d,0xbf7f3f7b,0xbf7f3f6d,0xbf623f7b,0x3f22bec4,0x3f75bf55,0xbf223f6d,0x3e953e48,0xbdc9bec4,0xbf623f0e,0x3e953ec4,0x3f7fbf55,0xbef13f6d,0x3f46be48
.long 0x3f75bec4,0x3dc9bf55,0x3f62bf6d,0xbf22be48,0x3f46bf6d,0xbf753e48,0xbf7f3ec4,0x3ef13f0e,0xbdc9bf6d,0xbef13f7b,0x3f463ec4,0xbe95bf55,0xbf62bec4,0x3f463f0e,0xbe95bf6d,0x3dc93f7b
.long 0xbf623ec4,0x3f46bf0e,0xbe953f6d,0x3dc9bf7b,0xbdc93f6d,0xbef1bf7b,0x3f46bec4,0xbe953f55,0x3f463f6d,0xbf75be48,0xbf7fbec4,0x3ef1bf0e,0x3f753ec4,0x3dc93f55,0x3f623f6d,0xbf223e48
.long 0x3e95bec4,0x3f7f3f55,0xbef1bf6d,0x3f463e48,0xbf22bf6d,0x3e95be48,0xbdc93ec4,0xbf62bf0e,0xbf7fbf6d,0xbf62bf7b,0x3f223ec4,0x3f753f55,0xbef1bec4,0xbf22bf0e,0xbf75bf6d,0xbf7fbf7b
.long 0x3f7f3f80,0x3f753f7b,0x3f223f35,0x3ef13f0e,0xbf75bf80,0xbf22bf55,0x3f623f35,0x3f7f3f7b,0x3f623f80,0x3dc93f0e,0xbe95bf35,0x3f223e48,0xbf46bf80,0x3ef1be48,0xbf7fbf35,0xbe95bf55
.long 0x3f223f80,0xbf62be48,0xbdc93f35,0xbf75bf55,0xbef1bf80,0x3f7f3f0e,0x3f753f35,0xbf463e48,0x3e953f80,0xbf46bf55,0x3ef1bf35,0x3dc93f7b,0xbdc9bf80,0x3e953f7b,0xbf46bf35,0x3f623f0e
.long 0xbdc93f80,0x3e95bf7b,0xbf463f35,0x3f62bf0e,0x3e95bf80,0xbf463f55,0x3ef13f35,0x3dc9bf7b,0xbef13f80,0x3f7fbf0e,0x3f75bf35,0xbf46be48,0x3f22bf80,0xbf623e48,0xbdc9bf35,0xbf753f55
.long 0xbf463f80,0x3ef13e48,0xbf7f3f35,0xbe953f55,0x3f62bf80,0x3dc9bf0e,0xbe953f35,0x3f22be48,0xbf753f80,0xbf223f55,0x3f62bf35,0x3f7fbf7b,0x3f7fbf80,0x3f75bf7b,0x3f22bf35,0x3ef1bf0e
.long 0xbf7f3f80,0xbf753f7b,0xbf223f35,0xbef13f0e,0x3f75bf80,0x3f22bf55,0xbf623f35,0xbf7f3f7b,0xbf623f80,0xbdc93f0e,0x3e95bf35,0xbf223e48,0x3f46bf80,0xbef1be48,0x3f7fbf35,0x3e95bf55
.long 0xbf223f80,0x3f62be48,0x3dc93f35,0x3f75bf55,0x3ef1bf80,0xbf7f3f0e,0xbf753f35,0x3f463e48,0xbe953f80,0x3f46bf55,0xbef1bf35,0xbdc93f7b,0x3dc9bf80,0xbe953f7b,0x3f46bf35,0xbf623f0e
.long 0x3dc93f80,0xbe95bf7b,0x3f463f35,0xbf62bf0e,0xbe95bf80,0x3f463f55,0xbef13f35,0xbdc9bf7b,0x3ef13f80,0xbf7fbf0e,0xbf75bf35,0x3f46be48,0xbf22bf80,0x3f623e48,0x3dc9bf35,0x3f753f55
.long 0x3f463f80,0xbef13e48,0x3f7f3f35,0x3e953f55,0xbf62bf80,0xbdc9bf0e,0x3e953f35,0xbf22be48,0x3f753f80,0x3f223f55,0xbf62bf35,0xbf7fbf7b,0xbf7fbf80,0xbf75bf7b,0xbf22bf35,0xbef1bf0e
.long 0x3f623f6d,0x3f463f55,0x3e953ec4,0x3dc93e48,0xbdc9bec4,0x3ef13e48,0x3f463f6d,0x3e953f0e,0xbf46bec4,0xbf75bf7b,0x3f7f3f6d,0x3ef13f55,0x3f753f6d,0xbdc93f0e,0x3f623ec4,0x3f223f7b
.long 0xbe95bf6d,0x3f7f3f0e,0x3ef1bec4,0x3f463f7b,0xbf223ec4,0xbe95bf7b,0xbdc9bf6d,0x3f623f55,0x3f7f3ec4,0xbf623e48,0xbf22bf6d,0x3f753f0e,0xbef1bf6d,0x3f223f55,0xbf75bec4,0x3f7f3e48
.long 0xbef13f6d,0x3f22bf55,0xbf753ec4,0x3f7fbe48,0x3f7fbec4,0xbf62be48,0xbf223f6d,0x3f75bf0e,0xbf22bec4,0xbe953f7b,0xbdc93f6d,0x3f62bf55,0xbe953f6d,0x3f7fbf0e,0x3ef13ec4,0x3f46bf7b
.long 0x3f75bf6d,0xbdc9bf0e,0x3f62bec4,0x3f22bf7b,0xbf463ec4,0xbf753f7b,0x3f7fbf6d,0x3ef1bf55,0xbdc93ec4,0x3ef1be48,0x3f46bf6d,0x3e95bf0e,0x3f62bf6d,0x3f46bf55,0x3e95bec4,0x3dc9be48
.long 0xbf623f6d,0xbf463f55,0xbe953ec4,0xbdc93e48,0x3dc9bec4,0xbef13e48,0xbf463f6d,0xbe953f0e,0x3f46bec4,0x3f75bf7b,0xbf7f3f6d,0xbef13f55,0xbf753f6d,0x3dc93f0e,0xbf623ec4,0xbf223f7b
.long 0x3e95bf6d,0xbf7f3f0e,0xbef1bec4,0xbf463f7b,0x3f223ec4,0x3e95bf7b,0x3dc9bf6d,0xbf623f55,0xbf7f3ec4,0x3f623e48,0x3f22bf6d,0xbf753f0e,0x3ef1bf6d,0xbf223f55,0x3f75bec4,0xbf7f3e48
.long 0x3ef13f6d,0xbf22bf55,0x3f753ec4,0xbf7fbe48,0xbf7fbec4,0x3f62be48,0x3f223f6d,0xbf75bf0e,0x3f22bec4,0x3e953f7b,0x3dc93f6d,0xbf62bf55,0x3e953f6d,0xbf7fbf0e,0xbef13ec4,0xbf46bf7b
.long 0xbf75bf6d,0x3dc9bf0e,0xbf62bec4,0xbf22bf7b,0x3f463ec4,0x3f753f7b,0xbf7fbf6d,0xbef1bf55,0x3dc93ec4,0xbef1be48,0xbf46bf6d,0xbe95bf0e,0xbf62bf6d,0xbf46bf55,0xbe95bec4,0xbdc9be48
.long 0xbdc98000,0xbe95be48,0xbf46bf35,0xbf62bf55,0xbe958000,0xbf46bf0e,0xbef1bf35,0x3dc9be48,0xbef18000,0xbf7fbf55,0x3f753f35,0x3f463f7b,0xbf228000,0xbf62bf7b,0x3dc93f35,0xbf75bf0e
.long 0xbf468000,0xbef1bf7b,0xbf7fbf35,0x3e95bf0e,0xbf628000,0x3dc9bf55,0x3e95bf35,0x3f223f7b,0xbf758000,0x3f22bf0e,0x3f623f35,0xbf7fbe48,0xbf7f8000,0x3f75be48,0xbf223f35,0x3ef1bf55
.long 0xbf7f8000,0x3f753e48,0xbf22bf35,0x3ef13f55,0xbf758000,0x3f223f0e,0x3f62bf35,0xbf7f3e48,0xbf628000,0x3dc93f55,0x3e953f35,0x3f22bf7b,0xbf468000,0xbef13f7b,0xbf7f3f35,0x3e953f0e
.long 0xbf228000,0xbf623f7b,0x3dc9bf35,0xbf753f0e,0xbef18000,0xbf7f3f55,0x3f75bf35,0x3f46bf7b,0xbe958000,0xbf463f0e,0xbef13f35,0x3dc93e48,0xbdc98000,0xbe953e48,0xbf463f35,0xbf623f55
.long 0x3dc98000,0x3e95be48,0x3f46bf35,0x3f62bf55,0x3e958000,0x3f46bf0e,0x3ef1bf35,0xbdc9be48,0x3ef18000,0x3f7fbf55,0xbf753f35,0xbf463f7b,0x3f228000,0x3f62bf7b,0xbdc93f35,0x3f75bf0e
.long 0x3f468000,0x3ef1bf7b,0x3f7fbf35,0xbe95bf0e,0x3f628000,0xbdc9bf55,0xbe95bf35,0xbf223f7b,0x3f758000,0xbf22bf0e,0xbf623f35,0x3f7fbe48,0x3f7f8000,0xbf75be48,0x3f223f35,0xbef1bf55
.long 0x3f7f8000,0xbf753e48,0x3f22bf35,0xbef13f55,0x3f758000,0xbf223f0e,0xbf62bf35,0x3f7f3e48,0x3f628000,0xbdc93f55,0xbe953f35,0xbf22bf7b,0x3f468000,0x3ef13f7b,0x3f7f3f35,0xbe953f0e
.long 0x3f228000,0x3f623f7b,0xbdc9bf35,0x3f753f0e,0x3ef18000,0x3f7f3f55,0xbf75bf35,0xbf46bf7b,0x3e958000,0x3f463f0e,0x3ef13f35,0xbdc93e48,0x3dc98000,0x3e953e48,0x3f463f35,0x3f623f55
.long 0xbef1bec4,0xbf22bf0e,0xbf75bf6d,0xbf7fbf7b,0xbf7fbf6d,0xbf62bf7b,0x3f223ec4,0x3f753f55,0xbf22bf6d,0x3e95be48,0xbdc93ec4,0xbf62bf0e,0x3e95bec4,0x3f7f3f55,0xbef1bf6d,0x3f463e48
.long 0x3f753ec4,0x3dc93f55,0x3f623f6d,0xbf223e48,0x3f463f6d,0xbf75be48,0xbf7fbec4,0x3ef1bf0e,0xbdc93f6d,0xbef1bf7b,0x3f46bec4,0xbe953f55,0xbf623ec4,0x3f46bf0e,0xbe953f6d,0x3dc9bf7b
.long 0xbf62bec4,0x3f463f0e,0xbe95bf6d,0x3dc93f7b,0xbdc9bf6d,0xbef13f7b,0x3f463ec4,0xbe95bf55,0x3f46bf6d,0xbf753e48,0xbf7f3ec4,0x3ef13f0e,0x3f75bec4,0x3dc9bf55,0x3f62bf6d,0xbf22be48
.long 0x3e953ec4,0x3f7fbf55,0xbef13f6d,0x3f46be48,0xbf223f6d,0x3e953e48,0xbdc9bec4,0xbf623f0e,0xbf7f3f6d,0xbf623f7b,0x3f22bec4,0x3f75bf55,0xbef13ec4,0xbf223f0e,0xbf753f6d,0xbf7f3f7b
.long 0x3ef1bec4,0x3f22bf0e,0x3f75bf6d,0x3f7fbf7b,0x3f7fbf6d,0x3f62bf7b,0xbf223ec4,0xbf753f55,0x3f22bf6d,0xbe95be48,0x3dc93ec4,0x3f62bf0e,0xbe95bec4,0xbf7f3f55,0x3ef1bf6d,0xbf463e48
.long 0xbf753ec4,0xbdc93f55,0xbf623f6d,0x3f223e48,0xbf463f6d,0x3f75be48,0x3f7fbec4,0xbef1bf0e,0x3dc93f6d,0x3ef1bf7b,0xbf46bec4,0x3e953f55,0x3f623ec4,0xbf46bf0e,0x3e953f6d,0xbdc9bf7b
.long 0x3f62bec4,0xbf463f0e,0x3e95bf6d,0xbdc93f7b,0x3dc9bf6d,0x3ef13f7b,0xbf463ec4,0x3e95bf55,0xbf46bf6d,0x3f753e48,0x3f7f3ec4,0xbef13f0e,0xbf75bec4,0xbdc9bf55,0xbf62bf6d,0x3f22be48
.long 0xbe953ec4,0xbf7fbf55,0x3ef13f6d,0xbf46be48,0x3f223f6d,0xbe953e48,0x3dc9bec4,0x3f623f0e,0x3f7f3f6d,0x3f623f7b,0xbf22bec4,0xbf75bf55,0x3ef13ec4,0x3f223f0e,0x3f753f6d,0x3f7f3f7b
.long 0xbf7fbf80,0xbf75bf7b,0xbf22bf35,0xbef1bf0e,0x3f753f80,0x3f223f55,0xbf62bf35,0xbf7fbf7b,0xbf62bf80,0xbdc9bf0e,0x3e953f35,0xbf22be48,0x3f463f80,0xbef13e48,0x3f7f3f35,0x3e953f55
.long 0xbf22bf80,0x3f623e48,0x3dc9bf35,0x3f753f55,0x3ef13f80,0xbf7fbf0e,0xbf75bf35,0x3f46be48,0xbe95bf80,0x3f463f55,0xbef13f35,0xbdc9bf7b,0x3dc93f80,0xbe95bf7b,0x3f463f35,0xbf62bf0e
.long 0x3dc9bf80,0xbe953f7b,0x3f46bf35,0xbf623f0e,0xbe953f80,0x3f46bf55,0xbef1bf35,0xbdc93f7b,0x3ef1bf80,0xbf7f3f0e,0xbf753f35,0x3f463e48,0xbf223f80,0x3f62be48,0x3dc93f35,0x3f75bf55
.long 0x3f46bf80,0xbef1be48,0x3f7fbf35,0x3e95bf55,0xbf623f80,0xbdc93f0e,0x3e95bf35,0xbf223e48,0x3f75bf80,0x3f22bf55,0xbf623f35,0xbf7f3f7b,0xbf7f3f80,0xbf753f7b,0xbf223f35,0xbef13f0e
.long 0x3f7fbf80,0x3f75bf7b,0x3f22bf35,0x3ef1bf0e,0xbf753f80,0xbf223f55,0x3f62bf35,0x3f7fbf7b,0x3f62bf80,0x3dc9bf0e,0xbe953f35,0x3f22be48,0xbf463f80,0x3ef13e48,0xbf7f3f35,0xbe953f55
.long 0x3f22bf80,0xbf623e48,0xbdc9bf35,0xbf753f55,0xbef13f80,0x3f7fbf0e,0x3f75bf35,0xbf46be48,0x3e95bf80,0xbf463f55,0x3ef13f35,0x3dc9bf7b,0xbdc93f80,0x3e95bf7b,0xbf463f35,0x3f62bf0e
.long 0xbdc9bf80,0x3e953f7b,0xbf46bf35,0x3f623f0e,0x3e953f80,0xbf46bf55,0x3ef1bf35,0x3dc93f7b,0xbef1bf80,0x3f7f3f0e,0x3f753f35,0xbf463e48,0x3f223f80,0xbf62be48,0xbdc93f35,0xbf75bf55
.long 0xbf46bf80,0x3ef1be48,0xbf7fbf35,0xbe95bf55,0x3f623f80,0x3dc93f0e,0xbe95bf35,0x3f223e48,0xbf75bf80,0xbf22bf55,0x3f623f35,0x3f7f3f7b,0x3f7f3f80,0x3f753f7b,0x3f223f35,0x3ef13f0e
.long 0xbf62bf6d,0xbf46bf55,0xbe95bec4,0xbdc9be48,0x3dc93ec4,0xbef1be48,0xbf46bf6d,0xbe95bf0e,0x3f463ec4,0x3f753f7b,0xbf7fbf6d,0xbef1bf55,0xbf75bf6d,0x3dc9bf0e,0xbf62bec4,0xbf22bf7b
.long 0x3e953f6d,0xbf7fbf0e,0xbef13ec4,0xbf46bf7b,0x3f22bec4,0x3e953f7b,0x3dc93f6d,0xbf62bf55,0xbf7fbec4,0x3f62be48,0x3f223f6d,0xbf75bf0e,0x3ef13f6d,0xbf22bf55,0x3f753ec4,0xbf7fbe48
.long 0x3ef1bf6d,0xbf223f55,0x3f75bec4,0xbf7f3e48,0xbf7f3ec4,0x3f623e48,0x3f22bf6d,0xbf753f0e,0x3f223ec4,0x3e95bf7b,0x3dc9bf6d,0xbf623f55,0x3e95bf6d,0xbf7f3f0e,0xbef1bec4,0xbf463f7b
.long 0xbf753f6d,0x3dc93f0e,0xbf623ec4,0xbf223f7b,0x3f46bec4,0x3f75bf7b,0xbf7f3f6d,0xbef13f55,0x3dc9bec4,0xbef13e48,0xbf463f6d,0xbe953f0e,0xbf623f6d,0xbf463f55,0xbe953ec4,0xbdc93e48
.long 0x3f62bf6d,0x3f46bf55,0x3e95bec4,0x3dc9be48,0xbdc93ec4,0x3ef1be48,0x3f46bf6d,0x3e95bf0e,0xbf463ec4,0xbf753f7b,0x3f7fbf6d,0x3ef1bf55,0x3f75bf6d,0xbdc9bf0e,0x3f62bec4,0x3f22bf7b
.long 0xbe953f6d,0x3f7fbf0e,0x3ef13ec4,0x3f46bf7b,0xbf22bec4,0xbe953f7b,0xbdc93f6d,0x3f62bf55,0x3f7fbec4,0xbf62be48,0xbf223f6d,0x3f75bf0e,0xbef13f6d,0x3f22bf55,0xbf753ec4,0x3f7fbe48
.long 0xbef1bf6d,0x3f223f55,0xbf75bec4,0x3f7f3e48,0x3f7f3ec4,0xbf623e48,0xbf22bf6d,0x3f753f0e,0xbf223ec4,0xbe95bf7b,0xbdc9bf6d,0x3f623f55,0xbe95bf6d,0x3f7f3f0e,0x3ef1bec4,0x3f463f7b
.long 0x3f753f6d,0xbdc93f0e,0x3f623ec4,0x3f223f7b,0xbf46bec4,0xbf75bf7b,0x3f7f3f6d,0x3ef13f55,0xbdc9bec4,0x3ef13e48,0x3f463f6d,0x3e953f0e,0x3f623f6d,0x3f463f55,0x3e953ec4,0x3dc93e48
.long 0x80003c00,0x80003c00,0x80003c00,0x80003c00,0x80003c00,0x9a483c00,0x9e483c00,0xa0b63c00,0x80003c00,0x9e483c00,0xa2483c00,0xa4b63c00,0x80003c00,0xa0b63c00,0xa4b63c00,0xa7113bff
.long 0x80003c00,0xa2483c00,0xa6483bff,0xa8b63bff,0x80003c00,0xa3db3c00,0xa7da3bff,0xa9e33bfe,0x80003c00,0xa4b63c00,0xa8b63bff,0xab113bfd,0x80003c00,0xa57f3c00,0xa97f3bfe,0xac1f3bfc
.long 0x80003c00,0xa6483bff,0xaa483bfe,0xacb53bfa,0x80003c00,0xa7113bff,0xab113bfd,0xad4c3bf9,0x80003c00,0xa7da3bff,0xabd93bfc,0xade23bf7,0x80003c00,0xa8523bff,0xac513bfb,0xae783bf6
.long 0x80003c00,0xa8b63bff,0xacb53bfa,0xaf0e3bf4,0x80003c00,0xa91b3bfe,0xad1a3bf9,0xafa43bf1,0x80003c00,0xa97f3bfe,0xad7e3bf8,0xb01d3bef,0x80003c00,0xa9e33bfe,0xade23bf7,0xb0673bed
.long 0x80003c00,0xaa483bfe,0xae463bf6,0xb0b23bea,0x80003c00,0xaaac3bfd,0xaeaa3bf5,0xb0fd3be7,0x80003c00,0xab113bfd,0xaf0e3bf4,0xb1473be4,0x80003c00,0xab753bfd,0xaf723bf2,0xb1913be1
.long 0x80003c00,0xabd93bfc,0xafd63bf1,0xb1db3bdd,0x80003c00,0xac1f3bfc,0xb01d3bef,0xb2263bda,0x80003c00,0xac513bfb,0xb04e3bed,0xb26f3bd6,0x80003c00,0xac833bfb,0xb0803bec,0xb2b93bd2
.long 0x80003c00,0xacb53bfa,0xb0b23bea,0xb3033bce,0x80003c00,0xace73bfa,0xb0e43be8,0xb34c3bca,0x80003c00,0xad1a3bf9,0xb1153be6,0xb3963bc6,0x80003c00,0xad4c3bf9,0xb1473be4,0xb3df3bc1
.long 0x80003c00,0xad7e3bf8,0xb1793be2,0xb4143bbc,0x80003c00,0xadb03bf8,0xb1aa3be0,0xb4383bb7,0x80003c00,0xade23bf7,0xb1db3bdd,0xb45d3bb2,0x80003c00,0xae143bf7,0xb20d3bdb,0xb4813bad
.long 0x80003c00,0x80003c00,0x80003c00,0x80003c00,0xa2483c00,0xa3db3c00,0xa4b63c00,0xa57f3c00,0xa6483bff,0xa7da3bff,0xa8b63bff,0xa97f3bfe,0xa8b63bff,0xa9e33bfe,0xab113bfd,0xac1f3bfc
.long 0xaa483bfe,0xabd93bfc,0xacb53bfa,0xad7e3bf8,0xabd93bfc,0xace73bfa,0xade23bf7,0xaedc3bf4,0xacb53bfa,0xade23bf7,0xaf0e3bf4,0xb01d3bef,0xad7e3bf8,0xaedc3bf4,0xb01d3bef,0xb0cb3be9
.long 0xae463bf6,0xafd63bf1,0xb0b23bea,0xb1793be2,0xaf0e3bf4,0xb0673bed,0xb1473be4,0xb2263bda,0xafd63bf1,0xb0e43be8,0xb1db3bdd,0xb2d23bd1,0xb04e3bed,0xb1603be3,0xb26f3bd6,0xb37d3bc7
.long 0xb0b23bea,0xb1db3bdd,0xb3033bce,0xb4143bbc,0xb1153be6,0xb2573bd7,0xb3963bc6,0xb4693bb1,0xb1793be2,0xb2d23bd1,0xb4143bbc,0xb4bd3ba4,0xb1db3bdd,0xb34c3bca,0xb45d3bb2,0xb5113b97
.long 0xb23e3bd9,0xb3c63bc3,0xb4a53ba8,0xb5643b88,0xb2a13bd4,0xb4203bbb,0xb4ed3b9d,0xb5b63b79,0xb3033bce,0xb45d3bb2,0xb5343b91,0xb6083b69,0xb3653bc9,0xb4993baa,0xb57c3b84,0xb6593b58
.long 0xb3c63bc3,0xb4d53ba0,0xb5c23b77,0xb6aa3b46,0xb4143bbc,0xb5113b97,0xb6083b69,0xb6f93b33,0xb4443bb6,0xb54c3b8c,0xb64e3b5a,0xb7483b20,0xb4753baf,0xb5873b82,0xb6933b4b,0xb7963b0b
.long 0xb4a53ba8,0xb5c23b77,0xb6d73b3b,0xb7e33af6,0xb4d53ba0,0xb5fd3b6b,0xb71b3b2b,0xb8173ae0,0xb5053b99,0xb6373b5f,0xb75e3b1a,0xb83d3ac9,0xb5343b91,0xb6703b53,0xb7a13b08,0xb8623ab1
.long 0xb5643b88,0xb6aa3b46,0xb7e33af6,0xb8873a99,0xb5933b80,0xb6e33b39,0xb8123ae3,0xb8ab3a7f,0xb5c23b77,0xb71b3b2b,0xb8323ad0,0xb8ce3a65,0xb5f13b6e,0xb7533b1d,0xb8523abc,0xb8f13a4b
.long 0x80003c00,0x80003c00,0x80003c00,0x80003c00,0xa6483bff,0xa7113bff,0xa7da3bff,0xa8523bff,0xaa483bfe,0xab113bfd,0xabd93bfc,0xac513bfb,0xacb53bfa,0xad4c3bf9,0xade23bf7,0xae783bf6
.long 0xae463bf6,0xaf0e3bf4,0xafd63bf1,0xb04e3bed,0xafd63bf1,0xb0673bed,0xb0e43be8,0xb1603be3,0xb0b23bea,0xb1473be4,0xb1db3bdd,0xb26f3bd6,0xb1793be2,0xb2263bda,0xb2d23bd1,0xb37d3bc7
.long 0xb23e3bd9,0xb3033bce,0xb3c63bc3,0xb4443bb6,0xb3033bce,0xb3df3bc1,0xb45d3bb2,0xb4c93ba2,0xb3c63bc3,0xb45d3bb2,0xb4d53ba0,0xb54c3b8c,0xb4443bb6,0xb4c93ba2,0xb54c3b8c,0xb5ce3b74
.long 0xb4a53ba8,0xb5343b91,0xb5c23b77,0xb64e3b5a,0xb5053b99,0xb59f3b7d,0xb6373b5f,0xb6cc3b3e,0xb5643b88,0xb6083b69,0xb6aa3b46,0xb7483b20,0xb5c23b77,0xb6703b53,0xb71b3b2b,0xb7c23aff
.long 0xb61f3b64,0xb6d73b3b,0xb78b3b0e,0xb81d3add,0xb67c3b50,0xb73d3b22,0xb7f93af0,0xb8583ab8,0xb6d73b3b,0xb7a13b08,0xb8323ad0,0xb8913a92,0xb7323b25,0xb8023aed,0xb8673aae,0xb8c93a69
.long 0xb78b3b0e,0xb8323ad0,0xb89b3a8a,0xb9003a3f,0xb7e33af6,0xb8623ab1,0xb8ce3a65,0xb9353a13,0xb81d3add,0xb8913a92,0xb9003a3f,0xb96939e5,0xb8483ac2,0xb8bf3a71,0xb9303a17,0xb99b39b5
.long 0xb8723aa7,0xb8ec3a4f,0xb95f39ed,0xb9cb3984,0xb89b3a8a,0xb9183a2b,0xb98d39c3,0xb9fa3951,0xb8c43a6d,0xb9433a07,0xb9ba3996,0xba27391d,0xb8ec3a4f,0xb96d39e1,0xb9e53969,0xba5238e7
.long 0xb9133a2f,0xb99639ba,0xba0f393a,0xba7c38b0,0xb93a3a0f,0xb9be3992,0xba373909,0xbaa33877,0xb95f39ed,0xb9e53969,0xba5e38d8,0xbac9383d,0xb98439cb,0xba0b393e,0xba8338a6,0xbaed3802
.long 0x80003c00,0x80003c00,0x80003c00,0x80003c00,0xa8b63bff,0xa91b3bfe,0xa97f3bfe,0xa9e33bfe,0xacb53bfa,0xad1a3bf9,0xad7e3bf8,0xade23bf7,0xaf0e3bf4,0xafa43bf1,0xb01d3bef,0xb0673bed
.long 0xb0b23bea,0xb1153be6,0xb1793be2,0xb1db3bdd,0xb1db3bdd,0xb2573bd7,0xb2d23bd1,0xb34c3bca,0xb3033bce,0xb3963bc6,0xb4143bbc,0xb45d3bb2,0xb4143bbc,0xb4693bb1,0xb4bd3ba4,0xb5113b97
.long 0xb4a53ba8,0xb5053b99,0xb5643b88,0xb5c23b77,0xb5343b91,0xb59f3b7d,0xb6083b69,0xb6703b53,0xb5c23b77,0xb6373b5f,0xb6aa3b46,0xb71b3b2b,0xb64e3b5a,0xb6cc3b3e,0xb7483b20,0xb7c23aff
.long 0xb6d73b3b,0xb75e3b1a,0xb7e33af6,0xb8323ad0,0xb75e3b1a,0xb7ee3af3,0xb83d3ac9,0xb8813a9c,0xb7e33af6,0xb83d3ac9,0xb8873a99,0xb8ce3a65,0xb8323ad0,0xb8813a9c,0xb8ce3a65,0xb9183a2b
.long 0xb8723aa7,0xb8c43a6d,0xb9133a2f,0xb95f39ed,0xb8b03a7c,0xb9053a3b,0xb95639f6,0xb9a439ad,0xb8ec3a4f,0xb9433a07,0xb99639ba,0xb9e53969,0xb9273a1f,0xb98039d0,0xb9d4397b,0xba233922
.long 0xb95f39ed,0xb9ba3996,0xba0f393a,0xba5e38d8,0xb99639ba,0xb9f2395b,0xba4738f6,0xba95388c,0xb9cb3984,0xba27391d,0xba7c38b0,0xbac9383d,0xb9fe394d,0xba5a38dd,0xbaae3867,0xbaf937d8
.long 0xba2f3913,0xba8a389b,0xbadd381d,0xbb253732,0xba5e38d8,0xbab83858,0xbb0837a1,0xbb4e3687,0xba8a389b,0xbae33812,0xbb303705,0xbb7235da,0xbab5385d,0xbb0b3796,0xbb553665,0xbb933529
.long 0xbadd381d,0xbb303705,0xbb7735c2,0xbbaf3475,0xbb0237b7,0xbb533670,0xbb95351d,0xbbc7337d,0xbb253732,0xbb7235da,0xbbaf3475,0xbbdb320d,0xbb4636aa,0xbb8f3540,0xbbc63396,0xbbeb3099
.long 0x80003c00,0x80003c00,0x80003c00,0x80003c00,0xaa483bfe,0xaaac3bfd,0xab113bfd,0xab753bfd,0xae463bf6,0xaeaa3bf5,0xaf0e3bf4,0xaf723bf2,0xb0b23bea,0xb0fd3be7,0xb1473be4,0xb1913be1
.long 0xb23e3bd9,0xb2a13bd4,0xb3033bce,0xb3653bc9,0xb3c63bc3,0xb4203bbb,0xb45d3bb2,0xb4993baa,0xb4a53ba8,0xb4ed3b9d,0xb5343b91,0xb57c3b84,0xb5643b88,0xb5b63b79,0xb6083b69,0xb6593b58
.long 0xb61f3b64,0xb67c3b50,0xb6d73b3b,0xb7323b25,0xb6d73b3b,0xb73d3b22,0xb7a13b08,0xb8023aed,0xb78b3b0e,0xb7f93af0,0xb8323ad0,0xb8673aae,0xb81d3add,0xb8583ab8,0xb8913a92,0xb8c93a69
.long 0xb8723aa7,0xb8b03a7c,0xb8ec3a4f,0xb9273a1f,0xb8c43a6d,0xb9053a3b,0xb9433a07,0xb98039d0,0xb9133a2f,0xb95639f6,0xb99639ba,0xb9d4397b,0xb95f39ed,0xb9a439ad,0xb9e53969,0xba233922
.long 0xb9a839a8,0xb9ed395f,0xba2f3913,0xba6d38c4,0xb9ed395f,0xba33390e,0xba7438ba,0xbab13862,0xba2f3913,0xba7438ba,0xbab5385d,0xbaf037f9,0xba6d38c4,0xbab13862,0xbaf037f9,0xbb283726
.long 0xbaa73872,0xbae93807,0xbb253732,0xbb5a364e,0xbadd381d,0xbb1d3753,0xbb553665,0xbb863570,0xbb0e378b,0xbb4b3693,0xbb803593,0xbbab348d,0xbb3b36d7,0xbb7435ce,0xbba434bd,0xbbca334c
.long 0xbb64361f,0xbb993505,0xbbc333c6,0xbbe23179,0xbb883564,0xbbb73438,0xbbdb320d,0xbbf32f40,0xbba834a5,0xbbd132d2,0xbbed304e,0xbbfd2b11,0xbbc333c6,0xbbe5312e,0xbbf92d1a,0xbc009a48
.long 0xbbd9323e,0xbbf42f0e,0xbbff2648,0xbbfcabd9,0xbbea30b2,0xbbfd2b75,0xbbffa7da,0xbbf1afa4,0xbbf62e46,0xbc001e48,0xbbf8ad7e,0xbbe0b1aa,0xbbfe2a48,0xbbfea9e3,0xbbecb080,0xbbc7b37d
.long 0x80003c00,0x80003c00,0x80003c00,0x80003c00,0xabd93bfc,0xac1f3bfc,0xac513bfb,0xac833bfb,0xafd63bf1,0xb01d3bef,0xb04e3bed,0xb0803bec,0xb1db3bdd,0xb2263bda,0xb26f3bd6,0xb2b93bd2
.long 0xb3c63bc3,0xb4143bbc,0xb4443bb6,0xb4753baf,0xb4d53ba0,0xb5113b97,0xb54c3b8c,0xb5873b82,0xb5c23b77,0xb6083b69,0xb64e3b5a,0xb6933b4b,0xb6aa3b46,0xb6f93b33,0xb7483b20,0xb7963b0b
.long 0xb78b3b0e,0xb7e33af6,0xb81d3add,0xb8483ac2,0xb8323ad0,0xb8623ab1,0xb8913a92,0xb8bf3a71,0xb89b3a8a,0xb8ce3a65,0xb9003a3f,0xb9303a17,0xb9003a3f,0xb9353a13,0xb96939e5,0xb99b39b5
.long 0xb95f39ed,0xb99639ba,0xb9cb3984,0xb9fe394d,0xb9ba3996,0xb9f2395b,0xba27391d,0xba5a38dd,0xba0f393a,0xba4738f6,0xba7c38b0,0xbaae3867,0xba5e38d8,0xba95388c,0xbac9383d,0xbaf937d8
.long 0xbaa73872,0xbadd381d,0xbb0e378b,0xbb3b36d7,0xbae93807,0xbb1d3753,0xbb4b3693,0xbb7435ce,0xbb253732,0xbb553665,0xbb803593,0xbba434bd,0xbb5a364e,0xbb863570,0xbbab348d,0xbbca334c
.long 0xbb883564,0xbbaf3475,0xbbce3303,0xbbe63115,0xbbaf3475,0xbbd032ea,0xbbe830e4,0xbbf82db0,0xbbce3303,0xbbe830e4,0xbbf82d7e,0xbc0024b6,0xbbe63115,0xbbf82db0,0xbc0024b6,0xbbfdaaac
.long 0xbbf62e46,0xbbff2648,0xbbfeaa48,0xbbf1afd6,0xbbff28b6,0xbbfea91b,0xbbf2af72,0xbbdab226,0xbbffa648,0xbbf5aeaa,0xbbddb1db,0xbbb9b42c,0xbbf8ad7e,0xbbe3b160,0xbbc0b3f7,0xbb8fb540
.long 0xbbeab0b2,0xbbc9b365,0xbb99b505,0xbb5ab64e,0xbbd4b2a1,0xbba6b4b1,0xbb69b608,0xbb1db753,0xbbb6b444,0xbb7bb5ab,0xbb30b705,0xbad6b828,0xbb91b534,0xbb49b69e,0xbaf0b7f9,0xba87b8a0
.long 0x80003c00,0x80003c00,0x80003c00,0x80003c00,0xacb53bfa,0xace73bfa,0xad1a3bf9,0xad4c3bf9,0xb0b23bea,0xb0e43be8,0xb1153be6,0xb1473be4,0xb3033bce,0xb34c3bca,0xb3963bc6,0xb3df3bc1
.long 0xb4a53ba8,0xb4d53ba0,0xb5053b99,0xb5343b91,0xb5c23b77,0xb5fd3b6b,0xb6373b5f,0xb6703b53,0xb6d73b3b,0xb71b3b2b,0xb75e3b1a,0xb7a13b08,0xb7e33af6,0xb8173ae0,0xb83d3ac9,0xb8623ab1
.long 0xb8723aa7,0xb89b3a8a,0xb8c43a6d,0xb8ec3a4f,0xb8ec3a4f,0xb9183a2b,0xb9433a07,0xb96d39e1,0xb95f39ed,0xb98d39c3,0xb9ba3996,0xb9e53969,0xb9cb3984,0xb9fa3951,0xba27391d,0xba5238e7
.long 0xba2f3913,0xba5e38d8,0xba8a389b,0xbab5385d,0xba8a389b,0xbab83858,0xbae33812,0xbb0b3796,0xbadd381d,0xbb0837a1,0xbb303705,0xbb553665,0xbb253732,0xbb4e3687,0xbb7235da,0xbb933529
.long 0xbb64361f,0xbb883564,0xbba834a5,0xbbc333c6,0xbb993505,0xbbb73438,0xbbd132d2,0xbbe5312e,0xbbc333c6,0xbbdb320d,0xbbed304e,0xbbf92d1a,0xbbe23179,0xbbf32f40,0xbbfd2b11,0xbc009a48
.long 0xbbf62e46,0xbbff28b6,0xbbffa648,0xbbf8ad7e,0xbbff2648,0xbbfea91b,0xbbf5aeaa,0xbbe3b160,0xbbfeaa48,0xbbf2af72,0xbbddb1db,0xbbc0b3f7,0xbbf1afd6,0xbbdab226,0xbbb9b42c,0xbb8fb540
.long 0xbbd9b23e,0xbbb6b444,0xbb88b564,0xbb50b67c,0xbbb6b444,0xbb86b570,0xbb4bb693,0xbb05b7ac,0xbb88b564,0xbb4bb693,0xbb02b7b7,0xbaaeb867,0xbb50b67c,0xbb05b7ac,0xbaaeb867,0xba4bb8f1
.long 0xbb0eb78b,0xbab5b85d,0xba4fb8ec,0xb9dcb972,0xbac2b848,0xba5ab8dd,0xb9e5b969,0xb964b9e9,0xba6db8c4,0xb9f6b956,0xb972b9dc,0xb8e2ba56,0xba0fb93a,0xb989b9c7,0xb8f6ba47,0xb858bab8
.long 0x80003c00,0x80003c00,0x80003c00,0x80003c00,0xad7e3bf8,0xadb03bf8,0xade23bf7,0xae143bf7,0xb1793be2,0xb1aa3be0,0xb1db3bdd,0xb20d3bdb,0xb4143bbc,0xb4383bb7,0xb45d3bb2,0xb4813bad
.long 0xb5643b88,0xb5933b80,0xb5c23b77,0xb5f13b6e,0xb6aa3b46,0xb6e33b39,0xb71b3b2b,0xb7533b1d,0xb7e33af6,0xb8123ae3,0xb8323ad0,0xb8523abc,0xb8873a99,0xb8ab3a7f,0xb8ce3a65,0xb8f13a4b
.long 0xb9133a2f,0xb93a3a0f,0xb95f39ed,0xb98439cb,0xb99639ba,0xb9be3992,0xb9e53969,0xba0b393e,0xba0f393a,0xba373909,0xba5e38d8,0xba8338a6,0xba7c38b0,0xbaa33877,0xbac9383d,0xbaed3802
.long 0xbadd381d,0xbb0237b7,0xbb253732,0xbb4636aa,0xbb303705,0xbb533670,0xbb7235da,0xbb8f3540,0xbb7735c2,0xbb95351d,0xbbaf3475,0xbbc63396,0xbbaf3475,0xbbc7337d,0xbbdb320d,0xbbeb3099
.long 0xbbd9323e,0xbbea30b2,0xbbf62e46,0xbbfe2a48,0xbbf42f0e,0xbbfd2b75,0xbc001e48,0xbbfea9e3,0xbbff2648,0xbbffa7da,0xbbf8ad7e,0xbbecb080,0xbbfcabd9,0xbbf1afa4,0xbbe0b1aa,0xbbc7b37d
.long 0xbbeab0b2,0xbbd4b2a1,0xbbb6b444,0xbb91b534,0xbbc9b365,0xbba6b4b1,0xbb7bb5ab,0xbb49b69e,0xbb99b505,0xbb69b608,0xbb30b705,0xbaf0b7f9,0xbb5ab64e,0xbb1db753,0xbad6b828,0xba87b8a0
.long 0xbb0eb78b,0xbac2b848,0xba6db8c4,0xba0fb93a,0xbab5b85d,0xba5ab8dd,0xb9f6b956,0xb989b9c7,0xba4fb8ec,0xb9e5b969,0xb972b9dc,0xb8f6ba47,0xb9dcb972,0xb964b9e9,0xb8e2ba56,0xb858bab8
.long 0xb95fb9ed,0xb8d8ba5e,0xb848bac2,0xb75ebb1a,0xb8d8ba5e,0xb842bac6,0xb748bb20,0xb5fdbb6b,0xb848bac2,0xb748bb20,0xb5f1bb6e,0xb48dbbab,0xb75ebb1a,0xb5fdbb6b,0xb48dbbab,0xb226bbda
.long 0x80003c00,0x80003c00,0x80003c00,0x80003c00,0xae463bf6,0xae783bf6,0xaeaa3bf5,0xaedc3bf4,0xb23e3bd9,0xb26f3bd6,0xb2a13bd4,0xb2d23bd1,0xb4a53ba8,0xb4c93ba2,0xb4ed3b9d,0xb5113b97
.long 0xb61f3b64,0xb64e3b5a,0xb67c3b50,0xb6aa3b46,0xb78b3b0e,0xb7c23aff,0xb7f93af0,0xb8173ae0,0xb8723aa7,0xb8913a92,0xb8b03a7c,0xb8ce3a65,0xb9133a2f,0xb9353a13,0xb95639f6,0xb97639d8
.long 0xb9a839a8,0xb9cb3984,0xb9ed395f,0xba0f393a,0xba2f3913,0xba5238e7,0xba7438ba,0xba95388c,0xbaa73872,0xbac9383d,0xbae93807,0xbb0837a1,0xbb0e378b,0xbb2e3710,0xbb4b3693,0xbb673614
.long 0xbb64361f,0xbb803593,0xbb993505,0xbbaf3475,0xbba834a5,0xbbbe3408,0xbbd132d2,0xbbe13191,0xbbd9323e,0xbbe830e4,0xbbf42f0e,0xbbfb2c51,0xbbf62e46,0xbbfd2aac,0xbc001e48,0xbbfea91b
.long 0xbc000000,0xbbfeaa48,0xbbf6ae46,0xbbeab0b2,0xbbf6ae46,0xbbe9b0cb,0xbbd6b26f,0xbbbeb408,0xbbd9b23e,0xbbc0b3f7,0xbba0b4d5,0xbb7bb5ab,0xbba8b4a5,0xbb82b587,0xbb55b665,0xbb22b73d
.long 0xbb64b61f,0xbb30b705,0xbaf6b7e3,0xbab5b85d,0xbb0eb78b,0xbaccb838,0xba83b8a6,0xba33b90e,0xbaa7b872,0xba56b8e2,0xb9feb94d,0xb99fb9b1,0xba2fb913,0xb9d0b980,0xb969b9e5,0xb8fbba43
.long 0xb9a8b9a8,0xb93aba0f,0xb8c4ba6d,0xb848bac2,0xb913ba2f,0xb896ba8e,0xb812bae3,0xb710bb2e,0xb872baa7,0xb7cdbafc,0xb6aabb46,0xb57cbb84,0xb78bbb0e,0xb659bb58,0xb51dbb95,0xb3aebbc4
.long 0xb61fbb64,0xb4d5bba0,0xb303bbce,0xb04ebbed,0xb4a5bba8,0xb288bbd5,0xaf72bbf2,0xa711bbff,0xb23ebbd9,0xaeaabbf5,0xa248bc00,0x2d1abbf9,0xae46bbf6,0x9a48bc00,0x2de2bbf7,0x31f4bbdc
.long 0x80003c00,0x80003c00,0x80003c00,0x80003c00,0xaf0e3bf4,0xaf403bf3,0xaf723bf2,0xafa43bf1,0xb3033bce,0xb3343bcb,0xb3653bc9,0xb3963bc6,0xb5343b91,0xb5583b8a,0xb57c3b84,0xb59f3b7d
.long 0xb6d73b3b,0xb7053b30,0xb7323b25,0xb75e3b1a,0xb8323ad0,0xb84d3abf,0xb8673aae,0xb8813a9c,0xb8ec3a4f,0xb9093a37,0xb9273a1f,0xb9433a07,0xb99639ba,0xb9b5399b,0xb9d4397b,0xb9f2395b
.long 0xba2f3913,0xba4f38ec,0xba6d38c4,0xba8a389b,0xbab5385d,0xbad3382d,0xbaf037f9,0xbb0b3796,0xbb253732,0xbb4136c1,0xbb5a364e,0xbb7235da,0xbb803593,0xbb973511,0xbbab348d,0xbbbe3408
.long 0xbbc333c6,0xbbd432a1,0xbbe23179,0xbbed304e,0xbbed304e,0xbbf72e14,0xbbfd2b11,0xbc0023db,0xbbff2648,0xbc00a4b6,0xbbfcabd9,0xbbf5aeaa,0xbbf8ad7e,0xbbeeb036,0xbbe0b1aa,0xbbcdb31b
.long 0xbbd9b23e,0xbbc3b3c6,0xbba8b4a5,0xbb88b564,0xbba0b4d5,0xbb7db59f,0xbb55b665,0xbb28b726,0xbb50b67c,0xbb20b748,0xbae9b807,0xbaaeb867,0xbae9b807,0xbaaab86d,0xba65b8ce,0xba1bb92b
.long 0xba6db8c4,0xba1fb927,0xb9cbb984,0xb972b9dc,0xb9dcb972,0xb980b9d0,0xb91dba27,0xb8b5ba78,0xb93aba0f,0xb8ceba65,0xb85dbab5,0xb7cdbafc,0xb887ba99,0xb80dbae6,0xb71bbb2b,0xb614bb67
.long 0xb78bbb0e,0xb67cbb50,0xb564bb88,0xb444bbb6,0xb5f1bb6e,0xb4c9bba2,0xb334bbcb,0xb0cbbbe9,0xb444bbb6,0xb20dbbdb,0xaf0ebbf4,0xa7dabbff,0xb115bbe6,0xace7bbfa,0x1e48bc00,0x2db0bbf8
.long 0xaa48bbfe,0x28b6bbff,0x2fd6bbf1,0x32a1bbd4,0x2bd9bbfc,0x30cbbbe9,0x3396bbc6,0x3529bb93,0x3179bbe2,0x342cbbb9,0x3593bb80,0x36eebb36,0x3475bbaf,0x35e5bb70,0x3748bb20,0x384dbabf
.long 0x80003c00,0x80003c00,0x80003c00,0x80003c00,0xafd63bf1,0xb0043bf0,0xb01d3bef,0xb0363bee,0xb3c63bc3,0xb3f73bc0,0xb4143bbc,0xb42c3bb9,0xb5c23b77,0xb5e53b70,0xb6083b69,0xb62b3b62
.long 0xb78b3b0e,0xb7b73b02,0xb7e33af6,0xb8073ae9,0xb89b3a8a,0xb8b53a78,0xb8ce3a65,0xb8e73a52,0xb95f39ed,0xb97b39d4,0xb99639ba,0xb9b1399f,0xba0f393a,0xba2b3918,0xba4738f6,0xba6238d3
.long 0xbaa73872,0xbac23848,0xbadd381d,0xbaf637e3,0xbb253732,0xbb3e36cc,0xbb553665,0xbb6b35fd,0xbb883564,0xbb9d34ed,0xbbaf3475,0xbbc033f7,0xbbce3303,0xbbdc31f4,0xbbe830e4,0xbbf12fa4
.long 0xbbf62e46,0xbbfc2bd9,0xbbff2648,0xbc00a248,0xbbffa648,0xbbfcac1f,0xbbf5aeaa,0xbbebb099,0xbbeab0b2,0xbbdbb20d,0xbbc9b365,0xbbb2b45d,0xbbb6b444,0xbb9bb4f9,0xbb7bb5ab,0xbb58b659
.long 0xbb64b61f,0xbb3bb6d7,0xbb0eb78b,0xbaddb81d,0xbaf6b7e3,0xbabfb84d,0xba83b8a6,0xba43b8fb,0xba6db8c4,0xba27b91d,0xb9dcb972,0xb98db9c3,0xb9cbb984,0xb976b9d8,0xb91dba27,0xb8bfba71
.long 0xb913ba2f,0xb8b0ba7c,0xb848bac2,0xb7b7bb02,0xb848bac2,0xb7acbb05,0xb6c1bb41,0xb5cebb74,0xb6d7bb3b,0xb5dabb72,0xb4d5bba0,0xb396bbc6,0xb505bb99,0xb3dfbbc1,0xb1aabbe0,0xaedcbbf4
.long 0xb23ebbd9,0xafd6bbf1,0xaa48bbfe,0x2648bbff,0xacb5bbfa,0x1a48bc00,0x2d1abbf9,0x30fdbbe7,0x2a48bbfe,0x301dbbef,0x32a1bbd4,0x348dbbab,0x3179bbe2,0x3408bbbe,0x354cbb8c,0x3687bb4e
.long 0x34a5bba8,0x35f1bb6e,0x3732bb25,0x3832bad0,0x367cbb50,0x37c2baff,0x387cbaa0,0x390eba33,0x381dbadd,0x38baba74,0x394db9fe,0x39d4b97b,0x38ecba4f,0x3980b9d0,0x3a07b943,0x3a7fb8ab
.long 0x80003c00,0x80003c00,0x80003c00,0x80003c00,0xb04e3bed,0xb0673bed,0xb0803bec,0xb0993beb,0xb4443bb6,0xb45d3bb2,0xb4753baf,0xb48d3bab,0xb64e3b5a,0xb6703b53,0xb6933b4b,0xb6b53b43
.long 0xb81d3add,0xb8323ad0,0xb8483ac2,0xb85d3ab5,0xb9003a3f,0xb9183a2b,0xb9303a17,0xb9483a02,0xb9cb3984,0xb9e53969,0xb9fe394d,0xba173930,0xba7c38b0,0xba95388c,0xbaae3867,0xbac63842
.long 0xbb0e378b,0xbb253732,0xbb3b36d7,0xbb50367c,0xbb803593,0xbb933529,0xbba434bd,0xbbb43451,0xbbce3303,0xbbdb320d,0xbbe63115,0xbbef301d,0xbbf82d7e,0xbbfd2aac,0xbc0024b6,0xbc00a3db
.long 0xbbfeaa48,0xbbf8ad7e,0xbbf1afd6,0xbbe6b115,0xbbddb1db,0xbbcdb31b,0xbbb9b42c,0xbba2b4c9,0xbb99b505,0xbb7bb5ab,0xbb5ab64e,0xbb36b6ee,0xbb30b705,0xbb05b7ac,0xbad6b828,0xbaa3b877
.long 0xbaa7b872,0xba6db8c4,0xba2fb913,0xb9edb95f,0xb9feb94d,0xb9b5b99b,0xb969b9e5,0xb918ba2b,0xb93aba0f,0xb8e2ba56,0xb887ba99,0xb828bad6,0xb85dbab5,0xb7eebaf3,0xb71bbb2b,0xb642bb5d
.long 0xb6d7bb3b,0xb5f1bb6e,0xb505bb99,0xb414bbbc,0xb4d5bba0,0xb3aebbc4,0xb1aabbe0,0xaf40bbf3,0xb179bbe2,0xaeaabbf5,0xa8b6bbff,0x27dabbff,0xa8b6bbff,0x2852bbff,0x2eaabbf5,0x3191bbe1
.long 0x2e46bbf6,0x3179bbe2,0x33c6bbc3,0x3505bb99,0x3365bbc9,0x34e1bb9e,0x3608bb69,0x3726bb28,0x35c2bb77,0x36eebb36,0x3807bae9,0x3891ba92,0x37b7bb02,0x386dbaaa,0x38f6ba47,0x3976b9d8
.long 0x38c4ba6d,0x394db9fe,0x39cbb984,0x3a3fb900,0x3996b9ba,0x3a13b935,0x3a83b8a6,0x3ae6b80d,0x3a4fb8ec,0x3abcb852,0x3b1ab75e,0x3b69b608,0x3ae9b807,0x3b43b6b5,0x3b8cb54c,0x3bc4b3ae
.long 0x80003c00,0x80003c00,0x80003c00,0x80003c00,0xb0b23bea,0xb0cb3be9,0xb0e43be8,0xb0fd3be7,0xb4a53ba8,0xb4bd3ba4,0xb4d53ba0,0xb4ed3b9d,0xb6d73b3b,0xb6f93b33,0xb71b3b2b,0xb73d3b22
.long 0xb8723aa7,0xb8873a99,0xb89b3a8a,0xb8b03a7c,0xb95f39ed,0xb97639d8,0xb98d39c3,0xb9a439ad,0xba2f3913,0xba4738f6,0xba5e38d8,0xba7438ba,0xbadd381d,0xbaf337ee,0xbb0837a1,0xbb1d3753
.long 0xbb64361f,0xbb7735c2,0xbb883564,0xbb993505,0xbbc333c6,0xbbd032ea,0xbbdb320d,0xbbe5312e,0xbbf62e46,0xbbfb2c51,0xbbff28b6,0xbc001e48,0xbbfeaa48,0xbbf9ad4c,0xbbf2af72,0xbbe9b0cb
.long 0xbbd9b23e,0xbbc9b365,0xbbb6b444,0xbba0b4d5,0xbb88b564,0xbb6bb5fd,0xbb4bb693,0xbb28b726,0xbb0eb78b,0xbae3b812,0xbab5b85d,0xba83b8a6,0xba6db8c4,0xba33b90e,0xb9f6b956,0xb9b5b99b
.long 0xb9a8b9a8,0xb95fb9ed,0xb913ba2f,0xb8c4ba6d,0xb8c4ba6d,0xb86dbaaa,0xb812bae3,0xb76abb17,0xb78bbb0e,0xb6c1bb41,0xb5f1bb6e,0xb51dbb95,0xb564bb88,0xb481bbad,0xb334bbcb,0xb160bbe3
.long 0xb23ebbd9,0xb04ebbed,0xacb5bbfa,0xa248bc00,0xaa48bbfe,0x23dbbc00,0x2d1abbf9,0x3099bbeb,0x2e46bbf6,0x3147bbe4,0x3365bbc9,0x34bdbba4,0x33c6bbc3,0x34f9bb9b,0x3608bb69,0x3710bb2e
.long 0x361fbb64,0x3732bb25,0x381dbadd,0x389bba8a,0x381dbadd,0x38a0ba87,0x391dba27,0x3992b9be,0x3913ba2f,0x398db9c3,0x39feb94d,0x3a65b8ce,0x39edb95f,0x3a5ab8dd,0x3abcb852,0x3b11b780
.long 0x3aa7b872,0x3b02b7b7,0x3b50b67c,0x3b91b534,0x3b3bb6d7,0x3b82b587,0x3bb9b42c,0x3be1b191,0x3ba8b4a5,0x3bd6b26f,0x3bf4af0e,0x3c00a4b6,0x3beab0b2,0x3bfdaaac,0x3bfe297f,0x3bed3067
.long 0x80003c00,0x80003c00,0x80003c00,0x80003c00,0xb1153be6,0xb12e3be5,0xb1473be4,0xb1603be3,0xb5053b99,0xb51d3b95,0xb5343b91,0xb54c3b8c,0xb75e3b1a,0xb7803b11,0xb7a13b08,0xb7c23aff
.long 0xb8c43a6d,0xb8d83a5e,0xb8ec3a4f,0xb9003a3f,0xb9ba3996,0xb9d03980,0xb9e53969,0xb9fa3951,0xba8a389b,0xbaa0387c,0xbab5385d,0xbac9383d,0xbb303705,0xbb4336b5,0xbb553665,0xbb673614
.long 0xbba834a5,0xbbb63444,0xbbc333c6,0xbbce3303,0xbbed304e,0xbbf42edc,0xbbf92d1a,0xbbfd2aac,0xbbffa648,0xbbfdab11,0xbbf8ad7e,0xbbf2af72,0xbbddb1db,0xbbd0b2ea,0xbbc0b3f7,0xbbadb481
.long 0xbb88b564,0xbb6eb5f1,0xbb50b67c,0xbb30b705,0xbb02b7b7,0xbad9b822,0xbaaeb867,0xba7fb8ab,0xba4fb8ec,0xba17b930,0xb9dcb972,0xb99fb9b1,0xb972b9dc,0xb92bba1b,0xb8e2ba56,0xb896ba8e
.long 0xb872baa7,0xb81dbadd,0xb78bbb0e,0xb6d7bb3b,0xb6aabb46,0xb5e5bb70,0xb51dbb95,0xb451bbb4,0xb444bbb6,0xb2d2bbd1,0xb115bbe6,0xaeaabbf5,0xaf0ebbf4,0xaaacbbfd,0x1e48bc00,0x2c1fbbfc
.long 0x2a48bbfe,0x2f0ebbf4,0x3179bbe2,0x3365bbc9,0x32a1bbd4,0x3451bbb4,0x354cbb8c,0x3642bb5d,0x35c2bb77,0x36c1bb41,0x37b7bb02,0x3852babc,0x3807bae9,0x3881ba9c,0x38f6ba47,0x3964b9e9
.long 0x3913ba2f,0x3984b9cb,0x39edb95f,0x3a4fb8ec,0x39feb94d,0x3a62b8d3,0x3abcb852,0x3b0bb796,0x3ac2b848,0x3b14b775,0x3b5ab64e,0x3b95b51d,0x3b5ab64e,0x3b97b511,0x3bc6b396,0x3be7b0fd
.long 0x3bc3b3c6,0x3be6b115,0x3bfaacb5,0x3c002248,0x3bf8ad7e,0x3c001a48,0x3bf72de2,0x3bdf31c3,0x3bfa2cb5,0x3be43147,0x3bbc3414,0x3b84357c,0x3bc93365,0x3b933529,0x3b4b3693,0x3af337ee
.long 0x80003c00,0x80003c00,0x80003c00,0x80003c00,0xb1793be2,0xb1913be1,0xb1aa3be0,0xb1c33bdf,0xb5643b88,0xb57c3b84,0xb5933b80,0xb5ab3b7b,0xb7e33af6,0xb8023aed,0xb8123ae3,0xb8223ad9
.long 0xb9133a2f,0xb9273a1f,0xb93a3a0f,0xb94d39fe,0xba0f393a,0xba233922,0xba373909,0xba4b38f1,0xbadd381d,0xbaf037f9,0xbb0237b7,0xbb143775,0xbb7735c2,0xbb863570,0xbb95351d,0xbba234c9
.long 0xbbd9323e,0xbbe23179,0xbbea30b2,0xbbf12fd6,0xbbff2648,0xbc009a48,0xbbffa7da,0xbbfdab75,0xbbeab0b2,0xbbe0b1aa,0xbbd4b2a1,0xbbc6b396,0xbb99b505,0xbb82b587,0xbb69b608,0xbb4eb687
.long 0xbb0eb78b,0xbae9b807,0xbac2b848,0xba99b887,0xba4fb8ec,0xba1bb92b,0xb9e5b969,0xb9adb9a4,0xb95fb9ed,0xb91dba27,0xb8d8ba5e,0xb891ba92,0xb848bac2,0xb7eebaf3,0xb748bb20,0xb69ebb49
.long 0xb61fbb64,0xb564bb88,0xb4a5bba8,0xb3c6bbc3,0xb303bbce,0xb160bbe3,0xaf72bbf2,0xac1fbbfc,0xaa48bbfe,0x1e48bc00,0x2bd9bbfc,0x2f72bbf2,0x2fd6bbf1,0x31c3bbdf,0x3396bbc6,0x34b1bba6
.long 0x34a5bba8,0x3593bb80,0x367cbb50,0x375ebb1a,0x3732bb25,0x380dbae6,0x387cbaa0,0x38e7ba52,0x38c4ba6d,0x3930ba17,0x3996b9ba,0x39f6b956,0x39cbb984,0x3a2bb918,0x3a83b8a6,0x3ad3b82d
.long 0x3aa7b872,0x3af6b7e3,0x3b3bb6d7,0x3b77b5c2,0x3b50b67c,0x3b8ab558,0x3bb9b42c,0x3bdcb1f4,0x3bc3b3c6,0x3be4b147,0x3bf8ad7e,0x3c009e48,0x3bfaacb5,0x3c0020b6,0x3bf72de2,0x3be13191
.long 0x3bf62e46,0x3bdd31db,0x3bb63444,0x3b803593,0x3bb63444,0x3b7d359f,0x3b3636ee,0x3ae03817,0x3b3b36d7,0x3ae33812,0x3a7c38b0,0x3a073943,0x3a8a389b,0x3a133935,0x398d39c3,0x38fb3a43
.long 0x80003c00,0x80003c00,0x80003c00,0x80003c00,0xb1db3bdd,0xb1f43bdc,0xb20d3bdb,0xb2263bda,0xb5c23b77,0xb5da3b72,0xb5f13b6e,0xb6083b69,0xb8323ad0,0xb8423ac6,0xb8523abc,0xb8623ab1
.long 0xb95f39ed,0xb97239dc,0xb98439cb,0xb99639ba,0xba5e38d8,0xba7138bf,0xba8338a6,0xba95388c,0xbb253732,0xbb3636ee,0xbb4636aa,0xbb553665,0xbbaf3475,0xbbbb3420,0xbbc63396,0xbbd032ea
.long 0xbbf62e46,0xbbfa2cb5,0xbbfe2a48,0xbbff2648,0xbbf8ad7e,0xbbf3af40,0xbbecb080,0xbbe3b160,0xbbb6b444,0xbba4b4bd,0xbb91b534,0xbb7bb5ab,0xbb30b705,0xbb11b780,0xbaf0b7f9,0xbaccb838
.long 0xba6db8c4,0xba3fb900,0xba0fb93a,0xb9dcb972,0xb972b9dc,0xb935ba13,0xb8f6ba47,0xb8b5ba78,0xb848bac2,0xb7f9baf0,0xb75ebb1a,0xb6c1bb41,0xb5f1bb6e,0xb540bb8f,0xb48dbbab,0xb3aebbc4
.long 0xb23ebbd9,0xb0b2bbea,0xae46bbf6,0xaa48bbfe,0xa248bc00,0x291bbbfe,0x2de2bbf7,0x3099bbeb,0x3179bbe2,0x3334bbcb,0x3475bbaf,0x354cbb8c,0x3593bb80,0x3670bb53,0x3748bb20,0x380dbae6
.long 0x381dbadd,0x3887ba99,0x38ecba4f,0x394db9fe,0x394db9fe,0x39adb9a4,0x3a07b943,0x3a5ab8dd,0x3a4fb8ec,0x3aa0b87c,0x3ae9b807,0x3b2bb71b,0x3b1ab75e,0x3b58b659,0x3b8cb54c,0x3bb7b438
.long 0x3ba8b4a5,0x3bceb303,0x3beab0b2,0x3bfaacb5,0x3bf4af0e,0x3bffa852,0x3bfe297f,0x3bf12fa4,0x3bfa2cb5,0x3be830e4,0x3bc93365,0x3b9d34ed,0x3bbc3414,0x3b8a3558,0x3b4b3693,0x3aff37c2
.long 0x3b3b36d7,0x3ae93807,0x3a8a389b,0x3a1f3927,0x3a7c38b0,0x3a0b393e,0x398d39c3,0x39053a3b,0x398439cb,0x38f63a47,0x385d3ab5,0x37753b14,0x385d3ab5,0x376a3b17,0x36083b69,0x34993baa
.long 0x3c00,0x3c00,0x3c00,0x3c00,0x3c00,0x1e483c00,0x22483c00,0x24b63c00,0x3c00,0x22483c00,0x26483bff,0x28b63bff,0x3c00,0x24b63c00,0x28b63bff,0x2b113bfd
.long 0x3c00,0x26483bff,0x2a483bfe,0x2cb53bfa,0x3c00,0x27da3bff,0x2bd93bfc,0x2de23bf7,0x3c00,0x28b63bff,0x2cb53bfa,0x2f0e3bf4,0x3c00,0x297f3bfe,0x2d7e3bf8,0x301d3bef
.long 0x3c00,0x2a483bfe,0x2e463bf6,0x30b23bea,0x3c00,0x2b113bfd,0x2f0e3bf4,0x31473be4,0x3c00,0x2bd93bfc,0x2fd63bf1,0x31db3bdd,0x3c00,0x2c513bfb,0x304e3bed,0x326f3bd6
.long 0x3c00,0x2cb53bfa,0x30b23bea,0x33033bce,0x3c00,0x2d1a3bf9,0x31153be6,0x33963bc6,0x3c00,0x2d7e3bf8,0x31793be2,0x34143bbc,0x3c00,0x2de23bf7,0x31db3bdd,0x345d3bb2
.long 0x3c00,0x2e463bf6,0x323e3bd9,0x34a53ba8,0x3c00,0x2eaa3bf5,0x32a13bd4,0x34ed3b9d,0x3c00,0x2f0e3bf4,0x33033bce,0x35343b91,0x3c00,0x2f723bf2,0x33653bc9,0x357c3b84
.long 0x3c00,0x2fd63bf1,0x33c63bc3,0x35c23b77,0x3c00,0x301d3bef,0x34143bbc,0x36083b69,0x3c00,0x304e3bed,0x34443bb6,0x364e3b5a,0x3c00,0x30803bec,0x34753baf,0x36933b4b
.long 0x3c00,0x30b23bea,0x34a53ba8,0x36d73b3b,0x3c00,0x30e43be8,0x34d53ba0,0x371b3b2b,0x3c00,0x31153be6,0x35053b99,0x375e3b1a,0x3c00,0x31473be4,0x35343b91,0x37a13b08
.long 0x3c00,0x31793be2,0x35643b88,0x37e33af6,0x3c00,0x31aa3be0,0x35933b80,0x38123ae3,0x3c00,0x31db3bdd,0x35c23b77,0x38323ad0,0x3c00,0x320d3bdb,0x35f13b6e,0x38523abc
.long 0x3c00,0x3c00,0x3c00,0x3c00,0x26483bff,0x27da3bff,0x28b63bff,0x297f3bfe,0x2a483bfe,0x2bd93bfc,0x2cb53bfa,0x2d7e3bf8,0x2cb53bfa,0x2de23bf7,0x2f0e3bf4,0x301d3bef
.long 0x2e463bf6,0x2fd63bf1,0x30b23bea,0x31793be2,0x2fd63bf1,0x30e43be8,0x31db3bdd,0x32d23bd1,0x30b23bea,0x31db3bdd,0x33033bce,0x34143bbc,0x31793be2,0x32d23bd1,0x34143bbc,0x34bd3ba4
.long 0x323e3bd9,0x33c63bc3,0x34a53ba8,0x35643b88,0x33033bce,0x345d3bb2,0x35343b91,0x36083b69,0x33c63bc3,0x34d53ba0,0x35c23b77,0x36aa3b46,0x34443bb6,0x354c3b8c,0x364e3b5a,0x37483b20
.long 0x34a53ba8,0x35c23b77,0x36d73b3b,0x37e33af6,0x35053b99,0x36373b5f,0x375e3b1a,0x383d3ac9,0x35643b88,0x36aa3b46,0x37e33af6,0x38873a99,0x35c23b77,0x371b3b2b,0x38323ad0,0x38ce3a65
.long 0x361f3b64,0x378b3b0e,0x38723aa7,0x39133a2f,0x367c3b50,0x37f93af0,0x38b03a7c,0x395639f6,0x36d73b3b,0x38323ad0,0x38ec3a4f,0x399639ba,0x37323b25,0x38673aae,0x39273a1f,0x39d4397b
.long 0x378b3b0e,0x389b3a8a,0x395f39ed,0x3a0f393a,0x37e33af6,0x38ce3a65,0x399639ba,0x3a4738f6,0x381d3add,0x39003a3f,0x39cb3984,0x3a7c38b0,0x38483ac2,0x39303a17,0x39fe394d,0x3aae3867
.long 0x38723aa7,0x395f39ed,0x3a2f3913,0x3add381d,0x389b3a8a,0x398d39c3,0x3a5e38d8,0x3b0837a1,0x38c43a6d,0x39ba3996,0x3a8a389b,0x3b303705,0x38ec3a4f,0x39e53969,0x3ab5385d,0x3b553665
.long 0x39133a2f,0x3a0f393a,0x3add381d,0x3b7735c2,0x393a3a0f,0x3a373909,0x3b0237b7,0x3b95351d,0x395f39ed,0x3a5e38d8,0x3b253732,0x3baf3475,0x398439cb,0x3a8338a6,0x3b4636aa,0x3bc63396
.long 0x3c00,0x3c00,0x3c00,0x3c00,0x2a483bfe,0x2b113bfd,0x2bd93bfc,0x2c513bfb,0x2e463bf6,0x2f0e3bf4,0x2fd63bf1,0x304e3bed,0x30b23bea,0x31473be4,0x31db3bdd,0x326f3bd6
.long 0x323e3bd9,0x33033bce,0x33c63bc3,0x34443bb6,0x33c63bc3,0x345d3bb2,0x34d53ba0,0x354c3b8c,0x34a53ba8,0x35343b91,0x35c23b77,0x364e3b5a,0x35643b88,0x36083b69,0x36aa3b46,0x37483b20
.long 0x361f3b64,0x36d73b3b,0x378b3b0e,0x381d3add,0x36d73b3b,0x37a13b08,0x38323ad0,0x38913a92,0x378b3b0e,0x38323ad0,0x389b3a8a,0x39003a3f,0x381d3add,0x38913a92,0x39003a3f,0x396939e5
.long 0x38723aa7,0x38ec3a4f,0x395f39ed,0x39cb3984,0x38c43a6d,0x39433a07,0x39ba3996,0x3a27391d,0x39133a2f,0x399639ba,0x3a0f393a,0x3a7c38b0,0x395f39ed,0x39e53969,0x3a5e38d8,0x3ac9383d
.long 0x39a839a8,0x3a2f3913,0x3aa73872,0x3b0e378b,0x39ed395f,0x3a7438ba,0x3ae93807,0x3b4b3693,0x3a2f3913,0x3ab5385d,0x3b253732,0x3b803593,0x3a6d38c4,0x3af037f9,0x3b5a364e,0x3bab348d
.long 0x3aa73872,0x3b253732,0x3b883564,0x3bce3303,0x3add381d,0x3b553665,0x3baf3475,0x3be830e4,0x3b0e378b,0x3b803593,0x3bce3303,0x3bf82d7e,0x3b3b36d7,0x3ba434bd,0x3be63115,0x3c0024b6
.long 0x3b64361f,0x3bc333c6,0x3bf62e46,0x3bfeaa48,0x3b883564,0x3bdb320d,0x3bff28b6,0x3bf2af72,0x3ba834a5,0x3bed304e,0x3bffa648,0x3bddb1db,0x3bc333c6,0x3bf92d1a,0x3bf8ad7e,0x3bc0b3f7
.long 0x3bd9323e,0x3bff2648,0x3beab0b2,0x3b99b505,0x3bea30b2,0x3bffa7da,0x3bd4b2a1,0x3b69b608,0x3bf62e46,0x3bf8ad7e,0x3bb6b444,0x3b30b705,0x3bfe2a48,0x3becb080,0x3b91b534,0x3af0b7f9
.long 0x3c00,0x3c00,0x3c00,0x3c00,0x2cb53bfa,0x2d1a3bf9,0x2d7e3bf8,0x2de23bf7,0x30b23bea,0x31153be6,0x31793be2,0x31db3bdd,0x33033bce,0x33963bc6,0x34143bbc,0x345d3bb2
.long 0x34a53ba8,0x35053b99,0x35643b88,0x35c23b77,0x35c23b77,0x36373b5f,0x36aa3b46,0x371b3b2b,0x36d73b3b,0x375e3b1a,0x37e33af6,0x38323ad0,0x37e33af6,0x383d3ac9,0x38873a99,0x38ce3a65
.long 0x38723aa7,0x38c43a6d,0x39133a2f,0x395f39ed,0x38ec3a4f,0x39433a07,0x399639ba,0x39e53969,0x395f39ed,0x39ba3996,0x3a0f393a,0x3a5e38d8,0x39cb3984,0x3a27391d,0x3a7c38b0,0x3ac9383d
.long 0x3a2f3913,0x3a8a389b,0x3add381d,0x3b253732,0x3a8a389b,0x3ae33812,0x3b303705,0x3b7235da,0x3add381d,0x3b303705,0x3b7735c2,0x3baf3475,0x3b253732,0x3b7235da,0x3baf3475,0x3bdb320d
.long 0x3b64361f,0x3ba834a5,0x3bd9323e,0x3bf62e46,0x3b993505,0x3bd132d2,0x3bf42f0e,0x3c001e48,0x3bc333c6,0x3bed304e,0x3bff2648,0x3bf8ad7e,0x3be23179,0x3bfd2b11,0x3bfcabd9,0x3be0b1aa
.long 0x3bf62e46,0x3bffa648,0x3beab0b2,0x3bb6b444,0x3bff2648,0x3bf5aeaa,0x3bc9b365,0x3b7bb5ab,0x3bfeaa48,0x3bddb1db,0x3b99b505,0x3b30b705,0x3bf1afd6,0x3bb9b42c,0x3b5ab64e,0x3ad6b828
.long 0x3bd9b23e,0x3b88b564,0x3b0eb78b,0x3a6db8c4,0x3bb6b444,0x3b4bb693,0x3ab5b85d,0x39f6b956,0x3b88b564,0x3b02b7b7,0x3a4fb8ec,0x3972b9dc,0x3b50b67c,0x3aaeb867,0x39dcb972,0x38e2ba56
.long 0x3b0eb78b,0x3a4fb8ec,0x395fb9ed,0x3848bac2,0x3ac2b848,0x39e5b969,0x38d8ba5e,0x3748bb20,0x3a6db8c4,0x3972b9dc,0x3848bac2,0x35f1bb6e,0x3a0fb93a,0x38f6ba47,0x375ebb1a,0x348dbbab
.long 0x3c00,0x3c00,0x3c00,0x3c00,0x2e463bf6,0x2eaa3bf5,0x2f0e3bf4,0x2f723bf2,0x323e3bd9,0x32a13bd4,0x33033bce,0x33653bc9,0x34a53ba8,0x34ed3b9d,0x35343b91,0x357c3b84
.long 0x361f3b64,0x367c3b50,0x36d73b3b,0x37323b25,0x378b3b0e,0x37f93af0,0x38323ad0,0x38673aae,0x38723aa7,0x38b03a7c,0x38ec3a4f,0x39273a1f,0x39133a2f,0x395639f6,0x399639ba,0x39d4397b
.long 0x39a839a8,0x39ed395f,0x3a2f3913,0x3a6d38c4,0x3a2f3913,0x3a7438ba,0x3ab5385d,0x3af037f9,0x3aa73872,0x3ae93807,0x3b253732,0x3b5a364e,0x3b0e378b,0x3b4b3693,0x3b803593,0x3bab348d
.long 0x3b64361f,0x3b993505,0x3bc333c6,0x3be23179,0x3ba834a5,0x3bd132d2,0x3bed304e,0x3bfd2b11,0x3bd9323e,0x3bf42f0e,0x3bff2648,0x3bfcabd9,0x3bf62e46,0x3c001e48,0x3bf8ad7e,0x3be0b1aa
.long 0x3c000000,0x3bf6ae46,0x3bd9b23e,0x3ba8b4a5,0x3bf6ae46,0x3bd6b26f,0x3ba0b4d5,0x3b55b665,0x3bd9b23e,0x3ba0b4d5,0x3b50b67c,0x3ae9b807,0x3ba8b4a5,0x3b55b665,0x3ae9b807,0x3a65b8ce
.long 0x3b64b61f,0x3af6b7e3,0x3a6db8c4,0x39cbb984,0x3b0eb78b,0x3a83b8a6,0x39dcb972,0x391dba27,0x3aa7b872,0x39feb94d,0x393aba0f,0x385dbab5,0x3a2fb913,0x3969b9e5,0x3887ba99,0x371bbb2b
.long 0x39a8b9a8,0x38c4ba6d,0x378bbb0e,0x3564bb88,0x3913ba2f,0x3812bae3,0x35f1bb6e,0x3334bbcb,0x3872baa7,0x36aabb46,0x3444bbb6,0x2f0ebbf4,0x378bbb0e,0x351dbb95,0x3115bbe6,0x9e48bc00
.long 0x361fbb64,0x3303bbce,0x2a48bbfe,0xafd6bbf1,0x34a5bba8,0x2f72bbf2,0xabd9bbfc,0xb396bbc6,0x323ebbd9,0x2248bc00,0xb179bbe2,0xb593bb80,0x2e46bbf6,0xade2bbf7,0xb475bbaf,0xb748bb20
.long 0x3c00,0x3c00,0x3c00,0x3c00,0x2fd63bf1,0x301d3bef,0x304e3bed,0x30803bec,0x33c63bc3,0x34143bbc,0x34443bb6,0x34753baf,0x35c23b77,0x36083b69,0x364e3b5a,0x36933b4b
.long 0x378b3b0e,0x37e33af6,0x381d3add,0x38483ac2,0x389b3a8a,0x38ce3a65,0x39003a3f,0x39303a17,0x395f39ed,0x399639ba,0x39cb3984,0x39fe394d,0x3a0f393a,0x3a4738f6,0x3a7c38b0,0x3aae3867
.long 0x3aa73872,0x3add381d,0x3b0e378b,0x3b3b36d7,0x3b253732,0x3b553665,0x3b803593,0x3ba434bd,0x3b883564,0x3baf3475,0x3bce3303,0x3be63115,0x3bce3303,0x3be830e4,0x3bf82d7e,0x3c0024b6
.long 0x3bf62e46,0x3bff2648,0x3bfeaa48,0x3bf1afd6,0x3bffa648,0x3bf5aeaa,0x3bddb1db,0x3bb9b42c,0x3beab0b2,0x3bc9b365,0x3b99b505,0x3b5ab64e,0x3bb6b444,0x3b7bb5ab,0x3b30b705,0x3ad6b828
.long 0x3b64b61f,0x3b0eb78b,0x3aa7b872,0x3a2fb913,0x3af6b7e3,0x3a83b8a6,0x39feb94d,0x3969b9e5,0x3a6db8c4,0x39dcb972,0x393aba0f,0x3887ba99,0x39cbb984,0x391dba27,0x385dbab5,0x371bbb2b
.long 0x3913ba2f,0x3848bac2,0x36d7bb3b,0x3505bb99,0x3848bac2,0x36c1bb41,0x34d5bba0,0x31aabbe0,0x36d7bb3b,0x34d5bba0,0x3179bbe2,0x28b6bbff,0x3505bb99,0x31aabbe0,0x28b6bbff,0xaeaabbf5
.long 0x323ebbd9,0x2a48bbfe,0xae46bbf6,0xb3c6bbc3,0x2cb5bbfa,0xad1abbf9,0xb365bbc9,0xb608bb69,0xaa48bbfe,0xb2a1bbd4,0xb5c2bb77,0xb807bae9,0xb179bbe2,0xb54cbb8c,0xb7b7bb02,0xb8f6ba47
.long 0xb4a5bba8,0xb732bb25,0xb8c4ba6d,0xb9cbb984,0xb67cbb50,0xb87cbaa0,0xb996b9ba,0xba83b8a6,0xb81dbadd,0xb94db9fe,0xba4fb8ec,0xbb1ab75e,0xb8ecba4f,0xba07b943,0xbae9b807,0xbb8cb54c
.long 0x3c00,0x3c00,0x3c00,0x3c00,0x30b23bea,0x30e43be8,0x31153be6,0x31473be4,0x34a53ba8,0x34d53ba0,0x35053b99,0x35343b91,0x36d73b3b,0x371b3b2b,0x375e3b1a,0x37a13b08
.long 0x38723aa7,0x389b3a8a,0x38c43a6d,0x38ec3a4f,0x395f39ed,0x398d39c3,0x39ba3996,0x39e53969,0x3a2f3913,0x3a5e38d8,0x3a8a389b,0x3ab5385d,0x3add381d,0x3b0837a1,0x3b303705,0x3b553665
.long 0x3b64361f,0x3b883564,0x3ba834a5,0x3bc333c6,0x3bc333c6,0x3bdb320d,0x3bed304e,0x3bf92d1a,0x3bf62e46,0x3bff28b6,0x3bffa648,0x3bf8ad7e,0x3bfeaa48,0x3bf2af72,0x3bddb1db,0x3bc0b3f7
.long 0x3bd9b23e,0x3bb6b444,0x3b88b564,0x3b50b67c,0x3b88b564,0x3b4bb693,0x3b02b7b7,0x3aaeb867,0x3b0eb78b,0x3ab5b85d,0x3a4fb8ec,0x39dcb972,0x3a6db8c4,0x39f6b956,0x3972b9dc,0x38e2ba56
.long 0x39a8b9a8,0x3913ba2f,0x3872baa7,0x378bbb0e,0x38c4ba6d,0x3812bae3,0x36aabb46,0x351dbb95,0x378bbb0e,0x35f1bb6e,0x3444bbb6,0x3115bbe6,0x3564bb88,0x3334bbcb,0x2f0ebbf4,0x9e48bc00
.long 0x323ebbd9,0x2cb5bbfa,0xaa48bbfe,0xb179bbe2,0x2a48bbfe,0xad1abbf9,0xb2a1bbd4,0xb54cbb8c,0xae46bbf6,0xb365bbc9,0xb5c2bb77,0xb7b7bb02,0xb3c6bbc3,0xb608bb69,0xb807bae9,0xb8f6ba47
.long 0xb61fbb64,0xb81dbadd,0xb913ba2f,0xb9edb95f,0xb81dbadd,0xb91dba27,0xb9feb94d,0xbabcb852,0xb913ba2f,0xb9feb94d,0xbac2b848,0xbb5ab64e,0xb9edb95f,0xbabcb852,0xbb5ab64e,0xbbc6b396
.long 0xbaa7b872,0xbb50b67c,0xbbc3b3c6,0xbbfaacb5,0xbb3bb6d7,0xbbb9b42c,0xbbf8ad7e,0xbbf72de2,0xbba8b4a5,0xbbf4af0e,0xbbfa2cb5,0xbbbc3414,0xbbeab0b2,0xbbfe297f,0xbbc93365,0xbb4b3693
.long 0x3c00,0x3c00,0x3c00,0x3c00,0x31793be2,0x31aa3be0,0x31db3bdd,0x320d3bdb,0x35643b88,0x35933b80,0x35c23b77,0x35f13b6e,0x37e33af6,0x38123ae3,0x38323ad0,0x38523abc
.long 0x39133a2f,0x393a3a0f,0x395f39ed,0x398439cb,0x3a0f393a,0x3a373909,0x3a5e38d8,0x3a8338a6,0x3add381d,0x3b0237b7,0x3b253732,0x3b4636aa,0x3b7735c2,0x3b95351d,0x3baf3475,0x3bc63396
.long 0x3bd9323e,0x3bea30b2,0x3bf62e46,0x3bfe2a48,0x3bff2648,0x3bffa7da,0x3bf8ad7e,0x3becb080,0x3beab0b2,0x3bd4b2a1,0x3bb6b444,0x3b91b534,0x3b99b505,0x3b69b608,0x3b30b705,0x3af0b7f9
.long 0x3b0eb78b,0x3ac2b848,0x3a6db8c4,0x3a0fb93a,0x3a4fb8ec,0x39e5b969,0x3972b9dc,0x38f6ba47,0x395fb9ed,0x38d8ba5e,0x3848bac2,0x375ebb1a,0x3848bac2,0x3748bb20,0x35f1bb6e,0x348dbbab
.long 0x361fbb64,0x34a5bba8,0x323ebbd9,0x2e46bbf6,0x3303bbce,0x2f72bbf2,0x2248bc00,0xade2bbf7,0x2a48bbfe,0xabd9bbfc,0xb179bbe2,0xb475bbaf,0xafd6bbf1,0xb396bbc6,0xb593bb80,0xb748bb20
.long 0xb4a5bba8,0xb67cbb50,0xb81dbadd,0xb8ecba4f,0xb732bb25,0xb87cbaa0,0xb94db9fe,0xba07b943,0xb8c4ba6d,0xb996b9ba,0xba4fb8ec,0xbae9b807,0xb9cbb984,0xba83b8a6,0xbb1ab75e,0xbb8cb54c
.long 0xbaa7b872,0xbb3bb6d7,0xbba8b4a5,0xbbeab0b2,0xbb50b67c,0xbbb9b42c,0xbbf4af0e,0xbbfe297f,0xbbc3b3c6,0xbbf8ad7e,0xbbfa2cb5,0xbbc93365,0xbbfaacb5,0xbbf72de2,0xbbbc3414,0xbb4b3693
.long 0xbbf62e46,0xbbb63444,0xbb3b36d7,0xba8a389b,0xbbb63444,0xbb3636ee,0xba7c38b0,0xb98d39c3,0xbb3b36d7,0xba7c38b0,0xb98439cb,0xb85d3ab5,0xba8a389b,0xb98d39c3,0xb85d3ab5,0xb6083b69
.long 0x3c00,0x1a483c00,0x1e483c00,0x20b63c00,0x3c00,0x20b63c00,0x24b63c00,0x27113bff,0x3c00,0x23db3c00,0x27da3bff,0x29e33bfe,0x3c00,0x257f3c00,0x297f3bfe,0x2c1f3bfc
.long 0x3c00,0x27113bff,0x2b113bfd,0x2d4c3bf9,0x3c00,0x28523bff,0x2c513bfb,0x2e783bf6,0x3c00,0x291b3bfe,0x2d1a3bf9,0x2fa43bf1,0x3c00,0x29e33bfe,0x2de23bf7,0x30673bed
.long 0x3c00,0x2aac3bfd,0x2eaa3bf5,0x30fd3be7,0x3c00,0x2b753bfd,0x2f723bf2,0x31913be1,0x3c00,0x2c1f3bfc,0x301d3bef,0x32263bda,0x3c00,0x2c833bfb,0x30803bec,0x32b93bd2
.long 0x3c00,0x2ce73bfa,0x30e43be8,0x334c3bca,0x3c00,0x2d4c3bf9,0x31473be4,0x33df3bc1,0x3c00,0x2db03bf8,0x31aa3be0,0x34383bb7,0x3c00,0x2e143bf7,0x320d3bdb,0x34813bad
.long 0x3c00,0x2e783bf6,0x326f3bd6,0x34c93ba2,0x3c00,0x2edc3bf4,0x32d23bd1,0x35113b97,0x3c00,0x2f403bf3,0x33343bcb,0x35583b8a,0x3c00,0x2fa43bf1,0x33963bc6,0x359f3b7d
.long 0x3c00,0x30043bf0,0x33f73bc0,0x35e53b70,0x3c00,0x30363bee,0x342c3bb9,0x362b3b62,0x3c00,0x30673bed,0x345d3bb2,0x36703b53,0x3c00,0x30993beb,0x348d3bab,0x36b53b43
.long 0x3c00,0x30cb3be9,0x34bd3ba4,0x36f93b33,0x3c00,0x30fd3be7,0x34ed3b9d,0x373d3b22,0x3c00,0x312e3be5,0x351d3b95,0x37803b11,0x3c00,0x31603be3,0x354c3b8c,0x37c23aff
.long 0x3c00,0x31913be1,0x357c3b84,0x38023aed,0x3c00,0x31c33bdf,0x35ab3b7b,0x38223ad9,0x3c00,0x31f43bdc,0x35da3b72,0x38423ac6,0x3c00,0x32263bda,0x36083b69,0x38623ab1
.long 0x22483c00,0x23db3c00,0x24b63c00,0x257f3c00,0x28b63bff,0x29e33bfe,0x2b113bfd,0x2c1f3bfc,0x2bd93bfc,0x2ce73bfa,0x2de23bf7,0x2edc3bf4,0x2d7e3bf8,0x2edc3bf4,0x301d3bef,0x30cb3be9
.long 0x2f0e3bf4,0x30673bed,0x31473be4,0x32263bda,0x304e3bed,0x31603be3,0x326f3bd6,0x337d3bc7,0x31153be6,0x32573bd7,0x33963bc6,0x34693bb1,0x31db3bdd,0x334c3bca,0x345d3bb2,0x35113b97
.long 0x32a13bd4,0x34203bbb,0x34ed3b9d,0x35b63b79,0x33653bc9,0x34993baa,0x357c3b84,0x36593b58,0x34143bbc,0x35113b97,0x36083b69,0x36f93b33,0x34753baf,0x35873b82,0x36933b4b,0x37963b0b
.long 0x34d53ba0,0x35fd3b6b,0x371b3b2b,0x38173ae0,0x35343b91,0x36703b53,0x37a13b08,0x38623ab1,0x35933b80,0x36e33b39,0x38123ae3,0x38ab3a7f,0x35f13b6e,0x37533b1d,0x38523abc,0x38f13a4b
.long 0x364e3b5a,0x37c23aff,0x38913a92,0x39353a13,0x36aa3b46,0x38173ae0,0x38ce3a65,0x397639d8,0x37053b30,0x384d3abf,0x39093a37,0x39b5399b,0x375e3b1a,0x38813a9c,0x39433a07,0x39f2395b
.long 0x37b73b02,0x38b53a78,0x397b39d4,0x3a2b3918,0x38073ae9,0x38e73a52,0x39b1399f,0x3a6238d3,0x38323ad0,0x39183a2b,0x39e53969,0x3a95388c,0x385d3ab5,0x39483a02,0x3a173930,0x3ac63842
.long 0x38873a99,0x397639d8,0x3a4738f6,0x3af337ee,0x38b03a7c,0x39a439ad,0x3a7438ba,0x3b1d3753,0x38d83a5e,0x39d03980,0x3aa0387c,0x3b4336b5,0x39003a3f,0x39fa3951,0x3ac9383d,0x3b673614
.long 0x39273a1f,0x3a233922,0x3af037f9,0x3b863570,0x394d39fe,0x3a4b38f1,0x3b143775,0x3ba234c9,0x397239dc,0x3a7138bf,0x3b3636ee,0x3bbb3420,0x399639ba,0x3a95388c,0x3b553665,0x3bd032ea
.long 0x26483bff,0x27113bff,0x27da3bff,0x28523bff,0x2cb53bfa,0x2d4c3bf9,0x2de23bf7,0x2e783bf6,0x2fd63bf1,0x30673bed,0x30e43be8,0x31603be3,0x31793be2,0x32263bda,0x32d23bd1,0x337d3bc7
.long 0x33033bce,0x33df3bc1,0x345d3bb2,0x34c93ba2,0x34443bb6,0x34c93ba2,0x354c3b8c,0x35ce3b74,0x35053b99,0x359f3b7d,0x36373b5f,0x36cc3b3e,0x35c23b77,0x36703b53,0x371b3b2b,0x37c23aff
.long 0x367c3b50,0x373d3b22,0x37f93af0,0x38583ab8,0x37323b25,0x38023aed,0x38673aae,0x38c93a69,0x37e33af6,0x38623ab1,0x38ce3a65,0x39353a13,0x38483ac2,0x38bf3a71,0x39303a17,0x399b39b5
.long 0x389b3a8a,0x39183a2b,0x398d39c3,0x39fa3951,0x38ec3a4f,0x396d39e1,0x39e53969,0x3a5238e7,0x393a3a0f,0x39be3992,0x3a373909,0x3aa33877,0x398439cb,0x3a0b393e,0x3a8338a6,0x3aed3802
.long 0x39cb3984,0x3a5238e7,0x3ac9383d,0x3b2e3710,0x3a0f393a,0x3a95388c,0x3b0837a1,0x3b673614,0x3a4f38ec,0x3ad3382d,0x3b4136c1,0x3b973511,0x3a8a389b,0x3b0b3796,0x3b7235da,0x3bbe3408
.long 0x3ac23848,0x3b3e36cc,0x3b9d34ed,0x3bdc31f4,0x3af637e3,0x3b6b35fd,0x3bc033f7,0x3bf12fa4,0x3b253732,0x3b933529,0x3bdb320d,0x3bfd2aac,0x3b50367c,0x3bb43451,0x3bef301d,0x3c00a3db
.long 0x3b7735c2,0x3bd032ea,0x3bfb2c51,0x3bf9ad4c,0x3b993505,0x3be5312e,0x3c001e48,0x3be9b0cb,0x3bb63444,0x3bf42edc,0x3bfdab11,0x3bd0b2ea,0x3bce3303,0x3bfd2aac,0x3bf2af72,0x3badb481
.long 0x3be23179,0x3c009a48,0x3be0b1aa,0x3b82b587,0x3bf12fd6,0x3bfdab75,0x3bc6b396,0x3b4eb687,0x3bfa2cb5,0x3bf3af40,0x3ba4b4bd,0x3b11b780,0x3bff2648,0x3be3b160,0x3b7bb5ab,0x3accb838
.long 0x28b63bff,0x291b3bfe,0x297f3bfe,0x29e33bfe,0x2f0e3bf4,0x2fa43bf1,0x301d3bef,0x30673bed,0x31db3bdd,0x32573bd7,0x32d23bd1,0x334c3bca,0x34143bbc,0x34693bb1,0x34bd3ba4,0x35113b97
.long 0x35343b91,0x359f3b7d,0x36083b69,0x36703b53,0x364e3b5a,0x36cc3b3e,0x37483b20,0x37c23aff,0x375e3b1a,0x37ee3af3,0x383d3ac9,0x38813a9c,0x38323ad0,0x38813a9c,0x38ce3a65,0x39183a2b
.long 0x38b03a7c,0x39053a3b,0x395639f6,0x39a439ad,0x39273a1f,0x398039d0,0x39d4397b,0x3a233922,0x399639ba,0x39f2395b,0x3a4738f6,0x3a95388c,0x39fe394d,0x3a5a38dd,0x3aae3867,0x3af937d8
.long 0x3a5e38d8,0x3ab83858,0x3b0837a1,0x3b4e3687,0x3ab5385d,0x3b0b3796,0x3b553665,0x3b933529,0x3b0237b7,0x3b533670,0x3b95351d,0x3bc7337d,0x3b4636aa,0x3b8f3540,0x3bc63396,0x3beb3099
.long 0x3b803593,0x3bbe3408,0x3be830e4,0x3bfd2aac,0x3baf3475,0x3be13191,0x3bfb2c51,0x3bfea91b,0x3bd432a1,0x3bf72e14,0x3c00a4b6,0x3beeb036,0x3bed304e,0x3c0023db,0x3bf5aeaa,0x3bcdb31b
.long 0x3bfc2bd9,0x3bfcac1f,0x3bdbb20d,0x3b9bb4f9,0x3c00a248,0x3bebb099,0x3bb2b45d,0x3b58b659,0x3bf8ad7e,0x3bcdb31b,0x3b7bb5ab,0x3b05b7ac,0x3be6b115,0x3ba2b4c9,0x3b36b6ee,0x3aa3b877
.long 0x3bc9b365,0x3b6bb5fd,0x3ae3b812,0x3a33b90e,0x3ba0b4d5,0x3b28b726,0x3a83b8a6,0x39b5b99b,0x3b6eb5f1,0x3ad9b822,0x3a17b930,0x392bba1b,0x3b30b705,0x3a7fb8ab,0x399fb9b1,0x3896ba8e
.long 0x3ae9b807,0x3a1bb92b,0x391dba27,0x37eebaf3,0x3a99b887,0x39adb9a4,0x3891ba92,0x369ebb49,0x3a3fb900,0x3935ba13,0x37f9baf0,0x3540bb8f,0x39dcb972,0x38b5ba78,0x36c1bb41,0x33aebbc4
.long 0x2a483bfe,0x2aac3bfd,0x2b113bfd,0x2b753bfd,0x30b23bea,0x30fd3be7,0x31473be4,0x31913be1,0x33c63bc3,0x34203bbb,0x345d3bb2,0x34993baa,0x35643b88,0x35b63b79,0x36083b69,0x36593b58
.long 0x36d73b3b,0x373d3b22,0x37a13b08,0x38023aed,0x381d3add,0x38583ab8,0x38913a92,0x38c93a69,0x38c43a6d,0x39053a3b,0x39433a07,0x398039d0,0x395f39ed,0x39a439ad,0x39e53969,0x3a233922
.long 0x39ed395f,0x3a33390e,0x3a7438ba,0x3ab13862,0x3a6d38c4,0x3ab13862,0x3af037f9,0x3b283726,0x3add381d,0x3b1d3753,0x3b553665,0x3b863570,0x3b3b36d7,0x3b7435ce,0x3ba434bd,0x3bca334c
.long 0x3b883564,0x3bb73438,0x3bdb320d,0x3bf32f40,0x3bc333c6,0x3be5312e,0x3bf92d1a,0x3c009a48,0x3bea30b2,0x3bfd2b75,0x3bffa7da,0x3bf1afa4,0x3bfe2a48,0x3bfea9e3,0x3becb080,0x3bc7b37d
.long 0x3bfeaa48,0x3be9b0cb,0x3bc0b3f7,0x3b82b587,0x3beab0b2,0x3bbeb408,0x3b7bb5ab,0x3b22b73d,0x3bc3b3c6,0x3b7db59f,0x3b20b748,0x3aaab86d,0x3b88b564,0x3b28b726,0x3aaeb867,0x3a1bb92b
.long 0x3b3bb6d7,0x3abfb84d,0x3a27b91d,0x3976b9d8,0x3addb81d,0x3a43b8fb,0x398db9c3,0x38bfba71,0x3a6db8c4,0x39b5b99b,0x38e2ba56,0x37eebaf3,0x39edb95f,0x3918ba2b,0x3828bad6,0x3642bb5d
.long 0x395fb9ed,0x386dbaaa,0x36c1bb41,0x3481bbad,0x38c4ba6d,0x376abb17,0x351dbb95,0x3160bbe3,0x381dbadd,0x35e5bb70,0x32d2bbd1,0x2aacbbfd,0x36d7bb3b,0x3451bbb4,0x2eaabbf5,0xac1fbbfc
.long 0x3564bb88,0x3160bbe3,0x9e48bc00,0xb1c3bbdf,0x33c6bbc3,0x2c1fbbfc,0xaf72bbf2,0xb4b1bba6,0x30b2bbea,0xa91bbbfe,0xb334bbcb,0xb670bb53,0x2a48bbfe,0xb099bbeb,0xb54cbb8c,0xb80dbae6
.long 0x2bd93bfc,0x2c1f3bfc,0x2c513bfb,0x2c833bfb,0x31db3bdd,0x32263bda,0x326f3bd6,0x32b93bd2,0x34d53ba0,0x35113b97,0x354c3b8c,0x35873b82,0x36aa3b46,0x36f93b33,0x37483b20,0x37963b0b
.long 0x38323ad0,0x38623ab1,0x38913a92,0x38bf3a71,0x39003a3f,0x39353a13,0x396939e5,0x399b39b5,0x39ba3996,0x39f2395b,0x3a27391d,0x3a5a38dd,0x3a5e38d8,0x3a95388c,0x3ac9383d,0x3af937d8
.long 0x3ae93807,0x3b1d3753,0x3b4b3693,0x3b7435ce,0x3b5a364e,0x3b863570,0x3bab348d,0x3bca334c,0x3baf3475,0x3bd032ea,0x3be830e4,0x3bf82db0,0x3be63115,0x3bf82db0,0x3c0024b6,0x3bfdaaac
.long 0x3bff28b6,0x3bfea91b,0x3bf2af72,0x3bdab226,0x3bf8ad7e,0x3be3b160,0x3bc0b3f7,0x3b8fb540,0x3bd4b2a1,0x3ba6b4b1,0x3b69b608,0x3b1db753,0x3b91b534,0x3b49b69e,0x3af0b7f9,0x3a87b8a0
.long 0x3b30b705,0x3accb838,0x3a56b8e2,0x39d0b980,0x3ab5b85d,0x3a33b90e,0x399fb9b1,0x38fbba43,0x3a1fb927,0x3980b9d0,0x38ceba65,0x380dbae6,0x3972b9dc,0x38b5ba78,0x37cdbafc,0x3614bb67
.long 0x38b0ba7c,0x37acbb05,0x35dabb72,0x33dfbbc1,0x37b7bb02,0x35cebb74,0x3396bbc6,0x2edcbbf4,0x35f1bb6e,0x33aebbc4,0x2eaabbf5,0xa852bbff,0x3414bbbc,0x2f40bbf3,0xa7dabbff,0xb191bbe1
.long 0x304ebbed,0xa3dbbc00,0xb147bbe4,0xb4f9bb9b,0x2248bc00,0xb099bbeb,0xb4bdbba4,0xb710bb2e,0xaf0ebbf4,0xb451bbb4,0xb6c1bb41,0xb881ba9c,0xb365bbc9,0xb642bb5d,0xb852babc,0xb964b9e9
.long 0xb593bb80,0xb80dbae6,0xb930ba17,0xba2bb918,0xb75ebb1a,0xb8e7ba52,0xb9f6b956,0xbad3b82d,0xb887ba99,0xb9adb9a4,0xbaa0b87c,0xbb58b659,0xb94db9fe,0xba5ab8dd,0xbb2bb71b,0xbbb7b438
.long 0x2cb53bfa,0x2ce73bfa,0x2d1a3bf9,0x2d4c3bf9,0x33033bce,0x334c3bca,0x33963bc6,0x33df3bc1,0x35c23b77,0x35fd3b6b,0x36373b5f,0x36703b53,0x37e33af6,0x38173ae0,0x383d3ac9,0x38623ab1
.long 0x38ec3a4f,0x39183a2b,0x39433a07,0x396d39e1,0x39cb3984,0x39fa3951,0x3a27391d,0x3a5238e7,0x3a8a389b,0x3ab83858,0x3ae33812,0x3b0b3796,0x3b253732,0x3b4e3687,0x3b7235da,0x3b933529
.long 0x3b993505,0x3bb73438,0x3bd132d2,0x3be5312e,0x3be23179,0x3bf32f40,0x3bfd2b11,0x3c009a48,0x3bff2648,0x3bfea91b,0x3bf5aeaa,0x3be3b160,0x3bf1afd6,0x3bdab226,0x3bb9b42c,0x3b8fb540
.long 0x3bb6b444,0x3b86b570,0x3b4bb693,0x3b05b7ac,0x3b50b67c,0x3b05b7ac,0x3aaeb867,0x3a4bb8f1,0x3ac2b848,0x3a5ab8dd,0x39e5b969,0x3964b9e9,0x3a0fb93a,0x3989b9c7,0x38f6ba47,0x3858bab8
.long 0x393aba0f,0x3896ba8e,0x37cdbafc,0x3659bb58,0x3848bac2,0x3710bb2e,0x357cbb84,0x33aebbc4,0x367cbb50,0x34c9bba2,0x320dbbdb,0x2ce7bbfa,0x3444bbb6,0x30cbbbe9,0x27dabbff,0xadb0bbf8
.long 0x2fd6bbf1,0x9a48bc00,0xb01dbbef,0xb408bbbe,0xa648bbff,0xb0fdbbe7,0xb48dbbab,0xb687bb4e,0xb179bbe2,0xb4e1bb9e,0xb6eebb36,0xb86dbaaa,0xb505bb99,0xb726bb28,0xb891ba92,0xb976b9d8
.long 0xb732bb25,0xb8a0ba87,0xb98db9c3,0xba5ab8dd,0xb89bba8a,0xb992b9be,0xba65b8ce,0xbb11b780,0xb984b9cb,0xba62b8d3,0xbb14b775,0xbb97b511,0xba4fb8ec,0xbb0bb796,0xbb95b51d,0xbbe7b0fd
.long 0xbaf6b7e3,0xbb8ab558,0xbbe4b147,0xbc0020b6,0xbb77b5c2,0xbbdcb1f4,0xbc009e48,0xbbe13191,0xbbceb303,0xbbffa852,0xbbe830e4,0xbb8a3558,0xbbfaacb5,0xbbf12fa4,0xbb9d34ed,0xbaff37c2
.long 0x2d7e3bf8,0x2db03bf8,0x2de23bf7,0x2e143bf7,0x34143bbc,0x34383bb7,0x345d3bb2,0x34813bad,0x36aa3b46,0x36e33b39,0x371b3b2b,0x37533b1d,0x38873a99,0x38ab3a7f,0x38ce3a65,0x38f13a4b
.long 0x399639ba,0x39be3992,0x39e53969,0x3a0b393e,0x3a7c38b0,0x3aa33877,0x3ac9383d,0x3aed3802,0x3b303705,0x3b533670,0x3b7235da,0x3b8f3540,0x3baf3475,0x3bc7337d,0x3bdb320d,0x3beb3099
.long 0x3bf42f0e,0x3bfd2b75,0x3c001e48,0x3bfea9e3,0x3bfcabd9,0x3bf1afa4,0x3be0b1aa,0x3bc7b37d,0x3bc9b365,0x3ba6b4b1,0x3b7bb5ab,0x3b49b69e,0x3b5ab64e,0x3b1db753,0x3ad6b828,0x3a87b8a0
.long 0x3ab5b85d,0x3a5ab8dd,0x39f6b956,0x3989b9c7,0x39dcb972,0x3964b9e9,0x38e2ba56,0x3858bab8,0x38d8ba5e,0x3842bac6,0x3748bb20,0x35fdbb6b,0x375ebb1a,0x35fdbb6b,0x348dbbab,0x3226bbda
.long 0x34d5bba0,0x3288bbd5,0x2eaabbf5,0x1a48bc00,0x304ebbed,0x2711bbff,0xad1abbf9,0xb1f4bbdc,0xa8b6bbff,0xb0cbbbe9,0xb42cbbb9,0xb5e5bb70,0xb2a1bbd4,0xb529bb93,0xb6eebb36,0xb84dbabf
.long 0xb5f1bb6e,0xb7c2baff,0xb8baba74,0xb980b9d0,0xb832bad0,0xb90eba33,0xb9d4b97b,0xba7fb8ab,0xb94db9fe,0xba13b935,0xbabcb852,0xbb43b6b5,0xba3fb900,0xbae6b80d,0xbb69b608,0xbbc4b3ae
.long 0xbb02b7b7,0xbb82b587,0xbbd6b26f,0xbbfdaaac,0xbb91b534,0xbbe1b191,0xbc00a4b6,0xbbed3067,0xbbe6b115,0xbc001a48,0xbbe43147,0xbb933529,0xbc002248,0xbbdf31c3,0xbb84357c,0xbaf337ee
.long 0xbbdd31db,0xbb7d359f,0xbae33812,0xba133935,0xbb803593,0xbae03817,0xba073943,0xb8fb3a43,0xbae93807,0xba0b393e,0xb8f63a47,0xb76a3b17,0xba1f3927,0xb9053a3b,0xb7753b14,0xb4993baa
.size table2, 40960
```
